```python
import torch

def _softmax(x, axis=-1):
    return torch.softmax(x, dim=axis)

def _gelu(x):
    return torch.nn.functional.gelu(x, approximate='tanh')

def _silu(x):
    return torch.nn.functional.silu(x)

def _sigmoid(x):
    return torch.sigmoid(x)

def _layernorm(x, axis=-1, eps=1e-05):
    m = x.mean(dim=axis, keepdim=True)
    v = x.var(dim=axis, keepdim=True, unbiased=False)
    return (x - m) / torch.sqrt(v + eps)

def _scatter_add(tgt, idx, src, axis=0):
    return tgt.clone().index_add_(axis, idx, src)

def _segment_sum(src, seg, n):
    out = torch.zeros((n,) + src.shape[1:], dtype=src.dtype)
    return out.index_add_(0, seg, src)

def _pad(x, pw):
    flat = tuple((v for pair in reversed(pw) for v in pair))
    return torch.nn.functional.pad(x, flat)
kernel_name = 'adaLN_cond__ssm_conv_s4__geglu_ffn__prompt'

def setup_inputs():

    _w = lambda a: (lambda t: t.to(torch.bfloat16) if t.is_floating_point() else t)(torch.as_tensor(a))

    def _A_setup():
        B, L, D, N = (1, 2048, 576, 128)
        A_re = -(lambda _x: torch.exp(torch.as_tensor(_x)))((lambda *s: torch.randn(*s, dtype=torch.bfloat16) * 3.2)(D, N))
        A_im = torch.pi * (lambda *s: torch.randn(*s, dtype=torch.bfloat16) * 0.1)(D, N)
        B_re = (lambda *s: torch.randn(*s, dtype=torch.bfloat16) * 0.2)(D, N)
        B_im = (lambda *s: torch.randn(*s, dtype=torch.bfloat16) * 0.2)(D, N)
        C_re = (lambda *s: torch.randn(*s, dtype=torch.bfloat16) * 0.2)(D, N)
        C_im = (lambda *s: torch.randn(*s, dtype=torch.bfloat16) * 0.2)(D, N)
        log_dt = (lambda *s: torch.randn(*s, dtype=torch.bfloat16) * 0.1)(D) * 0.5 - 4.0
        Dskip = (lambda *s: torch.randn(*s, dtype=torch.bfloat16) * 0.1)(D)
        return {'u': _w((lambda *s: torch.randn(*s, dtype=torch.bfloat16) * 0.05)(B, L, D)), 'A_re': _w(A_re), 'A_im': _w(A_im), 'B_re': _w(B_re), 'B_im': _w(B_im), 'C_re': _w(C_re), 'C_im': _w(C_im), 'log_dt': _w(log_dt), 'Dskip': _w(Dskip)}
    _A_in = _A_setup()

    def _B_setup():
        B, S, D, F = (1, 2048, 576, 4608)
        return {'x': _w((lambda *s: torch.randn(*s, dtype=torch.bfloat16) * 0.05)(B, S, D)), 'w_gate': _w((lambda *s: torch.randn(*s, dtype=torch.bfloat16) * 0.05)(D, F)), 'w_up': _w((lambda *s: torch.randn(*s, dtype=torch.bfloat16) * 0.05)(D, F)), 'w_down': _w((lambda *s: torch.randn(*s, dtype=torch.bfloat16) * 0.05)(F, D))}
    _B_in = _B_setup()
    return {'A_u': _A_in['u'], 'A_A_re': _A_in['A_re'], 'A_A_im': _A_in['A_im'], 'A_B_re': _A_in['B_re'], 'A_B_im': _A_in['B_im'], 'A_C_re': _A_in['C_re'], 'A_C_im': _A_in['C_im'], 'A_log_dt': _A_in['log_dt'], 'A_Dskip': _A_in['Dskip'], 'B_x': _B_in['x'], 'B_w_gate': _B_in['w_gate'], 'B_w_up': _B_in['w_up'], 'B_w_down': _B_in['w_down'], 'c': _w((lambda *s: torch.randn(*s, dtype=torch.bfloat16) * 0.1)(1, 576) * 8.0), 'w_mod': _w((lambda *s: torch.randn(*s, dtype=torch.bfloat16) * 0.1)(576, 6 * 576) * 576 ** (-0.5) * 8.0)}

def reference(A_u, A_A_re, A_A_im, A_B_re, A_B_im, A_C_re, A_C_im, A_log_dt, A_Dskip, B_x, B_w_gate, B_w_up, B_w_down, c, w_mod):

    def _A_ref(u, A_re, A_im, B_re, B_im, C_re, C_im, log_dt, Dskip):
        Bsz, L, D = u.shape
        dt = torch.exp(log_dt)[:, None]
        A = A_re + 1j * A_im
        Bc = B_re + 1j * B_im
        Cc = C_re + 1j * C_im
        logdA = dt * A
        dB = dt * Bc
        l = (lambda x, dt: x.to(dt))(torch.arange(L), A_re.dtype)
        P = torch.exp(logdA[:, :, None] * l[None, None, :])
        K = torch.einsum('dn,dnl,dn->dl', Cc, P, dB).real
        L2 = 2 * L
        Kp = _pad(K, ((0, 0), (0, L)))
        up = (lambda x, *d: x.permute(*d))(u, 0, 2, 1)
        up = _pad(up, ((0, 0), (0, 0), (0, L)))
        Kf = (lambda x, axes=(-2, -1): torch.fft.rfft2(x.float(), dim=axes))(Kp[:, None, :], axes=(-2, -1))
        Uf = (lambda x, axes=(-2, -1): torch.fft.rfft2(x.float(), dim=axes))(up[:, :, None, :], axes=(-2, -1))
        Yf = Uf * Kf[None, :, :, :]
        y = (lambda x, s, axes=(-2, -1): torch.fft.irfft2(x, s=s, dim=axes).to(torch.bfloat16))(Yf, (1, L2), axes=(-2, -1))[:, :, 0, :L]
        y = (lambda x, *d: x.permute(*d))(y, 0, 2, 1) + u * Dskip[None, None, :]
        return y

    def _B_ref(x, w_gate, w_up, w_down):
        return _gelu(x @ w_gate) * (x @ w_up) @ w_down
    x = A_u
    mod = (_silu(c) @ w_mod).reshape(c.shape[0], 6, 1, -1)
    sa, ca, ga, sb, cb, gb = (mod[:, 0].clone(), mod[:, 1].clone(), mod[:, 2].clone(), mod[:, 3].clone(), mod[:, 4].clone(), mod[:, 5].clone())
    h = _layernorm(x, axis=-1) * (1 + ca) + sa
    x = x + ga * _A_ref(h, A_A_re, A_A_im, A_B_re, A_B_im, A_C_re, A_C_im, A_log_dt, A_Dskip)
    h = _layernorm(x, axis=-1) * (1 + cb) + sb
    x = x + gb * _B_ref(h, B_w_gate, B_w_up, B_w_down)
    return x
```

```asm
; @launch kernel=k1_front_kernel grid=(256,1,1) block=(256,1,1) lds=159744
; @launch kernel=k3_ffn_kernel grid=(256,1,1) block=(256,1,1) lds=152576
.amdgcn_target "amdgcn-amd-amdhsa--gfx950"
.text
.globl k1_front_kernel
.p2align 8
.type k1_front_kernel,@function
k1_front_kernel:
	s_load_dwordx16 s[64:79], s[0:1], 0
	s_load_dwordx16 s[80:95], s[0:1], 64
	s_load_dwordx4 s[96:99], s[0:1], 128
	s_cmp_ge_u32 s2, 256
	s_cbranch_scc1 L_k12_exit
	s_getpc_b64 s[60:61]
L_epf_k1_front_kernel:
	s_add_u32 s60, s60, k1_front_kernel-L_epf_k1_front_kernel
	s_addc_u32 s61, s61, -1
	v_lshlrev_b32 v252, 7, v0
	s_mov_b32 s62, L_k12_exit-k1_front_kernel-4
	v_min_u32 v253, s62, v252
	v_and_b32 v253, -4, v253
	global_load_dword v254, v253, s[60:61]
	s_cmp_ge_u32 s2, 112
	s_cbranch_scc1 L_k12_C
	s_cmp_lt_u32 s2, 64
	s_cbranch_scc1 L_k12_A
	s_load_dwordx2 s[4:5], s[0:1], 104
	s_load_dwordx2 s[6:7], s[0:1], 112
	s_load_dwordx2 s[8:9], s[0:1], 136
	s_load_dwordx2 s[44:45], s[0:1], 128
	s_sub_u32 s3, s2, 64
	s_lshr_b32 s20, s3, 4
	s_and_b32 s21, s3, 15
	s_mov_b32 s22, 0x38e38e39
	v_mul_hi_u32 v1, v0, s22
	v_lshrrev_b32 v1, 4, v1
	v_mul_u32_u24 v2, 72, v1
	v_sub_u32 v2, v0, v2
	s_mul_i32 s23, s21, 36
	v_add_u32 v4, s23, v1
	s_movk_i32 s24, 6912
	v_mul_lo_u32 v4, v4, s24
	v_lshl_add_u32 v4, v2, 4, v4
	s_mul_i32 s25, s20, 1152
	v_add_u32 v4, s25, v4
	v_cmp_gt_u32 vcc, 3, v1
	v_mov_b32 v5, 0x7ffffff0
	v_lshlrev_b32 v3, 1, v0
	v_cndmask_b32 v4, v5, v4, vcc
	v_lshrrev_b32 v6, 6, v0
	s_nop 0
	v_readfirstlane_b32 s34, v6
	s_waitcnt lgkmcnt(0)
	s_mov_b32 s12, s4
	s_mov_b32 s13, s5
	s_mov_b32 s14, 1152
	s_mov_b32 s15, 0x20000
	s_mov_b32 s16, s6
	s_mov_b32 s17, s7
	s_mov_b32 s18, 3981312
	s_mov_b32 s19, 0x20000
	s_mov_b32 s24, s8
	s_mov_b32 s25, s9
	s_mov_b32 s26, 48168960
	s_mov_b32 s27, 0x20000
	buffer_load_ushort v10, v3, s[12:15], 0 offen offset:0
	buffer_load_ushort v11, v3, s[12:15], 0 offen offset:512
	buffer_load_ushort v12, v3, s[12:15], 0 offen offset:1024
	s_mov_b32 s30, 0
	buffer_load_dwordx4 v[32:35], v4, s[16:19], s30 offen
	s_mov_b32 s30, 20736
	buffer_load_dwordx4 v[36:39], v4, s[16:19], s30 offen
	s_mov_b32 s30, 41472
	buffer_load_dwordx4 v[40:43], v4, s[16:19], s30 offen
	s_mov_b32 s30, 62208
	buffer_load_dwordx4 v[44:47], v4, s[16:19], s30 offen
	s_mov_b32 s30, 82944
	buffer_load_dwordx4 v[48:51], v4, s[16:19], s30 offen
	s_mov_b32 s30, 103680
	buffer_load_dwordx4 v[52:55], v4, s[16:19], s30 offen
	s_mov_b32 s30, 124416
	buffer_load_dwordx4 v[56:59], v4, s[16:19], s30 offen
	s_mov_b32 s30, 145152
	buffer_load_dwordx4 v[60:63], v4, s[16:19], s30 offen
	s_mov_b32 s30, 165888
	buffer_load_dwordx4 v[64:67], v4, s[16:19], s30 offen
	s_mov_b32 s30, 186624
	buffer_load_dwordx4 v[68:71], v4, s[16:19], s30 offen
	s_mov_b32 s30, 207360
	buffer_load_dwordx4 v[72:75], v4, s[16:19], s30 offen
	s_mov_b32 s30, 228096
	buffer_load_dwordx4 v[76:79], v4, s[16:19], s30 offen
	s_cmp_ge_u32 s3, 16
	s_cbranch_scc1 L_k12_noflag
	v_mov_b32 v8, 0
	v_lshlrev_b32 v9, 2, v0
	s_lshl_b32 s28, s3, 10
	s_add_u32 s28, s28, 48136192
	buffer_store_dword v8, v9, s[24:27], s28 offen sc1
L_k12_noflag:
	s_mov_b32 s31, 0xbfb8aa3b
	s_waitcnt vmcnt(12)
	v_lshlrev_b32 v10, 16, v10
	v_lshlrev_b32 v11, 16, v11
	v_lshlrev_b32 v12, 16, v12
	v_mul_f32 v14, s31, v10
	v_mul_f32 v15, s31, v11
	v_mul_f32 v16, s31, v12
	v_exp_f32 v14, v14
	v_exp_f32 v15, v15
	v_exp_f32 v16, v16
	v_add_f32 v14, 1.0, v14
	v_add_f32 v15, 1.0, v15
	v_add_f32 v16, 1.0, v16
	v_rcp_f32 v14, v14
	v_rcp_f32 v15, v15
	v_rcp_f32 v16, v16
	v_mul_f32 v10, v10, v14
	v_mul_f32 v11, v11, v15
	v_mul_f32 v12, v12, v16
	v_cvt_pk_bf16_f32 v10, v10, v10
	v_cvt_pk_bf16_f32 v11, v11, v11
	v_cvt_pk_bf16_f32 v12, v12, v12
	v_lshlrev_b32 v10, 16, v10
	v_lshlrev_b32 v11, 16, v11
	v_lshlrev_b32 v12, 16, v12
	v_lshlrev_b32 v7, 2, v0
	ds_write_b32 v7, v10 offset:0
	ds_write_b32 v7, v11 offset:1024
	ds_write_b32 v7, v12 offset:2048
	s_waitcnt lgkmcnt(0)
	s_barrier
	v_add_u32 v8, s23, v1
	v_lshlrev_b32 v8, 2, v8
	ds_read_b32 v180, v8 offset:0
	ds_read_b32 v181, v8 offset:12
	ds_read_b32 v182, v8 offset:24
	ds_read_b32 v183, v8 offset:36
	ds_read_b32 v184, v8 offset:48
	ds_read_b32 v185, v8 offset:60
	ds_read_b32 v186, v8 offset:72
	ds_read_b32 v187, v8 offset:84
	ds_read_b32 v188, v8 offset:96
	ds_read_b32 v189, v8 offset:108
	ds_read_b32 v190, v8 offset:120
	ds_read_b32 v191, v8 offset:132
	s_mov_b32 s32, 0xffff0000
	v_mul_u32_u24 v9, 2304, v1
	v_lshl_add_u32 v9, v2, 5, v9
	v_mov_b32 v20, 0
	v_mov_b32 v21, 0
	v_mov_b32 v22, 0
	v_mov_b32 v23, 0
	v_mov_b32 v24, 0
	v_mov_b32 v25, 0
	v_mov_b32 v26, 0
	v_mov_b32 v27, 0
	s_waitcnt lgkmcnt(0)
	s_waitcnt vmcnt(11)
	v_lshlrev_b32 v28, 16, v32
	v_and_b32 v29, s32, v32
	v_fmac_f32 v20, v28, v180
	v_fmac_f32 v21, v29, v180
	v_lshlrev_b32 v28, 16, v33
	v_and_b32 v29, s32, v33
	v_fmac_f32 v22, v28, v180
	v_fmac_f32 v23, v29, v180
	v_lshlrev_b32 v28, 16, v34
	v_and_b32 v29, s32, v34
	v_fmac_f32 v24, v28, v180
	v_fmac_f32 v25, v29, v180
	v_lshlrev_b32 v28, 16, v35
	v_and_b32 v29, s32, v35
	v_fmac_f32 v26, v28, v180
	v_fmac_f32 v27, v29, v180
	s_waitcnt vmcnt(10)
	v_lshlrev_b32 v28, 16, v36
	v_and_b32 v29, s32, v36
	v_fmac_f32 v20, v28, v181
	v_fmac_f32 v21, v29, v181
	v_lshlrev_b32 v28, 16, v37
	v_and_b32 v29, s32, v37
	v_fmac_f32 v22, v28, v181
	v_fmac_f32 v23, v29, v181
	v_lshlrev_b32 v28, 16, v38
	v_and_b32 v29, s32, v38
	v_fmac_f32 v24, v28, v181
	v_fmac_f32 v25, v29, v181
	v_lshlrev_b32 v28, 16, v39
	v_and_b32 v29, s32, v39
	v_fmac_f32 v26, v28, v181
	v_fmac_f32 v27, v29, v181
	s_waitcnt vmcnt(9)
	v_lshlrev_b32 v28, 16, v40
	v_and_b32 v29, s32, v40
	v_fmac_f32 v20, v28, v182
	v_fmac_f32 v21, v29, v182
	v_lshlrev_b32 v28, 16, v41
	v_and_b32 v29, s32, v41
	v_fmac_f32 v22, v28, v182
	v_fmac_f32 v23, v29, v182
	v_lshlrev_b32 v28, 16, v42
	v_and_b32 v29, s32, v42
	v_fmac_f32 v24, v28, v182
	v_fmac_f32 v25, v29, v182
	v_lshlrev_b32 v28, 16, v43
	v_and_b32 v29, s32, v43
	v_fmac_f32 v26, v28, v182
	v_fmac_f32 v27, v29, v182
	s_waitcnt vmcnt(8)
	v_lshlrev_b32 v28, 16, v44
	v_and_b32 v29, s32, v44
	v_fmac_f32 v20, v28, v183
	v_fmac_f32 v21, v29, v183
	v_lshlrev_b32 v28, 16, v45
	v_and_b32 v29, s32, v45
	v_fmac_f32 v22, v28, v183
	v_fmac_f32 v23, v29, v183
	v_lshlrev_b32 v28, 16, v46
	v_and_b32 v29, s32, v46
	v_fmac_f32 v24, v28, v183
	v_fmac_f32 v25, v29, v183
	v_lshlrev_b32 v28, 16, v47
	v_and_b32 v29, s32, v47
	v_fmac_f32 v26, v28, v183
	v_fmac_f32 v27, v29, v183
	s_waitcnt vmcnt(7)
	v_lshlrev_b32 v28, 16, v48
	v_and_b32 v29, s32, v48
	v_fmac_f32 v20, v28, v184
	v_fmac_f32 v21, v29, v184
	v_lshlrev_b32 v28, 16, v49
	v_and_b32 v29, s32, v49
	v_fmac_f32 v22, v28, v184
	v_fmac_f32 v23, v29, v184
	v_lshlrev_b32 v28, 16, v50
	v_and_b32 v29, s32, v50
	v_fmac_f32 v24, v28, v184
	v_fmac_f32 v25, v29, v184
	v_lshlrev_b32 v28, 16, v51
	v_and_b32 v29, s32, v51
	v_fmac_f32 v26, v28, v184
	v_fmac_f32 v27, v29, v184
	s_waitcnt vmcnt(6)
	v_lshlrev_b32 v28, 16, v52
	v_and_b32 v29, s32, v52
	v_fmac_f32 v20, v28, v185
	v_fmac_f32 v21, v29, v185
	v_lshlrev_b32 v28, 16, v53
	v_and_b32 v29, s32, v53
	v_fmac_f32 v22, v28, v185
	v_fmac_f32 v23, v29, v185
	v_lshlrev_b32 v28, 16, v54
	v_and_b32 v29, s32, v54
	v_fmac_f32 v24, v28, v185
	v_fmac_f32 v25, v29, v185
	v_lshlrev_b32 v28, 16, v55
	v_and_b32 v29, s32, v55
	v_fmac_f32 v26, v28, v185
	v_fmac_f32 v27, v29, v185
	s_waitcnt vmcnt(5)
	v_lshlrev_b32 v28, 16, v56
	v_and_b32 v29, s32, v56
	v_fmac_f32 v20, v28, v186
	v_fmac_f32 v21, v29, v186
	v_lshlrev_b32 v28, 16, v57
	v_and_b32 v29, s32, v57
	v_fmac_f32 v22, v28, v186
	v_fmac_f32 v23, v29, v186
	v_lshlrev_b32 v28, 16, v58
	v_and_b32 v29, s32, v58
	v_fmac_f32 v24, v28, v186
	v_fmac_f32 v25, v29, v186
	v_lshlrev_b32 v28, 16, v59
	v_and_b32 v29, s32, v59
	v_fmac_f32 v26, v28, v186
	v_fmac_f32 v27, v29, v186
	s_waitcnt vmcnt(4)
	v_lshlrev_b32 v28, 16, v60
	v_and_b32 v29, s32, v60
	v_fmac_f32 v20, v28, v187
	v_fmac_f32 v21, v29, v187
	v_lshlrev_b32 v28, 16, v61
	v_and_b32 v29, s32, v61
	v_fmac_f32 v22, v28, v187
	v_fmac_f32 v23, v29, v187
	v_lshlrev_b32 v28, 16, v62
	v_and_b32 v29, s32, v62
	v_fmac_f32 v24, v28, v187
	v_fmac_f32 v25, v29, v187
	v_lshlrev_b32 v28, 16, v63
	v_and_b32 v29, s32, v63
	v_fmac_f32 v26, v28, v187
	v_fmac_f32 v27, v29, v187
	s_waitcnt vmcnt(3)
	v_lshlrev_b32 v28, 16, v64
	v_and_b32 v29, s32, v64
	v_fmac_f32 v20, v28, v188
	v_fmac_f32 v21, v29, v188
	v_lshlrev_b32 v28, 16, v65
	v_and_b32 v29, s32, v65
	v_fmac_f32 v22, v28, v188
	v_fmac_f32 v23, v29, v188
	v_lshlrev_b32 v28, 16, v66
	v_and_b32 v29, s32, v66
	v_fmac_f32 v24, v28, v188
	v_fmac_f32 v25, v29, v188
	v_lshlrev_b32 v28, 16, v67
	v_and_b32 v29, s32, v67
	v_fmac_f32 v26, v28, v188
	v_fmac_f32 v27, v29, v188
	s_waitcnt vmcnt(2)
	v_lshlrev_b32 v28, 16, v68
	v_and_b32 v29, s32, v68
	v_fmac_f32 v20, v28, v189
	v_fmac_f32 v21, v29, v189
	v_lshlrev_b32 v28, 16, v69
	v_and_b32 v29, s32, v69
	v_fmac_f32 v22, v28, v189
	v_fmac_f32 v23, v29, v189
	v_lshlrev_b32 v28, 16, v70
	v_and_b32 v29, s32, v70
	v_fmac_f32 v24, v28, v189
	v_fmac_f32 v25, v29, v189
	v_lshlrev_b32 v28, 16, v71
	v_and_b32 v29, s32, v71
	v_fmac_f32 v26, v28, v189
	v_fmac_f32 v27, v29, v189
	s_waitcnt vmcnt(1)
	v_lshlrev_b32 v28, 16, v72
	v_and_b32 v29, s32, v72
	v_fmac_f32 v20, v28, v190
	v_fmac_f32 v21, v29, v190
	v_lshlrev_b32 v28, 16, v73
	v_and_b32 v29, s32, v73
	v_fmac_f32 v22, v28, v190
	v_fmac_f32 v23, v29, v190
	v_lshlrev_b32 v28, 16, v74
	v_and_b32 v29, s32, v74
	v_fmac_f32 v24, v28, v190
	v_fmac_f32 v25, v29, v190
	v_lshlrev_b32 v28, 16, v75
	v_and_b32 v29, s32, v75
	v_fmac_f32 v26, v28, v190
	v_fmac_f32 v27, v29, v190
	s_waitcnt vmcnt(0)
	v_lshlrev_b32 v28, 16, v76
	v_and_b32 v29, s32, v76
	v_fmac_f32 v20, v28, v191
	v_fmac_f32 v21, v29, v191
	v_lshlrev_b32 v28, 16, v77
	v_and_b32 v29, s32, v77
	v_fmac_f32 v22, v28, v191
	v_fmac_f32 v23, v29, v191
	v_lshlrev_b32 v28, 16, v78
	v_and_b32 v29, s32, v78
	v_fmac_f32 v24, v28, v191
	v_fmac_f32 v25, v29, v191
	v_lshlrev_b32 v28, 16, v79
	v_and_b32 v29, s32, v79
	v_fmac_f32 v26, v28, v191
	v_fmac_f32 v27, v29, v191
	ds_write_b128 v9, v[20:23] offset:4096
	ds_write_b128 v9, v[24:27] offset:4112
	s_waitcnt lgkmcnt(0)
	s_barrier
	v_lshlrev_b32 v13, 2, v0
	ds_read_b32 v200, v13 offset:4096
	ds_read_b32 v201, v13 offset:6400
	ds_read_b32 v202, v13 offset:8704
	ds_read_b32 v203, v13 offset:5120
	ds_read_b32 v204, v13 offset:7424
	ds_read_b32 v205, v13 offset:9728
	ds_read_b32 v206, v13 offset:6144
	ds_read_b32 v207, v13 offset:8448
	ds_read_b32 v208, v13 offset:10752
	s_waitcnt lgkmcnt(0)
	v_add_f32 v200, v200, v201
	v_add_f32 v200, v200, v202
	v_add_f32 v203, v203, v204
	v_add_f32 v203, v203, v205
	v_add_f32 v206, v206, v207
	v_add_f32 v206, v206, v208
	s_mul_i32 s33, s21, 6912
	s_mul_i32 s35, s20, 2304
	s_add_u32 s33, s33, s35
	s_add_u32 s33, s33, 4784128
	v_cmp_gt_u32 vcc, 64, v0
	v_add_u32 v14, 2048, v13
	v_mov_b32 v15, 0x7ffffff0
	v_cndmask_b32 v14, v15, v14, vcc
	buffer_store_dword v200, v13, s[24:27], s33 offen sc1
	buffer_store_dword v203, v13, s[24:27], s33 offen offset:1024 sc1
	buffer_store_dword v206, v14, s[24:27], s33 offen sc1
	s_waitcnt vmcnt(0)
	s_barrier
	s_cmp_lg_u32 s34, 0
	s_cbranch_scc1 L_k12_B1
	v_and_b32 v2, 1, v0
	v_lshlrev_b32 v2, 7, v2
	v_mov_b32 v3, 1
	s_mov_b64 exec, 3
	global_atomic_add v2, v3, s[44:45] sc1
	s_mov_b64 exec, -1
L_k12_B1:
	s_cmp_ge_u32 s3, 27
	s_cbranch_scc1 L_k12_Bx
	v_lshrrev_b32 v1, 3, v0
	v_and_b32 v2, 7, v0
	s_movk_i32 s36, 6912
	v_mul_lo_u32 v4, v1, s36
	s_lshl_b32 s35, s3, 7
	v_lshl_add_u32 v5, v2, 4, s35
	v_add_u32 v4, v4, v5
	v_lshlrev_b32 v8, 2, v1
	s_mov_b32 s30, 3456
	buffer_load_dwordx4 v[32:35], v4, s[16:19], s30 offen
	s_mov_b32 s30, 224640
	buffer_load_dwordx4 v[36:39], v4, s[16:19], s30 offen
	s_mov_b32 s30, 445824
	buffer_load_dwordx4 v[40:43], v4, s[16:19], s30 offen
	s_mov_b32 s30, 667008
	buffer_load_dwordx4 v[44:47], v4, s[16:19], s30 offen
	s_mov_b32 s30, 888192
	buffer_load_dwordx4 v[48:51], v4, s[16:19], s30 offen
	s_mov_b32 s30, 1109376
	buffer_load_dwordx4 v[52:55], v4, s[16:19], s30 offen
	s_mov_b32 s30, 1330560
	buffer_load_dwordx4 v[56:59], v4, s[16:19], s30 offen
	s_mov_b32 s30, 1551744
	buffer_load_dwordx4 v[60:63], v4, s[16:19], s30 offen
	s_mov_b32 s30, 1772928
	buffer_load_dwordx4 v[64:67], v4, s[16:19], s30 offen
	s_mov_b32 s30, 1994112
	buffer_load_dwordx4 v[68:71], v4, s[16:19], s30 offen
	s_mov_b32 s30, 2215296
	buffer_load_dwordx4 v[72:75], v4, s[16:19], s30 offen
	s_mov_b32 s30, 2436480
	buffer_load_dwordx4 v[76:79], v4, s[16:19], s30 offen
	s_mov_b32 s30, 2657664
	buffer_load_dwordx4 v[80:83], v4, s[16:19], s30 offen
	s_mov_b32 s30, 2878848
	buffer_load_dwordx4 v[84:87], v4, s[16:19], s30 offen
	s_mov_b32 s30, 3100032
	buffer_load_dwordx4 v[88:91], v4, s[16:19], s30 offen
	s_mov_b32 s30, 3321216
	buffer_load_dwordx4 v[92:95], v4, s[16:19], s30 offen
	s_mov_b32 s30, 3542400
	buffer_load_dwordx4 v[96:99], v4, s[16:19], s30 offen
	s_mov_b32 s30, 3763584
	buffer_load_dwordx4 v[100:103], v4, s[16:19], s30 offen
	ds_read_b32 v180, v8 offset:0
	ds_read_b32 v181, v8 offset:128
	ds_read_b32 v182, v8 offset:256
	ds_read_b32 v183, v8 offset:384
	ds_read_b32 v184, v8 offset:512
	ds_read_b32 v185, v8 offset:640
	ds_read_b32 v186, v8 offset:768
	ds_read_b32 v187, v8 offset:896
	ds_read_b32 v188, v8 offset:1024
	ds_read_b32 v189, v8 offset:1152
	ds_read_b32 v190, v8 offset:1280
	ds_read_b32 v191, v8 offset:1408
	ds_read_b32 v192, v8 offset:1536
	ds_read_b32 v193, v8 offset:1664
	ds_read_b32 v194, v8 offset:1792
	ds_read_b32 v195, v8 offset:1920
	ds_read_b32 v196, v8 offset:2048
	ds_read_b32 v197, v8 offset:2176
	v_lshlrev_b32 v9, 8, v1
	v_lshl_add_u32 v9, v2, 5, v9
	v_and_b32 v13, 63, v0
	v_lshlrev_b32 v13, 2, v13
	v_mov_b32 v20, 0
	v_mov_b32 v21, 0
	v_mov_b32 v22, 0
	v_mov_b32 v23, 0
	v_mov_b32 v24, 0
	v_mov_b32 v25, 0
	v_mov_b32 v26, 0
	v_mov_b32 v27, 0
	s_waitcnt lgkmcnt(0)
	s_waitcnt vmcnt(17)
	v_lshlrev_b32 v28, 16, v32
	v_and_b32 v29, s32, v32
	v_fmac_f32 v20, v28, v180
	v_fmac_f32 v21, v29, v180
	v_lshlrev_b32 v28, 16, v33
	v_and_b32 v29, s32, v33
	v_fmac_f32 v22, v28, v180
	v_fmac_f32 v23, v29, v180
	v_lshlrev_b32 v28, 16, v34
	v_and_b32 v29, s32, v34
	v_fmac_f32 v24, v28, v180
	v_fmac_f32 v25, v29, v180
	v_lshlrev_b32 v28, 16, v35
	v_and_b32 v29, s32, v35
	v_fmac_f32 v26, v28, v180
	v_fmac_f32 v27, v29, v180
	s_waitcnt vmcnt(16)
	v_lshlrev_b32 v28, 16, v36
	v_and_b32 v29, s32, v36
	v_fmac_f32 v20, v28, v181
	v_fmac_f32 v21, v29, v181
	v_lshlrev_b32 v28, 16, v37
	v_and_b32 v29, s32, v37
	v_fmac_f32 v22, v28, v181
	v_fmac_f32 v23, v29, v181
	v_lshlrev_b32 v28, 16, v38
	v_and_b32 v29, s32, v38
	v_fmac_f32 v24, v28, v181
	v_fmac_f32 v25, v29, v181
	v_lshlrev_b32 v28, 16, v39
	v_and_b32 v29, s32, v39
	v_fmac_f32 v26, v28, v181
	v_fmac_f32 v27, v29, v181
	s_waitcnt vmcnt(15)
	v_lshlrev_b32 v28, 16, v40
	v_and_b32 v29, s32, v40
	v_fmac_f32 v20, v28, v182
	v_fmac_f32 v21, v29, v182
	v_lshlrev_b32 v28, 16, v41
	v_and_b32 v29, s32, v41
	v_fmac_f32 v22, v28, v182
	v_fmac_f32 v23, v29, v182
	v_lshlrev_b32 v28, 16, v42
	v_and_b32 v29, s32, v42
	v_fmac_f32 v24, v28, v182
	v_fmac_f32 v25, v29, v182
	v_lshlrev_b32 v28, 16, v43
	v_and_b32 v29, s32, v43
	v_fmac_f32 v26, v28, v182
	v_fmac_f32 v27, v29, v182
	s_waitcnt vmcnt(14)
	v_lshlrev_b32 v28, 16, v44
	v_and_b32 v29, s32, v44
	v_fmac_f32 v20, v28, v183
	v_fmac_f32 v21, v29, v183
	v_lshlrev_b32 v28, 16, v45
	v_and_b32 v29, s32, v45
	v_fmac_f32 v22, v28, v183
	v_fmac_f32 v23, v29, v183
	v_lshlrev_b32 v28, 16, v46
	v_and_b32 v29, s32, v46
	v_fmac_f32 v24, v28, v183
	v_fmac_f32 v25, v29, v183
	v_lshlrev_b32 v28, 16, v47
	v_and_b32 v29, s32, v47
	v_fmac_f32 v26, v28, v183
	v_fmac_f32 v27, v29, v183
	s_waitcnt vmcnt(13)
	v_lshlrev_b32 v28, 16, v48
	v_and_b32 v29, s32, v48
	v_fmac_f32 v20, v28, v184
	v_fmac_f32 v21, v29, v184
	v_lshlrev_b32 v28, 16, v49
	v_and_b32 v29, s32, v49
	v_fmac_f32 v22, v28, v184
	v_fmac_f32 v23, v29, v184
	v_lshlrev_b32 v28, 16, v50
	v_and_b32 v29, s32, v50
	v_fmac_f32 v24, v28, v184
	v_fmac_f32 v25, v29, v184
	v_lshlrev_b32 v28, 16, v51
	v_and_b32 v29, s32, v51
	v_fmac_f32 v26, v28, v184
	v_fmac_f32 v27, v29, v184
	s_waitcnt vmcnt(12)
	v_lshlrev_b32 v28, 16, v52
	v_and_b32 v29, s32, v52
	v_fmac_f32 v20, v28, v185
	v_fmac_f32 v21, v29, v185
	v_lshlrev_b32 v28, 16, v53
	v_and_b32 v29, s32, v53
	v_fmac_f32 v22, v28, v185
	v_fmac_f32 v23, v29, v185
	v_lshlrev_b32 v28, 16, v54
	v_and_b32 v29, s32, v54
	v_fmac_f32 v24, v28, v185
	v_fmac_f32 v25, v29, v185
	v_lshlrev_b32 v28, 16, v55
	v_and_b32 v29, s32, v55
	v_fmac_f32 v26, v28, v185
	v_fmac_f32 v27, v29, v185
	s_waitcnt vmcnt(11)
	v_lshlrev_b32 v28, 16, v56
	v_and_b32 v29, s32, v56
	v_fmac_f32 v20, v28, v186
	v_fmac_f32 v21, v29, v186
	v_lshlrev_b32 v28, 16, v57
	v_and_b32 v29, s32, v57
	v_fmac_f32 v22, v28, v186
	v_fmac_f32 v23, v29, v186
	v_lshlrev_b32 v28, 16, v58
	v_and_b32 v29, s32, v58
	v_fmac_f32 v24, v28, v186
	v_fmac_f32 v25, v29, v186
	v_lshlrev_b32 v28, 16, v59
	v_and_b32 v29, s32, v59
	v_fmac_f32 v26, v28, v186
	v_fmac_f32 v27, v29, v186
	s_waitcnt vmcnt(10)
	v_lshlrev_b32 v28, 16, v60
	v_and_b32 v29, s32, v60
	v_fmac_f32 v20, v28, v187
	v_fmac_f32 v21, v29, v187
	v_lshlrev_b32 v28, 16, v61
	v_and_b32 v29, s32, v61
	v_fmac_f32 v22, v28, v187
	v_fmac_f32 v23, v29, v187
	v_lshlrev_b32 v28, 16, v62
	v_and_b32 v29, s32, v62
	v_fmac_f32 v24, v28, v187
	v_fmac_f32 v25, v29, v187
	v_lshlrev_b32 v28, 16, v63
	v_and_b32 v29, s32, v63
	v_fmac_f32 v26, v28, v187
	v_fmac_f32 v27, v29, v187
	s_waitcnt vmcnt(9)
	v_lshlrev_b32 v28, 16, v64
	v_and_b32 v29, s32, v64
	v_fmac_f32 v20, v28, v188
	v_fmac_f32 v21, v29, v188
	v_lshlrev_b32 v28, 16, v65
	v_and_b32 v29, s32, v65
	v_fmac_f32 v22, v28, v188
	v_fmac_f32 v23, v29, v188
	v_lshlrev_b32 v28, 16, v66
	v_and_b32 v29, s32, v66
	v_fmac_f32 v24, v28, v188
	v_fmac_f32 v25, v29, v188
	v_lshlrev_b32 v28, 16, v67
	v_and_b32 v29, s32, v67
	v_fmac_f32 v26, v28, v188
	v_fmac_f32 v27, v29, v188
	s_waitcnt vmcnt(8)
	v_lshlrev_b32 v28, 16, v68
	v_and_b32 v29, s32, v68
	v_fmac_f32 v20, v28, v189
	v_fmac_f32 v21, v29, v189
	v_lshlrev_b32 v28, 16, v69
	v_and_b32 v29, s32, v69
	v_fmac_f32 v22, v28, v189
	v_fmac_f32 v23, v29, v189
	v_lshlrev_b32 v28, 16, v70
	v_and_b32 v29, s32, v70
	v_fmac_f32 v24, v28, v189
	v_fmac_f32 v25, v29, v189
	v_lshlrev_b32 v28, 16, v71
	v_and_b32 v29, s32, v71
	v_fmac_f32 v26, v28, v189
	v_fmac_f32 v27, v29, v189
	s_waitcnt vmcnt(7)
	v_lshlrev_b32 v28, 16, v72
	v_and_b32 v29, s32, v72
	v_fmac_f32 v20, v28, v190
	v_fmac_f32 v21, v29, v190
	v_lshlrev_b32 v28, 16, v73
	v_and_b32 v29, s32, v73
	v_fmac_f32 v22, v28, v190
	v_fmac_f32 v23, v29, v190
	v_lshlrev_b32 v28, 16, v74
	v_and_b32 v29, s32, v74
	v_fmac_f32 v24, v28, v190
	v_fmac_f32 v25, v29, v190
	v_lshlrev_b32 v28, 16, v75
	v_and_b32 v29, s32, v75
	v_fmac_f32 v26, v28, v190
	v_fmac_f32 v27, v29, v190
	s_waitcnt vmcnt(6)
	v_lshlrev_b32 v28, 16, v76
	v_and_b32 v29, s32, v76
	v_fmac_f32 v20, v28, v191
	v_fmac_f32 v21, v29, v191
	v_lshlrev_b32 v28, 16, v77
	v_and_b32 v29, s32, v77
	v_fmac_f32 v22, v28, v191
	v_fmac_f32 v23, v29, v191
	v_lshlrev_b32 v28, 16, v78
	v_and_b32 v29, s32, v78
	v_fmac_f32 v24, v28, v191
	v_fmac_f32 v25, v29, v191
	v_lshlrev_b32 v28, 16, v79
	v_and_b32 v29, s32, v79
	v_fmac_f32 v26, v28, v191
	v_fmac_f32 v27, v29, v191
	s_waitcnt vmcnt(5)
	v_lshlrev_b32 v28, 16, v80
	v_and_b32 v29, s32, v80
	v_fmac_f32 v20, v28, v192
	v_fmac_f32 v21, v29, v192
	v_lshlrev_b32 v28, 16, v81
	v_and_b32 v29, s32, v81
	v_fmac_f32 v22, v28, v192
	v_fmac_f32 v23, v29, v192
	v_lshlrev_b32 v28, 16, v82
	v_and_b32 v29, s32, v82
	v_fmac_f32 v24, v28, v192
	v_fmac_f32 v25, v29, v192
	v_lshlrev_b32 v28, 16, v83
	v_and_b32 v29, s32, v83
	v_fmac_f32 v26, v28, v192
	v_fmac_f32 v27, v29, v192
	s_waitcnt vmcnt(4)
	v_lshlrev_b32 v28, 16, v84
	v_and_b32 v29, s32, v84
	v_fmac_f32 v20, v28, v193
	v_fmac_f32 v21, v29, v193
	v_lshlrev_b32 v28, 16, v85
	v_and_b32 v29, s32, v85
	v_fmac_f32 v22, v28, v193
	v_fmac_f32 v23, v29, v193
	v_lshlrev_b32 v28, 16, v86
	v_and_b32 v29, s32, v86
	v_fmac_f32 v24, v28, v193
	v_fmac_f32 v25, v29, v193
	v_lshlrev_b32 v28, 16, v87
	v_and_b32 v29, s32, v87
	v_fmac_f32 v26, v28, v193
	v_fmac_f32 v27, v29, v193
	s_waitcnt vmcnt(3)
	v_lshlrev_b32 v28, 16, v88
	v_and_b32 v29, s32, v88
	v_fmac_f32 v20, v28, v194
	v_fmac_f32 v21, v29, v194
	v_lshlrev_b32 v28, 16, v89
	v_and_b32 v29, s32, v89
	v_fmac_f32 v22, v28, v194
	v_fmac_f32 v23, v29, v194
	v_lshlrev_b32 v28, 16, v90
	v_and_b32 v29, s32, v90
	v_fmac_f32 v24, v28, v194
	v_fmac_f32 v25, v29, v194
	v_lshlrev_b32 v28, 16, v91
	v_and_b32 v29, s32, v91
	v_fmac_f32 v26, v28, v194
	v_fmac_f32 v27, v29, v194
	s_waitcnt vmcnt(2)
	v_lshlrev_b32 v28, 16, v92
	v_and_b32 v29, s32, v92
	v_fmac_f32 v20, v28, v195
	v_fmac_f32 v21, v29, v195
	v_lshlrev_b32 v28, 16, v93
	v_and_b32 v29, s32, v93
	v_fmac_f32 v22, v28, v195
	v_fmac_f32 v23, v29, v195
	v_lshlrev_b32 v28, 16, v94
	v_and_b32 v29, s32, v94
	v_fmac_f32 v24, v28, v195
	v_fmac_f32 v25, v29, v195
	v_lshlrev_b32 v28, 16, v95
	v_and_b32 v29, s32, v95
	v_fmac_f32 v26, v28, v195
	v_fmac_f32 v27, v29, v195
	s_waitcnt vmcnt(1)
	v_lshlrev_b32 v28, 16, v96
	v_and_b32 v29, s32, v96
	v_fmac_f32 v20, v28, v196
	v_fmac_f32 v21, v29, v196
	v_lshlrev_b32 v28, 16, v97
	v_and_b32 v29, s32, v97
	v_fmac_f32 v22, v28, v196
	v_fmac_f32 v23, v29, v196
	v_lshlrev_b32 v28, 16, v98
	v_and_b32 v29, s32, v98
	v_fmac_f32 v24, v28, v196
	v_fmac_f32 v25, v29, v196
	v_lshlrev_b32 v28, 16, v99
	v_and_b32 v29, s32, v99
	v_fmac_f32 v26, v28, v196
	v_fmac_f32 v27, v29, v196
	s_waitcnt vmcnt(0)
	v_lshlrev_b32 v28, 16, v100
	v_and_b32 v29, s32, v100
	v_fmac_f32 v20, v28, v197
	v_fmac_f32 v21, v29, v197
	v_lshlrev_b32 v28, 16, v101
	v_and_b32 v29, s32, v101
	v_fmac_f32 v22, v28, v197
	v_fmac_f32 v23, v29, v197
	v_lshlrev_b32 v28, 16, v102
	v_and_b32 v29, s32, v102
	v_fmac_f32 v24, v28, v197
	v_fmac_f32 v25, v29, v197
	v_lshlrev_b32 v28, 16, v103
	v_and_b32 v29, s32, v103
	v_fmac_f32 v26, v28, v197
	v_fmac_f32 v27, v29, v197
	ds_write_b128 v9, v[20:23] offset:12288
	ds_write_b128 v9, v[24:27] offset:12304
	s_waitcnt lgkmcnt(0)
	s_barrier
	s_cmp_lg_u32 s34, 0
	s_cbranch_scc1 L_k12_prep
	ds_read_b32 v200, v13 offset:12288
	ds_read_b32 v201, v13 offset:12544
	ds_read_b32 v202, v13 offset:12800
	ds_read_b32 v203, v13 offset:13056
	ds_read_b32 v204, v13 offset:13312
	ds_read_b32 v205, v13 offset:13568
	ds_read_b32 v206, v13 offset:13824
	ds_read_b32 v207, v13 offset:14080
	ds_read_b32 v208, v13 offset:14336
	ds_read_b32 v209, v13 offset:14592
	ds_read_b32 v210, v13 offset:14848
	ds_read_b32 v211, v13 offset:15104
	ds_read_b32 v212, v13 offset:15360
	ds_read_b32 v213, v13 offset:15616
	ds_read_b32 v214, v13 offset:15872
	ds_read_b32 v215, v13 offset:16128
	ds_read_b32 v216, v13 offset:16384
	ds_read_b32 v217, v13 offset:16640
	ds_read_b32 v218, v13 offset:16896
	ds_read_b32 v219, v13 offset:17152
	ds_read_b32 v220, v13 offset:17408
	ds_read_b32 v221, v13 offset:17664
	ds_read_b32 v222, v13 offset:17920
	ds_read_b32 v223, v13 offset:18176
	ds_read_b32 v224, v13 offset:18432
	ds_read_b32 v225, v13 offset:18688
	ds_read_b32 v226, v13 offset:18944
	ds_read_b32 v227, v13 offset:19200
	ds_read_b32 v228, v13 offset:19456
	ds_read_b32 v229, v13 offset:19712
	ds_read_b32 v230, v13 offset:19968
	ds_read_b32 v231, v13 offset:20224
	s_waitcnt lgkmcnt(0)
	v_add_f32 v200, v200, v216
	v_add_f32 v201, v201, v217
	v_add_f32 v202, v202, v218
	v_add_f32 v203, v203, v219
	v_add_f32 v204, v204, v220
	v_add_f32 v205, v205, v221
	v_add_f32 v206, v206, v222
	v_add_f32 v207, v207, v223
	v_add_f32 v208, v208, v224
	v_add_f32 v209, v209, v225
	v_add_f32 v210, v210, v226
	v_add_f32 v211, v211, v227
	v_add_f32 v212, v212, v228
	v_add_f32 v213, v213, v229
	v_add_f32 v214, v214, v230
	v_add_f32 v215, v215, v231
	v_add_f32 v200, v200, v208
	v_add_f32 v201, v201, v209
	v_add_f32 v202, v202, v210
	v_add_f32 v203, v203, v211
	v_add_f32 v204, v204, v212
	v_add_f32 v205, v205, v213
	v_add_f32 v206, v206, v214
	v_add_f32 v207, v207, v215
	v_add_f32 v200, v200, v204
	v_add_f32 v201, v201, v205
	v_add_f32 v202, v202, v206
	v_add_f32 v203, v203, v207
	v_add_f32 v200, v200, v202
	v_add_f32 v201, v201, v203
	v_add_f32 v200, v200, v201
	v_cvt_pk_bf16_f32 v200, v200, v200
	v_lshlrev_b32 v200, 16, v200
	s_mul_i32 s35, s3, 7282
	s_lshr_b32 s35, s35, 16
	s_mul_i32 s36, s35, 9
	s_sub_u32 s36, s3, s36
	s_lshl_b32 s36, s36, 8
	s_cmp_lg_u32 s35, 1
	s_cbranch_scc1 L_k12_Bst
	v_add_f32 v200, 1.0, v200
	v_cvt_pk_bf16_f32 v200, v200, v200
L_k12_Bst:
	s_cmp_eq_u32 s35, 0
	s_cselect_b32 s37, 2304, 0
	s_cmp_eq_u32 s35, 2
	s_cselect_b32 s37, 4608, s37
	s_add_u32 s36, s36, s37
	s_add_u32 s36, s36, 57344
	buffer_store_dword v200, v13, s[24:27], s36 offen sc1
	s_branch L_k12_prep
L_k12_Bx:
	s_cmp_lg_u32 s3, 47
	s_cbranch_scc1 L_k12_prep
	s_getpc_b64 s[4:5]
L_k12_pc:
	s_add_u32 s4, s4, L_text_pf_start-L_k12_pc
	s_addc_u32 s5, s5, 0
	v_lshlrev_b32 v1, 7, v0
	s_mov_b32 s6, L_text_pf_end-L_text_pf_start-4
	v_min_u32 v2, s6, v1
	v_and_b32 v2, -4, v2
	global_load_dword v4, v2, s[4:5]
	v_add_u32 v1, 32768, v1
	v_min_u32 v2, s6, v1
	v_and_b32 v2, -4, v2
	global_load_dword v5, v2, s[4:5]
	v_add_u32 v1, 32768, v1
	v_min_u32 v2, s6, v1
	v_and_b32 v2, -4, v2
	global_load_dword v6, v2, s[4:5]
	v_add_u32 v1, 32768, v1
	s_branch L_k12_prep
L_k12_A:
	s_load_dwordx2 s[4:5], s[0:1], 0
	s_load_dwordx2 s[8:9], s[0:1], 136
	s_load_dwordx2 s[44:45], s[0:1], 128
	s_mov_b32 s3, s2
	v_lshrrev_b32 v1, 3, v0
	v_and_b32 v2, 7, v0
	s_lshl_b32 s20, s3, 5
	v_add_u32 v3, s20, v1
	s_movk_i32 s21, 1152
	v_mul_lo_u32 v3, v3, s21
	v_lshl_add_u32 v3, v2, 4, v3
	s_movk_i32 s21, 1184
	v_mul_lo_u32 v4, v1, s21
	v_lshl_add_u32 v4, v2, 4, v4
	s_waitcnt lgkmcnt(0)
	s_mov_b32 s12, s4
	s_mov_b32 s13, s5
	s_mov_b32 s14, 2359296
	s_mov_b32 s15, 0x20000
	s_mov_b32 s24, s8
	s_mov_b32 s25, s9
	s_mov_b32 s26, 48168960
	s_mov_b32 s27, 0x20000
	buffer_load_dwordx4 v[16:19], v3, s[12:15], 0 offen offset:0
	buffer_load_dwordx4 v[20:23], v3, s[12:15], 0 offen offset:128
	buffer_load_dwordx4 v[24:27], v3, s[12:15], 0 offen offset:256
	buffer_load_dwordx4 v[28:31], v3, s[12:15], 0 offen offset:384
	buffer_load_dwordx4 v[32:35], v3, s[12:15], 0 offen offset:512
	buffer_load_dwordx4 v[36:39], v3, s[12:15], 0 offen offset:640
	buffer_load_dwordx4 v[40:43], v3, s[12:15], 0 offen offset:768
	buffer_load_dwordx4 v[44:47], v3, s[12:15], 0 offen offset:896
	buffer_load_dwordx4 v[48:51], v3, s[12:15], 0 offen offset:1024
	s_mov_b32 s32, 0xffff0000
	v_mov_b32 v6, 0
	v_mov_b32 v7, 0
	s_waitcnt vmcnt(8)
	ds_write_b128 v4, v[16:19] offset:0
	v_lshlrev_b32 v56, 16, v16
	v_and_b32 v57, s32, v16
	v_lshlrev_b32 v58, 16, v17
	v_and_b32 v59, s32, v17
	v_lshlrev_b32 v60, 16, v18
	v_and_b32 v61, s32, v18
	v_lshlrev_b32 v62, 16, v19
	v_and_b32 v63, s32, v19
	v_pk_add_f32 v[6:7], v[6:7], v[56:57]
	v_pk_add_f32 v[6:7], v[6:7], v[58:59]
	v_pk_add_f32 v[6:7], v[6:7], v[60:61]
	v_pk_add_f32 v[6:7], v[6:7], v[62:63]
	s_waitcnt vmcnt(7)
	ds_write_b128 v4, v[20:23] offset:128
	v_lshlrev_b32 v64, 16, v20
	v_and_b32 v65, s32, v20
	v_lshlrev_b32 v66, 16, v21
	v_and_b32 v67, s32, v21
	v_lshlrev_b32 v68, 16, v22
	v_and_b32 v69, s32, v22
	v_lshlrev_b32 v70, 16, v23
	v_and_b32 v71, s32, v23
	v_pk_add_f32 v[6:7], v[6:7], v[64:65]
	v_pk_add_f32 v[6:7], v[6:7], v[66:67]
	v_pk_add_f32 v[6:7], v[6:7], v[68:69]
	v_pk_add_f32 v[6:7], v[6:7], v[70:71]
	s_waitcnt vmcnt(6)
	ds_write_b128 v4, v[24:27] offset:256
	v_lshlrev_b32 v72, 16, v24
	v_and_b32 v73, s32, v24
	v_lshlrev_b32 v74, 16, v25
	v_and_b32 v75, s32, v25
	v_lshlrev_b32 v76, 16, v26
	v_and_b32 v77, s32, v26
	v_lshlrev_b32 v78, 16, v27
	v_and_b32 v79, s32, v27
	v_pk_add_f32 v[6:7], v[6:7], v[72:73]
	v_pk_add_f32 v[6:7], v[6:7], v[74:75]
	v_pk_add_f32 v[6:7], v[6:7], v[76:77]
	v_pk_add_f32 v[6:7], v[6:7], v[78:79]
	s_waitcnt vmcnt(5)
	ds_write_b128 v4, v[28:31] offset:384
	v_lshlrev_b32 v80, 16, v28
	v_and_b32 v81, s32, v28
	v_lshlrev_b32 v82, 16, v29
	v_and_b32 v83, s32, v29
	v_lshlrev_b32 v84, 16, v30
	v_and_b32 v85, s32, v30
	v_lshlrev_b32 v86, 16, v31
	v_and_b32 v87, s32, v31
	v_pk_add_f32 v[6:7], v[6:7], v[80:81]
	v_pk_add_f32 v[6:7], v[6:7], v[82:83]
	v_pk_add_f32 v[6:7], v[6:7], v[84:85]
	v_pk_add_f32 v[6:7], v[6:7], v[86:87]
	s_waitcnt vmcnt(4)
	ds_write_b128 v4, v[32:35] offset:512
	v_lshlrev_b32 v88, 16, v32
	v_and_b32 v89, s32, v32
	v_lshlrev_b32 v90, 16, v33
	v_and_b32 v91, s32, v33
	v_lshlrev_b32 v92, 16, v34
	v_and_b32 v93, s32, v34
	v_lshlrev_b32 v94, 16, v35
	v_and_b32 v95, s32, v35
	v_pk_add_f32 v[6:7], v[6:7], v[88:89]
	v_pk_add_f32 v[6:7], v[6:7], v[90:91]
	v_pk_add_f32 v[6:7], v[6:7], v[92:93]
	v_pk_add_f32 v[6:7], v[6:7], v[94:95]
	s_waitcnt vmcnt(3)
	ds_write_b128 v4, v[36:39] offset:640
	v_lshlrev_b32 v96, 16, v36
	v_and_b32 v97, s32, v36
	v_lshlrev_b32 v98, 16, v37
	v_and_b32 v99, s32, v37
	v_lshlrev_b32 v100, 16, v38
	v_and_b32 v101, s32, v38
	v_lshlrev_b32 v102, 16, v39
	v_and_b32 v103, s32, v39
	v_pk_add_f32 v[6:7], v[6:7], v[96:97]
	v_pk_add_f32 v[6:7], v[6:7], v[98:99]
	v_pk_add_f32 v[6:7], v[6:7], v[100:101]
	v_pk_add_f32 v[6:7], v[6:7], v[102:103]
	s_waitcnt vmcnt(2)
	ds_write_b128 v4, v[40:43] offset:768
	v_lshlrev_b32 v104, 16, v40
	v_and_b32 v105, s32, v40
	v_lshlrev_b32 v106, 16, v41
	v_and_b32 v107, s32, v41
	v_lshlrev_b32 v108, 16, v42
	v_and_b32 v109, s32, v42
	v_lshlrev_b32 v110, 16, v43
	v_and_b32 v111, s32, v43
	v_pk_add_f32 v[6:7], v[6:7], v[104:105]
	v_pk_add_f32 v[6:7], v[6:7], v[106:107]
	v_pk_add_f32 v[6:7], v[6:7], v[108:109]
	v_pk_add_f32 v[6:7], v[6:7], v[110:111]
	s_waitcnt vmcnt(1)
	ds_write_b128 v4, v[44:47] offset:896
	v_lshlrev_b32 v112, 16, v44
	v_and_b32 v113, s32, v44
	v_lshlrev_b32 v114, 16, v45
	v_and_b32 v115, s32, v45
	v_lshlrev_b32 v116, 16, v46
	v_and_b32 v117, s32, v46
	v_lshlrev_b32 v118, 16, v47
	v_and_b32 v119, s32, v47
	v_pk_add_f32 v[6:7], v[6:7], v[112:113]
	v_pk_add_f32 v[6:7], v[6:7], v[114:115]
	v_pk_add_f32 v[6:7], v[6:7], v[116:117]
	v_pk_add_f32 v[6:7], v[6:7], v[118:119]
	s_waitcnt vmcnt(0)
	ds_write_b128 v4, v[48:51] offset:1024
	v_lshlrev_b32 v120, 16, v48
	v_and_b32 v121, s32, v48
	v_lshlrev_b32 v122, 16, v49
	v_and_b32 v123, s32, v49
	v_lshlrev_b32 v124, 16, v50
	v_and_b32 v125, s32, v50
	v_lshlrev_b32 v126, 16, v51
	v_and_b32 v127, s32, v51
	v_pk_add_f32 v[6:7], v[6:7], v[120:121]
	v_pk_add_f32 v[6:7], v[6:7], v[122:123]
	v_pk_add_f32 v[6:7], v[6:7], v[124:125]
	v_pk_add_f32 v[6:7], v[6:7], v[126:127]
	v_add_f32 v6, v6, v7
	s_nop 1
	v_add_f32_dpp v6, v6, v6 quad_perm:[1,0,3,2] row_mask:0xf bank_mask:0xf
	s_nop 1
	v_add_f32_dpp v6, v6, v6 quad_perm:[2,3,0,1] row_mask:0xf bank_mask:0xf
	s_nop 1
	v_add_f32_dpp v6, v6, v6 row_half_mirror row_mask:0xf bank_mask:0xf
	s_mov_b32 s33, 0x3ae38e39
	v_mul_f32 v8, s33, v6
	v_sub_f32 v10, 0, v8
	v_sub_f32 v11, 0, v8
	v_mov_b32 v6, 0
	v_mov_b32 v7, 0
	v_pk_add_f32 v[128:129], v[56:57], v[10:11]
	v_pk_fma_f32 v[6:7], v[128:129], v[128:129], v[6:7]
	v_pk_add_f32 v[130:131], v[58:59], v[10:11]
	v_pk_fma_f32 v[6:7], v[130:131], v[130:131], v[6:7]
	v_pk_add_f32 v[132:133], v[60:61], v[10:11]
	v_pk_fma_f32 v[6:7], v[132:133], v[132:133], v[6:7]
	v_pk_add_f32 v[134:135], v[62:63], v[10:11]
	v_pk_fma_f32 v[6:7], v[134:135], v[134:135], v[6:7]
	v_pk_add_f32 v[128:129], v[64:65], v[10:11]
	v_pk_fma_f32 v[6:7], v[128:129], v[128:129], v[6:7]
	v_pk_add_f32 v[130:131], v[66:67], v[10:11]
	v_pk_fma_f32 v[6:7], v[130:131], v[130:131], v[6:7]
	v_pk_add_f32 v[132:133], v[68:69], v[10:11]
	v_pk_fma_f32 v[6:7], v[132:133], v[132:133], v[6:7]
	v_pk_add_f32 v[134:135], v[70:71], v[10:11]
	v_pk_fma_f32 v[6:7], v[134:135], v[134:135], v[6:7]
	v_pk_add_f32 v[128:129], v[72:73], v[10:11]
	v_pk_fma_f32 v[6:7], v[128:129], v[128:129], v[6:7]
	v_pk_add_f32 v[130:131], v[74:75], v[10:11]
	v_pk_fma_f32 v[6:7], v[130:131], v[130:131], v[6:7]
	v_pk_add_f32 v[132:133], v[76:77], v[10:11]
	v_pk_fma_f32 v[6:7], v[132:133], v[132:133], v[6:7]
	v_pk_add_f32 v[134:135], v[78:79], v[10:11]
	v_pk_fma_f32 v[6:7], v[134:135], v[134:135], v[6:7]
	v_pk_add_f32 v[128:129], v[80:81], v[10:11]
	v_pk_fma_f32 v[6:7], v[128:129], v[128:129], v[6:7]
	v_pk_add_f32 v[130:131], v[82:83], v[10:11]
	v_pk_fma_f32 v[6:7], v[130:131], v[130:131], v[6:7]
	v_pk_add_f32 v[132:133], v[84:85], v[10:11]
	v_pk_fma_f32 v[6:7], v[132:133], v[132:133], v[6:7]
	v_pk_add_f32 v[134:135], v[86:87], v[10:11]
	v_pk_fma_f32 v[6:7], v[134:135], v[134:135], v[6:7]
	v_pk_add_f32 v[128:129], v[88:89], v[10:11]
	v_pk_fma_f32 v[6:7], v[128:129], v[128:129], v[6:7]
	v_pk_add_f32 v[130:131], v[90:91], v[10:11]
	v_pk_fma_f32 v[6:7], v[130:131], v[130:131], v[6:7]
	v_pk_add_f32 v[132:133], v[92:93], v[10:11]
	v_pk_fma_f32 v[6:7], v[132:133], v[132:133], v[6:7]
	v_pk_add_f32 v[134:135], v[94:95], v[10:11]
	v_pk_fma_f32 v[6:7], v[134:135], v[134:135], v[6:7]
	v_pk_add_f32 v[128:129], v[96:97], v[10:11]
	v_pk_fma_f32 v[6:7], v[128:129], v[128:129], v[6:7]
	v_pk_add_f32 v[130:131], v[98:99], v[10:11]
	v_pk_fma_f32 v[6:7], v[130:131], v[130:131], v[6:7]
	v_pk_add_f32 v[132:133], v[100:101], v[10:11]
	v_pk_fma_f32 v[6:7], v[132:133], v[132:133], v[6:7]
	v_pk_add_f32 v[134:135], v[102:103], v[10:11]
	v_pk_fma_f32 v[6:7], v[134:135], v[134:135], v[6:7]
	v_pk_add_f32 v[128:129], v[104:105], v[10:11]
	v_pk_fma_f32 v[6:7], v[128:129], v[128:129], v[6:7]
	v_pk_add_f32 v[130:131], v[106:107], v[10:11]
	v_pk_fma_f32 v[6:7], v[130:131], v[130:131], v[6:7]
	v_pk_add_f32 v[132:133], v[108:109], v[10:11]
	v_pk_fma_f32 v[6:7], v[132:133], v[132:133], v[6:7]
	v_pk_add_f32 v[134:135], v[110:111], v[10:11]
	v_pk_fma_f32 v[6:7], v[134:135], v[134:135], v[6:7]
	v_pk_add_f32 v[128:129], v[112:113], v[10:11]
	v_pk_fma_f32 v[6:7], v[128:129], v[128:129], v[6:7]
	v_pk_add_f32 v[130:131], v[114:115], v[10:11]
	v_pk_fma_f32 v[6:7], v[130:131], v[130:131], v[6:7]
	v_pk_add_f32 v[132:133], v[116:117], v[10:11]
	v_pk_fma_f32 v[6:7], v[132:133], v[132:133], v[6:7]
	v_pk_add_f32 v[134:135], v[118:119], v[10:11]
	v_pk_fma_f32 v[6:7], v[134:135], v[134:135], v[6:7]
	v_pk_add_f32 v[128:129], v[120:121], v[10:11]
	v_pk_fma_f32 v[6:7], v[128:129], v[128:129], v[6:7]
	v_pk_add_f32 v[130:131], v[122:123], v[10:11]
	v_pk_fma_f32 v[6:7], v[130:131], v[130:131], v[6:7]
	v_pk_add_f32 v[132:133], v[124:125], v[10:11]
	v_pk_fma_f32 v[6:7], v[132:133], v[132:133], v[6:7]
	v_pk_add_f32 v[134:135], v[126:127], v[10:11]
	v_pk_fma_f32 v[6:7], v[134:135], v[134:135], v[6:7]
	v_add_f32 v6, v6, v7
	s_nop 1
	v_add_f32_dpp v6, v6, v6 quad_perm:[1,0,3,2] row_mask:0xf bank_mask:0xf
	s_nop 1
	v_add_f32_dpp v6, v6, v6 quad_perm:[2,3,0,1] row_mask:0xf bank_mask:0xf
	s_nop 1
	v_add_f32_dpp v6, v6, v6 row_half_mirror row_mask:0xf bank_mask:0xf
	v_mul_f32 v6, s33, v6
	v_cvt_pk_bf16_f32 v6, v6, v6
	v_lshlrev_b32 v6, 16, v6
	v_add_f32 v6, 0x3727c5ac, v6
	v_cvt_pk_bf16_f32 v6, v6, v6
	v_lshlrev_b32 v6, 16, v6
	v_sqrt_f32 v6, v6
	s_nop 0
	v_cvt_pk_bf16_f32 v6, v6, v6
	v_lshlrev_b32 v6, 16, v6
	v_rcp_f32 v12, v6
	v_cvt_pk_bf16_f32 v8, v8, v8
	v_lshlrev_b32 v8, 16, v8
	v_sub_f32 v10, 0, v8
	v_sub_f32 v11, 0, v8
	v_mov_b32 v13, v12
	v_mul_f32 v10, v10, v12
	v_mul_f32 v11, v11, v13
	v_pk_fma_f32 v[56:57], v[56:57], v[12:13], v[10:11]
	v_pk_fma_f32 v[58:59], v[58:59], v[12:13], v[10:11]
	v_pk_fma_f32 v[60:61], v[60:61], v[12:13], v[10:11]
	v_pk_fma_f32 v[62:63], v[62:63], v[12:13], v[10:11]
	v_pk_fma_f32 v[64:65], v[64:65], v[12:13], v[10:11]
	v_pk_fma_f32 v[66:67], v[66:67], v[12:13], v[10:11]
	v_pk_fma_f32 v[68:69], v[68:69], v[12:13], v[10:11]
	v_pk_fma_f32 v[70:71], v[70:71], v[12:13], v[10:11]
	v_pk_fma_f32 v[72:73], v[72:73], v[12:13], v[10:11]
	v_pk_fma_f32 v[74:75], v[74:75], v[12:13], v[10:11]
	v_pk_fma_f32 v[76:77], v[76:77], v[12:13], v[10:11]
	v_pk_fma_f32 v[78:79], v[78:79], v[12:13], v[10:11]
	v_pk_fma_f32 v[80:81], v[80:81], v[12:13], v[10:11]
	v_pk_fma_f32 v[82:83], v[82:83], v[12:13], v[10:11]
	v_pk_fma_f32 v[84:85], v[84:85], v[12:13], v[10:11]
	v_pk_fma_f32 v[86:87], v[86:87], v[12:13], v[10:11]
	v_pk_fma_f32 v[88:89], v[88:89], v[12:13], v[10:11]
	v_pk_fma_f32 v[90:91], v[90:91], v[12:13], v[10:11]
	v_pk_fma_f32 v[92:93], v[92:93], v[12:13], v[10:11]
	v_pk_fma_f32 v[94:95], v[94:95], v[12:13], v[10:11]
	v_pk_fma_f32 v[96:97], v[96:97], v[12:13], v[10:11]
	v_pk_fma_f32 v[98:99], v[98:99], v[12:13], v[10:11]
	v_pk_fma_f32 v[100:101], v[100:101], v[12:13], v[10:11]
	v_pk_fma_f32 v[102:103], v[102:103], v[12:13], v[10:11]
	v_pk_fma_f32 v[104:105], v[104:105], v[12:13], v[10:11]
	v_pk_fma_f32 v[106:107], v[106:107], v[12:13], v[10:11]
	v_pk_fma_f32 v[108:109], v[108:109], v[12:13], v[10:11]
	v_pk_fma_f32 v[110:111], v[110:111], v[12:13], v[10:11]
	v_pk_fma_f32 v[112:113], v[112:113], v[12:13], v[10:11]
	v_pk_fma_f32 v[114:115], v[114:115], v[12:13], v[10:11]
	v_pk_fma_f32 v[116:117], v[116:117], v[12:13], v[10:11]
	v_pk_fma_f32 v[118:119], v[118:119], v[12:13], v[10:11]
	v_pk_fma_f32 v[120:121], v[120:121], v[12:13], v[10:11]
	v_pk_fma_f32 v[122:123], v[122:123], v[12:13], v[10:11]
	v_pk_fma_f32 v[124:125], v[124:125], v[12:13], v[10:11]
	v_pk_fma_f32 v[126:127], v[126:127], v[12:13], v[10:11]
	v_cvt_pk_bf16_f32 v16, v56, v57
	v_cvt_pk_bf16_f32 v17, v58, v59
	v_cvt_pk_bf16_f32 v18, v60, v61
	v_cvt_pk_bf16_f32 v19, v62, v63
	ds_write_b128 v4, v[16:19] offset:37888
	v_cvt_pk_bf16_f32 v20, v64, v65
	v_cvt_pk_bf16_f32 v21, v66, v67
	v_cvt_pk_bf16_f32 v22, v68, v69
	v_cvt_pk_bf16_f32 v23, v70, v71
	ds_write_b128 v4, v[20:23] offset:38016
	v_cvt_pk_bf16_f32 v24, v72, v73
	v_cvt_pk_bf16_f32 v25, v74, v75
	v_cvt_pk_bf16_f32 v26, v76, v77
	v_cvt_pk_bf16_f32 v27, v78, v79
	ds_write_b128 v4, v[24:27] offset:38144
	v_cvt_pk_bf16_f32 v28, v80, v81
	v_cvt_pk_bf16_f32 v29, v82, v83
	v_cvt_pk_bf16_f32 v30, v84, v85
	v_cvt_pk_bf16_f32 v31, v86, v87
	ds_write_b128 v4, v[28:31] offset:38272
	v_cvt_pk_bf16_f32 v32, v88, v89
	v_cvt_pk_bf16_f32 v33, v90, v91
	v_cvt_pk_bf16_f32 v34, v92, v93
	v_cvt_pk_bf16_f32 v35, v94, v95
	ds_write_b128 v4, v[32:35] offset:38400
	v_cvt_pk_bf16_f32 v36, v96, v97
	v_cvt_pk_bf16_f32 v37, v98, v99
	v_cvt_pk_bf16_f32 v38, v100, v101
	v_cvt_pk_bf16_f32 v39, v102, v103
	ds_write_b128 v4, v[36:39] offset:38528
	v_cvt_pk_bf16_f32 v40, v104, v105
	v_cvt_pk_bf16_f32 v41, v106, v107
	v_cvt_pk_bf16_f32 v42, v108, v109
	v_cvt_pk_bf16_f32 v43, v110, v111
	ds_write_b128 v4, v[40:43] offset:38656
	v_cvt_pk_bf16_f32 v44, v112, v113
	v_cvt_pk_bf16_f32 v45, v114, v115
	v_cvt_pk_bf16_f32 v46, v116, v117
	v_cvt_pk_bf16_f32 v47, v118, v119
	ds_write_b128 v4, v[44:47] offset:38784
	v_cvt_pk_bf16_f32 v48, v120, v121
	v_cvt_pk_bf16_f32 v49, v122, v123
	v_cvt_pk_bf16_f32 v50, v124, v125
	v_cvt_pk_bf16_f32 v51, v126, v127
	ds_write_b128 v4, v[48:51] offset:38912
	v_and_b32 v1, 63, v0
	v_lshrrev_b32 v2, 6, v0
	v_and_b32 v3, 15, v1
	v_lshrrev_b32 v5, 4, v1
	v_lshrrev_b32 v6, 2, v3
	v_lshl_add_u32 v6, v5, 3, v6
	s_movk_i32 s21, 1184
	v_mul_lo_u32 v6, v6, s21
	v_and_b32 v7, 3, v3
	v_lshl_add_u32 v6, v7, 3, v6
	v_lshl_add_u32 v6, v2, 5, v6
	v_lshlrev_b32 v7, 6, v3
	v_lshl_add_u32 v7, v5, 4, v7
	v_lshl_add_u32 v7, v2, 10, v7
	s_mul_i32 s22, s3, 36864
	v_readfirstlane_b32 s34, v2
	s_waitcnt lgkmcnt(0)
	s_barrier
	ds_read_b64_tr_b16 v[16:17], v6 offset:37888
	ds_read_b64_tr_b16 v[18:19], v6 offset:42624
	ds_read_b64_tr_b16 v[20:21], v6 offset:38016
	ds_read_b64_tr_b16 v[22:23], v6 offset:42752
	ds_read_b64_tr_b16 v[24:25], v6 offset:38144
	ds_read_b64_tr_b16 v[26:27], v6 offset:42880
	ds_read_b64_tr_b16 v[28:29], v6 offset:38272
	ds_read_b64_tr_b16 v[30:31], v6 offset:43008
	ds_read_b64_tr_b16 v[32:33], v6 offset:38400
	ds_read_b64_tr_b16 v[34:35], v6 offset:43136
	ds_read_b64_tr_b16 v[36:37], v6 offset:38528
	ds_read_b64_tr_b16 v[38:39], v6 offset:43264
	ds_read_b64_tr_b16 v[40:41], v6 offset:38656
	ds_read_b64_tr_b16 v[42:43], v6 offset:43392
	ds_read_b64_tr_b16 v[44:45], v6 offset:38784
	ds_read_b64_tr_b16 v[46:47], v6 offset:43520
	ds_read_b64_tr_b16 v[48:49], v6 offset:38912
	ds_read_b64_tr_b16 v[50:51], v6 offset:43648
	s_add_u32 s23, s22, 2424832
	s_waitcnt lgkmcnt(15)
	buffer_store_dwordx4 v[16:19], v7, s[24:27], s23 offen sc1
	s_add_u32 s23, s22, 2428928
	s_waitcnt lgkmcnt(14)
	buffer_store_dwordx4 v[20:23], v7, s[24:27], s23 offen sc1
	s_add_u32 s23, s22, 2433024
	s_waitcnt lgkmcnt(12)
	buffer_store_dwordx4 v[24:27], v7, s[24:27], s23 offen sc1
	s_add_u32 s23, s22, 2437120
	s_waitcnt lgkmcnt(10)
	buffer_store_dwordx4 v[28:31], v7, s[24:27], s23 offen sc1
	s_add_u32 s23, s22, 2441216
	s_waitcnt lgkmcnt(8)
	buffer_store_dwordx4 v[32:35], v7, s[24:27], s23 offen sc1
	s_add_u32 s23, s22, 2445312
	s_waitcnt lgkmcnt(6)
	buffer_store_dwordx4 v[36:39], v7, s[24:27], s23 offen sc1
	s_add_u32 s23, s22, 2449408
	s_waitcnt lgkmcnt(4)
	buffer_store_dwordx4 v[40:43], v7, s[24:27], s23 offen sc1
	s_add_u32 s23, s22, 2453504
	s_waitcnt lgkmcnt(2)
	buffer_store_dwordx4 v[44:47], v7, s[24:27], s23 offen sc1
	s_add_u32 s23, s22, 2457600
	s_waitcnt lgkmcnt(0)
	buffer_store_dwordx4 v[48:51], v7, s[24:27], s23 offen sc1
	ds_read_b64_tr_b16 v[56:57], v6 offset:0
	ds_read_b64_tr_b16 v[58:59], v6 offset:4736
	ds_read_b64_tr_b16 v[60:61], v6 offset:128
	ds_read_b64_tr_b16 v[62:63], v6 offset:4864
	ds_read_b64_tr_b16 v[64:65], v6 offset:256
	ds_read_b64_tr_b16 v[66:67], v6 offset:4992
	ds_read_b64_tr_b16 v[68:69], v6 offset:384
	ds_read_b64_tr_b16 v[70:71], v6 offset:5120
	ds_read_b64_tr_b16 v[72:73], v6 offset:512
	ds_read_b64_tr_b16 v[74:75], v6 offset:5248
	ds_read_b64_tr_b16 v[76:77], v6 offset:640
	ds_read_b64_tr_b16 v[78:79], v6 offset:5376
	ds_read_b64_tr_b16 v[80:81], v6 offset:768
	ds_read_b64_tr_b16 v[82:83], v6 offset:5504
	ds_read_b64_tr_b16 v[84:85], v6 offset:896
	ds_read_b64_tr_b16 v[86:87], v6 offset:5632
	ds_read_b64_tr_b16 v[88:89], v6 offset:1024
	ds_read_b64_tr_b16 v[90:91], v6 offset:5760
	s_add_u32 s23, s22, 65536
	s_waitcnt lgkmcnt(15)
	buffer_store_dwordx4 v[56:59], v7, s[24:27], s23 offen sc1
	s_add_u32 s23, s22, 69632
	s_waitcnt lgkmcnt(14)
	buffer_store_dwordx4 v[60:63], v7, s[24:27], s23 offen sc1
	s_add_u32 s23, s22, 73728
	s_waitcnt lgkmcnt(12)
	buffer_store_dwordx4 v[64:67], v7, s[24:27], s23 offen sc1
	s_add_u32 s23, s22, 77824
	s_waitcnt lgkmcnt(10)
	buffer_store_dwordx4 v[68:71], v7, s[24:27], s23 offen sc1
	s_add_u32 s23, s22, 81920
	s_waitcnt lgkmcnt(8)
	buffer_store_dwordx4 v[72:75], v7, s[24:27], s23 offen sc1
	s_add_u32 s23, s22, 86016
	s_waitcnt lgkmcnt(6)
	buffer_store_dwordx4 v[76:79], v7, s[24:27], s23 offen sc1
	s_add_u32 s23, s22, 90112
	s_waitcnt lgkmcnt(4)
	buffer_store_dwordx4 v[80:83], v7, s[24:27], s23 offen sc1
	s_add_u32 s23, s22, 94208
	s_waitcnt lgkmcnt(2)
	buffer_store_dwordx4 v[84:87], v7, s[24:27], s23 offen sc1
	s_add_u32 s23, s22, 98304
	s_waitcnt lgkmcnt(0)
	buffer_store_dwordx4 v[88:91], v7, s[24:27], s23 offen sc1
	s_waitcnt vmcnt(0) lgkmcnt(0)
	s_barrier
	s_cmp_lg_u32 s34, 0
	s_cbranch_scc1 L_k12_prep
	v_and_b32 v2, 1, v0
	v_lshlrev_b32 v2, 7, v2
	v_mov_b32 v3, 1
	s_mov_b64 exec, 3
	global_atomic_add v2, v3, s[44:45] sc1
	s_mov_b64 exec, -1
	s_branch L_k12_prep
L_k12_prep:
	s_waitcnt vmcnt(0) lgkmcnt(0)
	s_barrier
	s_load_dwordx4 s[4:7], s[0:1], 80
	s_load_dwordx2 s[8:9], s[0:1], 96
	s_load_dwordx2 s[26:27], s[0:1], 136
	s_mov_b32 s3, s2
	v_lshrrev_b32 v2, 6, v0
	v_and_b32 v1, 63, v0
	s_lshl_b32 s28, s3, 8
	v_readfirstlane_b32 s25, v2
	v_add_u32 v3, s28, v0
	v_lshlrev_b32 v3, 7, v3
	v_add_u32 v4, 3670016, v3
	s_mov_b32 s30, 0xe38f
	s_movk_i32 s31, 864
	v_lshlrev_b32 v15, 4, v1
	v_add_u32 v5, 0, v1
	v_mul_lo_u32 v16, v5, s30
	v_lshrrev_b32 v16, 20, v16
	v_mul_lo_u32 v16, v16, s31
	v_lshl_add_u32 v6, v5, 4, v16
	v_add_u32 v5, 64, v1
	v_mul_lo_u32 v16, v5, s30
	v_lshrrev_b32 v16, 20, v16
	v_mul_lo_u32 v16, v16, s31
	v_lshl_add_u32 v7, v5, 4, v16
	v_add_u32 v5, 128, v1
	v_mul_lo_u32 v16, v5, s30
	v_lshrrev_b32 v16, 20, v16
	v_mul_lo_u32 v16, v16, s31
	v_lshl_add_u32 v8, v5, 4, v16
	v_add_u32 v5, 192, v1
	v_mul_lo_u32 v16, v5, s30
	v_lshrrev_b32 v16, 20, v16
	v_mul_lo_u32 v16, v16, s31
	v_lshl_add_u32 v9, v5, 4, v16
	v_add_u32 v5, 256, v1
	v_mul_lo_u32 v16, v5, s30
	v_lshrrev_b32 v16, 20, v16
	v_mul_lo_u32 v16, v16, s31
	v_lshl_add_u32 v10, v5, 4, v16
	v_add_u32 v5, 320, v1
	v_mul_lo_u32 v16, v5, s30
	v_lshrrev_b32 v16, 20, v16
	v_mul_lo_u32 v16, v16, s31
	v_lshl_add_u32 v11, v5, 4, v16
	v_add_u32 v5, 384, v1
	v_mul_lo_u32 v16, v5, s30
	v_lshrrev_b32 v16, 20, v16
	v_mul_lo_u32 v16, v16, s31
	v_lshl_add_u32 v12, v5, 4, v16
	v_add_u32 v5, 448, v1
	v_mul_lo_u32 v16, v5, s30
	v_lshrrev_b32 v16, 20, v16
	v_mul_lo_u32 v16, v16, s31
	v_lshl_add_u32 v13, v5, 4, v16
	v_add_u32 v5, 512, v1
	v_mul_lo_u32 v16, v5, s30
	v_lshrrev_b32 v16, 20, v16
	v_mul_lo_u32 v16, v16, s31
	v_lshl_add_u32 v14, v5, 4, v16
	v_and_b32 v16, 15, v1
	v_lshrrev_b32 v17, 4, v1
	v_lshrrev_b32 v18, 1, v17
	v_lshlrev_b32 v18, 4, v18
	v_and_b32 v19, 1, v17
	v_lshl_add_u32 v18, v19, 2, v18
	v_lshrrev_b32 v19, 2, v16
	v_add_u32 v18, v18, v19
	v_mul_u32_u24 v18, 288, v18
	v_and_b32 v19, 3, v16
	v_lshl_add_u32 v16, v19, 3, v18
	s_mul_i32 s32, s25, 27648
	v_add_u32 v16, s32, v16
	s_mul_i32 s33, s25, 288
	s_mul_i32 s34, s25, 1327104
	s_add_u32 s34, s34, 42827776
	s_waitcnt lgkmcnt(0)
	s_mov_b32 s12, s4
	s_mov_b32 s13, s5
	s_mov_b32 s14, 5308416
	s_mov_b32 s15, 0x20000
	s_mov_b32 s16, s6
	s_mov_b32 s17, s7
	s_mov_b32 s18, 5308416
	s_mov_b32 s19, 0x20000
	s_mov_b32 s20, s8
	s_mov_b32 s21, s9
	s_mov_b32 s22, 5308416
	s_mov_b32 s23, 0x20000
	s_mov_b32 s36, s26
	s_mov_b32 s37, s27
	s_mov_b32 s38, 48168960
	s_mov_b32 s39, 0x20000
	s_mov_b32 s47, s3
	s_mov_b32 s46, 255
	s_mov_b32 s43, 255
	s_cmp_lt_u32 s3, 54
	s_cbranch_scc1 L_k12_blk
	s_mov_b32 s47, 255
	s_cmp_lt_u32 s3, 64
	s_cbranch_scc1 L_k12_blk
	s_sub_u32 s47, s3, 10
	s_cmp_lt_u32 s3, 91
	s_cbranch_scc1 L_k12_blk
	s_sub_u32 s47, s3, 91
	s_mul_i32 s47, s47, 3
	s_add_u32 s47, s47, 81
	s_add_u32 s46, s47, 1
	s_add_u32 s43, s47, 2
L_k12_blk:
	s_cmp_eq_u32 s47, 255
	s_cbranch_scc1 L_k12_none
	s_mul_i32 s40, s47, 36864
	s_add_u32 s40, s40, s33
	s_add_u32 m0, s32, 0
	s_nop 0
	buffer_load_dwordx4 v6, s[20:23], s40 offen lds
	s_add_u32 m0, m0, 1024
	s_nop 0
	buffer_load_dwordx4 v7, s[20:23], s40 offen lds
	s_add_u32 m0, m0, 1024
	s_nop 0
	buffer_load_dwordx4 v8, s[20:23], s40 offen lds
	s_add_u32 m0, m0, 1024
	s_nop 0
	buffer_load_dwordx4 v9, s[20:23], s40 offen lds
	s_add_u32 m0, m0, 1024
	s_nop 0
	buffer_load_dwordx4 v10, s[20:23], s40 offen lds
	s_add_u32 m0, m0, 1024
	s_nop 0
	buffer_load_dwordx4 v11, s[20:23], s40 offen lds
	s_add_u32 m0, m0, 1024
	s_nop 0
	buffer_load_dwordx4 v12, s[20:23], s40 offen lds
	s_add_u32 m0, m0, 1024
	s_nop 0
	buffer_load_dwordx4 v13, s[20:23], s40 offen lds
	s_add_u32 m0, m0, 1024
	s_nop 0
	buffer_load_dwordx4 v14, s[20:23], s40 offen lds
	s_cmp_eq_u32 s46, 255
	s_cbranch_scc1 L_k12_one
	s_mul_i32 s40, s46, 36864
	s_add_u32 s40, s40, s33
	s_add_u32 m0, s32, 9216
	s_nop 0
	buffer_load_dwordx4 v6, s[20:23], s40 offen lds
	s_add_u32 m0, m0, 1024
	s_nop 0
	buffer_load_dwordx4 v7, s[20:23], s40 offen lds
	s_add_u32 m0, m0, 1024
	s_nop 0
	buffer_load_dwordx4 v8, s[20:23], s40 offen lds
	s_add_u32 m0, m0, 1024
	s_nop 0
	buffer_load_dwordx4 v9, s[20:23], s40 offen lds
	s_add_u32 m0, m0, 1024
	s_nop 0
	buffer_load_dwordx4 v10, s[20:23], s40 offen lds
	s_add_u32 m0, m0, 1024
	s_nop 0
	buffer_load_dwordx4 v11, s[20:23], s40 offen lds
	s_add_u32 m0, m0, 1024
	s_nop 0
	buffer_load_dwordx4 v12, s[20:23], s40 offen lds
	s_add_u32 m0, m0, 1024
	s_nop 0
	buffer_load_dwordx4 v13, s[20:23], s40 offen lds
	s_add_u32 m0, m0, 1024
	s_nop 0
	buffer_load_dwordx4 v14, s[20:23], s40 offen lds
	s_mul_i32 s40, s43, 36864
	s_add_u32 s40, s40, s33
	s_add_u32 m0, s32, 18432
	s_nop 0
	buffer_load_dwordx4 v6, s[20:23], s40 offen lds
	s_add_u32 m0, m0, 1024
	s_nop 0
	buffer_load_dwordx4 v7, s[20:23], s40 offen lds
	s_add_u32 m0, m0, 1024
	s_nop 0
	buffer_load_dwordx4 v8, s[20:23], s40 offen lds
	s_add_u32 m0, m0, 1024
	s_nop 0
	buffer_load_dwordx4 v9, s[20:23], s40 offen lds
	s_add_u32 m0, m0, 1024
	s_nop 0
	buffer_load_dwordx4 v10, s[20:23], s40 offen lds
	s_add_u32 m0, m0, 1024
	s_nop 0
	buffer_load_dwordx4 v11, s[20:23], s40 offen lds
	s_add_u32 m0, m0, 1024
	s_nop 0
	buffer_load_dwordx4 v12, s[20:23], s40 offen lds
	s_add_u32 m0, m0, 1024
	s_nop 0
	buffer_load_dwordx4 v13, s[20:23], s40 offen lds
	s_add_u32 m0, m0, 1024
	s_nop 0
	buffer_load_dwordx4 v14, s[20:23], s40 offen lds
	s_waitcnt vmcnt(18)
	ds_read_b64_tr_b16 v[32:33], v16 offset:0
	ds_read_b64_tr_b16 v[34:35], v16 offset:2304
	ds_read_b64_tr_b16 v[36:37], v16 offset:32
	ds_read_b64_tr_b16 v[38:39], v16 offset:2336
	ds_read_b64_tr_b16 v[40:41], v16 offset:64
	ds_read_b64_tr_b16 v[42:43], v16 offset:2368
	ds_read_b64_tr_b16 v[44:45], v16 offset:96
	ds_read_b64_tr_b16 v[46:47], v16 offset:2400
	ds_read_b64_tr_b16 v[48:49], v16 offset:128
	ds_read_b64_tr_b16 v[50:51], v16 offset:2432
	ds_read_b64_tr_b16 v[52:53], v16 offset:160
	ds_read_b64_tr_b16 v[54:55], v16 offset:2464
	ds_read_b64_tr_b16 v[56:57], v16 offset:192
	ds_read_b64_tr_b16 v[58:59], v16 offset:2496
	ds_read_b64_tr_b16 v[60:61], v16 offset:224
	ds_read_b64_tr_b16 v[62:63], v16 offset:2528
	ds_read_b64_tr_b16 v[64:65], v16 offset:256
	ds_read_b64_tr_b16 v[66:67], v16 offset:2560
	s_mul_i32 s41, s47, 9216
	s_add_u32 s41, s41, s34
	s_waitcnt lgkmcnt(15)
	s_add_u32 s42, s41, 0
	buffer_store_dwordx4 v[32:35], v15, s[36:39], s42 offen sc1
	s_waitcnt lgkmcnt(14)
	s_add_u32 s42, s41, 1024
	buffer_store_dwordx4 v[36:39], v15, s[36:39], s42 offen sc1
	s_waitcnt lgkmcnt(12)
	s_add_u32 s42, s41, 2048
	buffer_store_dwordx4 v[40:43], v15, s[36:39], s42 offen sc1
	s_waitcnt lgkmcnt(10)
	s_add_u32 s42, s41, 3072
	buffer_store_dwordx4 v[44:47], v15, s[36:39], s42 offen sc1
	s_waitcnt lgkmcnt(8)
	s_add_u32 s42, s41, 4096
	buffer_store_dwordx4 v[48:51], v15, s[36:39], s42 offen sc1
	s_waitcnt lgkmcnt(6)
	s_add_u32 s42, s41, 5120
	buffer_store_dwordx4 v[52:55], v15, s[36:39], s42 offen sc1
	s_waitcnt lgkmcnt(4)
	s_add_u32 s42, s41, 6144
	buffer_store_dwordx4 v[56:59], v15, s[36:39], s42 offen sc1
	s_waitcnt lgkmcnt(2)
	s_add_u32 s42, s41, 7168
	buffer_store_dwordx4 v[60:63], v15, s[36:39], s42 offen sc1
	s_waitcnt lgkmcnt(0)
	s_add_u32 s42, s41, 8192
	buffer_store_dwordx4 v[64:67], v15, s[36:39], s42 offen sc1
	s_waitcnt vmcnt(18)
	ds_read_b64_tr_b16 v[32:33], v16 offset:9216
	ds_read_b64_tr_b16 v[34:35], v16 offset:11520
	ds_read_b64_tr_b16 v[36:37], v16 offset:9248
	ds_read_b64_tr_b16 v[38:39], v16 offset:11552
	ds_read_b64_tr_b16 v[40:41], v16 offset:9280
	ds_read_b64_tr_b16 v[42:43], v16 offset:11584
	ds_read_b64_tr_b16 v[44:45], v16 offset:9312
	ds_read_b64_tr_b16 v[46:47], v16 offset:11616
	ds_read_b64_tr_b16 v[48:49], v16 offset:9344
	ds_read_b64_tr_b16 v[50:51], v16 offset:11648
	ds_read_b64_tr_b16 v[52:53], v16 offset:9376
	ds_read_b64_tr_b16 v[54:55], v16 offset:11680
	ds_read_b64_tr_b16 v[56:57], v16 offset:9408
	ds_read_b64_tr_b16 v[58:59], v16 offset:11712
	ds_read_b64_tr_b16 v[60:61], v16 offset:9440
	ds_read_b64_tr_b16 v[62:63], v16 offset:11744
	ds_read_b64_tr_b16 v[64:65], v16 offset:9472
	ds_read_b64_tr_b16 v[66:67], v16 offset:11776
	s_mul_i32 s41, s46, 9216
	s_add_u32 s41, s41, s34
	s_waitcnt lgkmcnt(15)
	s_add_u32 s42, s41, 0
	buffer_store_dwordx4 v[32:35], v15, s[36:39], s42 offen sc1
	s_waitcnt lgkmcnt(14)
	s_add_u32 s42, s41, 1024
	buffer_store_dwordx4 v[36:39], v15, s[36:39], s42 offen sc1
	s_waitcnt lgkmcnt(12)
	s_add_u32 s42, s41, 2048
	buffer_store_dwordx4 v[40:43], v15, s[36:39], s42 offen sc1
	s_waitcnt lgkmcnt(10)
	s_add_u32 s42, s41, 3072
	buffer_store_dwordx4 v[44:47], v15, s[36:39], s42 offen sc1
	s_waitcnt lgkmcnt(8)
	s_add_u32 s42, s41, 4096
	buffer_store_dwordx4 v[48:51], v15, s[36:39], s42 offen sc1
	s_waitcnt lgkmcnt(6)
	s_add_u32 s42, s41, 5120
	buffer_store_dwordx4 v[52:55], v15, s[36:39], s42 offen sc1
	s_waitcnt lgkmcnt(4)
	s_add_u32 s42, s41, 6144
	buffer_store_dwordx4 v[56:59], v15, s[36:39], s42 offen sc1
	s_waitcnt lgkmcnt(2)
	s_add_u32 s42, s41, 7168
	buffer_store_dwordx4 v[60:63], v15, s[36:39], s42 offen sc1
	s_waitcnt lgkmcnt(0)
	s_add_u32 s42, s41, 8192
	buffer_store_dwordx4 v[64:67], v15, s[36:39], s42 offen sc1
	s_waitcnt vmcnt(18)
	ds_read_b64_tr_b16 v[32:33], v16 offset:18432
	ds_read_b64_tr_b16 v[34:35], v16 offset:20736
	ds_read_b64_tr_b16 v[36:37], v16 offset:18464
	ds_read_b64_tr_b16 v[38:39], v16 offset:20768
	ds_read_b64_tr_b16 v[40:41], v16 offset:18496
	ds_read_b64_tr_b16 v[42:43], v16 offset:20800
	ds_read_b64_tr_b16 v[44:45], v16 offset:18528
	ds_read_b64_tr_b16 v[46:47], v16 offset:20832
	ds_read_b64_tr_b16 v[48:49], v16 offset:18560
	ds_read_b64_tr_b16 v[50:51], v16 offset:20864
	ds_read_b64_tr_b16 v[52:53], v16 offset:18592
	ds_read_b64_tr_b16 v[54:55], v16 offset:20896
	ds_read_b64_tr_b16 v[56:57], v16 offset:18624
	ds_read_b64_tr_b16 v[58:59], v16 offset:20928
	ds_read_b64_tr_b16 v[60:61], v16 offset:18656
	ds_read_b64_tr_b16 v[62:63], v16 offset:20960
	ds_read_b64_tr_b16 v[64:65], v16 offset:18688
	ds_read_b64_tr_b16 v[66:67], v16 offset:20992
	s_mul_i32 s41, s43, 9216
	s_add_u32 s41, s41, s34
	s_waitcnt lgkmcnt(15)
	s_add_u32 s42, s41, 0
	buffer_store_dwordx4 v[32:35], v15, s[36:39], s42 offen sc1
	s_waitcnt lgkmcnt(14)
	s_add_u32 s42, s41, 1024
	buffer_store_dwordx4 v[36:39], v15, s[36:39], s42 offen sc1
	s_waitcnt lgkmcnt(12)
	s_add_u32 s42, s41, 2048
	buffer_store_dwordx4 v[40:43], v15, s[36:39], s42 offen sc1
	s_waitcnt lgkmcnt(10)
	s_add_u32 s42, s41, 3072
	buffer_store_dwordx4 v[44:47], v15, s[36:39], s42 offen sc1
	s_waitcnt lgkmcnt(8)
	s_add_u32 s42, s41, 4096
	buffer_store_dwordx4 v[48:51], v15, s[36:39], s42 offen sc1
	s_waitcnt lgkmcnt(6)
	s_add_u32 s42, s41, 5120
	buffer_store_dwordx4 v[52:55], v15, s[36:39], s42 offen sc1
	s_waitcnt lgkmcnt(4)
	s_add_u32 s42, s41, 6144
	buffer_store_dwordx4 v[56:59], v15, s[36:39], s42 offen sc1
	s_waitcnt lgkmcnt(2)
	s_add_u32 s42, s41, 7168
	buffer_store_dwordx4 v[60:63], v15, s[36:39], s42 offen sc1
	s_waitcnt lgkmcnt(0)
	s_add_u32 s42, s41, 8192
	buffer_store_dwordx4 v[64:67], v15, s[36:39], s42 offen sc1
	s_cmp_lg_u32 s25, 0
	s_cbranch_scc1 L_k12_tlb1678
	s_load_dwordx2 s[48:49], s[0:1], 120
	v_lshlrev_b32 v80, 20, v1
	s_waitcnt lgkmcnt(0)
	s_mov_b32 s52, s48
	s_mov_b32 s53, s49
	s_mov_b32 s54, 2359296
	s_mov_b32 s55, 0x20000
	s_mov_b32 s56, 0
	buffer_load_dword v81, v80, s[36:39], s56 offen
	s_mov_b32 s56, 0
	buffer_load_dword v82, v80, s[52:55], s56 offen
	s_mov_b32 s56, 0
	buffer_load_dword v83, v80, s[12:15], s56 offen
	s_mov_b32 s56, 0
	buffer_load_dword v84, v80, s[16:19], s56 offen
	s_mov_b32 s56, 0
	buffer_load_dword v85, v80, s[20:23], s56 offen
L_k12_tlb1678:
	buffer_load_dword v76, v3, s[12:15], 0 offen
	buffer_load_dword v77, v4, s[12:15], 0 offen
	buffer_load_dword v78, v3, s[16:19], 0 offen
	buffer_load_dword v79, v4, s[16:19], 0 offen
	s_endpgm
L_k12_one:
	s_waitcnt vmcnt(0)
	ds_read_b64_tr_b16 v[32:33], v16 offset:0
	ds_read_b64_tr_b16 v[34:35], v16 offset:2304
	ds_read_b64_tr_b16 v[36:37], v16 offset:32
	ds_read_b64_tr_b16 v[38:39], v16 offset:2336
	ds_read_b64_tr_b16 v[40:41], v16 offset:64
	ds_read_b64_tr_b16 v[42:43], v16 offset:2368
	ds_read_b64_tr_b16 v[44:45], v16 offset:96
	ds_read_b64_tr_b16 v[46:47], v16 offset:2400
	ds_read_b64_tr_b16 v[48:49], v16 offset:128
	ds_read_b64_tr_b16 v[50:51], v16 offset:2432
	ds_read_b64_tr_b16 v[52:53], v16 offset:160
	ds_read_b64_tr_b16 v[54:55], v16 offset:2464
	ds_read_b64_tr_b16 v[56:57], v16 offset:192
	ds_read_b64_tr_b16 v[58:59], v16 offset:2496
	ds_read_b64_tr_b16 v[60:61], v16 offset:224
	ds_read_b64_tr_b16 v[62:63], v16 offset:2528
	ds_read_b64_tr_b16 v[64:65], v16 offset:256
	ds_read_b64_tr_b16 v[66:67], v16 offset:2560
	s_mul_i32 s41, s47, 9216
	s_add_u32 s41, s41, s34
	s_waitcnt lgkmcnt(15)
	s_add_u32 s42, s41, 0
	buffer_store_dwordx4 v[32:35], v15, s[36:39], s42 offen sc1
	s_waitcnt lgkmcnt(14)
	s_add_u32 s42, s41, 1024
	buffer_store_dwordx4 v[36:39], v15, s[36:39], s42 offen sc1
	s_waitcnt lgkmcnt(12)
	s_add_u32 s42, s41, 2048
	buffer_store_dwordx4 v[40:43], v15, s[36:39], s42 offen sc1
	s_waitcnt lgkmcnt(10)
	s_add_u32 s42, s41, 3072
	buffer_store_dwordx4 v[44:47], v15, s[36:39], s42 offen sc1
	s_waitcnt lgkmcnt(8)
	s_add_u32 s42, s41, 4096
	buffer_store_dwordx4 v[48:51], v15, s[36:39], s42 offen sc1
	s_waitcnt lgkmcnt(6)
	s_add_u32 s42, s41, 5120
	buffer_store_dwordx4 v[52:55], v15, s[36:39], s42 offen sc1
	s_waitcnt lgkmcnt(4)
	s_add_u32 s42, s41, 6144
	buffer_store_dwordx4 v[56:59], v15, s[36:39], s42 offen sc1
	s_waitcnt lgkmcnt(2)
	s_add_u32 s42, s41, 7168
	buffer_store_dwordx4 v[60:63], v15, s[36:39], s42 offen sc1
	s_waitcnt lgkmcnt(0)
	s_add_u32 s42, s41, 8192
	buffer_store_dwordx4 v[64:67], v15, s[36:39], s42 offen sc1
	s_cmp_lg_u32 s25, 0
	s_cbranch_scc1 L_k12_tlb1752
	s_load_dwordx2 s[48:49], s[0:1], 120
	v_lshlrev_b32 v80, 20, v1
	s_waitcnt lgkmcnt(0)
	s_mov_b32 s52, s48
	s_mov_b32 s53, s49
	s_mov_b32 s54, 2359296
	s_mov_b32 s55, 0x20000
	s_mov_b32 s56, 0
	buffer_load_dword v81, v80, s[36:39], s56 offen
	s_mov_b32 s56, 0
	buffer_load_dword v82, v80, s[52:55], s56 offen
	s_mov_b32 s56, 0
	buffer_load_dword v83, v80, s[12:15], s56 offen
	s_mov_b32 s56, 0
	buffer_load_dword v84, v80, s[16:19], s56 offen
	s_mov_b32 s56, 0
	buffer_load_dword v85, v80, s[20:23], s56 offen
L_k12_tlb1752:
	buffer_load_dword v76, v3, s[12:15], 0 offen
	buffer_load_dword v77, v4, s[12:15], 0 offen
	buffer_load_dword v78, v3, s[16:19], 0 offen
	buffer_load_dword v79, v4, s[16:19], 0 offen
	s_endpgm
L_k12_none:
	s_cmp_lg_u32 s25, 0
	s_cbranch_scc1 L_k12_tlb1778
	s_load_dwordx2 s[48:49], s[0:1], 120
	v_lshlrev_b32 v80, 20, v1
	s_waitcnt lgkmcnt(0)
	s_mov_b32 s52, s48
	s_mov_b32 s53, s49
	s_mov_b32 s54, 2359296
	s_mov_b32 s55, 0x20000
	s_mov_b32 s56, 0
	buffer_load_dword v81, v80, s[36:39], s56 offen
	s_mov_b32 s56, 0
	buffer_load_dword v82, v80, s[52:55], s56 offen
	s_mov_b32 s56, 0
	buffer_load_dword v83, v80, s[12:15], s56 offen
	s_mov_b32 s56, 0
	buffer_load_dword v84, v80, s[16:19], s56 offen
	s_mov_b32 s56, 0
	buffer_load_dword v85, v80, s[20:23], s56 offen
L_k12_tlb1778:
	buffer_load_dword v76, v3, s[12:15], 0 offen
	buffer_load_dword v77, v4, s[12:15], 0 offen
	buffer_load_dword v78, v3, s[16:19], 0 offen
	buffer_load_dword v79, v4, s[16:19], 0 offen
	s_endpgm
L_k12_C:
	s_load_dwordx4 s[4:7], s[0:1], 8
	s_load_dwordx4 s[8:11], s[0:1], 24
	s_load_dwordx4 s[12:15], s[0:1], 40
	s_load_dwordx4 s[16:19], s[0:1], 56
	s_load_dwordx2 s[24:25], s[0:1], 136
	s_load_dwordx2 s[26:27], s[0:1], 128
	v_lshrrev_b32 v2, 6, v0
	v_and_b32 v1, 63, v0
	s_sub_u32 s3, s2, 112
	v_readfirstlane_b32 s20, v2
	s_nop 3
	s_lshl_b32 s21, s3, 2
	s_add_u32 s21, s21, s20
	s_mul_i32 s22, s20, 39936
	s_lshl_b32 s23, s21, 8
	v_lshl_add_u32 v4, v1, 2, s23
	s_lshl_b32 s23, s21, 1
	v_mov_b32 v5, s23
	s_getpc_b64 s[28:29]
L_k12C_pc:
	s_add_u32 s28, s28, K1_TBL-L_k12C_pc
	s_addc_u32 s29, s29, 0
	s_waitcnt lgkmcnt(0)
	global_load_dword v110, v4, s[4:5]
	global_load_dword v111, v4, s[6:7]
	global_load_dword v112, v4, s[8:9]
	global_load_dword v113, v4, s[10:11]
	global_load_dword v114, v4, s[12:13]
	global_load_dword v115, v4, s[14:15]
	global_load_ushort v116, v5, s[16:17]
	global_load_ushort v117, v5, s[18:19]
	v_lshlrev_b32 v6, 4, v1
	v_min_u32 v7, 256, v6
	v_add_u32 v7, 4096, v7
	global_load_dwordx4 v[200:203], v6, s[28:29] offset:0
	global_load_ushort v204, v6, s[28:29] offset:16
	global_load_dwordx4 v[206:209], v6, s[28:29] offset:1024
	global_load_ushort v210, v6, s[28:29] offset:1040
	global_load_dwordx4 v[212:215], v6, s[28:29] offset:2048
	global_load_ushort v216, v6, s[28:29] offset:2064
	global_load_dwordx4 v[218:221], v6, s[28:29] offset:3072
	global_load_ushort v222, v6, s[28:29] offset:3088
	global_load_dwordx4 v[224:227], v7, s[28:29]
	global_load_ushort v228, v7, s[28:29] offset:16
	s_mov_b32 s32, s24
	s_mov_b32 s33, s25
	s_mov_b32 s34, 48168960
	s_mov_b32 s35, 0x20000
	v_lshl_add_u32 v8, v1, 3, s22
	s_mov_b32 s31, 0x3fb8aa3b
	s_mov_b32 s36, 0x3e22f983
	s_mov_b32 s58, 0xffff0000
	s_waitcnt vmcnt(10)
	v_lshlrev_b32 v116, 16, v116
	v_lshlrev_b32 v117, 16, v117
	v_mul_f32 v116, s31, v116
	v_exp_f32 v116, v116
	s_nop 0
	v_cvt_pk_bf16_f32 v116, v116, v116
	v_lshlrev_b32 v116, 16, v116
	v_readfirstlane_b32 s28, v117
	v_lshlrev_b32 v10, 16, v110
	v_and_b32 v60, s58, v110
	v_lshlrev_b32 v11, 16, v111
	v_and_b32 v61, s58, v111
	v_lshlrev_b32 v12, 16, v112
	v_and_b32 v62, s58, v112
	v_lshlrev_b32 v13, 16, v113
	v_and_b32 v63, s58, v113
	v_lshlrev_b32 v14, 16, v114
	v_and_b32 v64, s58, v114
	v_lshlrev_b32 v15, 16, v115
	v_and_b32 v65, s58, v115
	v_mul_f32 v10, v116, v10
	v_mul_f32 v60, v116, v60
	v_mul_f32 v11, v116, v11
	v_mul_f32 v61, v116, v61
	v_mul_f32 v12, v116, v12
	v_mul_f32 v62, v116, v62
	v_mul_f32 v13, v116, v13
	v_mul_f32 v63, v116, v63
	v_mul_f32 v20, v14, v12
	v_mul_f32 v70, v64, v62
	v_mul_f32 v21, v14, v13
	v_mul_f32 v71, v64, v63
	v_fma_f32 v20, -v15, v13, v20
	v_fma_f32 v70, -v65, v63, v70
	v_fma_f32 v21, v15, v12, v21
	v_fma_f32 v71, v65, v62, v71
	v_mul_f32 v10, s31, v10
	v_mul_f32 v60, s31, v60
	v_mul_f32 v11, s36, v11
	v_mul_f32 v61, s36, v61
	v_mov_b32 v17, v10
	v_mov_b32 v67, v60
	v_mov_b32 v18, v11
	v_mov_b32 v68, v61
	v_rndne_f32 v19, v18
	v_rndne_f32 v69, v68
	v_exp_f32 v17, v17
	v_exp_f32 v67, v67
	v_sub_f32 v18, v18, v19
	v_sub_f32 v68, v68, v69
	v_cos_f32 v22, v18
	v_cos_f32 v72, v68
	v_sin_f32 v23, v18
	v_sin_f32 v73, v68
	v_mul_f32 v22, v17, v22
	v_mul_f32 v72, v67, v72
	v_mul_f32 v23, v17, v23
	v_mul_f32 v73, v67, v73
	v_mul_f32 v17, 0x43800000, v10
	v_mul_f32 v67, 0x43800000, v60
	v_mul_f32 v18, 0x43800000, v11
	v_mul_f32 v68, 0x43800000, v61
	v_rndne_f32 v19, v18
	v_rndne_f32 v69, v68
	v_exp_f32 v17, v17
	v_exp_f32 v67, v67
	v_sub_f32 v18, v18, v19
	v_sub_f32 v68, v68, v69
	v_cos_f32 v24, v18
	v_cos_f32 v74, v68
	v_sin_f32 v25, v18
	v_sin_f32 v75, v68
	v_mul_f32 v24, v17, v24
	v_mul_f32 v74, v67, v74
	v_mul_f32 v25, v17, v25
	v_mul_f32 v75, v67, v75
	v_sub_f32 v44, 0, v23
	v_sub_f32 v94, 0, v73
	v_mov_b32 v45, v23
	v_mov_b32 v95, v73
	v_sub_f32 v46, 0, v25
	v_sub_f32 v96, 0, v75
	v_mov_b32 v47, v25
	v_mov_b32 v97, v75
	v_pk_mul_f32 v[26:27], v[22:23], v[22:23] op_sel:[0,0] op_sel_hi:[1,0]
	v_pk_mul_f32 v[76:77], v[72:73], v[72:73] op_sel:[0,0] op_sel_hi:[1,0]
	v_pk_fma_f32 v[26:27], v[22:23], v[44:45], v[26:27] op_sel:[1,0,0] op_sel_hi:[0,1,1]
	v_pk_fma_f32 v[76:77], v[72:73], v[94:95], v[76:77] op_sel:[1,0,0] op_sel_hi:[0,1,1]
	v_sub_f32 v48, 0, v27
	v_sub_f32 v98, 0, v77
	v_mov_b32 v49, v27
	v_mov_b32 v99, v77
	v_pk_mul_f32 v[28:29], v[26:27], v[26:27] op_sel:[0,0] op_sel_hi:[1,0]
	v_pk_mul_f32 v[78:79], v[76:77], v[76:77] op_sel:[0,0] op_sel_hi:[1,0]
	v_pk_fma_f32 v[28:29], v[26:27], v[48:49], v[28:29] op_sel:[1,0,0] op_sel_hi:[0,1,1]
	v_pk_fma_f32 v[78:79], v[76:77], v[98:99], v[78:79] op_sel:[1,0,0] op_sel_hi:[0,1,1]
	v_sub_f32 v50, 0, v29
	v_sub_f32 v100, 0, v79
	v_mov_b32 v51, v29
	v_mov_b32 v101, v79
	v_pk_mul_f32 v[30:31], v[28:29], v[28:29] op_sel:[0,0] op_sel_hi:[1,0]
	v_pk_mul_f32 v[80:81], v[78:79], v[78:79] op_sel:[0,0] op_sel_hi:[1,0]
	v_pk_fma_f32 v[30:31], v[28:29], v[50:51], v[30:31] op_sel:[1,0,0] op_sel_hi:[0,1,1]
	v_pk_fma_f32 v[80:81], v[78:79], v[100:101], v[80:81] op_sel:[1,0,0] op_sel_hi:[0,1,1]
	v_sub_f32 v52, 0, v31
	v_sub_f32 v102, 0, v81
	v_mov_b32 v53, v31
	v_mov_b32 v103, v81
	v_cvt_pk_bf16_f32 v120, v20, -v21
	v_cvt_pk_bf16_f32 v121, v70, -v71
	ds_write_b64 v8, v[120:121] offset:0
	v_pk_mul_f32 v[32:33], v[20:21], v[22:23] op_sel:[0,0] op_sel_hi:[1,0]
	v_pk_mul_f32 v[82:83], v[70:71], v[72:73] op_sel:[0,0] op_sel_hi:[1,0]
	v_pk_fma_f32 v[32:33], v[20:21], v[44:45], v[32:33] op_sel:[1,0,0] op_sel_hi:[0,1,1]
	v_pk_fma_f32 v[82:83], v[70:71], v[94:95], v[82:83] op_sel:[1,0,0] op_sel_hi:[0,1,1]
	v_cvt_pk_bf16_f32 v122, v32, -v33
	v_cvt_pk_bf16_f32 v123, v82, -v83
	ds_write_b64 v8, v[122:123] offset:528
	v_pk_mul_f32 v[34:35], v[32:33], v[22:23] op_sel:[0,0] op_sel_hi:[1,0]
	v_pk_mul_f32 v[84:85], v[82:83], v[72:73] op_sel:[0,0] op_sel_hi:[1,0]
	v_pk_fma_f32 v[34:35], v[32:33], v[44:45], v[34:35] op_sel:[1,0,0] op_sel_hi:[0,1,1]
	v_pk_fma_f32 v[84:85], v[82:83], v[94:95], v[84:85] op_sel:[1,0,0] op_sel_hi:[0,1,1]
	v_cvt_pk_bf16_f32 v124, v34, -v35
	v_cvt_pk_bf16_f32 v125, v84, -v85
	ds_write_b64 v8, v[124:125] offset:1056
	v_pk_mul_f32 v[32:33], v[34:35], v[22:23] op_sel:[0,0] op_sel_hi:[1,0]
	v_pk_mul_f32 v[82:83], v[84:85], v[72:73] op_sel:[0,0] op_sel_hi:[1,0]
	v_pk_fma_f32 v[32:33], v[34:35], v[44:45], v[32:33] op_sel:[1,0,0] op_sel_hi:[0,1,1]
	v_pk_fma_f32 v[82:83], v[84:85], v[94:95], v[82:83] op_sel:[1,0,0] op_sel_hi:[0,1,1]
	v_cvt_pk_bf16_f32 v126, v32, -v33
	v_cvt_pk_bf16_f32 v127, v82, -v83
	ds_write_b64 v8, v[126:127] offset:1584
	v_pk_mul_f32 v[34:35], v[32:33], v[22:23] op_sel:[0,0] op_sel_hi:[1,0]
	v_pk_mul_f32 v[84:85], v[82:83], v[72:73] op_sel:[0,0] op_sel_hi:[1,0]
	v_pk_fma_f32 v[34:35], v[32:33], v[44:45], v[34:35] op_sel:[1,0,0] op_sel_hi:[0,1,1]
	v_pk_fma_f32 v[84:85], v[82:83], v[94:95], v[84:85] op_sel:[1,0,0] op_sel_hi:[0,1,1]
	v_cvt_pk_bf16_f32 v120, v34, -v35
	v_cvt_pk_bf16_f32 v121, v84, -v85
	ds_write_b64 v8, v[120:121] offset:2112
	v_pk_mul_f32 v[32:33], v[34:35], v[22:23] op_sel:[0,0] op_sel_hi:[1,0]
	v_pk_mul_f32 v[82:83], v[84:85], v[72:73] op_sel:[0,0] op_sel_hi:[1,0]
	v_pk_fma_f32 v[32:33], v[34:35], v[44:45], v[32:33] op_sel:[1,0,0] op_sel_hi:[0,1,1]
	v_pk_fma_f32 v[82:83], v[84:85], v[94:95], v[82:83] op_sel:[1,0,0] op_sel_hi:[0,1,1]
	v_cvt_pk_bf16_f32 v122, v32, -v33
	v_cvt_pk_bf16_f32 v123, v82, -v83
	ds_write_b64 v8, v[122:123] offset:2640
	v_pk_mul_f32 v[34:35], v[32:33], v[22:23] op_sel:[0,0] op_sel_hi:[1,0]
	v_pk_mul_f32 v[84:85], v[82:83], v[72:73] op_sel:[0,0] op_sel_hi:[1,0]
	v_pk_fma_f32 v[34:35], v[32:33], v[44:45], v[34:35] op_sel:[1,0,0] op_sel_hi:[0,1,1]
	v_pk_fma_f32 v[84:85], v[82:83], v[94:95], v[84:85] op_sel:[1,0,0] op_sel_hi:[0,1,1]
	v_cvt_pk_bf16_f32 v124, v34, -v35
	v_cvt_pk_bf16_f32 v125, v84, -v85
	ds_write_b64 v8, v[124:125] offset:3168
	v_pk_mul_f32 v[32:33], v[34:35], v[22:23] op_sel:[0,0] op_sel_hi:[1,0]
	v_pk_mul_f32 v[82:83], v[84:85], v[72:73] op_sel:[0,0] op_sel_hi:[1,0]
	v_pk_fma_f32 v[32:33], v[34:35], v[44:45], v[32:33] op_sel:[1,0,0] op_sel_hi:[0,1,1]
	v_pk_fma_f32 v[82:83], v[84:85], v[94:95], v[82:83] op_sel:[1,0,0] op_sel_hi:[0,1,1]
	v_cvt_pk_bf16_f32 v126, v32, -v33
	v_cvt_pk_bf16_f32 v127, v82, -v83
	ds_write_b64 v8, v[126:127] offset:3696
	v_pk_mul_f32 v[36:37], v[20:21], v[24:25] op_sel:[0,0] op_sel_hi:[1,0]
	v_pk_mul_f32 v[86:87], v[70:71], v[74:75] op_sel:[0,0] op_sel_hi:[1,0]
	v_pk_fma_f32 v[36:37], v[20:21], v[46:47], v[36:37] op_sel:[1,0,0] op_sel_hi:[0,1,1]
	v_pk_fma_f32 v[86:87], v[70:71], v[96:97], v[86:87] op_sel:[1,0,0] op_sel_hi:[0,1,1]
	v_cvt_pk_bf16_f32 v120, v36, -v37
	v_cvt_pk_bf16_f32 v121, v86, -v87
	ds_write_b64 v8, v[120:121] offset:4224
	v_pk_mul_f32 v[32:33], v[36:37], v[26:27] op_sel:[0,0] op_sel_hi:[1,0]
	v_pk_mul_f32 v[82:83], v[86:87], v[76:77] op_sel:[0,0] op_sel_hi:[1,0]
	v_pk_fma_f32 v[32:33], v[36:37], v[48:49], v[32:33] op_sel:[1,0,0] op_sel_hi:[0,1,1]
	v_pk_fma_f32 v[82:83], v[86:87], v[98:99], v[82:83] op_sel:[1,0,0] op_sel_hi:[0,1,1]
	v_cvt_pk_bf16_f32 v122, v32, -v33
	v_cvt_pk_bf16_f32 v123, v82, -v83
	ds_write_b64 v8, v[122:123] offset:4752
	v_pk_mul_f32 v[34:35], v[32:33], v[26:27] op_sel:[0,0] op_sel_hi:[1,0]
	v_pk_mul_f32 v[84:85], v[82:83], v[76:77] op_sel:[0,0] op_sel_hi:[1,0]
	v_pk_fma_f32 v[34:35], v[32:33], v[48:49], v[34:35] op_sel:[1,0,0] op_sel_hi:[0,1,1]
	v_pk_fma_f32 v[84:85], v[82:83], v[98:99], v[84:85] op_sel:[1,0,0] op_sel_hi:[0,1,1]
	v_cvt_pk_bf16_f32 v124, v34, -v35
	v_cvt_pk_bf16_f32 v125, v84, -v85
	ds_write_b64 v8, v[124:125] offset:5280
	v_pk_mul_f32 v[32:33], v[34:35], v[26:27] op_sel:[0,0] op_sel_hi:[1,0]
	v_pk_mul_f32 v[82:83], v[84:85], v[76:77] op_sel:[0,0] op_sel_hi:[1,0]
	v_pk_fma_f32 v[32:33], v[34:35], v[48:49], v[32:33] op_sel:[1,0,0] op_sel_hi:[0,1,1]
	v_pk_fma_f32 v[82:83], v[84:85], v[98:99], v[82:83] op_sel:[1,0,0] op_sel_hi:[0,1,1]
	v_cvt_pk_bf16_f32 v126, v32, -v33
	v_cvt_pk_bf16_f32 v127, v82, -v83
	ds_write_b64 v8, v[126:127] offset:5808
	v_pk_mul_f32 v[38:39], v[36:37], v[24:25] op_sel:[0,0] op_sel_hi:[1,0]
	v_pk_mul_f32 v[88:89], v[86:87], v[74:75] op_sel:[0,0] op_sel_hi:[1,0]
	v_pk_fma_f32 v[38:39], v[36:37], v[46:47], v[38:39] op_sel:[1,0,0] op_sel_hi:[0,1,1]
	v_pk_fma_f32 v[88:89], v[86:87], v[96:97], v[88:89] op_sel:[1,0,0] op_sel_hi:[0,1,1]
	v_cvt_pk_bf16_f32 v120, v38, -v39
	v_cvt_pk_bf16_f32 v121, v88, -v89
	ds_write_b64 v8, v[120:121] offset:6336
	v_pk_mul_f32 v[32:33], v[38:39], v[28:29] op_sel:[0,0] op_sel_hi:[1,0]
	v_pk_mul_f32 v[82:83], v[88:89], v[78:79] op_sel:[0,0] op_sel_hi:[1,0]
	v_pk_fma_f32 v[32:33], v[38:39], v[50:51], v[32:33] op_sel:[1,0,0] op_sel_hi:[0,1,1]
	v_pk_fma_f32 v[82:83], v[88:89], v[100:101], v[82:83] op_sel:[1,0,0] op_sel_hi:[0,1,1]
	v_cvt_pk_bf16_f32 v122, v32, -v33
	v_cvt_pk_bf16_f32 v123, v82, -v83
	ds_write_b64 v8, v[122:123] offset:6864
	v_pk_mul_f32 v[36:37], v[38:39], v[24:25] op_sel:[0,0] op_sel_hi:[1,0]
	v_pk_mul_f32 v[86:87], v[88:89], v[74:75] op_sel:[0,0] op_sel_hi:[1,0]
	v_pk_fma_f32 v[36:37], v[38:39], v[46:47], v[36:37] op_sel:[1,0,0] op_sel_hi:[0,1,1]
	v_pk_fma_f32 v[86:87], v[88:89], v[96:97], v[86:87] op_sel:[1,0,0] op_sel_hi:[0,1,1]
	v_cvt_pk_bf16_f32 v124, v36, -v37
	v_cvt_pk_bf16_f32 v125, v86, -v87
	ds_write_b64 v8, v[124:125] offset:7392
	v_pk_mul_f32 v[32:33], v[36:37], v[28:29] op_sel:[0,0] op_sel_hi:[1,0]
	v_pk_mul_f32 v[82:83], v[86:87], v[78:79] op_sel:[0,0] op_sel_hi:[1,0]
	v_pk_fma_f32 v[32:33], v[36:37], v[50:51], v[32:33] op_sel:[1,0,0] op_sel_hi:[0,1,1]
	v_pk_fma_f32 v[82:83], v[86:87], v[100:101], v[82:83] op_sel:[1,0,0] op_sel_hi:[0,1,1]
	v_cvt_pk_bf16_f32 v126, v32, -v33
	v_cvt_pk_bf16_f32 v127, v82, -v83
	ds_write_b64 v8, v[126:127] offset:7920
	v_pk_mul_f32 v[38:39], v[36:37], v[24:25] op_sel:[0,0] op_sel_hi:[1,0]
	v_pk_mul_f32 v[88:89], v[86:87], v[74:75] op_sel:[0,0] op_sel_hi:[1,0]
	v_pk_fma_f32 v[38:39], v[36:37], v[46:47], v[38:39] op_sel:[1,0,0] op_sel_hi:[0,1,1]
	v_pk_fma_f32 v[88:89], v[86:87], v[96:97], v[88:89] op_sel:[1,0,0] op_sel_hi:[0,1,1]
	v_cvt_pk_bf16_f32 v120, v38, -v39
	v_cvt_pk_bf16_f32 v121, v88, -v89
	ds_write_b64 v8, v[120:121] offset:8448
	v_pk_mul_f32 v[36:37], v[38:39], v[24:25] op_sel:[0,0] op_sel_hi:[1,0]
	v_pk_mul_f32 v[86:87], v[88:89], v[74:75] op_sel:[0,0] op_sel_hi:[1,0]
	v_pk_fma_f32 v[36:37], v[38:39], v[46:47], v[36:37] op_sel:[1,0,0] op_sel_hi:[0,1,1]
	v_pk_fma_f32 v[86:87], v[88:89], v[96:97], v[86:87] op_sel:[1,0,0] op_sel_hi:[0,1,1]
	v_cvt_pk_bf16_f32 v122, v36, -v37
	v_cvt_pk_bf16_f32 v123, v86, -v87
	ds_write_b64 v8, v[122:123] offset:8976
	v_pk_mul_f32 v[38:39], v[36:37], v[24:25] op_sel:[0,0] op_sel_hi:[1,0]
	v_pk_mul_f32 v[88:89], v[86:87], v[74:75] op_sel:[0,0] op_sel_hi:[1,0]
	v_pk_fma_f32 v[38:39], v[36:37], v[46:47], v[38:39] op_sel:[1,0,0] op_sel_hi:[0,1,1]
	v_pk_fma_f32 v[88:89], v[86:87], v[96:97], v[88:89] op_sel:[1,0,0] op_sel_hi:[0,1,1]
	v_cvt_pk_bf16_f32 v124, v38, -v39
	v_cvt_pk_bf16_f32 v125, v88, -v89
	ds_write_b64 v8, v[124:125] offset:9504
	v_pk_mul_f32 v[36:37], v[38:39], v[24:25] op_sel:[0,0] op_sel_hi:[1,0]
	v_pk_mul_f32 v[86:87], v[88:89], v[74:75] op_sel:[0,0] op_sel_hi:[1,0]
	v_pk_fma_f32 v[36:37], v[38:39], v[46:47], v[36:37] op_sel:[1,0,0] op_sel_hi:[0,1,1]
	v_pk_fma_f32 v[86:87], v[88:89], v[96:97], v[86:87] op_sel:[1,0,0] op_sel_hi:[0,1,1]
	v_cvt_pk_bf16_f32 v126, v36, -v37
	v_cvt_pk_bf16_f32 v127, v86, -v87
	ds_write_b64 v8, v[126:127] offset:10032
	v_pk_mul_f32 v[38:39], v[36:37], v[24:25] op_sel:[0,0] op_sel_hi:[1,0]
	v_pk_mul_f32 v[88:89], v[86:87], v[74:75] op_sel:[0,0] op_sel_hi:[1,0]
	v_pk_fma_f32 v[38:39], v[36:37], v[46:47], v[38:39] op_sel:[1,0,0] op_sel_hi:[0,1,1]
	v_pk_fma_f32 v[88:89], v[86:87], v[96:97], v[88:89] op_sel:[1,0,0] op_sel_hi:[0,1,1]
	v_cvt_pk_bf16_f32 v120, v38, -v39
	v_cvt_pk_bf16_f32 v121, v88, -v89
	ds_write_b64 v8, v[120:121] offset:10560
	v_mov_b32 v32, 1.0
	v_mov_b32 v82, 1.0
	v_mov_b32 v33, 0
	v_mov_b32 v83, 0
	v_cvt_pk_bf16_f32 v122, v32, v33
	v_cvt_pk_bf16_f32 v123, v82, v83
	ds_write_b64 v8, v[122:123] offset:12672
	v_cvt_pk_bf16_f32 v124, v30, v31
	v_cvt_pk_bf16_f32 v125, v80, v81
	ds_write_b64 v8, v[124:125] offset:13200
	v_pk_mul_f32 v[32:33], v[30:31], v[30:31] op_sel:[0,0] op_sel_hi:[1,0]
	v_pk_mul_f32 v[82:83], v[80:81], v[80:81] op_sel:[0,0] op_sel_hi:[1,0]
	v_pk_fma_f32 v[32:33], v[30:31], v[52:53], v[32:33] op_sel:[1,0,0] op_sel_hi:[0,1,1]
	v_pk_fma_f32 v[82:83], v[80:81], v[102:103], v[82:83] op_sel:[1,0,0] op_sel_hi:[0,1,1]
	v_cvt_pk_bf16_f32 v126, v32, v33
	v_cvt_pk_bf16_f32 v127, v82, v83
	ds_write_b64 v8, v[126:127] offset:13728
	v_pk_mul_f32 v[34:35], v[32:33], v[30:31] op_sel:[0,0] op_sel_hi:[1,0]
	v_pk_mul_f32 v[84:85], v[82:83], v[80:81] op_sel:[0,0] op_sel_hi:[1,0]
	v_pk_fma_f32 v[34:35], v[32:33], v[52:53], v[34:35] op_sel:[1,0,0] op_sel_hi:[0,1,1]
	v_pk_fma_f32 v[84:85], v[82:83], v[102:103], v[84:85] op_sel:[1,0,0] op_sel_hi:[0,1,1]
	v_cvt_pk_bf16_f32 v120, v34, v35
	v_cvt_pk_bf16_f32 v121, v84, v85
	ds_write_b64 v8, v[120:121] offset:14256
	v_pk_mul_f32 v[32:33], v[34:35], v[30:31] op_sel:[0,0] op_sel_hi:[1,0]
	v_pk_mul_f32 v[82:83], v[84:85], v[80:81] op_sel:[0,0] op_sel_hi:[1,0]
	v_pk_fma_f32 v[32:33], v[34:35], v[52:53], v[32:33] op_sel:[1,0,0] op_sel_hi:[0,1,1]
	v_pk_fma_f32 v[82:83], v[84:85], v[102:103], v[82:83] op_sel:[1,0,0] op_sel_hi:[0,1,1]
	v_cvt_pk_bf16_f32 v122, v32, v33
	v_cvt_pk_bf16_f32 v123, v82, v83
	ds_write_b64 v8, v[122:123] offset:14784
	v_pk_mul_f32 v[34:35], v[32:33], v[30:31] op_sel:[0,0] op_sel_hi:[1,0]
	v_pk_mul_f32 v[84:85], v[82:83], v[80:81] op_sel:[0,0] op_sel_hi:[1,0]
	v_pk_fma_f32 v[34:35], v[32:33], v[52:53], v[34:35] op_sel:[1,0,0] op_sel_hi:[0,1,1]
	v_pk_fma_f32 v[84:85], v[82:83], v[102:103], v[84:85] op_sel:[1,0,0] op_sel_hi:[0,1,1]
	v_cvt_pk_bf16_f32 v124, v34, v35
	v_cvt_pk_bf16_f32 v125, v84, v85
	ds_write_b64 v8, v[124:125] offset:15312
	v_pk_mul_f32 v[32:33], v[34:35], v[30:31] op_sel:[0,0] op_sel_hi:[1,0]
	v_pk_mul_f32 v[82:83], v[84:85], v[80:81] op_sel:[0,0] op_sel_hi:[1,0]
	v_pk_fma_f32 v[32:33], v[34:35], v[52:53], v[32:33] op_sel:[1,0,0] op_sel_hi:[0,1,1]
	v_pk_fma_f32 v[82:83], v[84:85], v[102:103], v[82:83] op_sel:[1,0,0] op_sel_hi:[0,1,1]
	v_cvt_pk_bf16_f32 v126, v32, v33
	v_cvt_pk_bf16_f32 v127, v82, v83
	ds_write_b64 v8, v[126:127] offset:15840
	v_pk_mul_f32 v[34:35], v[32:33], v[30:31] op_sel:[0,0] op_sel_hi:[1,0]
	v_pk_mul_f32 v[84:85], v[82:83], v[80:81] op_sel:[0,0] op_sel_hi:[1,0]
	v_pk_fma_f32 v[34:35], v[32:33], v[52:53], v[34:35] op_sel:[1,0,0] op_sel_hi:[0,1,1]
	v_pk_fma_f32 v[84:85], v[82:83], v[102:103], v[84:85] op_sel:[1,0,0] op_sel_hi:[0,1,1]
	v_cvt_pk_bf16_f32 v120, v34, v35
	v_cvt_pk_bf16_f32 v121, v84, v85
	ds_write_b64 v8, v[120:121] offset:16368
	v_pk_mul_f32 v[32:33], v[34:35], v[30:31] op_sel:[0,0] op_sel_hi:[1,0]
	v_pk_mul_f32 v[82:83], v[84:85], v[80:81] op_sel:[0,0] op_sel_hi:[1,0]
	v_pk_fma_f32 v[32:33], v[34:35], v[52:53], v[32:33] op_sel:[1,0,0] op_sel_hi:[0,1,1]
	v_pk_fma_f32 v[82:83], v[84:85], v[102:103], v[82:83] op_sel:[1,0,0] op_sel_hi:[0,1,1]
	v_cvt_pk_bf16_f32 v122, v32, v33
	v_cvt_pk_bf16_f32 v123, v82, v83
	ds_write_b64 v8, v[122:123] offset:16896
	v_pk_mul_f32 v[34:35], v[32:33], v[30:31] op_sel:[0,0] op_sel_hi:[1,0]
	v_pk_mul_f32 v[84:85], v[82:83], v[80:81] op_sel:[0,0] op_sel_hi:[1,0]
	v_pk_fma_f32 v[34:35], v[32:33], v[52:53], v[34:35] op_sel:[1,0,0] op_sel_hi:[0,1,1]
	v_pk_fma_f32 v[84:85], v[82:83], v[102:103], v[84:85] op_sel:[1,0,0] op_sel_hi:[0,1,1]
	v_cvt_pk_bf16_f32 v124, v34, v35
	v_cvt_pk_bf16_f32 v125, v84, v85
	ds_write_b64 v8, v[124:125] offset:17424
	v_pk_mul_f32 v[32:33], v[34:35], v[30:31] op_sel:[0,0] op_sel_hi:[1,0]
	v_pk_mul_f32 v[82:83], v[84:85], v[80:81] op_sel:[0,0] op_sel_hi:[1,0]
	v_pk_fma_f32 v[32:33], v[34:35], v[52:53], v[32:33] op_sel:[1,0,0] op_sel_hi:[0,1,1]
	v_pk_fma_f32 v[82:83], v[84:85], v[102:103], v[82:83] op_sel:[1,0,0] op_sel_hi:[0,1,1]
	v_cvt_pk_bf16_f32 v126, v32, v33
	v_cvt_pk_bf16_f32 v127, v82, v83
	ds_write_b64 v8, v[126:127] offset:17952
	v_pk_mul_f32 v[34:35], v[32:33], v[30:31] op_sel:[0,0] op_sel_hi:[1,0]
	v_pk_mul_f32 v[84:85], v[82:83], v[80:81] op_sel:[0,0] op_sel_hi:[1,0]
	v_pk_fma_f32 v[34:35], v[32:33], v[52:53], v[34:35] op_sel:[1,0,0] op_sel_hi:[0,1,1]
	v_pk_fma_f32 v[84:85], v[82:83], v[102:103], v[84:85] op_sel:[1,0,0] op_sel_hi:[0,1,1]
	v_cvt_pk_bf16_f32 v120, v34, v35
	v_cvt_pk_bf16_f32 v121, v84, v85
	ds_write_b64 v8, v[120:121] offset:18480
	v_pk_mul_f32 v[32:33], v[34:35], v[30:31] op_sel:[0,0] op_sel_hi:[1,0]
	v_pk_mul_f32 v[82:83], v[84:85], v[80:81] op_sel:[0,0] op_sel_hi:[1,0]
	v_pk_fma_f32 v[32:33], v[34:35], v[52:53], v[32:33] op_sel:[1,0,0] op_sel_hi:[0,1,1]
	v_pk_fma_f32 v[82:83], v[84:85], v[102:103], v[82:83] op_sel:[1,0,0] op_sel_hi:[0,1,1]
	v_cvt_pk_bf16_f32 v122, v32, v33
	v_cvt_pk_bf16_f32 v123, v82, v83
	ds_write_b64 v8, v[122:123] offset:19008
	v_pk_mul_f32 v[34:35], v[32:33], v[30:31] op_sel:[0,0] op_sel_hi:[1,0]
	v_pk_mul_f32 v[84:85], v[82:83], v[80:81] op_sel:[0,0] op_sel_hi:[1,0]
	v_pk_fma_f32 v[34:35], v[32:33], v[52:53], v[34:35] op_sel:[1,0,0] op_sel_hi:[0,1,1]
	v_pk_fma_f32 v[84:85], v[82:83], v[102:103], v[84:85] op_sel:[1,0,0] op_sel_hi:[0,1,1]
	v_cvt_pk_bf16_f32 v124, v34, v35
	v_cvt_pk_bf16_f32 v125, v84, v85
	ds_write_b64 v8, v[124:125] offset:19536
	v_pk_mul_f32 v[32:33], v[34:35], v[30:31] op_sel:[0,0] op_sel_hi:[1,0]
	v_pk_mul_f32 v[82:83], v[84:85], v[80:81] op_sel:[0,0] op_sel_hi:[1,0]
	v_pk_fma_f32 v[32:33], v[34:35], v[52:53], v[32:33] op_sel:[1,0,0] op_sel_hi:[0,1,1]
	v_pk_fma_f32 v[82:83], v[84:85], v[102:103], v[82:83] op_sel:[1,0,0] op_sel_hi:[0,1,1]
	v_cvt_pk_bf16_f32 v126, v32, v33
	v_cvt_pk_bf16_f32 v127, v82, v83
	ds_write_b64 v8, v[126:127] offset:20064
	v_pk_mul_f32 v[34:35], v[32:33], v[30:31] op_sel:[0,0] op_sel_hi:[1,0]
	v_pk_mul_f32 v[84:85], v[82:83], v[80:81] op_sel:[0,0] op_sel_hi:[1,0]
	v_pk_fma_f32 v[34:35], v[32:33], v[52:53], v[34:35] op_sel:[1,0,0] op_sel_hi:[0,1,1]
	v_pk_fma_f32 v[84:85], v[82:83], v[102:103], v[84:85] op_sel:[1,0,0] op_sel_hi:[0,1,1]
	v_cvt_pk_bf16_f32 v120, v34, v35
	v_cvt_pk_bf16_f32 v121, v84, v85
	ds_write_b64 v8, v[120:121] offset:20592
	v_pk_mul_f32 v[32:33], v[34:35], v[30:31] op_sel:[0,0] op_sel_hi:[1,0]
	v_pk_mul_f32 v[82:83], v[84:85], v[80:81] op_sel:[0,0] op_sel_hi:[1,0]
	v_pk_fma_f32 v[32:33], v[34:35], v[52:53], v[32:33] op_sel:[1,0,0] op_sel_hi:[0,1,1]
	v_pk_fma_f32 v[82:83], v[84:85], v[102:103], v[82:83] op_sel:[1,0,0] op_sel_hi:[0,1,1]
	v_cvt_pk_bf16_f32 v122, v32, v33
	v_cvt_pk_bf16_f32 v123, v82, v83
	ds_write_b64 v8, v[122:123] offset:21120
	v_pk_mul_f32 v[34:35], v[32:33], v[30:31] op_sel:[0,0] op_sel_hi:[1,0]
	v_pk_mul_f32 v[84:85], v[82:83], v[80:81] op_sel:[0,0] op_sel_hi:[1,0]
	v_pk_fma_f32 v[34:35], v[32:33], v[52:53], v[34:35] op_sel:[1,0,0] op_sel_hi:[0,1,1]
	v_pk_fma_f32 v[84:85], v[82:83], v[102:103], v[84:85] op_sel:[1,0,0] op_sel_hi:[0,1,1]
	v_cvt_pk_bf16_f32 v124, v34, v35
	v_cvt_pk_bf16_f32 v125, v84, v85
	ds_write_b64 v8, v[124:125] offset:21648
	v_pk_mul_f32 v[32:33], v[34:35], v[30:31] op_sel:[0,0] op_sel_hi:[1,0]
	v_pk_mul_f32 v[82:83], v[84:85], v[80:81] op_sel:[0,0] op_sel_hi:[1,0]
	v_pk_fma_f32 v[32:33], v[34:35], v[52:53], v[32:33] op_sel:[1,0,0] op_sel_hi:[0,1,1]
	v_pk_fma_f32 v[82:83], v[84:85], v[102:103], v[82:83] op_sel:[1,0,0] op_sel_hi:[0,1,1]
	v_cvt_pk_bf16_f32 v126, v32, v33
	v_cvt_pk_bf16_f32 v127, v82, v83
	ds_write_b64 v8, v[126:127] offset:22176
	v_pk_mul_f32 v[34:35], v[32:33], v[30:31] op_sel:[0,0] op_sel_hi:[1,0]
	v_pk_mul_f32 v[84:85], v[82:83], v[80:81] op_sel:[0,0] op_sel_hi:[1,0]
	v_pk_fma_f32 v[34:35], v[32:33], v[52:53], v[34:35] op_sel:[1,0,0] op_sel_hi:[0,1,1]
	v_pk_fma_f32 v[84:85], v[82:83], v[102:103], v[84:85] op_sel:[1,0,0] op_sel_hi:[0,1,1]
	v_cvt_pk_bf16_f32 v120, v34, v35
	v_cvt_pk_bf16_f32 v121, v84, v85
	ds_write_b64 v8, v[120:121] offset:22704
	v_pk_mul_f32 v[32:33], v[34:35], v[30:31] op_sel:[0,0] op_sel_hi:[1,0]
	v_pk_mul_f32 v[82:83], v[84:85], v[80:81] op_sel:[0,0] op_sel_hi:[1,0]
	v_pk_fma_f32 v[32:33], v[34:35], v[52:53], v[32:33] op_sel:[1,0,0] op_sel_hi:[0,1,1]
	v_pk_fma_f32 v[82:83], v[84:85], v[102:103], v[82:83] op_sel:[1,0,0] op_sel_hi:[0,1,1]
	v_cvt_pk_bf16_f32 v122, v32, v33
	v_cvt_pk_bf16_f32 v123, v82, v83
	ds_write_b64 v8, v[122:123] offset:23232
	v_pk_mul_f32 v[34:35], v[32:33], v[30:31] op_sel:[0,0] op_sel_hi:[1,0]
	v_pk_mul_f32 v[84:85], v[82:83], v[80:81] op_sel:[0,0] op_sel_hi:[1,0]
	v_pk_fma_f32 v[34:35], v[32:33], v[52:53], v[34:35] op_sel:[1,0,0] op_sel_hi:[0,1,1]
	v_pk_fma_f32 v[84:85], v[82:83], v[102:103], v[84:85] op_sel:[1,0,0] op_sel_hi:[0,1,1]
	v_cvt_pk_bf16_f32 v124, v34, v35
	v_cvt_pk_bf16_f32 v125, v84, v85
	ds_write_b64 v8, v[124:125] offset:23760
	v_pk_mul_f32 v[32:33], v[34:35], v[30:31] op_sel:[0,0] op_sel_hi:[1,0]
	v_pk_mul_f32 v[82:83], v[84:85], v[80:81] op_sel:[0,0] op_sel_hi:[1,0]
	v_pk_fma_f32 v[32:33], v[34:35], v[52:53], v[32:33] op_sel:[1,0,0] op_sel_hi:[0,1,1]
	v_pk_fma_f32 v[82:83], v[84:85], v[102:103], v[82:83] op_sel:[1,0,0] op_sel_hi:[0,1,1]
	v_cvt_pk_bf16_f32 v126, v32, v33
	v_cvt_pk_bf16_f32 v127, v82, v83
	ds_write_b64 v8, v[126:127] offset:24288
	v_pk_mul_f32 v[34:35], v[32:33], v[30:31] op_sel:[0,0] op_sel_hi:[1,0]
	v_pk_mul_f32 v[84:85], v[82:83], v[80:81] op_sel:[0,0] op_sel_hi:[1,0]
	v_pk_fma_f32 v[34:35], v[32:33], v[52:53], v[34:35] op_sel:[1,0,0] op_sel_hi:[0,1,1]
	v_pk_fma_f32 v[84:85], v[82:83], v[102:103], v[84:85] op_sel:[1,0,0] op_sel_hi:[0,1,1]
	v_cvt_pk_bf16_f32 v120, v34, v35
	v_cvt_pk_bf16_f32 v121, v84, v85
	ds_write_b64 v8, v[120:121] offset:24816
	v_pk_mul_f32 v[32:33], v[34:35], v[30:31] op_sel:[0,0] op_sel_hi:[1,0]
	v_pk_mul_f32 v[82:83], v[84:85], v[80:81] op_sel:[0,0] op_sel_hi:[1,0]
	v_pk_fma_f32 v[32:33], v[34:35], v[52:53], v[32:33] op_sel:[1,0,0] op_sel_hi:[0,1,1]
	v_pk_fma_f32 v[82:83], v[84:85], v[102:103], v[82:83] op_sel:[1,0,0] op_sel_hi:[0,1,1]
	v_cvt_pk_bf16_f32 v122, v32, v33
	v_cvt_pk_bf16_f32 v123, v82, v83
	ds_write_b64 v8, v[122:123] offset:25344
	v_pk_mul_f32 v[34:35], v[32:33], v[30:31] op_sel:[0,0] op_sel_hi:[1,0]
	v_pk_mul_f32 v[84:85], v[82:83], v[80:81] op_sel:[0,0] op_sel_hi:[1,0]
	v_pk_fma_f32 v[34:35], v[32:33], v[52:53], v[34:35] op_sel:[1,0,0] op_sel_hi:[0,1,1]
	v_pk_fma_f32 v[84:85], v[82:83], v[102:103], v[84:85] op_sel:[1,0,0] op_sel_hi:[0,1,1]
	v_cvt_pk_bf16_f32 v124, v34, v35
	v_cvt_pk_bf16_f32 v125, v84, v85
	ds_write_b64 v8, v[124:125] offset:25872
	v_pk_mul_f32 v[32:33], v[34:35], v[30:31] op_sel:[0,0] op_sel_hi:[1,0]
	v_pk_mul_f32 v[82:83], v[84:85], v[80:81] op_sel:[0,0] op_sel_hi:[1,0]
	v_pk_fma_f32 v[32:33], v[34:35], v[52:53], v[32:33] op_sel:[1,0,0] op_sel_hi:[0,1,1]
	v_pk_fma_f32 v[82:83], v[84:85], v[102:103], v[82:83] op_sel:[1,0,0] op_sel_hi:[0,1,1]
	v_cvt_pk_bf16_f32 v126, v32, v33
	v_cvt_pk_bf16_f32 v127, v82, v83
	ds_write_b64 v8, v[126:127] offset:26400
	v_pk_mul_f32 v[34:35], v[32:33], v[30:31] op_sel:[0,0] op_sel_hi:[1,0]
	v_pk_mul_f32 v[84:85], v[82:83], v[80:81] op_sel:[0,0] op_sel_hi:[1,0]
	v_pk_fma_f32 v[34:35], v[32:33], v[52:53], v[34:35] op_sel:[1,0,0] op_sel_hi:[0,1,1]
	v_pk_fma_f32 v[84:85], v[82:83], v[102:103], v[84:85] op_sel:[1,0,0] op_sel_hi:[0,1,1]
	v_cvt_pk_bf16_f32 v120, v34, v35
	v_cvt_pk_bf16_f32 v121, v84, v85
	ds_write_b64 v8, v[120:121] offset:26928
	v_pk_mul_f32 v[32:33], v[34:35], v[30:31] op_sel:[0,0] op_sel_hi:[1,0]
	v_pk_mul_f32 v[82:83], v[84:85], v[80:81] op_sel:[0,0] op_sel_hi:[1,0]
	v_pk_fma_f32 v[32:33], v[34:35], v[52:53], v[32:33] op_sel:[1,0,0] op_sel_hi:[0,1,1]
	v_pk_fma_f32 v[82:83], v[84:85], v[102:103], v[82:83] op_sel:[1,0,0] op_sel_hi:[0,1,1]
	v_cvt_pk_bf16_f32 v122, v32, v33
	v_cvt_pk_bf16_f32 v123, v82, v83
	ds_write_b64 v8, v[122:123] offset:27456
	v_pk_mul_f32 v[34:35], v[32:33], v[30:31] op_sel:[0,0] op_sel_hi:[1,0]
	v_pk_mul_f32 v[84:85], v[82:83], v[80:81] op_sel:[0,0] op_sel_hi:[1,0]
	v_pk_fma_f32 v[34:35], v[32:33], v[52:53], v[34:35] op_sel:[1,0,0] op_sel_hi:[0,1,1]
	v_pk_fma_f32 v[84:85], v[82:83], v[102:103], v[84:85] op_sel:[1,0,0] op_sel_hi:[0,1,1]
	v_cvt_pk_bf16_f32 v124, v34, v35
	v_cvt_pk_bf16_f32 v125, v84, v85
	ds_write_b64 v8, v[124:125] offset:27984
	v_pk_mul_f32 v[32:33], v[34:35], v[30:31] op_sel:[0,0] op_sel_hi:[1,0]
	v_pk_mul_f32 v[82:83], v[84:85], v[80:81] op_sel:[0,0] op_sel_hi:[1,0]
	v_pk_fma_f32 v[32:33], v[34:35], v[52:53], v[32:33] op_sel:[1,0,0] op_sel_hi:[0,1,1]
	v_pk_fma_f32 v[82:83], v[84:85], v[102:103], v[82:83] op_sel:[1,0,0] op_sel_hi:[0,1,1]
	v_cvt_pk_bf16_f32 v126, v32, v33
	v_cvt_pk_bf16_f32 v127, v82, v83
	ds_write_b64 v8, v[126:127] offset:28512
	v_pk_mul_f32 v[34:35], v[32:33], v[30:31] op_sel:[0,0] op_sel_hi:[1,0]
	v_pk_mul_f32 v[84:85], v[82:83], v[80:81] op_sel:[0,0] op_sel_hi:[1,0]
	v_pk_fma_f32 v[34:35], v[32:33], v[52:53], v[34:35] op_sel:[1,0,0] op_sel_hi:[0,1,1]
	v_pk_fma_f32 v[84:85], v[82:83], v[102:103], v[84:85] op_sel:[1,0,0] op_sel_hi:[0,1,1]
	v_cvt_pk_bf16_f32 v120, v34, v35
	v_cvt_pk_bf16_f32 v121, v84, v85
	ds_write_b64 v8, v[120:121] offset:29040
	v_and_b32 v9, 31, v1
	v_lshrrev_b32 v17, 5, v1
	s_movk_i32 s37, 528
	v_mul_lo_u32 v18, v9, s37
	v_lshl_add_u32 v18, v17, 4, v18
	v_add_u32 v18, s22, v18
	ds_read_b128 v[128:131], v18 offset:0
	ds_read_b128 v[132:135], v18 offset:12672
	ds_read_b128 v[136:139], v18 offset:32
	ds_read_b128 v[140:143], v18 offset:12704
	ds_read_b128 v[144:147], v18 offset:64
	ds_read_b128 v[148:151], v18 offset:12736
	ds_read_b128 v[152:155], v18 offset:96
	ds_read_b128 v[156:159], v18 offset:12768
	ds_read_b128 v[160:163], v18 offset:128
	ds_read_b128 v[164:167], v18 offset:12800
	ds_read_b128 v[168:171], v18 offset:160
	ds_read_b128 v[172:175], v18 offset:12832
	ds_read_b128 v[176:179], v18 offset:192
	ds_read_b128 v[180:183], v18 offset:12864
	ds_read_b128 v[184:187], v18 offset:224
	ds_read_b128 v[188:191], v18 offset:12896
	s_waitcnt lgkmcnt(14)
	v_mfma_f32_32x32x16_bf16 v[64:79], v[128:131], v[132:135], 0
	ds_read_b128 v[128:131], v18 offset:256
	ds_read_b128 v[132:135], v18 offset:12928
	s_waitcnt lgkmcnt(14)
	v_mfma_f32_32x32x16_bf16 v[64:79], v[136:139], v[140:143], v[64:79]
	ds_read_b128 v[136:139], v18 offset:288
	ds_read_b128 v[140:143], v18 offset:12960
	s_waitcnt lgkmcnt(14)
	v_mfma_f32_32x32x16_bf16 v[64:79], v[144:147], v[148:151], v[64:79]
	ds_read_b128 v[144:147], v18 offset:320
	ds_read_b128 v[148:151], v18 offset:12992
	s_waitcnt lgkmcnt(14)
	v_mfma_f32_32x32x16_bf16 v[64:79], v[152:155], v[156:159], v[64:79]
	ds_read_b128 v[152:155], v18 offset:352
	ds_read_b128 v[156:159], v18 offset:13024
	s_waitcnt lgkmcnt(14)
	v_mfma_f32_32x32x16_bf16 v[64:79], v[160:163], v[164:167], v[64:79]
	ds_read_b128 v[160:163], v18 offset:384
	ds_read_b128 v[164:167], v18 offset:13056
	s_waitcnt lgkmcnt(14)
	v_mfma_f32_32x32x16_bf16 v[64:79], v[168:171], v[172:175], v[64:79]
	ds_read_b128 v[168:171], v18 offset:416
	ds_read_b128 v[172:175], v18 offset:13088
	s_waitcnt lgkmcnt(14)
	v_mfma_f32_32x32x16_bf16 v[64:79], v[176:179], v[180:183], v[64:79]
	ds_read_b128 v[176:179], v18 offset:448
	ds_read_b128 v[180:183], v18 offset:13120
	s_waitcnt lgkmcnt(14)
	v_mfma_f32_32x32x16_bf16 v[64:79], v[184:187], v[188:191], v[64:79]
	ds_read_b128 v[184:187], v18 offset:480
	ds_read_b128 v[188:191], v18 offset:13152
	s_waitcnt lgkmcnt(14)
	v_mfma_f32_32x32x16_bf16 v[64:79], v[128:131], v[132:135], v[64:79]
	s_waitcnt lgkmcnt(12)
	v_mfma_f32_32x32x16_bf16 v[64:79], v[136:139], v[140:143], v[64:79]
	s_waitcnt lgkmcnt(10)
	v_mfma_f32_32x32x16_bf16 v[64:79], v[144:147], v[148:151], v[64:79]
	s_waitcnt lgkmcnt(8)
	v_mfma_f32_32x32x16_bf16 v[64:79], v[152:155], v[156:159], v[64:79]
	s_waitcnt lgkmcnt(6)
	v_mfma_f32_32x32x16_bf16 v[64:79], v[160:163], v[164:167], v[64:79]
	s_waitcnt lgkmcnt(4)
	v_mfma_f32_32x32x16_bf16 v[64:79], v[168:171], v[172:175], v[64:79]
	s_waitcnt lgkmcnt(2)
	v_mfma_f32_32x32x16_bf16 v[64:79], v[176:179], v[180:183], v[64:79]
	s_waitcnt lgkmcnt(0)
	v_mfma_f32_32x32x16_bf16 v[64:79], v[184:187], v[188:191], v[64:79]
	s_add_u32 s38, s22, 33792
	v_lshl_add_u32 v19, v9, 4, s38
	v_lshl_add_u32 v40, v17, 3, v19
	v_mov_b32 v41, 0
	v_mov_b32 v42, s38
	ds_write_b16 v42, v41 offset:4600
	s_nop 5
	v_cvt_pk_bf16_f32 v44, v64, v64
	v_cvt_pk_bf16_f32 v45, v65, v65
	v_cvt_pk_bf16_f32 v46, v66, v66
	v_cvt_pk_bf16_f32 v47, v67, v67
	v_cvt_pk_bf16_f32 v48, v68, v68
	v_cvt_pk_bf16_f32 v49, v69, v69
	v_cvt_pk_bf16_f32 v50, v70, v70
	v_cvt_pk_bf16_f32 v51, v71, v71
	v_cvt_pk_bf16_f32 v52, v72, v72
	v_cvt_pk_bf16_f32 v53, v73, v73
	v_cvt_pk_bf16_f32 v54, v74, v74
	v_cvt_pk_bf16_f32 v55, v75, v75
	ds_write_b16 v40, v44 offset:0
	ds_write_b16 v40, v45 offset:2
	ds_write_b16 v40, v46 offset:4
	ds_write_b16 v40, v47 offset:6
	s_movk_i32 s39, 512
	v_mad_u32_u24 v43, v17, s39, v19
	ds_write_b16 v43, v48 offset:512
	s_movk_i32 s39, 516
	v_mad_u32_u24 v43, v17, s39, v19
	ds_write_b16 v43, v49 offset:516
	s_movk_i32 s39, 1016
	v_mad_u32_u24 v43, v17, s39, v19
	ds_write_b16 v43, v50 offset:520
	s_movk_i32 s39, 1020
	v_mad_u32_u24 v43, v17, s39, v19
	ds_write_b16 v43, v51 offset:524
	s_movk_i32 s39, 2048
	v_mad_u32_u24 v43, v17, s39, v19
	ds_write_b16 v43, v52 offset:2048
	s_mov_b32 exec_hi, 0
	ds_write_b16 v19, v53 offset:2560
	ds_write_b16 v19, v54 offset:3072
	ds_write_b16 v19, v55 offset:3584
	s_mov_b32 exec_hi, -1
	s_add_u32 s39, s22, 25024
	v_lshl_add_u32 v6, v1, 4, s39
	s_waitcnt vmcnt(8)
	v_mad_u32_u16 v96, v200, 1, s38
	v_mad_u32_u16 v97, v200, 1, s38 op_sel:[1,0,0,0]
	v_mad_u32_u16 v98, v201, 1, s38
	v_mad_u32_u16 v99, v201, 1, s38 op_sel:[1,0,0,0]
	v_mad_u32_u16 v100, v202, 1, s38
	v_mad_u32_u16 v101, v202, 1, s38 op_sel:[1,0,0,0]
	v_mad_u32_u16 v102, v203, 1, s38
	v_mad_u32_u16 v103, v203, 1, s38 op_sel:[1,0,0,0]
	v_mad_u32_u16 v104, v204, 1, s38
	ds_read_u16 v128, v96
	ds_read_u16 v129, v97
	ds_read_u16 v130, v98
	ds_read_u16 v131, v99
	ds_read_u16 v132, v100
	ds_read_u16 v133, v101
	ds_read_u16 v134, v102
	ds_read_u16 v135, v103
	ds_read_u16 v136, v104
	s_waitcnt vmcnt(6)
	v_mad_u32_u16 v96, v206, 1, s38
	v_mad_u32_u16 v97, v206, 1, s38 op_sel:[1,0,0,0]
	v_mad_u32_u16 v98, v207, 1, s38
	v_mad_u32_u16 v99, v207, 1, s38 op_sel:[1,0,0,0]
	v_mad_u32_u16 v100, v208, 1, s38
	v_mad_u32_u16 v101, v208, 1, s38 op_sel:[1,0,0,0]
	v_mad_u32_u16 v102, v209, 1, s38
	v_mad_u32_u16 v103, v209, 1, s38 op_sel:[1,0,0,0]
	v_mad_u32_u16 v104, v210, 1, s38
	ds_read_u16 v140, v96
	ds_read_u16 v141, v97
	ds_read_u16 v142, v98
	ds_read_u16 v143, v99
	ds_read_u16 v144, v100
	ds_read_u16 v145, v101
	ds_read_u16 v146, v102
	ds_read_u16 v147, v103
	ds_read_u16 v148, v104
	s_waitcnt vmcnt(4)
	v_mad_u32_u16 v96, v212, 1, s38
	v_mad_u32_u16 v97, v212, 1, s38 op_sel:[1,0,0,0]
	v_mad_u32_u16 v98, v213, 1, s38
	v_mad_u32_u16 v99, v213, 1, s38 op_sel:[1,0,0,0]
	v_mad_u32_u16 v100, v214, 1, s38
	v_mad_u32_u16 v101, v214, 1, s38 op_sel:[1,0,0,0]
	v_mad_u32_u16 v102, v215, 1, s38
	v_mad_u32_u16 v103, v215, 1, s38 op_sel:[1,0,0,0]
	v_mad_u32_u16 v104, v216, 1, s38
	ds_read_u16 v152, v96
	ds_read_u16 v153, v97
	ds_read_u16 v154, v98
	ds_read_u16 v155, v99
	ds_read_u16 v156, v100
	ds_read_u16 v157, v101
	ds_read_u16 v158, v102
	ds_read_u16 v159, v103
	ds_read_u16 v160, v104
	s_waitcnt vmcnt(2)
	v_mad_u32_u16 v96, v218, 1, s38
	v_mad_u32_u16 v97, v218, 1, s38 op_sel:[1,0,0,0]
	v_mad_u32_u16 v98, v219, 1, s38
	v_mad_u32_u16 v99, v219, 1, s38 op_sel:[1,0,0,0]
	v_mad_u32_u16 v100, v220, 1, s38
	v_mad_u32_u16 v101, v220, 1, s38 op_sel:[1,0,0,0]
	v_mad_u32_u16 v102, v221, 1, s38
	v_mad_u32_u16 v103, v221, 1, s38 op_sel:[1,0,0,0]
	v_mad_u32_u16 v104, v222, 1, s38
	ds_read_u16 v164, v96
	ds_read_u16 v165, v97
	ds_read_u16 v166, v98
	ds_read_u16 v167, v99
	ds_read_u16 v168, v100
	ds_read_u16 v169, v101
	ds_read_u16 v170, v102
	ds_read_u16 v171, v103
	ds_read_u16 v172, v104
	s_waitcnt vmcnt(0)
	v_mad_u32_u16 v96, v224, 1, s38
	v_mad_u32_u16 v97, v224, 1, s38 op_sel:[1,0,0,0]
	v_mad_u32_u16 v98, v225, 1, s38
	v_mad_u32_u16 v99, v225, 1, s38 op_sel:[1,0,0,0]
	v_mad_u32_u16 v100, v226, 1, s38
	v_mad_u32_u16 v101, v226, 1, s38 op_sel:[1,0,0,0]
	v_mad_u32_u16 v102, v227, 1, s38
	v_mad_u32_u16 v103, v227, 1, s38 op_sel:[1,0,0,0]
	v_mad_u32_u16 v104, v228, 1, s38
	ds_read_u16 v176, v96
	ds_read_u16 v177, v97
	ds_read_u16 v178, v98
	ds_read_u16 v179, v99
	ds_read_u16 v180, v100
	ds_read_u16 v181, v101
	ds_read_u16 v182, v102
	ds_read_u16 v183, v103
	ds_read_u16 v184, v104
	s_waitcnt lgkmcnt(15)
	v_lshl_or_b32 v108, v129, 16, v128
	v_lshl_or_b32 v112, v130, 16, v129
	v_lshl_or_b32 v109, v131, 16, v130
	v_lshl_or_b32 v113, v132, 16, v131
	v_lshl_or_b32 v110, v133, 16, v132
	v_lshl_or_b32 v114, v134, 16, v133
	v_lshl_or_b32 v111, v135, 16, v134
	v_lshl_or_b32 v115, v136, 16, v135
	ds_write_b128 v6, v[108:111] offset:0
	ds_write_b128 v6, v[112:115] offset:4416
	v_lshl_or_b32 v116, v141, 16, v140
	v_lshl_or_b32 v120, v142, 16, v141
	v_lshl_or_b32 v117, v143, 16, v142
	v_lshl_or_b32 v121, v144, 16, v143
	v_lshl_or_b32 v118, v145, 16, v144
	v_lshl_or_b32 v122, v146, 16, v145
	v_lshl_or_b32 v119, v147, 16, v146
	v_lshl_or_b32 v123, v148, 16, v147
	ds_write_b128 v6, v[116:119] offset:1024
	ds_write_b128 v6, v[120:123] offset:5440
	v_lshl_or_b32 v108, v153, 16, v152
	v_lshl_or_b32 v112, v154, 16, v153
	v_lshl_or_b32 v109, v155, 16, v154
	v_lshl_or_b32 v113, v156, 16, v155
	v_lshl_or_b32 v110, v157, 16, v156
	v_lshl_or_b32 v114, v158, 16, v157
	v_lshl_or_b32 v111, v159, 16, v158
	v_lshl_or_b32 v115, v160, 16, v159
	ds_write_b128 v6, v[108:111] offset:2048
	ds_write_b128 v6, v[112:115] offset:6464
	s_waitcnt lgkmcnt(15)
	v_lshl_or_b32 v116, v165, 16, v164
	v_lshl_or_b32 v120, v166, 16, v165
	v_lshl_or_b32 v117, v167, 16, v166
	v_lshl_or_b32 v121, v168, 16, v167
	v_lshl_or_b32 v118, v169, 16, v168
	v_lshl_or_b32 v122, v170, 16, v169
	v_lshl_or_b32 v119, v171, 16, v170
	v_lshl_or_b32 v123, v172, 16, v171
	ds_write_b128 v6, v[116:119] offset:3072
	ds_write_b128 v6, v[120:123] offset:7488
	s_mov_b64 exec, 0xffff
	s_waitcnt lgkmcnt(8)
	v_lshl_or_b32 v108, v177, 16, v176
	v_lshl_or_b32 v112, v178, 16, v177
	v_lshl_or_b32 v109, v179, 16, v178
	v_lshl_or_b32 v113, v180, 16, v179
	v_lshl_or_b32 v110, v181, 16, v180
	v_lshl_or_b32 v114, v182, 16, v181
	v_lshl_or_b32 v111, v183, 16, v182
	v_lshl_or_b32 v115, v184, 16, v183
	ds_write_b128 v6, v[108:111] offset:4096
	ds_write_b128 v6, v[112:115] offset:8512
	s_mov_b64 exec, -1
	v_bfe_u32 v7, v1, 4, 1
	v_lshlrev_b32 v6, 1, v7
	v_sub_u32 v6, v1, v6
	v_and_b32 v6, 15, v6
	v_lshl_add_u32 v6, v6, 1, v7
	v_and_b32 v8, 32, v1
	v_add_u32 v6, v6, v8
	v_add_u32 v8, v6, v7
	v_lshlrev_b32 v8, 1, v8
	v_sub_u32 v8, 128, v8
	s_movk_i32 s31, 4416
	v_mad_u32_u24 v8, v7, s31, v8
	s_add_u32 s39, s22, 25024
	v_add_u32 v8, s39, v8
	v_lshl_add_u32 v7, v1, 4, s22
	v_add_u32 v100, 0, v8
	v_add_u32 v101, 1024, v8
	v_add_u32 v102, 2048, v8
	v_add_u32 v103, 3072, v8
	v_add_u32 v104, 4096, v8
	ds_read2_b32 v[128:129], v101 offset0:0 offset1:1
	ds_read2_b32 v[130:131], v101 offset0:2 offset1:3
	ds_read2_b32 v[132:133], v100 offset0:224 offset1:225
	ds_read2_b32 v[134:135], v100 offset0:226 offset1:227
	ds_read2_b32 v[136:137], v100 offset0:192 offset1:193
	ds_read2_b32 v[138:139], v100 offset0:194 offset1:195
	ds_read2_b32 v[140:141], v100 offset0:160 offset1:161
	ds_read2_b32 v[142:143], v100 offset0:162 offset1:163
	ds_read2_b32 v[144:145], v100 offset0:128 offset1:129
	ds_read2_b32 v[146:147], v100 offset0:130 offset1:131
	ds_read2_b32 v[148:149], v100 offset0:96 offset1:97
	ds_read2_b32 v[150:151], v100 offset0:98 offset1:99
	ds_read2_b32 v[152:153], v100 offset0:64 offset1:65
	ds_read2_b32 v[154:155], v100 offset0:66 offset1:67
	ds_read2_b32 v[156:157], v100 offset0:32 offset1:33
	ds_read2_b32 v[158:159], v100 offset0:34 offset1:35
	ds_read2_b32 v[160:161], v100 offset0:0 offset1:1
	ds_read2_b32 v[162:163], v100 offset0:2 offset1:3
	ds_read2_b32 v[16:17], v104 offset0:0 offset1:1
	ds_read2_b32 v[18:19], v104 offset0:2 offset1:3
	ds_read2_b32 v[20:21], v103 offset0:224 offset1:225
	ds_read2_b32 v[22:23], v103 offset0:226 offset1:227
	ds_read2_b32 v[24:25], v103 offset0:192 offset1:193
	ds_read2_b32 v[26:27], v103 offset0:194 offset1:195
	ds_read2_b32 v[28:29], v103 offset0:160 offset1:161
	ds_read2_b32 v[30:31], v103 offset0:162 offset1:163
	ds_read2_b32 v[32:33], v103 offset0:128 offset1:129
	ds_read2_b32 v[34:35], v103 offset0:130 offset1:131
	ds_read2_b32 v[36:37], v103 offset0:96 offset1:97
	ds_read2_b32 v[38:39], v103 offset0:98 offset1:99
	ds_read2_b32 v[40:41], v103 offset0:64 offset1:65
	ds_read2_b32 v[42:43], v103 offset0:66 offset1:67
	ds_read2_b32 v[44:45], v103 offset0:32 offset1:33
	ds_read2_b32 v[46:47], v103 offset0:34 offset1:35
	s_waitcnt lgkmcnt(14)
	ds_write_b128 v7, v[16:19] offset:0
	ds_read2_b32 v[16:17], v103 offset0:0 offset1:1
	ds_read2_b32 v[18:19], v103 offset0:2 offset1:3
	s_waitcnt lgkmcnt(15)
	ds_write_b128 v7, v[20:23] offset:1024
	ds_read2_b32 v[20:21], v102 offset0:224 offset1:225
	ds_read2_b32 v[22:23], v102 offset0:226 offset1:227
	s_waitcnt lgkmcnt(15)
	ds_write_b128 v7, v[24:27] offset:2048
	ds_read2_b32 v[24:25], v102 offset0:192 offset1:193
	ds_read2_b32 v[26:27], v102 offset0:194 offset1:195
	s_waitcnt lgkmcnt(15)
	ds_write_b128 v7, v[28:31] offset:3072
	ds_read2_b32 v[28:29], v102 offset0:160 offset1:161
	ds_read2_b32 v[30:31], v102 offset0:162 offset1:163
	ds_write_b128 v7, v[32:35] offset:4096
	ds_read2_b32 v[32:33], v102 offset0:128 offset1:129
	ds_read2_b32 v[34:35], v102 offset0:130 offset1:131
	s_waitcnt lgkmcnt(15)
	ds_write_b128 v7, v[36:39] offset:5120
	ds_read2_b32 v[36:37], v102 offset0:96 offset1:97
	ds_read2_b32 v[38:39], v102 offset0:98 offset1:99
	ds_write_b128 v7, v[40:43] offset:6144
	ds_read2_b32 v[40:41], v102 offset0:64 offset1:65
	ds_read2_b32 v[42:43], v102 offset0:66 offset1:67
	ds_write_b128 v7, v[44:47] offset:7168
	ds_read2_b32 v[44:45], v102 offset0:32 offset1:33
	ds_read2_b32 v[46:47], v102 offset0:34 offset1:35
	s_waitcnt lgkmcnt(15)
	ds_write_b128 v7, v[16:19] offset:8192
	ds_read2_b32 v[16:17], v102 offset0:0 offset1:1
	ds_read2_b32 v[18:19], v102 offset0:2 offset1:3
	ds_write_b128 v7, v[20:23] offset:9216
	ds_read2_b32 v[20:21], v101 offset0:224 offset1:225
	ds_read2_b32 v[22:23], v101 offset0:226 offset1:227
	ds_write_b128 v7, v[24:27] offset:10240
	ds_read2_b32 v[24:25], v101 offset0:192 offset1:193
	ds_read2_b32 v[26:27], v101 offset0:194 offset1:195
	s_waitcnt lgkmcnt(15)
	ds_write_b128 v7, v[28:31] offset:11264
	ds_read2_b32 v[28:29], v101 offset0:160 offset1:161
	ds_read2_b32 v[30:31], v101 offset0:162 offset1:163
	ds_write_b128 v7, v[32:35] offset:12288
	ds_read2_b32 v[32:33], v101 offset0:128 offset1:129
	ds_read2_b32 v[34:35], v101 offset0:130 offset1:131
	ds_write_b128 v7, v[36:39] offset:13312
	ds_read2_b32 v[36:37], v101 offset0:96 offset1:97
	ds_read2_b32 v[38:39], v101 offset0:98 offset1:99
	s_waitcnt lgkmcnt(15)
	ds_write_b128 v7, v[40:43] offset:14336
	ds_read2_b32 v[40:41], v101 offset0:64 offset1:65
	ds_read2_b32 v[42:43], v101 offset0:66 offset1:67
	ds_write_b128 v7, v[44:47] offset:15360
	ds_read2_b32 v[44:45], v101 offset0:32 offset1:33
	ds_read2_b32 v[46:47], v101 offset0:34 offset1:35
	ds_write_b128 v7, v[16:19] offset:16384
	s_waitcnt lgkmcnt(15)
	ds_write_b128 v7, v[20:23] offset:17408
	ds_write_b128 v7, v[24:27] offset:18432
	s_waitcnt lgkmcnt(15)
	ds_write_b128 v7, v[28:31] offset:19456
	s_waitcnt lgkmcnt(13)
	ds_write_b128 v7, v[32:35] offset:20480
	s_waitcnt lgkmcnt(11)
	ds_write_b128 v7, v[36:39] offset:21504
	s_waitcnt lgkmcnt(9)
	ds_write_b128 v7, v[40:43] offset:22528
	s_waitcnt lgkmcnt(7)
	ds_write_b128 v7, v[44:47] offset:23552
	v_lshrrev_b32 v3, 2, v1
	v_and_b32 v4, 3, v1
	s_mov_b32 s29, 36864
	v_mul_lo_u32 v5, v3, s29
	v_lshl_add_u32 v5, v4, 4, v5
	s_lshl_b32 s30, s21, 6
	v_and_b32 v9, 15, v1
	v_lshrrev_b32 v10, 4, v1
	s_mov_b32 s29, 73728
	v_mul_lo_u32 v11, v9, s29
	v_lshl_add_u32 v11, v10, 4, v11
	v_lshrrev_b32 v12, 2, v9
	v_lshlrev_b32 v12, 3, v12
	v_and_b32 v13, 3, v9
	v_add_u32 v12, v12, v13
	v_lshlrev_b32 v13, 3, v10
	v_sub_u32 v12, v12, v13
	v_add_u32 v12, 32, v12
	v_add_u32 v13, 4, v12
	v_and_b32 v14, 1, v12
	v_bfe_u32 v2, v12, 1, 4
	v_lshl_add_u32 v2, v14, 1, v2
	v_and_b32 v2, 15, v2
	v_lshl_add_u32 v2, v14, 4, v2
	v_and_b32 v12, 32, v12
	v_add_u32 v12, v12, v2
	v_lshl_add_u32 v12, v12, 4, s22
	v_and_b32 v14, 1, v13
	v_bfe_u32 v2, v13, 1, 4
	v_lshl_add_u32 v2, v14, 1, v2
	v_and_b32 v2, 15, v2
	v_lshl_add_u32 v2, v14, 4, v2
	v_and_b32 v13, 32, v13
	v_add_u32 v13, v13, v2
	v_lshl_add_u32 v13, v13, 4, s22
	s_movk_i32 s31, 768
	v_mul_u32_u24 v14, s31, v10
	v_lshl_add_u32 v14, v9, 4, v14
	s_add_u32 s57, s22, 33792
	v_add_u32 v14, s57, v14
	v_and_b32 v15, 1, v3
	v_lshl_add_u32 v15, v15, 2, v4
	v_mul_u32_u24 v15, s31, v15
	v_lshrrev_b32 v2, 1, v3
	v_lshl_add_u32 v15, v2, 4, v15
	v_add_u32 v15, s57, v15
	v_lshrrev_b32 v2, 3, v1
	v_mul_u32_u24 v2, s31, v2
	v_and_b32 v3, 7, v1
	v_lshl_add_u32 v2, v3, 4, v2
	v_add_u32 v2, s57, v2
	v_mov_b32 v108, 0
	v_mov_b32 v109, 0
	v_mov_b32 v110, 0
	v_mov_b32 v111, 0
	ds_write_b128 v2, v[108:111]
	ds_write_b128 v2, v[108:111] offset:128
	s_and_b32 s59, s2, 1
	s_lshl_b32 s59, s59, 7
	v_mov_b32 v3, s59
	s_mov_b32 s59, 0x20000
	s_cmp_lg_u32 s20, 0
	s_cbranch_scc1 L_k12_passed
	s_mov_b64 exec, 1
L_k12_poll:
	global_load_dword v6, v3, s[26:27] sc1
	s_sub_u32 s59, s59, 1
	s_waitcnt vmcnt(0)
	v_readfirstlane_b32 s60, v6
	s_cmp_eq_u32 s59, 0
	s_cbranch_scc1 L_k12_got
	s_nop 0
	s_cmp_ge_u32 s60, 112
	s_cbranch_scc1 L_k12_got
	s_sleep 16
	s_branch L_k12_poll
L_k12_got:
	s_mov_b64 exec, -1
L_k12_passed:
	s_waitcnt lgkmcnt(0)
	s_barrier
	v_and_b32 v2, 15, v1
	v_mul_u32_u24 v2, 6912, v2
	v_lshrrev_b32 v3, 4, v1
	v_min_u32 v3, 2, v3
	v_mul_u32_u24 v3, 2304, v3
	v_add_u32 v2, v2, v3
	s_lshl_b32 s23, s21, 2
	s_add_u32 s23, s23, 4784128
	buffer_load_dword v167, v2, s[32:35], s23 offen sc1
	s_add_u32 s31, s30, 2424832
	buffer_load_dwordx4 v[224:227], v5, s[32:35], s31 offen sc1
	s_add_u32 s31, s30, 3014656
	buffer_load_dwordx4 v[228:231], v5, s[32:35], s31 offen sc1
	s_add_u32 s31, s30, 3604480
	buffer_load_dwordx4 v[232:235], v5, s[32:35], s31 offen sc1
	s_add_u32 s31, s30, 4194304
	buffer_load_dwordx4 v[236:239], v5, s[32:35], s31 offen sc1
	s_add_u32 s31, s30, 65536
	buffer_load_dwordx4 v[240:243], v11, s[32:35], s31 offen sc1
	s_add_u32 s31, s30, 102400
	buffer_load_dwordx4 v[244:247], v11, s[32:35], s31 offen sc1
	s_add_u32 s31, s30, 1245184
	buffer_load_dwordx4 v[248:251], v11, s[32:35], s31 offen sc1
	s_add_u32 s31, s30, 1282048
	buffer_load_dwordx4 v[252:255], v11, s[32:35], s31 offen sc1
	v_min_u32 v2, 3, v1
	v_lshlrev_b32 v2, 20, v2
	s_mov_b32 s31, 9797632
	buffer_load_dword v168, v2, s[32:35], s31 offen
	ds_write_b128 v7, v[128:131] offset:24576
	ds_write_b128 v7, v[132:135] offset:25600
	ds_write_b128 v7, v[136:139] offset:26624
	ds_write_b128 v7, v[140:143] offset:27648
	ds_write_b128 v7, v[144:147] offset:28672
	ds_write_b128 v7, v[148:151] offset:29696
	ds_write_b128 v7, v[152:155] offset:30720
	ds_write_b128 v7, v[156:159] offset:31744
	ds_write_b128 v7, v[160:163] offset:32768
	s_waitcnt vmcnt(9)
	v_add_f32_dpp v167, v167, v167 quad_perm:[1,0,3,2] row_mask:0xf bank_mask:0xf
	s_nop 1
	v_add_f32_dpp v167, v167, v167 quad_perm:[2,3,0,1] row_mask:0xf bank_mask:0xf
	s_nop 1
	v_add_f32_dpp v167, v167, v167 row_half_mirror row_mask:0xf bank_mask:0xf
	s_nop 1
	v_add_f32_dpp v167, v167, v167 row_mirror row_mask:0xf bank_mask:0xf
	v_cvt_pk_bf16_f32 v167, v167, v167
	v_lshlrev_b32 v167, 16, v167
	s_nop 0
	v_readlane_b32 s40, v167, 0
	v_readlane_b32 s41, v167, 16
	v_readlane_b32 s42, v167, 32
	v_mov_b32 v164, s40
	v_mov_b32 v165, s41
	v_mov_b32 v166, s42
	v_add_f32 v165, 1.0, v165
	v_cvt_pk_bf16_f32 v165, v165, v165
	v_lshlrev_b32 v165, 16, v165
	v_mov_b32 v170, v165
	v_mov_b32 v171, v165
	v_mov_b32 v172, v164
	v_mov_b32 v173, v164
	v_mov_b32 v174, s28
	v_mov_b32 v175, s28
	v_mov_b32 v176, v166
	v_mov_b32 v177, v166
	s_waitcnt vmcnt(8)
	v_lshlrev_b32 v180, 16, v224
	v_and_b32 v181, s58, v224
	v_lshlrev_b32 v182, 16, v225
	v_and_b32 v183, s58, v225
	v_lshlrev_b32 v184, 16, v226
	v_and_b32 v185, s58, v226
	v_lshlrev_b32 v186, 16, v227
	v_and_b32 v187, s58, v227
	v_pk_mul_f32 v[180:181], v[180:181], v[170:171]
	v_pk_mul_f32 v[182:183], v[182:183], v[170:171]
	v_pk_mul_f32 v[184:185], v[184:185], v[170:171]
	v_pk_mul_f32 v[186:187], v[186:187], v[170:171]
	v_cvt_pk_bf16_f32 v224, v180, v181
	v_cvt_pk_bf16_f32 v225, v182, v183
	v_cvt_pk_bf16_f32 v226, v184, v185
	v_cvt_pk_bf16_f32 v227, v186, v187
	v_lshlrev_b32 v180, 16, v224
	v_and_b32 v181, s58, v224
	v_lshlrev_b32 v182, 16, v225
	v_and_b32 v183, s58, v225
	v_lshlrev_b32 v184, 16, v226
	v_and_b32 v185, s58, v226
	v_lshlrev_b32 v186, 16, v227
	v_and_b32 v187, s58, v227
	v_pk_add_f32 v[180:181], v[180:181], v[172:173]
	v_pk_add_f32 v[182:183], v[182:183], v[172:173]
	v_pk_add_f32 v[184:185], v[184:185], v[172:173]
	v_pk_add_f32 v[186:187], v[186:187], v[172:173]
	v_cvt_pk_bf16_f32 v224, v180, v181
	v_cvt_pk_bf16_f32 v225, v182, v183
	v_cvt_pk_bf16_f32 v226, v184, v185
	v_cvt_pk_bf16_f32 v227, v186, v187
	ds_write_b128 v15, v[224:227] offset:256
	s_waitcnt vmcnt(7)
	v_lshlrev_b32 v180, 16, v228
	v_and_b32 v181, s58, v228
	v_lshlrev_b32 v182, 16, v229
	v_and_b32 v183, s58, v229
	v_lshlrev_b32 v184, 16, v230
	v_and_b32 v185, s58, v230
	v_lshlrev_b32 v186, 16, v231
	v_and_b32 v187, s58, v231
	v_pk_mul_f32 v[180:181], v[180:181], v[170:171]
	v_pk_mul_f32 v[182:183], v[182:183], v[170:171]
	v_pk_mul_f32 v[184:185], v[184:185], v[170:171]
	v_pk_mul_f32 v[186:187], v[186:187], v[170:171]
	v_cvt_pk_bf16_f32 v228, v180, v181
	v_cvt_pk_bf16_f32 v229, v182, v183
	v_cvt_pk_bf16_f32 v230, v184, v185
	v_cvt_pk_bf16_f32 v231, v186, v187
	v_lshlrev_b32 v180, 16, v228
	v_and_b32 v181, s58, v228
	v_lshlrev_b32 v182, 16, v229
	v_and_b32 v183, s58, v229
	v_lshlrev_b32 v184, 16, v230
	v_and_b32 v185, s58, v230
	v_lshlrev_b32 v186, 16, v231
	v_and_b32 v187, s58, v231
	v_pk_add_f32 v[180:181], v[180:181], v[172:173]
	v_pk_add_f32 v[182:183], v[182:183], v[172:173]
	v_pk_add_f32 v[184:185], v[184:185], v[172:173]
	v_pk_add_f32 v[186:187], v[186:187], v[172:173]
	v_cvt_pk_bf16_f32 v228, v180, v181
	v_cvt_pk_bf16_f32 v229, v182, v183
	v_cvt_pk_bf16_f32 v230, v184, v185
	v_cvt_pk_bf16_f32 v231, v186, v187
	ds_write_b128 v15, v[228:231] offset:384
	s_waitcnt vmcnt(6)
	v_lshlrev_b32 v180, 16, v232
	v_and_b32 v181, s58, v232
	v_lshlrev_b32 v182, 16, v233
	v_and_b32 v183, s58, v233
	v_lshlrev_b32 v184, 16, v234
	v_and_b32 v185, s58, v234
	v_lshlrev_b32 v186, 16, v235
	v_and_b32 v187, s58, v235
	v_pk_mul_f32 v[180:181], v[180:181], v[170:171]
	v_pk_mul_f32 v[182:183], v[182:183], v[170:171]
	v_pk_mul_f32 v[184:185], v[184:185], v[170:171]
	v_pk_mul_f32 v[186:187], v[186:187], v[170:171]
	v_cvt_pk_bf16_f32 v232, v180, v181
	v_cvt_pk_bf16_f32 v233, v182, v183
	v_cvt_pk_bf16_f32 v234, v184, v185
	v_cvt_pk_bf16_f32 v235, v186, v187
	v_lshlrev_b32 v180, 16, v232
	v_and_b32 v181, s58, v232
	v_lshlrev_b32 v182, 16, v233
	v_and_b32 v183, s58, v233
	v_lshlrev_b32 v184, 16, v234
	v_and_b32 v185, s58, v234
	v_lshlrev_b32 v186, 16, v235
	v_and_b32 v187, s58, v235
	v_pk_add_f32 v[180:181], v[180:181], v[172:173]
	v_pk_add_f32 v[182:183], v[182:183], v[172:173]
	v_pk_add_f32 v[184:185], v[184:185], v[172:173]
	v_pk_add_f32 v[186:187], v[186:187], v[172:173]
	v_cvt_pk_bf16_f32 v232, v180, v181
	v_cvt_pk_bf16_f32 v233, v182, v183
	v_cvt_pk_bf16_f32 v234, v184, v185
	v_cvt_pk_bf16_f32 v235, v186, v187
	ds_write_b128 v15, v[232:235] offset:512
	s_waitcnt vmcnt(5)
	v_lshlrev_b32 v180, 16, v236
	v_and_b32 v181, s58, v236
	v_lshlrev_b32 v182, 16, v237
	v_and_b32 v183, s58, v237
	v_lshlrev_b32 v184, 16, v238
	v_and_b32 v185, s58, v238
	v_lshlrev_b32 v186, 16, v239
	v_and_b32 v187, s58, v239
	v_pk_mul_f32 v[180:181], v[180:181], v[170:171]
	v_pk_mul_f32 v[182:183], v[182:183], v[170:171]
	v_pk_mul_f32 v[184:185], v[184:185], v[170:171]
	v_pk_mul_f32 v[186:187], v[186:187], v[170:171]
	v_cvt_pk_bf16_f32 v236, v180, v181
	v_cvt_pk_bf16_f32 v237, v182, v183
	v_cvt_pk_bf16_f32 v238, v184, v185
	v_cvt_pk_bf16_f32 v239, v186, v187
	v_lshlrev_b32 v180, 16, v236
	v_and_b32 v181, s58, v236
	v_lshlrev_b32 v182, 16, v237
	v_and_b32 v183, s58, v237
	v_lshlrev_b32 v184, 16, v238
	v_and_b32 v185, s58, v238
	v_lshlrev_b32 v186, 16, v239
	v_and_b32 v187, s58, v239
	v_pk_add_f32 v[180:181], v[180:181], v[172:173]
	v_pk_add_f32 v[182:183], v[182:183], v[172:173]
	v_pk_add_f32 v[184:185], v[184:185], v[172:173]
	v_pk_add_f32 v[186:187], v[186:187], v[172:173]
	v_cvt_pk_bf16_f32 v236, v180, v181
	v_cvt_pk_bf16_f32 v237, v182, v183
	v_cvt_pk_bf16_f32 v238, v184, v185
	v_cvt_pk_bf16_f32 v239, v186, v187
	ds_write_b128 v15, v[236:239] offset:640
	ds_read_b128 v[120:123], v12 offset:15872
	ds_read_b128 v[124:127], v13 offset:15872
	ds_read_b128 v[204:207], v14 offset:3584
	ds_read_b128 v[196:199], v14 offset:3328
	ds_read_b128 v[48:51], v12 offset:0
	ds_read_b128 v[52:55], v13 offset:0
	ds_read_b128 v[88:91], v12 offset:16384
	ds_read_b128 v[92:95], v13 offset:16384
	ds_read_b128 v[200:203], v14 offset:512
	ds_read_b128 v[192:195], v14 offset:256
	ds_read_b128 v[64:67], v12 offset:512
	ds_read_b128 v[68:71], v13 offset:512
	ds_read_b128 v[104:107], v12 offset:16896
	ds_read_b128 v[108:111], v13 offset:16896
	s_waitcnt lgkmcnt(0)
	v_mfma_f32_16x16x32_bf16 v[32:35], v[120:123], v[196:199], 0
	v_mfma_f32_16x16x32_bf16 v[36:39], v[124:127], v[196:199], 0
	ds_read_b128 v[220:223], v14 offset:3568
	v_mfma_f32_16x16x32_bf16 v[40:43], v[48:51], v[204:207], 0
	ds_read_b128 v[212:215], v14 offset:3312
	v_mfma_f32_16x16x32_bf16 v[44:47], v[52:55], v[204:207], 0
	ds_read_b128 v[56:59], v12 offset:1024
	v_mfma_f32_16x16x32_bf16 v[40:43], v[88:91], v[196:199], v[40:43]
	ds_read_b128 v[60:63], v13 offset:1024
	v_mfma_f32_16x16x32_bf16 v[44:47], v[92:95], v[196:199], v[44:47]
	ds_read_b128 v[96:99], v12 offset:17408
	v_mfma_f32_16x16x32_bf16 v[24:27], v[48:51], v[196:199], 0
	ds_read_b128 v[100:103], v13 offset:17408
	v_mfma_f32_16x16x32_bf16 v[28:31], v[52:55], v[196:199], 0
	ds_read_b128 v[216:219], v14 offset:496
	v_mfma_f32_16x16x32_bf16 v[32:35], v[48:51], v[200:203], v[32:35]
	ds_read_b128 v[208:211], v14 offset:240
	v_mfma_f32_16x16x32_bf16 v[36:39], v[52:55], v[200:203], v[36:39]
	ds_read_b128 v[72:75], v12 offset:1536
	v_mfma_f32_16x16x32_bf16 v[32:35], v[88:91], v[192:195], v[32:35]
	ds_read_b128 v[76:79], v13 offset:1536
	v_mfma_f32_16x16x32_bf16 v[36:39], v[92:95], v[192:195], v[36:39]
	ds_read_b128 v[112:115], v12 offset:17920
	v_mfma_f32_16x16x32_bf16 v[16:19], v[48:51], v[192:195], 0
	ds_read_b128 v[116:119], v13 offset:17920
	v_mfma_f32_16x16x32_bf16 v[20:23], v[52:55], v[192:195], 0
	v_mfma_f32_16x16x32_bf16 v[40:43], v[64:67], v[200:203], v[40:43]
	v_mfma_f32_16x16x32_bf16 v[44:47], v[68:71], v[200:203], v[44:47]
	v_mfma_f32_16x16x32_bf16 v[40:43], v[104:107], v[192:195], v[40:43]
	v_mfma_f32_16x16x32_bf16 v[44:47], v[108:111], v[192:195], v[44:47]
	v_mfma_f32_16x16x32_bf16 v[24:27], v[64:67], v[192:195], v[24:27]
	v_mfma_f32_16x16x32_bf16 v[28:31], v[68:71], v[192:195], v[28:31]
	s_waitcnt lgkmcnt(0)
	v_mfma_f32_16x16x32_bf16 v[32:35], v[64:67], v[220:223], v[32:35]
	v_mfma_f32_16x16x32_bf16 v[36:39], v[68:71], v[220:223], v[36:39]
	ds_read_b128 v[204:207], v14 offset:3552
	v_mfma_f32_16x16x32_bf16 v[32:35], v[104:107], v[212:215], v[32:35]
	ds_read_b128 v[196:199], v14 offset:3296
	v_mfma_f32_16x16x32_bf16 v[36:39], v[108:111], v[212:215], v[36:39]
	ds_read_b128 v[48:51], v12 offset:2048
	v_mfma_f32_16x16x32_bf16 v[16:19], v[64:67], v[212:215], v[16:19]
	ds_read_b128 v[52:55], v13 offset:2048
	v_mfma_f32_16x16x32_bf16 v[20:23], v[68:71], v[212:215], v[20:23]
	ds_read_b128 v[88:91], v12 offset:18432
	v_mfma_f32_16x16x32_bf16 v[40:43], v[56:59], v[220:223], v[40:43]
	ds_read_b128 v[92:95], v13 offset:18432
	v_mfma_f32_16x16x32_bf16 v[44:47], v[60:63], v[220:223], v[44:47]
	ds_read_b128 v[200:203], v14 offset:480
	v_mfma_f32_16x16x32_bf16 v[40:43], v[96:99], v[212:215], v[40:43]
	ds_read_b128 v[192:195], v14 offset:224
	v_mfma_f32_16x16x32_bf16 v[44:47], v[100:103], v[212:215], v[44:47]
	ds_read_b128 v[80:83], v12 offset:2560
	v_mfma_f32_16x16x32_bf16 v[24:27], v[56:59], v[212:215], v[24:27]
	ds_read_b128 v[84:87], v13 offset:2560
	v_mfma_f32_16x16x32_bf16 v[28:31], v[60:63], v[212:215], v[28:31]
	ds_read_b128 v[120:123], v12 offset:18944
	v_mfma_f32_16x16x32_bf16 v[32:35], v[56:59], v[216:219], v[32:35]
	ds_read_b128 v[124:127], v13 offset:18944
	v_mfma_f32_16x16x32_bf16 v[36:39], v[60:63], v[216:219], v[36:39]
	v_mfma_f32_16x16x32_bf16 v[32:35], v[96:99], v[208:211], v[32:35]
	v_mfma_f32_16x16x32_bf16 v[36:39], v[100:103], v[208:211], v[36:39]
	v_mfma_f32_16x16x32_bf16 v[16:19], v[56:59], v[208:211], v[16:19]
	v_mfma_f32_16x16x32_bf16 v[20:23], v[60:63], v[208:211], v[20:23]
	v_mfma_f32_16x16x32_bf16 v[40:43], v[72:75], v[216:219], v[40:43]
	v_mfma_f32_16x16x32_bf16 v[44:47], v[76:79], v[216:219], v[44:47]
	v_mfma_f32_16x16x32_bf16 v[40:43], v[112:115], v[208:211], v[40:43]
	v_mfma_f32_16x16x32_bf16 v[44:47], v[116:119], v[208:211], v[44:47]
	v_mfma_f32_16x16x32_bf16 v[24:27], v[72:75], v[208:211], v[24:27]
	v_mfma_f32_16x16x32_bf16 v[28:31], v[76:79], v[208:211], v[28:31]
	s_waitcnt lgkmcnt(0)
	v_mfma_f32_16x16x32_bf16 v[32:35], v[72:75], v[204:207], v[32:35]
	v_mfma_f32_16x16x32_bf16 v[36:39], v[76:79], v[204:207], v[36:39]
	ds_read_b128 v[220:223], v14 offset:3536
	v_mfma_f32_16x16x32_bf16 v[32:35], v[112:115], v[196:199], v[32:35]
	ds_read_b128 v[212:215], v14 offset:3280
	v_mfma_f32_16x16x32_bf16 v[36:39], v[116:119], v[196:199], v[36:39]
	ds_read_b128 v[56:59], v12 offset:3072
	v_mfma_f32_16x16x32_bf16 v[16:19], v[72:75], v[196:199], v[16:19]
	ds_read_b128 v[60:63], v13 offset:3072
	v_mfma_f32_16x16x32_bf16 v[20:23], v[76:79], v[196:199], v[20:23]
	ds_read_b128 v[96:99], v12 offset:19456
	v_mfma_f32_16x16x32_bf16 v[40:43], v[48:51], v[204:207], v[40:43]
	ds_read_b128 v[100:103], v13 offset:19456
	v_mfma_f32_16x16x32_bf16 v[44:47], v[52:55], v[204:207], v[44:47]
	ds_read_b128 v[216:219], v14 offset:464
	v_mfma_f32_16x16x32_bf16 v[40:43], v[88:91], v[196:199], v[40:43]
	ds_read_b128 v[208:211], v14 offset:208
	v_mfma_f32_16x16x32_bf16 v[44:47], v[92:95], v[196:199], v[44:47]
	ds_read_b128 v[64:67], v12 offset:3584
	v_mfma_f32_16x16x32_bf16 v[24:27], v[48:51], v[196:199], v[24:27]
	ds_read_b128 v[68:71], v13 offset:3584
	v_mfma_f32_16x16x32_bf16 v[28:31], v[52:55], v[196:199], v[28:31]
	ds_read_b128 v[104:107], v12 offset:19968
	v_mfma_f32_16x16x32_bf16 v[32:35], v[48:51], v[200:203], v[32:35]
	ds_read_b128 v[108:111], v13 offset:19968
	v_mfma_f32_16x16x32_bf16 v[36:39], v[52:55], v[200:203], v[36:39]
	v_mfma_f32_16x16x32_bf16 v[32:35], v[88:91], v[192:195], v[32:35]
	v_mfma_f32_16x16x32_bf16 v[36:39], v[92:95], v[192:195], v[36:39]
	v_mfma_f32_16x16x32_bf16 v[16:19], v[48:51], v[192:195], v[16:19]
	v_mfma_f32_16x16x32_bf16 v[20:23], v[52:55], v[192:195], v[20:23]
	v_mfma_f32_16x16x32_bf16 v[40:43], v[80:83], v[200:203], v[40:43]
	v_mfma_f32_16x16x32_bf16 v[44:47], v[84:87], v[200:203], v[44:47]
	v_mfma_f32_16x16x32_bf16 v[40:43], v[120:123], v[192:195], v[40:43]
	v_mfma_f32_16x16x32_bf16 v[44:47], v[124:127], v[192:195], v[44:47]
	v_mfma_f32_16x16x32_bf16 v[24:27], v[80:83], v[192:195], v[24:27]
	v_mfma_f32_16x16x32_bf16 v[28:31], v[84:87], v[192:195], v[28:31]
	s_waitcnt lgkmcnt(0)
	v_mfma_f32_16x16x32_bf16 v[32:35], v[80:83], v[220:223], v[32:35]
	v_mfma_f32_16x16x32_bf16 v[36:39], v[84:87], v[220:223], v[36:39]
	ds_read_b128 v[204:207], v14 offset:3520
	v_mfma_f32_16x16x32_bf16 v[32:35], v[120:123], v[212:215], v[32:35]
	ds_read_b128 v[196:199], v14 offset:3264
	v_mfma_f32_16x16x32_bf16 v[36:39], v[124:127], v[212:215], v[36:39]
	ds_read_b128 v[48:51], v12 offset:4096
	v_mfma_f32_16x16x32_bf16 v[16:19], v[80:83], v[212:215], v[16:19]
	ds_read_b128 v[52:55], v13 offset:4096
	v_mfma_f32_16x16x32_bf16 v[20:23], v[84:87], v[212:215], v[20:23]
	ds_read_b128 v[88:91], v12 offset:20480
	v_mfma_f32_16x16x32_bf16 v[40:43], v[56:59], v[220:223], v[40:43]
	ds_read_b128 v[92:95], v13 offset:20480
	v_mfma_f32_16x16x32_bf16 v[44:47], v[60:63], v[220:223], v[44:47]
	ds_read_b128 v[200:203], v14 offset:448
	v_mfma_f32_16x16x32_bf16 v[40:43], v[96:99], v[212:215], v[40:43]
	ds_read_b128 v[192:195], v14 offset:192
	v_mfma_f32_16x16x32_bf16 v[44:47], v[100:103], v[212:215], v[44:47]
	ds_read_b128 v[72:75], v12 offset:4608
	v_mfma_f32_16x16x32_bf16 v[24:27], v[56:59], v[212:215], v[24:27]
	ds_read_b128 v[76:79], v13 offset:4608
	v_mfma_f32_16x16x32_bf16 v[28:31], v[60:63], v[212:215], v[28:31]
	ds_read_b128 v[112:115], v12 offset:20992
	v_mfma_f32_16x16x32_bf16 v[32:35], v[56:59], v[216:219], v[32:35]
	ds_read_b128 v[116:119], v13 offset:20992
	v_mfma_f32_16x16x32_bf16 v[36:39], v[60:63], v[216:219], v[36:39]
	v_mfma_f32_16x16x32_bf16 v[32:35], v[96:99], v[208:211], v[32:35]
	v_mfma_f32_16x16x32_bf16 v[36:39], v[100:103], v[208:211], v[36:39]
	v_mfma_f32_16x16x32_bf16 v[16:19], v[56:59], v[208:211], v[16:19]
	v_mfma_f32_16x16x32_bf16 v[20:23], v[60:63], v[208:211], v[20:23]
	v_mfma_f32_16x16x32_bf16 v[40:43], v[64:67], v[216:219], v[40:43]
	v_mfma_f32_16x16x32_bf16 v[44:47], v[68:71], v[216:219], v[44:47]
	v_mfma_f32_16x16x32_bf16 v[40:43], v[104:107], v[208:211], v[40:43]
	v_mfma_f32_16x16x32_bf16 v[44:47], v[108:111], v[208:211], v[44:47]
	v_mfma_f32_16x16x32_bf16 v[24:27], v[64:67], v[208:211], v[24:27]
	v_mfma_f32_16x16x32_bf16 v[28:31], v[68:71], v[208:211], v[28:31]
	s_waitcnt lgkmcnt(0)
	v_mfma_f32_16x16x32_bf16 v[32:35], v[64:67], v[204:207], v[32:35]
	v_mfma_f32_16x16x32_bf16 v[36:39], v[68:71], v[204:207], v[36:39]
	ds_read_b128 v[220:223], v14 offset:3504
	v_mfma_f32_16x16x32_bf16 v[32:35], v[104:107], v[196:199], v[32:35]
	ds_read_b128 v[212:215], v14 offset:3248
	v_mfma_f32_16x16x32_bf16 v[36:39], v[108:111], v[196:199], v[36:39]
	ds_read_b128 v[56:59], v12 offset:5120
	v_mfma_f32_16x16x32_bf16 v[16:19], v[64:67], v[196:199], v[16:19]
	ds_read_b128 v[60:63], v13 offset:5120
	v_mfma_f32_16x16x32_bf16 v[20:23], v[68:71], v[196:199], v[20:23]
	ds_read_b128 v[96:99], v12 offset:21504
	v_mfma_f32_16x16x32_bf16 v[40:43], v[48:51], v[204:207], v[40:43]
	ds_read_b128 v[100:103], v13 offset:21504
	v_mfma_f32_16x16x32_bf16 v[44:47], v[52:55], v[204:207], v[44:47]
	ds_read_b128 v[216:219], v14 offset:432
	v_mfma_f32_16x16x32_bf16 v[40:43], v[88:91], v[196:199], v[40:43]
	ds_read_b128 v[208:211], v14 offset:176
	v_mfma_f32_16x16x32_bf16 v[44:47], v[92:95], v[196:199], v[44:47]
	ds_read_b128 v[80:83], v12 offset:5632
	v_mfma_f32_16x16x32_bf16 v[24:27], v[48:51], v[196:199], v[24:27]
	ds_read_b128 v[84:87], v13 offset:5632
	v_mfma_f32_16x16x32_bf16 v[28:31], v[52:55], v[196:199], v[28:31]
	ds_read_b128 v[120:123], v12 offset:22016
	v_mfma_f32_16x16x32_bf16 v[32:35], v[48:51], v[200:203], v[32:35]
	ds_read_b128 v[124:127], v13 offset:22016
	v_mfma_f32_16x16x32_bf16 v[36:39], v[52:55], v[200:203], v[36:39]
	v_mfma_f32_16x16x32_bf16 v[32:35], v[88:91], v[192:195], v[32:35]
	v_mfma_f32_16x16x32_bf16 v[36:39], v[92:95], v[192:195], v[36:39]
	v_mfma_f32_16x16x32_bf16 v[16:19], v[48:51], v[192:195], v[16:19]
	v_mfma_f32_16x16x32_bf16 v[20:23], v[52:55], v[192:195], v[20:23]
	v_mfma_f32_16x16x32_bf16 v[40:43], v[72:75], v[200:203], v[40:43]
	v_mfma_f32_16x16x32_bf16 v[44:47], v[76:79], v[200:203], v[44:47]
	v_mfma_f32_16x16x32_bf16 v[40:43], v[112:115], v[192:195], v[40:43]
	v_mfma_f32_16x16x32_bf16 v[44:47], v[116:119], v[192:195], v[44:47]
	v_mfma_f32_16x16x32_bf16 v[24:27], v[72:75], v[192:195], v[24:27]
	v_mfma_f32_16x16x32_bf16 v[28:31], v[76:79], v[192:195], v[28:31]
	s_waitcnt lgkmcnt(0)
	v_mfma_f32_16x16x32_bf16 v[32:35], v[72:75], v[220:223], v[32:35]
	v_mfma_f32_16x16x32_bf16 v[36:39], v[76:79], v[220:223], v[36:39]
	ds_read_b128 v[204:207], v14 offset:3488
	v_mfma_f32_16x16x32_bf16 v[32:35], v[112:115], v[212:215], v[32:35]
	ds_read_b128 v[196:199], v14 offset:3232
	v_mfma_f32_16x16x32_bf16 v[36:39], v[116:119], v[212:215], v[36:39]
	ds_read_b128 v[48:51], v12 offset:6144
	v_mfma_f32_16x16x32_bf16 v[16:19], v[72:75], v[212:215], v[16:19]
	ds_read_b128 v[52:55], v13 offset:6144
	v_mfma_f32_16x16x32_bf16 v[20:23], v[76:79], v[212:215], v[20:23]
	ds_read_b128 v[88:91], v12 offset:22528
	v_mfma_f32_16x16x32_bf16 v[40:43], v[56:59], v[220:223], v[40:43]
	ds_read_b128 v[92:95], v13 offset:22528
	v_mfma_f32_16x16x32_bf16 v[44:47], v[60:63], v[220:223], v[44:47]
	ds_read_b128 v[200:203], v14 offset:416
	v_mfma_f32_16x16x32_bf16 v[40:43], v[96:99], v[212:215], v[40:43]
	ds_read_b128 v[192:195], v14 offset:160
	v_mfma_f32_16x16x32_bf16 v[44:47], v[100:103], v[212:215], v[44:47]
	ds_read_b128 v[64:67], v12 offset:6656
	v_mfma_f32_16x16x32_bf16 v[24:27], v[56:59], v[212:215], v[24:27]
	ds_read_b128 v[68:71], v13 offset:6656
	v_mfma_f32_16x16x32_bf16 v[28:31], v[60:63], v[212:215], v[28:31]
	ds_read_b128 v[104:107], v12 offset:23040
	v_mfma_f32_16x16x32_bf16 v[32:35], v[56:59], v[216:219], v[32:35]
	ds_read_b128 v[108:111], v13 offset:23040
	v_mfma_f32_16x16x32_bf16 v[36:39], v[60:63], v[216:219], v[36:39]
	v_mfma_f32_16x16x32_bf16 v[32:35], v[96:99], v[208:211], v[32:35]
	v_mfma_f32_16x16x32_bf16 v[36:39], v[100:103], v[208:211], v[36:39]
	v_mfma_f32_16x16x32_bf16 v[16:19], v[56:59], v[208:211], v[16:19]
	v_mfma_f32_16x16x32_bf16 v[20:23], v[60:63], v[208:211], v[20:23]
	v_mfma_f32_16x16x32_bf16 v[40:43], v[80:83], v[216:219], v[40:43]
	v_mfma_f32_16x16x32_bf16 v[44:47], v[84:87], v[216:219], v[44:47]
	v_mfma_f32_16x16x32_bf16 v[40:43], v[120:123], v[208:211], v[40:43]
	v_mfma_f32_16x16x32_bf16 v[44:47], v[124:127], v[208:211], v[44:47]
	v_mfma_f32_16x16x32_bf16 v[24:27], v[80:83], v[208:211], v[24:27]
	v_mfma_f32_16x16x32_bf16 v[28:31], v[84:87], v[208:211], v[28:31]
	s_waitcnt lgkmcnt(0)
	v_mfma_f32_16x16x32_bf16 v[32:35], v[80:83], v[204:207], v[32:35]
	v_mfma_f32_16x16x32_bf16 v[36:39], v[84:87], v[204:207], v[36:39]
	ds_read_b128 v[220:223], v14 offset:3472
	v_mfma_f32_16x16x32_bf16 v[32:35], v[120:123], v[196:199], v[32:35]
	ds_read_b128 v[212:215], v14 offset:3216
	v_mfma_f32_16x16x32_bf16 v[36:39], v[124:127], v[196:199], v[36:39]
	ds_read_b128 v[56:59], v12 offset:7168
	v_mfma_f32_16x16x32_bf16 v[16:19], v[80:83], v[196:199], v[16:19]
	ds_read_b128 v[60:63], v13 offset:7168
	v_mfma_f32_16x16x32_bf16 v[20:23], v[84:87], v[196:199], v[20:23]
	ds_read_b128 v[96:99], v12 offset:23552
	v_mfma_f32_16x16x32_bf16 v[40:43], v[48:51], v[204:207], v[40:43]
	ds_read_b128 v[100:103], v13 offset:23552
	v_mfma_f32_16x16x32_bf16 v[44:47], v[52:55], v[204:207], v[44:47]
	ds_read_b128 v[216:219], v14 offset:400
	v_mfma_f32_16x16x32_bf16 v[40:43], v[88:91], v[196:199], v[40:43]
	ds_read_b128 v[208:211], v14 offset:144
	v_mfma_f32_16x16x32_bf16 v[44:47], v[92:95], v[196:199], v[44:47]
	ds_read_b128 v[72:75], v12 offset:7680
	v_mfma_f32_16x16x32_bf16 v[24:27], v[48:51], v[196:199], v[24:27]
	ds_read_b128 v[76:79], v13 offset:7680
	v_mfma_f32_16x16x32_bf16 v[28:31], v[52:55], v[196:199], v[28:31]
	ds_read_b128 v[112:115], v12 offset:24064
	v_mfma_f32_16x16x32_bf16 v[32:35], v[48:51], v[200:203], v[32:35]
	ds_read_b128 v[116:119], v13 offset:24064
	v_mfma_f32_16x16x32_bf16 v[36:39], v[52:55], v[200:203], v[36:39]
	v_mfma_f32_16x16x32_bf16 v[32:35], v[88:91], v[192:195], v[32:35]
	v_mfma_f32_16x16x32_bf16 v[36:39], v[92:95], v[192:195], v[36:39]
	v_mfma_f32_16x16x32_bf16 v[16:19], v[48:51], v[192:195], v[16:19]
	v_mfma_f32_16x16x32_bf16 v[20:23], v[52:55], v[192:195], v[20:23]
	v_mfma_f32_16x16x32_bf16 v[40:43], v[64:67], v[200:203], v[40:43]
	v_mfma_f32_16x16x32_bf16 v[44:47], v[68:71], v[200:203], v[44:47]
	v_mfma_f32_16x16x32_bf16 v[40:43], v[104:107], v[192:195], v[40:43]
	v_mfma_f32_16x16x32_bf16 v[44:47], v[108:111], v[192:195], v[44:47]
	v_mfma_f32_16x16x32_bf16 v[24:27], v[64:67], v[192:195], v[24:27]
	v_mfma_f32_16x16x32_bf16 v[28:31], v[68:71], v[192:195], v[28:31]
	s_waitcnt lgkmcnt(0)
	v_mfma_f32_16x16x32_bf16 v[32:35], v[64:67], v[220:223], v[32:35]
	v_mfma_f32_16x16x32_bf16 v[36:39], v[68:71], v[220:223], v[36:39]
	ds_read_b128 v[204:207], v14 offset:3456
	v_mfma_f32_16x16x32_bf16 v[32:35], v[104:107], v[212:215], v[32:35]
	ds_read_b128 v[196:199], v14 offset:3200
	v_mfma_f32_16x16x32_bf16 v[36:39], v[108:111], v[212:215], v[36:39]
	ds_read_b128 v[48:51], v12 offset:8192
	v_mfma_f32_16x16x32_bf16 v[16:19], v[64:67], v[212:215], v[16:19]
	ds_read_b128 v[52:55], v13 offset:8192
	v_mfma_f32_16x16x32_bf16 v[20:23], v[68:71], v[212:215], v[20:23]
	ds_read_b128 v[88:91], v12 offset:24576
	v_mfma_f32_16x16x32_bf16 v[40:43], v[56:59], v[220:223], v[40:43]
	ds_read_b128 v[92:95], v13 offset:24576
	v_mfma_f32_16x16x32_bf16 v[44:47], v[60:63], v[220:223], v[44:47]
	ds_read_b128 v[200:203], v14 offset:384
	v_mfma_f32_16x16x32_bf16 v[40:43], v[96:99], v[212:215], v[40:43]
	ds_read_b128 v[192:195], v14 offset:128
	v_mfma_f32_16x16x32_bf16 v[44:47], v[100:103], v[212:215], v[44:47]
	ds_read_b128 v[80:83], v12 offset:8704
	v_mfma_f32_16x16x32_bf16 v[24:27], v[56:59], v[212:215], v[24:27]
	ds_read_b128 v[84:87], v13 offset:8704
	v_mfma_f32_16x16x32_bf16 v[28:31], v[60:63], v[212:215], v[28:31]
	ds_read_b128 v[120:123], v12 offset:25088
	v_mfma_f32_16x16x32_bf16 v[32:35], v[56:59], v[216:219], v[32:35]
	ds_read_b128 v[124:127], v13 offset:25088
	v_mfma_f32_16x16x32_bf16 v[36:39], v[60:63], v[216:219], v[36:39]
	v_mfma_f32_16x16x32_bf16 v[32:35], v[96:99], v[208:211], v[32:35]
	v_mfma_f32_16x16x32_bf16 v[36:39], v[100:103], v[208:211], v[36:39]
	v_mfma_f32_16x16x32_bf16 v[16:19], v[56:59], v[208:211], v[16:19]
	v_mfma_f32_16x16x32_bf16 v[20:23], v[60:63], v[208:211], v[20:23]
	v_mfma_f32_16x16x32_bf16 v[40:43], v[72:75], v[216:219], v[40:43]
	v_mfma_f32_16x16x32_bf16 v[44:47], v[76:79], v[216:219], v[44:47]
	v_mfma_f32_16x16x32_bf16 v[40:43], v[112:115], v[208:211], v[40:43]
	v_mfma_f32_16x16x32_bf16 v[44:47], v[116:119], v[208:211], v[44:47]
	v_mfma_f32_16x16x32_bf16 v[24:27], v[72:75], v[208:211], v[24:27]
	v_mfma_f32_16x16x32_bf16 v[28:31], v[76:79], v[208:211], v[28:31]
	s_waitcnt lgkmcnt(0)
	v_mfma_f32_16x16x32_bf16 v[32:35], v[72:75], v[204:207], v[32:35]
	v_mfma_f32_16x16x32_bf16 v[36:39], v[76:79], v[204:207], v[36:39]
	ds_read_b128 v[220:223], v14 offset:3440
	v_mfma_f32_16x16x32_bf16 v[32:35], v[112:115], v[196:199], v[32:35]
	ds_read_b128 v[212:215], v14 offset:3184
	v_mfma_f32_16x16x32_bf16 v[36:39], v[116:119], v[196:199], v[36:39]
	ds_read_b128 v[56:59], v12 offset:9216
	v_mfma_f32_16x16x32_bf16 v[16:19], v[72:75], v[196:199], v[16:19]
	ds_read_b128 v[60:63], v13 offset:9216
	v_mfma_f32_16x16x32_bf16 v[20:23], v[76:79], v[196:199], v[20:23]
	ds_read_b128 v[96:99], v12 offset:25600
	v_mfma_f32_16x16x32_bf16 v[40:43], v[48:51], v[204:207], v[40:43]
	ds_read_b128 v[100:103], v13 offset:25600
	v_mfma_f32_16x16x32_bf16 v[44:47], v[52:55], v[204:207], v[44:47]
	ds_read_b128 v[216:219], v14 offset:368
	v_mfma_f32_16x16x32_bf16 v[40:43], v[88:91], v[196:199], v[40:43]
	ds_read_b128 v[208:211], v14 offset:112
	v_mfma_f32_16x16x32_bf16 v[44:47], v[92:95], v[196:199], v[44:47]
	ds_read_b128 v[64:67], v12 offset:9728
	v_mfma_f32_16x16x32_bf16 v[24:27], v[48:51], v[196:199], v[24:27]
	ds_read_b128 v[68:71], v13 offset:9728
	v_mfma_f32_16x16x32_bf16 v[28:31], v[52:55], v[196:199], v[28:31]
	ds_read_b128 v[104:107], v12 offset:26112
	v_mfma_f32_16x16x32_bf16 v[32:35], v[48:51], v[200:203], v[32:35]
	ds_read_b128 v[108:111], v13 offset:26112
	v_mfma_f32_16x16x32_bf16 v[36:39], v[52:55], v[200:203], v[36:39]
	v_mfma_f32_16x16x32_bf16 v[32:35], v[88:91], v[192:195], v[32:35]
	v_mfma_f32_16x16x32_bf16 v[36:39], v[92:95], v[192:195], v[36:39]
	v_mfma_f32_16x16x32_bf16 v[16:19], v[48:51], v[192:195], v[16:19]
	v_mfma_f32_16x16x32_bf16 v[20:23], v[52:55], v[192:195], v[20:23]
	v_mfma_f32_16x16x32_bf16 v[40:43], v[80:83], v[200:203], v[40:43]
	v_mfma_f32_16x16x32_bf16 v[44:47], v[84:87], v[200:203], v[44:47]
	v_mfma_f32_16x16x32_bf16 v[40:43], v[120:123], v[192:195], v[40:43]
	v_mfma_f32_16x16x32_bf16 v[44:47], v[124:127], v[192:195], v[44:47]
	v_mfma_f32_16x16x32_bf16 v[24:27], v[80:83], v[192:195], v[24:27]
	v_mfma_f32_16x16x32_bf16 v[28:31], v[84:87], v[192:195], v[28:31]
	s_waitcnt lgkmcnt(0)
	v_mfma_f32_16x16x32_bf16 v[32:35], v[80:83], v[220:223], v[32:35]
	v_mfma_f32_16x16x32_bf16 v[36:39], v[84:87], v[220:223], v[36:39]
	ds_read_b128 v[204:207], v14 offset:3424
	v_mfma_f32_16x16x32_bf16 v[32:35], v[120:123], v[212:215], v[32:35]
	ds_read_b128 v[196:199], v14 offset:3168
	v_mfma_f32_16x16x32_bf16 v[36:39], v[124:127], v[212:215], v[36:39]
	ds_read_b128 v[48:51], v12 offset:10240
	v_mfma_f32_16x16x32_bf16 v[16:19], v[80:83], v[212:215], v[16:19]
	ds_read_b128 v[52:55], v13 offset:10240
	v_mfma_f32_16x16x32_bf16 v[20:23], v[84:87], v[212:215], v[20:23]
	ds_read_b128 v[88:91], v12 offset:26624
	v_mfma_f32_16x16x32_bf16 v[40:43], v[56:59], v[220:223], v[40:43]
	ds_read_b128 v[92:95], v13 offset:26624
	v_mfma_f32_16x16x32_bf16 v[44:47], v[60:63], v[220:223], v[44:47]
	ds_read_b128 v[200:203], v14 offset:352
	v_mfma_f32_16x16x32_bf16 v[40:43], v[96:99], v[212:215], v[40:43]
	ds_read_b128 v[192:195], v14 offset:96
	v_mfma_f32_16x16x32_bf16 v[44:47], v[100:103], v[212:215], v[44:47]
	ds_read_b128 v[72:75], v12 offset:10752
	v_mfma_f32_16x16x32_bf16 v[24:27], v[56:59], v[212:215], v[24:27]
	ds_read_b128 v[76:79], v13 offset:10752
	v_mfma_f32_16x16x32_bf16 v[28:31], v[60:63], v[212:215], v[28:31]
	ds_read_b128 v[112:115], v12 offset:27136
	v_mfma_f32_16x16x32_bf16 v[32:35], v[56:59], v[216:219], v[32:35]
	ds_read_b128 v[116:119], v13 offset:27136
	v_mfma_f32_16x16x32_bf16 v[36:39], v[60:63], v[216:219], v[36:39]
	v_mfma_f32_16x16x32_bf16 v[32:35], v[96:99], v[208:211], v[32:35]
	v_mfma_f32_16x16x32_bf16 v[36:39], v[100:103], v[208:211], v[36:39]
	v_mfma_f32_16x16x32_bf16 v[16:19], v[56:59], v[208:211], v[16:19]
	v_mfma_f32_16x16x32_bf16 v[20:23], v[60:63], v[208:211], v[20:23]
	v_mfma_f32_16x16x32_bf16 v[40:43], v[64:67], v[216:219], v[40:43]
	v_mfma_f32_16x16x32_bf16 v[44:47], v[68:71], v[216:219], v[44:47]
	v_mfma_f32_16x16x32_bf16 v[40:43], v[104:107], v[208:211], v[40:43]
	v_mfma_f32_16x16x32_bf16 v[44:47], v[108:111], v[208:211], v[44:47]
	v_mfma_f32_16x16x32_bf16 v[24:27], v[64:67], v[208:211], v[24:27]
	v_mfma_f32_16x16x32_bf16 v[28:31], v[68:71], v[208:211], v[28:31]
	s_waitcnt lgkmcnt(0)
	v_mfma_f32_16x16x32_bf16 v[32:35], v[64:67], v[204:207], v[32:35]
	v_mfma_f32_16x16x32_bf16 v[36:39], v[68:71], v[204:207], v[36:39]
	ds_read_b128 v[220:223], v14 offset:3408
	v_mfma_f32_16x16x32_bf16 v[32:35], v[104:107], v[196:199], v[32:35]
	ds_read_b128 v[212:215], v14 offset:3152
	v_mfma_f32_16x16x32_bf16 v[36:39], v[108:111], v[196:199], v[36:39]
	ds_read_b128 v[56:59], v12 offset:11264
	v_mfma_f32_16x16x32_bf16 v[16:19], v[64:67], v[196:199], v[16:19]
	ds_read_b128 v[60:63], v13 offset:11264
	v_mfma_f32_16x16x32_bf16 v[20:23], v[68:71], v[196:199], v[20:23]
	ds_read_b128 v[96:99], v12 offset:27648
	v_mfma_f32_16x16x32_bf16 v[40:43], v[48:51], v[204:207], v[40:43]
	ds_read_b128 v[100:103], v13 offset:27648
	v_mfma_f32_16x16x32_bf16 v[44:47], v[52:55], v[204:207], v[44:47]
	ds_read_b128 v[216:219], v14 offset:336
	v_mfma_f32_16x16x32_bf16 v[40:43], v[88:91], v[196:199], v[40:43]
	ds_read_b128 v[208:211], v14 offset:80
	v_mfma_f32_16x16x32_bf16 v[44:47], v[92:95], v[196:199], v[44:47]
	ds_read_b128 v[80:83], v12 offset:11776
	v_mfma_f32_16x16x32_bf16 v[24:27], v[48:51], v[196:199], v[24:27]
	ds_read_b128 v[84:87], v13 offset:11776
	v_mfma_f32_16x16x32_bf16 v[28:31], v[52:55], v[196:199], v[28:31]
	ds_read_b128 v[120:123], v12 offset:28160
	v_mfma_f32_16x16x32_bf16 v[32:35], v[48:51], v[200:203], v[32:35]
	ds_read_b128 v[124:127], v13 offset:28160
	v_mfma_f32_16x16x32_bf16 v[36:39], v[52:55], v[200:203], v[36:39]
	v_mfma_f32_16x16x32_bf16 v[32:35], v[88:91], v[192:195], v[32:35]
	v_mfma_f32_16x16x32_bf16 v[36:39], v[92:95], v[192:195], v[36:39]
	v_mfma_f32_16x16x32_bf16 v[16:19], v[48:51], v[192:195], v[16:19]
	v_mfma_f32_16x16x32_bf16 v[20:23], v[52:55], v[192:195], v[20:23]
	v_mfma_f32_16x16x32_bf16 v[40:43], v[72:75], v[200:203], v[40:43]
	v_mfma_f32_16x16x32_bf16 v[44:47], v[76:79], v[200:203], v[44:47]
	v_mfma_f32_16x16x32_bf16 v[40:43], v[112:115], v[192:195], v[40:43]
	v_mfma_f32_16x16x32_bf16 v[44:47], v[116:119], v[192:195], v[44:47]
	v_mfma_f32_16x16x32_bf16 v[24:27], v[72:75], v[192:195], v[24:27]
	v_mfma_f32_16x16x32_bf16 v[28:31], v[76:79], v[192:195], v[28:31]
	s_waitcnt lgkmcnt(0)
	v_mfma_f32_16x16x32_bf16 v[32:35], v[72:75], v[220:223], v[32:35]
	v_mfma_f32_16x16x32_bf16 v[36:39], v[76:79], v[220:223], v[36:39]
	ds_read_b128 v[204:207], v14 offset:3392
	v_mfma_f32_16x16x32_bf16 v[32:35], v[112:115], v[212:215], v[32:35]
	ds_read_b128 v[196:199], v14 offset:3136
	v_mfma_f32_16x16x32_bf16 v[36:39], v[116:119], v[212:215], v[36:39]
	ds_read_b128 v[48:51], v12 offset:12288
	v_mfma_f32_16x16x32_bf16 v[16:19], v[72:75], v[212:215], v[16:19]
	ds_read_b128 v[52:55], v13 offset:12288
	v_mfma_f32_16x16x32_bf16 v[20:23], v[76:79], v[212:215], v[20:23]
	ds_read_b128 v[88:91], v12 offset:28672
	v_mfma_f32_16x16x32_bf16 v[40:43], v[56:59], v[220:223], v[40:43]
	ds_read_b128 v[92:95], v13 offset:28672
	v_mfma_f32_16x16x32_bf16 v[44:47], v[60:63], v[220:223], v[44:47]
	ds_read_b128 v[200:203], v14 offset:320
	v_mfma_f32_16x16x32_bf16 v[40:43], v[96:99], v[212:215], v[40:43]
	ds_read_b128 v[192:195], v14 offset:64
	v_mfma_f32_16x16x32_bf16 v[44:47], v[100:103], v[212:215], v[44:47]
	ds_read_b128 v[64:67], v12 offset:12800
	v_mfma_f32_16x16x32_bf16 v[24:27], v[56:59], v[212:215], v[24:27]
	ds_read_b128 v[68:71], v13 offset:12800
	v_mfma_f32_16x16x32_bf16 v[28:31], v[60:63], v[212:215], v[28:31]
	ds_read_b128 v[104:107], v12 offset:29184
	v_mfma_f32_16x16x32_bf16 v[32:35], v[56:59], v[216:219], v[32:35]
	ds_read_b128 v[108:111], v13 offset:29184
	v_mfma_f32_16x16x32_bf16 v[36:39], v[60:63], v[216:219], v[36:39]
	v_mfma_f32_16x16x32_bf16 v[32:35], v[96:99], v[208:211], v[32:35]
	v_mfma_f32_16x16x32_bf16 v[36:39], v[100:103], v[208:211], v[36:39]
	v_mfma_f32_16x16x32_bf16 v[16:19], v[56:59], v[208:211], v[16:19]
	v_mfma_f32_16x16x32_bf16 v[20:23], v[60:63], v[208:211], v[20:23]
	v_mfma_f32_16x16x32_bf16 v[40:43], v[80:83], v[216:219], v[40:43]
	v_mfma_f32_16x16x32_bf16 v[44:47], v[84:87], v[216:219], v[44:47]
	v_mfma_f32_16x16x32_bf16 v[40:43], v[120:123], v[208:211], v[40:43]
	v_mfma_f32_16x16x32_bf16 v[44:47], v[124:127], v[208:211], v[44:47]
	v_mfma_f32_16x16x32_bf16 v[24:27], v[80:83], v[208:211], v[24:27]
	v_mfma_f32_16x16x32_bf16 v[28:31], v[84:87], v[208:211], v[28:31]
	s_waitcnt lgkmcnt(0)
	v_mfma_f32_16x16x32_bf16 v[32:35], v[80:83], v[204:207], v[32:35]
	v_mfma_f32_16x16x32_bf16 v[36:39], v[84:87], v[204:207], v[36:39]
	ds_read_b128 v[220:223], v14 offset:3376
	v_mfma_f32_16x16x32_bf16 v[32:35], v[120:123], v[196:199], v[32:35]
	ds_read_b128 v[212:215], v14 offset:3120
	v_mfma_f32_16x16x32_bf16 v[36:39], v[124:127], v[196:199], v[36:39]
	ds_read_b128 v[56:59], v12 offset:13312
	v_mfma_f32_16x16x32_bf16 v[16:19], v[80:83], v[196:199], v[16:19]
	ds_read_b128 v[60:63], v13 offset:13312
	v_mfma_f32_16x16x32_bf16 v[20:23], v[84:87], v[196:199], v[20:23]
	ds_read_b128 v[96:99], v12 offset:29696
	v_mfma_f32_16x16x32_bf16 v[40:43], v[48:51], v[204:207], v[40:43]
	ds_read_b128 v[100:103], v13 offset:29696
	v_mfma_f32_16x16x32_bf16 v[44:47], v[52:55], v[204:207], v[44:47]
	ds_read_b128 v[216:219], v14 offset:304
	v_mfma_f32_16x16x32_bf16 v[40:43], v[88:91], v[196:199], v[40:43]
	ds_read_b128 v[208:211], v14 offset:48
	v_mfma_f32_16x16x32_bf16 v[44:47], v[92:95], v[196:199], v[44:47]
	ds_read_b128 v[72:75], v12 offset:13824
	v_mfma_f32_16x16x32_bf16 v[24:27], v[48:51], v[196:199], v[24:27]
	ds_read_b128 v[76:79], v13 offset:13824
	v_mfma_f32_16x16x32_bf16 v[28:31], v[52:55], v[196:199], v[28:31]
	ds_read_b128 v[112:115], v12 offset:30208
	v_mfma_f32_16x16x32_bf16 v[32:35], v[48:51], v[200:203], v[32:35]
	ds_read_b128 v[116:119], v13 offset:30208
	v_mfma_f32_16x16x32_bf16 v[36:39], v[52:55], v[200:203], v[36:39]
	v_mfma_f32_16x16x32_bf16 v[32:35], v[88:91], v[192:195], v[32:35]
	v_mfma_f32_16x16x32_bf16 v[36:39], v[92:95], v[192:195], v[36:39]
	v_mfma_f32_16x16x32_bf16 v[16:19], v[48:51], v[192:195], v[16:19]
	v_mfma_f32_16x16x32_bf16 v[20:23], v[52:55], v[192:195], v[20:23]
	v_mfma_f32_16x16x32_bf16 v[40:43], v[64:67], v[200:203], v[40:43]
	v_mfma_f32_16x16x32_bf16 v[44:47], v[68:71], v[200:203], v[44:47]
	v_mfma_f32_16x16x32_bf16 v[40:43], v[104:107], v[192:195], v[40:43]
	v_mfma_f32_16x16x32_bf16 v[44:47], v[108:111], v[192:195], v[44:47]
	v_mfma_f32_16x16x32_bf16 v[24:27], v[64:67], v[192:195], v[24:27]
	v_mfma_f32_16x16x32_bf16 v[28:31], v[68:71], v[192:195], v[28:31]
	s_waitcnt lgkmcnt(0)
	v_mfma_f32_16x16x32_bf16 v[32:35], v[64:67], v[220:223], v[32:35]
	v_mfma_f32_16x16x32_bf16 v[36:39], v[68:71], v[220:223], v[36:39]
	ds_read_b128 v[204:207], v14 offset:3360
	v_mfma_f32_16x16x32_bf16 v[32:35], v[104:107], v[212:215], v[32:35]
	ds_read_b128 v[196:199], v14 offset:3104
	v_mfma_f32_16x16x32_bf16 v[36:39], v[108:111], v[212:215], v[36:39]
	ds_read_b128 v[48:51], v12 offset:14336
	v_mfma_f32_16x16x32_bf16 v[16:19], v[64:67], v[212:215], v[16:19]
	ds_read_b128 v[52:55], v13 offset:14336
	v_mfma_f32_16x16x32_bf16 v[20:23], v[68:71], v[212:215], v[20:23]
	ds_read_b128 v[88:91], v12 offset:30720
	v_mfma_f32_16x16x32_bf16 v[40:43], v[56:59], v[220:223], v[40:43]
	ds_read_b128 v[92:95], v13 offset:30720
	v_mfma_f32_16x16x32_bf16 v[44:47], v[60:63], v[220:223], v[44:47]
	ds_read_b128 v[200:203], v14 offset:288
	v_mfma_f32_16x16x32_bf16 v[40:43], v[96:99], v[212:215], v[40:43]
	ds_read_b128 v[192:195], v14 offset:32
	v_mfma_f32_16x16x32_bf16 v[44:47], v[100:103], v[212:215], v[44:47]
	ds_read_b128 v[80:83], v12 offset:14848
	v_mfma_f32_16x16x32_bf16 v[24:27], v[56:59], v[212:215], v[24:27]
	ds_read_b128 v[84:87], v13 offset:14848
	v_mfma_f32_16x16x32_bf16 v[28:31], v[60:63], v[212:215], v[28:31]
	ds_read_b128 v[120:123], v12 offset:31232
	v_mfma_f32_16x16x32_bf16 v[32:35], v[56:59], v[216:219], v[32:35]
	ds_read_b128 v[124:127], v13 offset:31232
	v_mfma_f32_16x16x32_bf16 v[36:39], v[60:63], v[216:219], v[36:39]
	v_mfma_f32_16x16x32_bf16 v[32:35], v[96:99], v[208:211], v[32:35]
	v_mfma_f32_16x16x32_bf16 v[36:39], v[100:103], v[208:211], v[36:39]
	v_mfma_f32_16x16x32_bf16 v[16:19], v[56:59], v[208:211], v[16:19]
	v_mfma_f32_16x16x32_bf16 v[20:23], v[60:63], v[208:211], v[20:23]
	v_mfma_f32_16x16x32_bf16 v[40:43], v[72:75], v[216:219], v[40:43]
	v_mfma_f32_16x16x32_bf16 v[44:47], v[76:79], v[216:219], v[44:47]
	v_mfma_f32_16x16x32_bf16 v[40:43], v[112:115], v[208:211], v[40:43]
	v_mfma_f32_16x16x32_bf16 v[44:47], v[116:119], v[208:211], v[44:47]
	v_mfma_f32_16x16x32_bf16 v[24:27], v[72:75], v[208:211], v[24:27]
	v_mfma_f32_16x16x32_bf16 v[28:31], v[76:79], v[208:211], v[28:31]
	s_waitcnt lgkmcnt(0)
	v_mfma_f32_16x16x32_bf16 v[32:35], v[72:75], v[204:207], v[32:35]
	v_mfma_f32_16x16x32_bf16 v[36:39], v[76:79], v[204:207], v[36:39]
	ds_read_b128 v[220:223], v14 offset:3344
	v_mfma_f32_16x16x32_bf16 v[32:35], v[112:115], v[196:199], v[32:35]
	ds_read_b128 v[212:215], v14 offset:3088
	v_mfma_f32_16x16x32_bf16 v[36:39], v[116:119], v[196:199], v[36:39]
	ds_read_b128 v[56:59], v12 offset:15360
	v_mfma_f32_16x16x32_bf16 v[16:19], v[72:75], v[196:199], v[16:19]
	ds_read_b128 v[60:63], v13 offset:15360
	v_mfma_f32_16x16x32_bf16 v[20:23], v[76:79], v[196:199], v[20:23]
	ds_read_b128 v[96:99], v12 offset:31744
	v_mfma_f32_16x16x32_bf16 v[40:43], v[48:51], v[204:207], v[40:43]
	ds_read_b128 v[100:103], v13 offset:31744
	v_mfma_f32_16x16x32_bf16 v[44:47], v[52:55], v[204:207], v[44:47]
	ds_read_b128 v[216:219], v14 offset:272
	v_mfma_f32_16x16x32_bf16 v[40:43], v[88:91], v[196:199], v[40:43]
	ds_read_b128 v[208:211], v14 offset:16
	v_mfma_f32_16x16x32_bf16 v[44:47], v[92:95], v[196:199], v[44:47]
	ds_read_b128 v[64:67], v12 offset:15872
	v_mfma_f32_16x16x32_bf16 v[24:27], v[48:51], v[196:199], v[24:27]
	ds_read_b128 v[68:71], v13 offset:15872
	v_mfma_f32_16x16x32_bf16 v[28:31], v[52:55], v[196:199], v[28:31]
	ds_read_b128 v[104:107], v12 offset:32256
	v_mfma_f32_16x16x32_bf16 v[32:35], v[48:51], v[200:203], v[32:35]
	ds_read_b128 v[108:111], v13 offset:32256
	v_mfma_f32_16x16x32_bf16 v[36:39], v[52:55], v[200:203], v[36:39]
	v_mfma_f32_16x16x32_bf16 v[32:35], v[88:91], v[192:195], v[32:35]
	v_mfma_f32_16x16x32_bf16 v[36:39], v[92:95], v[192:195], v[36:39]
	v_mfma_f32_16x16x32_bf16 v[16:19], v[48:51], v[192:195], v[16:19]
	v_mfma_f32_16x16x32_bf16 v[20:23], v[52:55], v[192:195], v[20:23]
	v_mfma_f32_16x16x32_bf16 v[40:43], v[80:83], v[200:203], v[40:43]
	v_mfma_f32_16x16x32_bf16 v[44:47], v[84:87], v[200:203], v[44:47]
	v_mfma_f32_16x16x32_bf16 v[40:43], v[120:123], v[192:195], v[40:43]
	v_mfma_f32_16x16x32_bf16 v[44:47], v[124:127], v[192:195], v[44:47]
	v_mfma_f32_16x16x32_bf16 v[24:27], v[80:83], v[192:195], v[24:27]
	v_mfma_f32_16x16x32_bf16 v[28:31], v[84:87], v[192:195], v[28:31]
	s_waitcnt lgkmcnt(0)
	v_mfma_f32_16x16x32_bf16 v[32:35], v[80:83], v[220:223], v[32:35]
	v_mfma_f32_16x16x32_bf16 v[36:39], v[84:87], v[220:223], v[36:39]
	v_mfma_f32_16x16x32_bf16 v[32:35], v[120:123], v[212:215], v[32:35]
	v_mfma_f32_16x16x32_bf16 v[36:39], v[124:127], v[212:215], v[36:39]
	v_mfma_f32_16x16x32_bf16 v[16:19], v[80:83], v[212:215], v[16:19]
	v_mfma_f32_16x16x32_bf16 v[20:23], v[84:87], v[212:215], v[20:23]
	v_mfma_f32_16x16x32_bf16 v[40:43], v[56:59], v[220:223], v[40:43]
	v_mfma_f32_16x16x32_bf16 v[44:47], v[60:63], v[220:223], v[44:47]
	v_mfma_f32_16x16x32_bf16 v[40:43], v[96:99], v[212:215], v[40:43]
	v_mfma_f32_16x16x32_bf16 v[44:47], v[100:103], v[212:215], v[44:47]
	v_mfma_f32_16x16x32_bf16 v[24:27], v[56:59], v[212:215], v[24:27]
	v_mfma_f32_16x16x32_bf16 v[28:31], v[60:63], v[212:215], v[28:31]
	v_mfma_f32_16x16x32_bf16 v[32:35], v[56:59], v[216:219], v[32:35]
	v_mfma_f32_16x16x32_bf16 v[36:39], v[60:63], v[216:219], v[36:39]
	v_mfma_f32_16x16x32_bf16 v[32:35], v[96:99], v[208:211], v[32:35]
	v_mfma_f32_16x16x32_bf16 v[36:39], v[100:103], v[208:211], v[36:39]
	v_mfma_f32_16x16x32_bf16 v[16:19], v[56:59], v[208:211], v[16:19]
	v_mfma_f32_16x16x32_bf16 v[20:23], v[60:63], v[208:211], v[20:23]
	v_mfma_f32_16x16x32_bf16 v[40:43], v[64:67], v[216:219], v[40:43]
	v_mfma_f32_16x16x32_bf16 v[44:47], v[68:71], v[216:219], v[44:47]
	v_mfma_f32_16x16x32_bf16 v[40:43], v[104:107], v[208:211], v[40:43]
	v_mfma_f32_16x16x32_bf16 v[44:47], v[108:111], v[208:211], v[44:47]
	v_mfma_f32_16x16x32_bf16 v[24:27], v[64:67], v[208:211], v[24:27]
	v_mfma_f32_16x16x32_bf16 v[28:31], v[68:71], v[208:211], v[28:31]
	v_lshlrev_b32 v9, 7, v9
	v_lshl_add_u32 v9, v10, 4, v9
	v_add_u32 v9, s22, v9
	ds_read_b128 v[48:51], v14 offset:256
	ds_read_b128 v[52:55], v14 offset:3328
	ds_read_b128 v[56:59], v14 offset:512
	ds_read_b128 v[60:63], v14 offset:3584
	s_waitcnt vmcnt(4) lgkmcnt(3)
	v_lshlrev_b32 v180, 16, v48
	v_and_b32 v181, s58, v48
	v_lshlrev_b32 v182, 16, v49
	v_and_b32 v183, s58, v49
	v_lshlrev_b32 v184, 16, v50
	v_and_b32 v185, s58, v50
	v_lshlrev_b32 v186, 16, v51
	v_and_b32 v187, s58, v51
	v_pk_fma_f32 v[180:181], v[180:181], v[174:175], v[16:17]
	v_pk_fma_f32 v[182:183], v[182:183], v[174:175], v[18:19]
	v_pk_fma_f32 v[184:185], v[184:185], v[174:175], v[20:21]
	v_pk_fma_f32 v[186:187], v[186:187], v[174:175], v[22:23]
	v_lshlrev_b32 v192, 16, v240
	v_and_b32 v193, s58, v240
	v_lshlrev_b32 v194, 16, v241
	v_and_b32 v195, s58, v241
	v_lshlrev_b32 v196, 16, v242
	v_and_b32 v197, s58, v242
	v_lshlrev_b32 v198, 16, v243
	v_and_b32 v199, s58, v243
	v_pk_fma_f32 v[180:181], v[180:181], v[176:177], v[192:193]
	v_pk_fma_f32 v[182:183], v[182:183], v[176:177], v[194:195]
	v_pk_fma_f32 v[184:185], v[184:185], v[176:177], v[196:197]
	v_pk_fma_f32 v[186:187], v[186:187], v[176:177], v[198:199]
	v_cvt_pk_bf16_f32 v240, v180, v181
	v_cvt_pk_bf16_f32 v241, v182, v183
	v_cvt_pk_bf16_f32 v242, v184, v185
	v_cvt_pk_bf16_f32 v243, v186, v187
	ds_write_b128 v9, v[240:243] offset:0
	s_waitcnt vmcnt(3) lgkmcnt(3)
	v_lshlrev_b32 v180, 16, v52
	v_and_b32 v181, s58, v52
	v_lshlrev_b32 v182, 16, v53
	v_and_b32 v183, s58, v53
	v_lshlrev_b32 v184, 16, v54
	v_and_b32 v185, s58, v54
	v_lshlrev_b32 v186, 16, v55
	v_and_b32 v187, s58, v55
	v_pk_fma_f32 v[180:181], v[180:181], v[174:175], v[24:25]
	v_pk_fma_f32 v[182:183], v[182:183], v[174:175], v[26:27]
	v_pk_fma_f32 v[184:185], v[184:185], v[174:175], v[28:29]
	v_pk_fma_f32 v[186:187], v[186:187], v[174:175], v[30:31]
	v_lshlrev_b32 v192, 16, v244
	v_and_b32 v193, s58, v244
	v_lshlrev_b32 v194, 16, v245
	v_and_b32 v195, s58, v245
	v_lshlrev_b32 v196, 16, v246
	v_and_b32 v197, s58, v246
	v_lshlrev_b32 v198, 16, v247
	v_and_b32 v199, s58, v247
	v_pk_fma_f32 v[180:181], v[180:181], v[176:177], v[192:193]
	v_pk_fma_f32 v[182:183], v[182:183], v[176:177], v[194:195]
	v_pk_fma_f32 v[184:185], v[184:185], v[176:177], v[196:197]
	v_pk_fma_f32 v[186:187], v[186:187], v[176:177], v[198:199]
	v_cvt_pk_bf16_f32 v244, v180, v181
	v_cvt_pk_bf16_f32 v245, v182, v183
	v_cvt_pk_bf16_f32 v246, v184, v185
	v_cvt_pk_bf16_f32 v247, v186, v187
	ds_write_b128 v9, v[244:247] offset:64
	s_waitcnt vmcnt(2) lgkmcnt(3)
	v_lshlrev_b32 v180, 16, v56
	v_and_b32 v181, s58, v56
	v_lshlrev_b32 v182, 16, v57
	v_and_b32 v183, s58, v57
	v_lshlrev_b32 v184, 16, v58
	v_and_b32 v185, s58, v58
	v_lshlrev_b32 v186, 16, v59
	v_and_b32 v187, s58, v59
	v_pk_fma_f32 v[180:181], v[180:181], v[174:175], v[32:33]
	v_pk_fma_f32 v[182:183], v[182:183], v[174:175], v[34:35]
	v_pk_fma_f32 v[184:185], v[184:185], v[174:175], v[36:37]
	v_pk_fma_f32 v[186:187], v[186:187], v[174:175], v[38:39]
	v_lshlrev_b32 v192, 16, v248
	v_and_b32 v193, s58, v248
	v_lshlrev_b32 v194, 16, v249
	v_and_b32 v195, s58, v249
	v_lshlrev_b32 v196, 16, v250
	v_and_b32 v197, s58, v250
	v_lshlrev_b32 v198, 16, v251
	v_and_b32 v199, s58, v251
	v_pk_fma_f32 v[180:181], v[180:181], v[176:177], v[192:193]
	v_pk_fma_f32 v[182:183], v[182:183], v[176:177], v[194:195]
	v_pk_fma_f32 v[184:185], v[184:185], v[176:177], v[196:197]
	v_pk_fma_f32 v[186:187], v[186:187], v[176:177], v[198:199]
	v_cvt_pk_bf16_f32 v248, v180, v181
	v_cvt_pk_bf16_f32 v249, v182, v183
	v_cvt_pk_bf16_f32 v250, v184, v185
	v_cvt_pk_bf16_f32 v251, v186, v187
	ds_write_b128 v9, v[248:251] offset:2048
	s_waitcnt vmcnt(1) lgkmcnt(3)
	v_lshlrev_b32 v180, 16, v60
	v_and_b32 v181, s58, v60
	v_lshlrev_b32 v182, 16, v61
	v_and_b32 v183, s58, v61
	v_lshlrev_b32 v184, 16, v62
	v_and_b32 v185, s58, v62
	v_lshlrev_b32 v186, 16, v63
	v_and_b32 v187, s58, v63
	v_pk_fma_f32 v[180:181], v[180:181], v[174:175], v[40:41]
	v_pk_fma_f32 v[182:183], v[182:183], v[174:175], v[42:43]
	v_pk_fma_f32 v[184:185], v[184:185], v[174:175], v[44:45]
	v_pk_fma_f32 v[186:187], v[186:187], v[174:175], v[46:47]
	v_lshlrev_b32 v192, 16, v252
	v_and_b32 v193, s58, v252
	v_lshlrev_b32 v194, 16, v253
	v_and_b32 v195, s58, v253
	v_lshlrev_b32 v196, 16, v254
	v_and_b32 v197, s58, v254
	v_lshlrev_b32 v198, 16, v255
	v_and_b32 v199, s58, v255
	v_pk_fma_f32 v[180:181], v[180:181], v[176:177], v[192:193]
	v_pk_fma_f32 v[182:183], v[182:183], v[176:177], v[194:195]
	v_pk_fma_f32 v[184:185], v[184:185], v[176:177], v[196:197]
	v_pk_fma_f32 v[186:187], v[186:187], v[176:177], v[198:199]
	v_cvt_pk_bf16_f32 v252, v180, v181
	v_cvt_pk_bf16_f32 v253, v182, v183
	v_cvt_pk_bf16_f32 v254, v184, v185
	v_cvt_pk_bf16_f32 v255, v186, v187
	ds_write_b128 v9, v[252:255] offset:2112
	v_lshrrev_b32 v3, 4, v1
	v_and_b32 v4, 15, v1
	v_lshlrev_b32 v2, 6, v3
	v_lshl_add_u32 v2, v4, 2, v2
	s_lshl_b32 s31, s20, 10
	v_add_u32 v2, s31, v2
	v_add_u32 v5, 79872, v2
	s_mov_b32 s29, 36864
	v_mul_lo_u32 v3, v3, s29
	v_lshl_add_u32 v3, v4, 4, v3
	s_mul_i32 s31, s20, 589824
	s_lshl_b32 s59, s3, 8
	s_add_u32 s31, s31, s59
	s_add_u32 s31, s31, 9797632
	s_mov_b32 s61, 0x05040100
	s_mov_b32 s62, 0x07060302
	s_waitcnt lgkmcnt(0)
	s_barrier
	ds_read_b32 v48, v2 offset:0
	ds_read_b32 v49, v2 offset:39936
	ds_read_b32 v50, v5 offset:0
	ds_read_b32 v51, v5 offset:39936
	ds_read_b32 v52, v2 offset:256
	ds_read_b32 v53, v2 offset:40192
	ds_read_b32 v54, v5 offset:256
	ds_read_b32 v55, v5 offset:40192
	ds_read_b32 v56, v2 offset:512
	ds_read_b32 v57, v2 offset:40448
	ds_read_b32 v58, v5 offset:512
	ds_read_b32 v59, v5 offset:40448
	ds_read_b32 v60, v2 offset:768
	ds_read_b32 v61, v2 offset:40704
	ds_read_b32 v62, v5 offset:768
	ds_read_b32 v63, v5 offset:40704
	s_waitcnt lgkmcnt(12)
	v_perm_b32 v64, v49, v48, s61
	v_perm_b32 v65, v51, v50, s61
	v_perm_b32 v66, v49, v48, s62
	v_perm_b32 v67, v51, v50, s62
	s_add_u32 s59, s31, 0
	buffer_store_dwordx4 v[64:67], v3, s[32:35], s59 offen sc1
	s_waitcnt lgkmcnt(8)
	v_perm_b32 v68, v53, v52, s61
	v_perm_b32 v69, v55, v54, s61
	v_perm_b32 v70, v53, v52, s62
	v_perm_b32 v71, v55, v54, s62
	s_add_u32 s59, s31, 147456
	buffer_store_dwordx4 v[68:71], v3, s[32:35], s59 offen sc1
	s_waitcnt lgkmcnt(4)
	v_perm_b32 v72, v57, v56, s61
	v_perm_b32 v73, v59, v58, s61
	v_perm_b32 v74, v57, v56, s62
	v_perm_b32 v75, v59, v58, s62
	s_add_u32 s59, s31, 294912
	buffer_store_dwordx4 v[72:75], v3, s[32:35], s59 offen sc1
	s_waitcnt lgkmcnt(0)
	v_perm_b32 v76, v61, v60, s61
	v_perm_b32 v77, v63, v62, s61
	v_perm_b32 v78, v61, v60, s62
	v_perm_b32 v79, v63, v62, s62
	s_add_u32 s59, s31, 442368
	buffer_store_dwordx4 v[76:79], v3, s[32:35], s59 offen sc1
	s_endpgm
L_k12_exit:
	s_endpgm
.p2align 4
.type K1_TBL,@object
K1_TBL:
.short 4600,4600,4600,4600,4600,4600,4600,4600,4600,4600,4600,4600,4600,4600,4600,4600
.short 4600,4600,4600,4600,4600,4600,4600,4600,4600,4600,4600,4600,4600,4600,4600,4600
.short 4600,4096,4096,4096,4096,4080,4080,4080,4080,4080,4080,4080,4064,4064,4064,4064
.short 4064,4064,4064,4064,4064,4048,4048,4048,4048,4048,4048,4048,4032,4032,4032,4032
.short 4032,4032,4032,4032,4032,4016,4016,4016,4016,4016,4016,4016,4000,4000,4000,4000
.short 4000,4000,4000,4000,4000,3984,3984,3984,3984,3984,3984,3984,3968,3968,3968,3968
.short 3968,3968,3968,3968,3968,3952,3952,3952,3952,3952,3952,3952,3936,3936,3936,3936
.short 3936,3936,3936,3936,3936,3920,3920,3920,3920,3920,3920,3920,3904,3904,3904,3904
.short 3904,3904,3904,3904,3904,3888,3888,3888,3888,3888,3888,3888,3872,3872,3872,3872
.short 3872,3872,3872,3872,3872,3856,3856,3856,3856,3856,3856,3856,3840,3840,3840,3840
.short 3840,3840,3840,3840,3840,3824,3824,3824,3824,3824,3824,3824,3808,3808,3808,3808
.short 3808,3808,3808,3808,3808,3792,3792,3792,3792,3792,3792,3792,3776,3776,3776,3776
.short 3776,3776,3776,3776,3776,3760,3760,3760,3760,3760,3760,3760,3744,3744,3744,3744
.short 3744,3744,3744,3744,3744,3728,3728,3728,3728,3728,3728,3728,3712,3712,3712,3712
.short 3712,3712,3712,3712,3712,3696,3696,3696,3696,3696,3696,3696,3680,3680,3680,3680
.short 3680,3680,3680,3680,3680,3664,3664,3664,3664,3664,3664,3664,3648,3648,3648,3648
.short 3648,3648,3648,3648,3648,3632,3632,3632,3632,3632,3632,3632,3616,3616,3616,3616
.short 3616,3616,3616,3616,3616,3600,3600,3600,3600,3600,3600,3600,3584,3584,3584,3584
.short 3584,3584,3584,3584,3584,3568,3568,3568,3568,3568,3568,3568,3552,3552,3552,3552
.short 3552,3552,3552,3552,3552,3536,3536,3536,3536,3536,3536,3536,3520,3520,3520,3520
.short 3520,3520,3520,3520,3520,3504,3504,3504,3504,3504,3504,3504,3488,3488,3488,3488
.short 3488,3488,3488,3488,3488,3472,3472,3472,3472,3472,3472,3472,3456,3456,3456,3456
.short 3456,3456,3456,3456,3456,3440,3440,3440,3440,3440,3440,3440,3424,3424,3424,3424
.short 3424,3424,3424,3424,3424,3408,3408,3408,3408,3408,3408,3408,3392,3392,3392,3392
.short 3392,3392,3392,3392,3392,3376,3376,3376,3376,3376,3376,3376,3360,3360,3360,3360
.short 3360,3360,3360,3360,3360,3344,3344,3344,3344,3344,3344,3344,3328,3328,3328,3328
.short 3328,3328,3328,3328,3328,3312,3312,3312,3312,3312,3312,3312,3296,3296,3296,3296
.short 3296,3296,3296,3296,3296,3280,3280,3280,3280,3280,3280,3280,3264,3264,3264,3264
.short 3264,3264,3264,3264,3264,3248,3248,3248,3248,3248,3248,3248,3232,3232,3232,3232
.short 3232,3232,3232,3232,3232,3216,3216,3216,3216,3216,3216,3216,3200,3200,3200,3200
.short 3200,3200,3200,3200,3200,3184,3184,3184,3184,3184,3184,3184,3168,3168,3168,3168
.short 3168,3168,3168,3168,3168,3152,3152,3152,3152,3152,3152,3152,3136,3136,3136,3136
.short 3136,3136,3136,3136,3136,3120,3120,3120,3120,3120,3120,3120,3104,3104,3104,3104
.short 3104,3104,3104,3104,3104,3088,3088,3088,3088,3088,3088,3088,3072,3072,3072,3072
.short 3072,3072,3072,3072,3072,3056,3056,3056,3056,3056,3056,3056,3040,3040,3040,3040
.short 3040,3040,3040,3040,3040,3024,3024,3024,3024,3024,3024,3024,3008,3008,3008,3008
.short 3008,3008,3008,3008,3008,2992,2992,2992,2992,2992,2992,2992,2976,2976,2976,2976
.short 2976,2976,2976,2976,2976,2960,2960,2960,2960,2960,2960,2960,2944,2944,2944,2944
.short 2944,2944,2944,2944,2944,2928,2928,2928,2928,2928,2928,2928,2912,2912,2912,2912
.short 2912,2912,2912,2912,2912,2896,2896,2896,2896,2896,2896,2896,2880,2880,2880,2880
.short 2880,2880,2880,2880,2880,2864,2864,2864,2864,2864,2864,2864,2848,2848,2848,2848
.short 2848,2848,2848,2848,2848,2832,2832,2832,2832,2832,2832,2832,2816,2816,2816,2816
.short 2816,2816,2816,2816,2816,2800,2800,2800,2800,2800,2800,2800,2784,2784,2784,2784
.short 2784,2784,2784,2784,2784,2768,2768,2768,2768,2768,2768,2768,2752,2752,2752,2752
.short 2752,2752,2752,2752,2752,2736,2736,2736,2736,2736,2736,2736,2720,2720,2720,2720
.short 2720,2720,2720,2720,2720,2704,2704,2704,2704,2704,2704,2704,2688,2688,2688,2688
.short 2688,2688,2688,2688,2688,2672,2672,2672,2672,2672,2672,2672,2656,2656,2656,2656
.short 2656,2656,2656,2656,2656,2640,2640,2640,2640,2640,2640,2640,2624,2624,2624,2624
.short 2624,2624,2624,2624,2624,2608,2608,2608,2608,2608,2608,2608,2592,2592,2592,2592
.short 2592,2592,2592,2592,2592,2576,2576,2576,2576,2576,2576,2576,2560,2560,2560,2560
.short 2560,2560,2560,2560,2560,2544,2544,2544,2544,2544,2544,2544,2528,2528,2528,2528
.short 2528,2528,2528,2528,2528,2512,2512,2512,2512,2512,2512,2512,2496,2496,2496,2496
.short 2496,2496,2496,2496,2496,2480,2480,2480,2480,2480,2480,2480,2464,2464,2464,2464
.short 2464,2464,2464,2464,2464,2448,2448,2448,2448,2448,2448,2448,2432,2432,2432,2432
.short 2432,2432,2432,2432,2432,2416,2416,2416,2416,2416,2416,2416,2400,2400,2400,2400
.short 2400,2400,2400,2400,2400,2384,2384,2384,2384,2384,2384,2384,2368,2368,2368,2368
.short 2368,2368,2368,2368,2368,2352,2352,2352,2352,2352,2352,2352,2336,2336,2336,2336
.short 2336,2336,2336,2336,2336,2320,2320,2320,2320,2320,2320,2320,2304,2304,2304,2304
.short 2304,2304,2304,2304,2304,2288,2288,2288,2288,2288,2288,2288,2272,2272,2272,2272
.short 2272,2272,2272,2272,2272,2256,2256,2256,2256,2256,2256,2256,2240,2240,2240,2240
.short 2240,2240,2240,2240,2240,2224,2224,2224,2224,2224,2224,2224,2208,2208,2208,2208
.short 2208,2208,2208,2208,2208,2192,2192,2192,2192,2192,2192,2192,2176,2176,2176,2176
.short 2176,2176,2176,2176,2176,2160,2160,2160,2160,2160,2160,2160,2144,2144,2144,2144
.short 2144,2144,2144,2144,2144,2128,2128,2128,2128,2128,2128,2128,2112,2112,2112,2112
.short 2112,2112,2112,2112,2112,2096,2096,2096,2096,2096,2096,2096,2080,2080,2080,2080
.short 2080,2080,2080,2080,2080,2064,2064,2064,2064,2064,2064,2064,2048,2048,2048,2048
.short 2048,2048,2048,2040,2040,2040,2032,2032,2032,2032,2032,2024,2024,2024,2016,2016
.short 2016,2016,2016,2008,2008,2008,2000,2000,2000,2000,2000,1992,1992,1992,1984,1984
.short 1984,1984,1984,1976,1976,1976,1968,1968,1968,1968,1968,1960,1960,1960,1952,1952
.short 1952,1952,1952,1944,1944,1944,1936,1936,1936,1936,1936,1928,1928,1928,1920,1920
.short 1920,1920,1920,1912,1912,1912,1904,1904,1904,1904,1904,1896,1896,1896,1888,1888
.short 1888,1888,1888,1880,1880,1880,1872,1872,1872,1872,1872,1864,1864,1864,1856,1856
.short 1856,1856,1856,1848,1848,1848,1840,1840,1840,1840,1840,1832,1832,1832,1824,1824
.short 1824,1824,1824,1816,1816,1816,1808,1808,1808,1808,1808,1800,1800,1800,1792,1792
.short 1792,1792,1792,1784,1784,1784,1776,1776,1776,1776,1776,1768,1768,1768,1760,1760
.short 1760,1760,1760,1752,1752,1752,1744,1744,1744,1744,1744,1736,1736,1736,1728,1728
.short 1728,1728,1728,1720,1720,1720,1712,1712,1712,1712,1712,1704,1704,1704,1696,1696
.short 1696,1696,1696,1688,1688,1688,1680,1680,1680,1680,1680,1672,1672,1672,1664,1664
.short 1664,1664,1664,1656,1656,1656,1648,1648,1648,1648,1648,1640,1640,1640,1632,1632
.short 1632,1632,1632,1624,1624,1624,1616,1616,1616,1616,1616,1608,1608,1608,1600,1600
.short 1600,1600,1600,1592,1592,1592,1584,1584,1584,1584,1584,1576,1576,1576,1568,1568
.short 1568,1568,1568,1560,1560,1560,1552,1552,1552,1552,1552,1544,1544,1544,1536,1536
.short 1536,1536,1536,1528,1528,1528,1520,1520,1520,1520,1520,1512,1512,1512,1504,1504
.short 1504,1504,1504,1496,1496,1496,1488,1488,1488,1488,1488,1480,1480,1480,1472,1472
.short 1472,1472,1472,1464,1464,1464,1456,1456,1456,1456,1456,1448,1448,1448,1440,1440
.short 1440,1440,1440,1432,1432,1432,1424,1424,1424,1424,1424,1416,1416,1416,1408,1408
.short 1408,1408,1408,1400,1400,1400,1392,1392,1392,1392,1392,1384,1384,1384,1376,1376
.short 1376,1376,1376,1368,1368,1368,1360,1360,1360,1360,1360,1352,1352,1352,1344,1344
.short 1344,1344,1344,1336,1336,1336,1328,1328,1328,1328,1328,1320,1320,1320,1312,1312
.short 1312,1312,1312,1304,1304,1304,1296,1296,1296,1296,1296,1288,1288,1288,1280,1280
.short 1280,1280,1280,1272,1272,1272,1264,1264,1264,1264,1264,1256,1256,1256,1248,1248
.short 1248,1248,1248,1240,1240,1240,1232,1232,1232,1232,1232,1224,1224,1224,1216,1216
.short 1216,1216,1216,1208,1208,1208,1200,1200,1200,1200,1200,1192,1192,1192,1184,1184
.short 1184,1184,1184,1176,1176,1176,1168,1168,1168,1168,1168,1160,1160,1160,1152,1152
.short 1152,1152,1152,1144,1144,1144,1136,1136,1136,1136,1136,1128,1128,1128,1120,1120
.short 1120,1120,1120,1112,1112,1112,1104,1104,1104,1104,1104,1096,1096,1096,1088,1088
.short 1088,1088,1088,1080,1080,1080,1072,1072,1072,1072,1072,1064,1064,1064,1056,1056
.short 1056,1056,1056,1048,1048,1048,1040,1040,1040,1040,1040,1032,1032,1032,1024,1024
.short 1024,1024,1020,1016,1016,1016,1012,1008,1008,1008,1004,1000,1000,1000,996,992
.short 992,992,988,984,984,984,980,976,976,976,972,968,968,968,964,960
.short 960,960,956,952,952,952,948,944,944,944,940,936,936,936,932,928
.short 928,928,924,920,920,920,916,912,912,912,908,904,904,904,900,896
.short 896,896,892,888,888,888,884,880,880,880,876,872,872,872,868,864
.short 864,864,860,856,856,856,852,848,848,848,844,840,840,840,836,832
.short 832,832,828,824,824,824,820,816,816,816,812,808,808,808,804,800
.short 800,800,796,792,792,792,788,784,784,784,780,776,776,776,772,768
.short 768,768,764,760,760,760,756,752,752,752,748,744,744,744,740,736
.short 736,736,732,728,728,728,724,720,720,720,716,712,712,712,708,704
.short 704,704,700,696,696,696,692,688,688,688,684,680,680,680,676,672
.short 672,672,668,664,664,664,660,656,656,656,652,648,648,648,644,640
.short 640,640,636,632,632,632,628,624,624,624,620,616,616,616,612,608
.short 608,608,604,600,600,600,596,592,592,592,588,584,584,584,580,576
.short 576,576,572,568,568,568,564,560,560,560,556,552,552,552,548,544
.short 544,544,540,536,536,536,532,528,528,528,524,520,520,520,516,512
.short 512,510,508,506,504,502,500,498,496,494,492,490,488,486,484,482
.short 480,478,476,474,472,470,468,466,464,462,460,458,456,454,452,450
.short 448,446,444,442,440,438,436,434,432,430,428,426,424,422,420,418
.short 416,414,412,410,408,406,404,402,400,398,396,394,392,390,388,386
.short 384,382,380,378,376,374,372,370,368,366,364,362,360,358,356,354
.short 352,350,348,346,344,342,340,338,336,334,332,330,328,326,324,322
.short 320,318,316,314,312,310,308,306,304,302,300,298,296,294,292,290
.short 288,286,284,282,280,278,276,274,272,270,268,266,264,262,260,258
.short 256,254,252,250,248,246,244,242,240,238,236,234,232,230,228,226
.short 224,222,220,218,216,214,212,210,208,206,204,202,200,198,196,194
.short 192,190,188,186,184,182,180,178,176,174,172,170,168,166,164,162
.short 160,158,156,154,152,150,148,146,144,142,140,138,136,134,132,130
.short 128,126,124,122,120,118,116,114,112,110,108,106,104,102,100,98
.short 96,94,92,90,88,86,84,82,80,78,76,74,72,70,68,66
.short 64,62,60,58,56,54,52,50,48,46,44,42,40,38,36,34
.short 32,30,28,26,24,22,20,18,16,14,12,10,8,6,4,2
.short 0,4600,4600,4600,4600,4600,4600,4600,4600,4600,4600,4600,4600,4600,4600,4600
.short 4600,4600,4600,4600,4600,4600,4600,4600,4600,4600,4600,4600,4600,4600,4600,4600
.short 4600,4600,4600,4600,4600,4600,4600,4600,4600,4600,4600,4600,4600,4600,4600,4600
.short 4600,4600,4600,4600,4600,4600,4600,4600,4600,4600,4600,4600,4600,4600,4600,4600
.short 4600,4600,4600,4600,4600,4600,4600,4600,4600,4600,4600,4600,4600,4600,4600,4600
.short 4600,4600,4600,4600,4600,4600,4600,4600,4600,4600,4600,4600,4600,4600,4600,4600
.short 4600,4600,4600,4600,4600,4600,4600,4600,4600,4600,4600,4600,4600,4600,4600,4600
.size K1_TBL, 4384
.p2align 2
L_text_pf_start:

.globl k3_ffn_kernel
.p2align 8
.type k3_ffn_kernel,@function
k3_ffn_kernel:
	s_cmp_ge_u32 s2, 256
	s_cbranch_scc1 L_k3_exit
	s_load_dwordx2 s[4:5], s[0:1], 136
	s_load_dwordx4 s[16:19], s[0:1], 80
	s_load_dwordx2 s[6:7], s[0:1], 120
	v_lshrrev_b32 v2, 6, v0
	v_and_b32 v1, 63, v0
	s_and_b32 s21, s2, 7
	v_readfirstlane_b32 s20, v2
	s_lshr_b32 s23, s2, 3
	s_lshr_b32 s22, s21, 1
	s_lshl_b32 s22, s22, 2
	s_lshr_b32 s27, s23, 3
	s_add_u32 s22, s22, s27
	s_and_b32 s21, s21, 1
	s_lshl_b32 s21, s21, 3
	s_and_b32 s23, s23, 7
	s_add_u32 s21, s21, s23
	s_lshl_b32 s24, s22, 2
	s_add_u32 s24, s24, s20
	s_mul_i32 s25, s20, 36864
	s_mul_i32 s26, s24, 36864
	s_add_u32 s26, s26, 9797632
	v_lshlrev_b32 v15, 4, v1
	s_getpc_b64 s[66:67]
L_epf_k3_ffn_kernel:
	s_add_u32 s66, s66, k3_ffn_kernel-L_epf_k3_ffn_kernel
	s_addc_u32 s67, s67, -1
	v_lshlrev_b32 v252, 7, v0
	s_mov_b32 s68, L_k3_exit-k3_ffn_kernel-4
	v_min_u32 v253, s68, v252
	v_and_b32 v253, -4, v253
	global_load_dword v254, v253, s[66:67]
	v_add_u32 v252, 32768, v252
	v_min_u32 v253, s68, v252
	v_and_b32 v253, -4, v253
	global_load_dword v255, v253, s[66:67]
	s_waitcnt lgkmcnt(0)
	s_mov_b32 s8, s4
	s_mov_b32 s9, s5
	s_mov_b32 s10, 48168960
	s_mov_b32 s11, 0x20000
	buffer_load_dwordx4 v[16:19], v15, s[8:11], s26 offen offset:0
	buffer_load_dwordx4 v[20:23], v15, s[8:11], s26 offen offset:1024
	buffer_load_dwordx4 v[24:27], v15, s[8:11], s26 offen offset:2048
	buffer_load_dwordx4 v[28:31], v15, s[8:11], s26 offen offset:3072
	s_lshl_b32 s27, s20, 10
	s_add_u32 s28, s27, 57344
	s_add_u32 m0, s27, 147456
	s_nop 0
	buffer_load_dwordx4 v15, s[8:11], s28 offen lds
	s_mov_b32 s28, 61440
	s_mov_b32 m0, 151552
	s_nop 0
	buffer_load_dwordx4 v15, s[8:11], s28 offen lds
	s_add_u32 s26, s26, 4096
	buffer_load_dwordx4 v[32:35], v15, s[8:11], s26 offen offset:0
	buffer_load_dwordx4 v[36:39], v15, s[8:11], s26 offen offset:1024
	buffer_load_dwordx4 v[40:43], v15, s[8:11], s26 offen offset:2048
	buffer_load_dwordx4 v[44:47], v15, s[8:11], s26 offen offset:3072
	s_add_u32 s26, s26, 4096
	buffer_load_dwordx4 v[48:51], v15, s[8:11], s26 offen offset:0
	buffer_load_dwordx4 v[52:55], v15, s[8:11], s26 offen offset:1024
	buffer_load_dwordx4 v[56:59], v15, s[8:11], s26 offen offset:2048
	buffer_load_dwordx4 v[60:63], v15, s[8:11], s26 offen offset:3072
	s_add_u32 s26, s26, 4096
	buffer_load_dwordx4 v[64:67], v15, s[8:11], s26 offen offset:0
	buffer_load_dwordx4 v[68:71], v15, s[8:11], s26 offen offset:1024
	buffer_load_dwordx4 v[72:75], v15, s[8:11], s26 offen offset:2048
	buffer_load_dwordx4 v[76:79], v15, s[8:11], s26 offen offset:3072
	s_add_u32 s26, s26, 4096
	buffer_load_dwordx4 v[80:83], v15, s[8:11], s26 offen offset:0
	buffer_load_dwordx4 v[84:87], v15, s[8:11], s26 offen offset:1024
	buffer_load_dwordx4 v[88:91], v15, s[8:11], s26 offen offset:2048
	buffer_load_dwordx4 v[92:95], v15, s[8:11], s26 offen offset:3072
	s_add_u32 s26, s26, 4096
	buffer_load_dwordx4 v[96:99], v15, s[8:11], s26 offen offset:0
	buffer_load_dwordx4 v[100:103], v15, s[8:11], s26 offen offset:1024
	buffer_load_dwordx4 v[104:107], v15, s[8:11], s26 offen offset:2048
	buffer_load_dwordx4 v[108:111], v15, s[8:11], s26 offen offset:3072
	s_add_u32 s26, s26, 4096
	buffer_load_dwordx4 v[112:115], v15, s[8:11], s26 offen offset:0
	buffer_load_dwordx4 v[116:119], v15, s[8:11], s26 offen offset:1024
	buffer_load_dwordx4 v[120:123], v15, s[8:11], s26 offen offset:2048
	buffer_load_dwordx4 v[124:127], v15, s[8:11], s26 offen offset:3072
	s_add_u32 s26, s26, 4096
	buffer_load_dwordx4 v[128:131], v15, s[8:11], s26 offen offset:0
	buffer_load_dwordx4 v[132:135], v15, s[8:11], s26 offen offset:1024
	buffer_load_dwordx4 v[136:139], v15, s[8:11], s26 offen offset:2048
	buffer_load_dwordx4 v[140:143], v15, s[8:11], s26 offen offset:3072
	s_add_u32 s26, s26, 4096
	buffer_load_dwordx4 v[208:211], v15, s[8:11], s26 offen offset:0
	buffer_load_dwordx4 v[212:215], v15, s[8:11], s26 offen offset:1024
	buffer_load_dwordx4 v[216:219], v15, s[8:11], s26 offen offset:2048
	buffer_load_dwordx4 v[220:223], v15, s[8:11], s26 offen offset:3072
	s_lshr_b32 s29, s20, 1
	s_and_b32 s30, s20, 1
	s_cmp_eq_u32 s29, 0
	s_cselect_b32 s12, s16, s18
	s_cselect_b32 s13, s17, s19
	s_mov_b32 s14, 5308416
	s_mov_b32 s15, 0x20000
	s_and_b32 s31, s21, 1
	s_mul_i32 s32, s21, 576
	s_lshl_b32 s33, s31, 6
	s_add_u32 s33, s33, s32
	s_xor_b32 s34, s31, 1
	s_lshl_b32 s34, s34, 9
	s_add_u32 s34, s34, s32
	v_lshrrev_b32 v9, 5, v1
	v_bfe_u32 v10, v1, 4, 1
	v_bfe_u32 v11, v1, 2, 2
	v_and_b32 v12, 3, v1
	v_lshl_add_u32 v13, v9, 2, v11
	s_movk_i32 s35, 9216
	v_mul_lo_u32 v6, v13, s35
	v_lshl_add_u32 v6, v10, 6, v6
	v_lshl_add_u32 v6, v12, 4, v6
	s_mul_i32 s36, s30, 663552
	s_add_u32 s36, s36, s33
	v_add_u32 v6, s36, v6
	v_lshl_add_u32 v13, v10, 4, v13
	v_mul_lo_u32 v7, v13, s35
	v_lshl_add_u32 v7, v12, 4, v7
	v_add_u32 v7, s34, v7
	s_mul_i32 s37, s20, 9216
	s_mov_b32 s40, 0
	s_mul_i32 s38, s30, 9
	s_add_u32 s38, s38, 0
	s_lshr_b32 s39, s38, 1
	s_lshl_b32 s39, s39, 2
	s_and_b32 s38, s38, 1
	s_add_u32 s38, s38, s39
	s_mul_i32 s50, s38, 73728
	s_mov_b32 s41, 73728
	s_mul_i32 s38, s30, 9
	s_add_u32 s38, s38, 1
	s_lshr_b32 s39, s38, 1
	s_lshl_b32 s39, s39, 2
	s_and_b32 s38, s38, 1
	s_add_u32 s38, s38, s39
	s_mul_i32 s51, s38, 73728
	s_mov_b32 s42, 147456
	s_mul_i32 s38, s30, 9
	s_add_u32 s38, s38, 2
	s_lshr_b32 s39, s38, 1
	s_lshl_b32 s39, s39, 2
	s_and_b32 s38, s38, 1
	s_add_u32 s38, s38, s39
	s_mul_i32 s52, s38, 73728
	s_mov_b32 s43, 221184
	s_mul_i32 s38, s30, 9
	s_add_u32 s38, s38, 3
	s_lshr_b32 s39, s38, 1
	s_lshl_b32 s39, s39, 2
	s_and_b32 s38, s38, 1
	s_add_u32 s38, s38, s39
	s_mul_i32 s53, s38, 73728
	s_mov_b32 s44, 294912
	s_mul_i32 s38, s30, 9
	s_add_u32 s38, s38, 4
	s_lshr_b32 s39, s38, 1
	s_lshl_b32 s39, s39, 2
	s_and_b32 s38, s38, 1
	s_add_u32 s38, s38, s39
	s_mul_i32 s54, s38, 73728
	s_mov_b32 s45, 368640
	s_mul_i32 s38, s30, 9
	s_add_u32 s38, s38, 5
	s_lshr_b32 s39, s38, 1
	s_lshl_b32 s39, s39, 2
	s_and_b32 s38, s38, 1
	s_add_u32 s38, s38, s39
	s_mul_i32 s55, s38, 73728
	s_mov_b32 s46, 442368
	s_mul_i32 s38, s30, 9
	s_add_u32 s38, s38, 6
	s_lshr_b32 s39, s38, 1
	s_lshl_b32 s39, s39, 2
	s_and_b32 s38, s38, 1
	s_add_u32 s38, s38, s39
	s_mul_i32 s56, s38, 73728
	s_mov_b32 s47, 516096
	s_mul_i32 s38, s30, 9
	s_add_u32 s38, s38, 7
	s_lshr_b32 s39, s38, 1
	s_lshl_b32 s39, s39, 2
	s_and_b32 s38, s38, 1
	s_add_u32 s38, s38, s39
	s_mul_i32 s57, s38, 73728
	s_mov_b32 s48, 589824
	s_mul_i32 s38, s30, 9
	s_add_u32 s38, s38, 8
	s_lshr_b32 s39, s38, 1
	s_lshl_b32 s39, s39, 2
	s_and_b32 s38, s38, 1
	s_add_u32 s38, s38, s39
	s_mul_i32 s58, s38, 73728
	v_and_b32 v13, 15, v1
	v_lshrrev_b32 v2, 2, v13
	v_lshlrev_b32 v2, 6, v2
	v_lshl_add_u32 v2, v10, 5, v2
	v_and_b32 v13, 3, v13
	v_lshl_add_u32 v2, v13, 3, v2
	v_lshl_add_u32 v2, v9, 10, v2
	v_add_u32 v3, 36864, v2
	v_add_u32 v4, 73728, v2
	v_add_u32 v5, 110592, v2
	v_and_b32 v13, 15, v1
	v_lshl_add_u32 v13, v9, 4, v13
	v_lshlrev_b32 v8, 4, v13
	s_mov_b32 s38, 147456
	v_mul_lo_u32 v13, v10, s38
	v_add_u32 v8, v8, v13
	s_mul_i32 s62, s24, 294912
	s_add_u32 s62, s62, 14516224
	s_lshl_b32 s38, s33, 4
	s_add_u32 s63, s62, s38
	s_lshl_b32 s38, s34, 4
	s_add_u32 s64, s62, s38
	s_mov_b32 s61, 0xbdd2d3e8
	v_mov_b32 v14, 0xc0135761
	s_mov_b32 s60, 0x3f803f80
	s_mov_b32 s59, 0xffff0000
	v_mov_b32 v184, 0
	v_mov_b32 v185, 0
	v_mov_b32 v186, 0
	v_mov_b32 v187, 0
	v_lshlrev_b32 v9, 5, v9
	v_add_u32 v9, 147456, v9
	s_lshr_b32 s3, s21, 2
	s_and_b32 s49, s21, 3
	s_mov_b32 s16, s6
	s_mov_b32 s17, s7
	s_mov_b32 s18, 2359296
	s_mov_b32 s19, 0x20000
	s_mul_i32 s23, s3, 36864
	s_add_u32 s23, s23, s62
	s_add_u32 s25, s23, 147456
	s_mul_i32 s38, s49, 1327104
	s_add_u32 s38, s38, 42827776
	s_mul_i32 s39, s3, 36
	s_lshr_b32 s30, s20, 1
	s_and_b32 s31, s20, 1
	s_mul_i32 s32, s30, 9
	s_and_b32 s33, s30, 1
	s_add_u32 s32, s32, s33
	s_add_u32 s32, s32, s31
	s_add_u32 s32, s32, s39
	s_mul_i32 s26, s32, 9216
	s_add_u32 s26, s26, s38
	s_add_u32 s27, s26, 165888
	s_mul_i32 s32, s20, 9
	s_xor_b32 s33, s31, 1
	s_lshl_b32 s33, s33, 3
	s_add_u32 s32, s32, s33
	s_add_u32 s32, s32, s39
	s_mul_i32 s28, s32, 9216
	s_add_u32 s28, s28, s38
	s_lshl_b32 s29, s22, 2
	s_add_u32 s29, s29, s3
	s_lshl_b32 s29, s29, 7
	s_add_u32 s29, s29, 48144384
	s_lshl_b32 s30, s49, 2
	s_add_u32 s30, s30, s29
	v_lshrrev_b32 v193, 5, v1
	v_and_b32 v180, 31, v1
	v_and_b32 v181, 3, v180
	v_lshrrev_b32 v182, 3, v180
	v_lshl_add_u32 v181, v182, 2, v181
	v_bfe_u32 v182, v180, 2, 1
	v_lshrrev_b32 v183, 3, v181
	v_lshlrev_b32 v183, 4, v183
	v_lshl_add_u32 v183, v182, 3, v183
	v_and_b32 v181, 7, v181
	v_add_u32 v183, v183, v181
	v_lshlrev_b32 v9, 2, v183
	v_add_u32 v9, 147456, v9
	v_lshlrev_b32 v193, 3, v193
	v_sub_u32 v183, v183, v193
	v_cmp_eq_u32 vcc, 0, v183
	v_mov_b32 v181, 0
	v_mov_b32 v182, 0xffff
	v_cndmask_b32 v181, v181, v182, vcc
	v_cmp_eq_u32 vcc, 1, v183
	v_mov_b32 v182, 0xffff0000
	s_nop 0
	v_cndmask_b32 v224, v181, v182, vcc
	v_cmp_eq_u32 vcc, 2, v183
	v_mov_b32 v181, 0
	v_mov_b32 v182, 0xffff
	v_cndmask_b32 v181, v181, v182, vcc
	v_cmp_eq_u32 vcc, 3, v183
	v_mov_b32 v182, 0xffff0000
	s_nop 0
	v_cndmask_b32 v225, v181, v182, vcc
	v_cmp_eq_u32 vcc, 4, v183
	v_mov_b32 v181, 0
	v_mov_b32 v182, 0xffff
	v_cndmask_b32 v181, v181, v182, vcc
	v_cmp_eq_u32 vcc, 5, v183
	v_mov_b32 v182, 0xffff0000
	s_nop 0
	v_cndmask_b32 v226, v181, v182, vcc
	v_cmp_eq_u32 vcc, 6, v183
	v_mov_b32 v181, 0
	v_mov_b32 v182, 0xffff
	v_cndmask_b32 v181, v181, v182, vcc
	v_cmp_eq_u32 vcc, 7, v183
	v_mov_b32 v182, 0xffff0000
	s_nop 0
	v_cndmask_b32 v227, v181, v182, vcc
	v_cmp_eq_u32 vcc, 16, v183
	v_mov_b32 v181, 0
	v_mov_b32 v182, 0xffff
	v_cndmask_b32 v181, v181, v182, vcc
	v_cmp_eq_u32 vcc, 17, v183
	v_mov_b32 v182, 0xffff0000
	s_nop 0
	v_cndmask_b32 v228, v181, v182, vcc
	v_cmp_eq_u32 vcc, 18, v183
	v_mov_b32 v181, 0
	v_mov_b32 v182, 0xffff
	v_cndmask_b32 v181, v181, v182, vcc
	v_cmp_eq_u32 vcc, 19, v183
	v_mov_b32 v182, 0xffff0000
	s_nop 0
	v_cndmask_b32 v229, v181, v182, vcc
	v_cmp_eq_u32 vcc, 20, v183
	v_mov_b32 v181, 0
	v_mov_b32 v182, 0xffff
	v_cndmask_b32 v181, v181, v182, vcc
	v_cmp_eq_u32 vcc, 21, v183
	v_mov_b32 v182, 0xffff0000
	s_nop 0
	v_cndmask_b32 v230, v181, v182, vcc
	v_cmp_eq_u32 vcc, 22, v183
	v_mov_b32 v181, 0
	v_mov_b32 v182, 0xffff
	v_cndmask_b32 v181, v181, v182, vcc
	v_cmp_eq_u32 vcc, 23, v183
	v_mov_b32 v182, 0xffff0000
	s_nop 0
	v_cndmask_b32 v231, v181, v182, vcc
	s_add_u32 m0, s37, 0
	s_nop 0
	buffer_load_dwordx4 v6, s[12:15], s40 offen lds
	s_add_u32 m0, s37, 1024
	s_nop 0
	buffer_load_dwordx4 v6, s[12:15], s41 offen lds
	s_add_u32 m0, s37, 2048
	s_nop 0
	buffer_load_dwordx4 v6, s[12:15], s42 offen lds
	s_add_u32 m0, s37, 3072
	s_nop 0
	buffer_load_dwordx4 v6, s[12:15], s43 offen lds
	s_add_u32 m0, s37, 4096
	s_nop 0
	buffer_load_dwordx4 v6, s[12:15], s44 offen lds
	s_add_u32 m0, s37, 5120
	s_nop 0
	buffer_load_dwordx4 v6, s[12:15], s45 offen lds
	s_add_u32 m0, s37, 6144
	s_nop 0
	buffer_load_dwordx4 v6, s[12:15], s46 offen lds
	s_add_u32 m0, s37, 7168
	s_nop 0
	buffer_load_dwordx4 v6, s[12:15], s47 offen lds
	s_add_u32 m0, s37, 8192
	s_nop 0
	buffer_load_dwordx4 v6, s[12:15], s48 offen lds
	s_waitcnt vmcnt(43)
	v_permlane16_swap_b32 v16, v18
	v_permlane16_swap_b32 v17, v19
	v_permlane16_swap_b32 v20, v22
	v_permlane16_swap_b32 v21, v23
	v_permlane16_swap_b32 v24, v26
	v_permlane16_swap_b32 v25, v27
	v_permlane16_swap_b32 v28, v30
	v_permlane16_swap_b32 v29, v31
	v_dot2_f32_bf16 v184, v16, s60, v184
	v_dot2_f32_bf16 v186, v16, v16, v186
	v_dot2_f32_bf16 v185, v17, s60, v185
	v_dot2_f32_bf16 v187, v17, v17, v187
	v_dot2_f32_bf16 v184, v18, s60, v184
	v_dot2_f32_bf16 v186, v18, v18, v186
	v_dot2_f32_bf16 v185, v19, s60, v185
	v_dot2_f32_bf16 v187, v19, v19, v187
	v_dot2_f32_bf16 v184, v20, s60, v184
	v_dot2_f32_bf16 v186, v20, v20, v186
	v_dot2_f32_bf16 v185, v21, s60, v185
	v_dot2_f32_bf16 v187, v21, v21, v187
	v_dot2_f32_bf16 v184, v22, s60, v184
	v_dot2_f32_bf16 v186, v22, v22, v186
	v_dot2_f32_bf16 v185, v23, s60, v185
	v_dot2_f32_bf16 v187, v23, v23, v187
	v_dot2_f32_bf16 v184, v24, s60, v184
	v_dot2_f32_bf16 v186, v24, v24, v186
	v_dot2_f32_bf16 v185, v25, s60, v185
	v_dot2_f32_bf16 v187, v25, v25, v187
	v_dot2_f32_bf16 v184, v26, s60, v184
	v_dot2_f32_bf16 v186, v26, v26, v186
	v_dot2_f32_bf16 v185, v27, s60, v185
	v_dot2_f32_bf16 v187, v27, v27, v187
	v_dot2_f32_bf16 v184, v28, s60, v184
	v_dot2_f32_bf16 v186, v28, v28, v186
	v_dot2_f32_bf16 v185, v29, s60, v185
	v_dot2_f32_bf16 v187, v29, v29, v187
	v_dot2_f32_bf16 v184, v30, s60, v184
	v_dot2_f32_bf16 v186, v30, v30, v186
	v_dot2_f32_bf16 v185, v31, s60, v185
	v_dot2_f32_bf16 v187, v31, v31, v187
	s_waitcnt vmcnt(37)
	v_permlane16_swap_b32 v32, v34
	v_permlane16_swap_b32 v33, v35
	v_permlane16_swap_b32 v36, v38
	v_permlane16_swap_b32 v37, v39
	v_permlane16_swap_b32 v40, v42
	v_permlane16_swap_b32 v41, v43
	v_permlane16_swap_b32 v44, v46
	v_permlane16_swap_b32 v45, v47
	v_dot2_f32_bf16 v184, v32, s60, v184
	v_dot2_f32_bf16 v186, v32, v32, v186
	v_dot2_f32_bf16 v185, v33, s60, v185
	v_dot2_f32_bf16 v187, v33, v33, v187
	v_dot2_f32_bf16 v184, v34, s60, v184
	v_dot2_f32_bf16 v186, v34, v34, v186
	v_dot2_f32_bf16 v185, v35, s60, v185
	v_dot2_f32_bf16 v187, v35, v35, v187
	v_dot2_f32_bf16 v184, v36, s60, v184
	v_dot2_f32_bf16 v186, v36, v36, v186
	v_dot2_f32_bf16 v185, v37, s60, v185
	v_dot2_f32_bf16 v187, v37, v37, v187
	v_dot2_f32_bf16 v184, v38, s60, v184
	v_dot2_f32_bf16 v186, v38, v38, v186
	v_dot2_f32_bf16 v185, v39, s60, v185
	v_dot2_f32_bf16 v187, v39, v39, v187
	v_dot2_f32_bf16 v184, v40, s60, v184
	v_dot2_f32_bf16 v186, v40, v40, v186
	v_dot2_f32_bf16 v185, v41, s60, v185
	v_dot2_f32_bf16 v187, v41, v41, v187
	v_dot2_f32_bf16 v184, v42, s60, v184
	v_dot2_f32_bf16 v186, v42, v42, v186
	v_dot2_f32_bf16 v185, v43, s60, v185
	v_dot2_f32_bf16 v187, v43, v43, v187
	v_dot2_f32_bf16 v184, v44, s60, v184
	v_dot2_f32_bf16 v186, v44, v44, v186
	v_dot2_f32_bf16 v185, v45, s60, v185
	v_dot2_f32_bf16 v187, v45, v45, v187
	v_dot2_f32_bf16 v184, v46, s60, v184
	v_dot2_f32_bf16 v186, v46, v46, v186
	v_dot2_f32_bf16 v185, v47, s60, v185
	v_dot2_f32_bf16 v187, v47, v47, v187
	s_waitcnt vmcnt(33)
	v_permlane16_swap_b32 v48, v50
	v_permlane16_swap_b32 v49, v51
	v_permlane16_swap_b32 v52, v54
	v_permlane16_swap_b32 v53, v55
	v_permlane16_swap_b32 v56, v58
	v_permlane16_swap_b32 v57, v59
	v_permlane16_swap_b32 v60, v62
	v_permlane16_swap_b32 v61, v63
	v_dot2_f32_bf16 v184, v48, s60, v184
	v_dot2_f32_bf16 v186, v48, v48, v186
	v_dot2_f32_bf16 v185, v49, s60, v185
	v_dot2_f32_bf16 v187, v49, v49, v187
	v_dot2_f32_bf16 v184, v50, s60, v184
	v_dot2_f32_bf16 v186, v50, v50, v186
	v_dot2_f32_bf16 v185, v51, s60, v185
	v_dot2_f32_bf16 v187, v51, v51, v187
	v_dot2_f32_bf16 v184, v52, s60, v184
	v_dot2_f32_bf16 v186, v52, v52, v186
	v_dot2_f32_bf16 v185, v53, s60, v185
	v_dot2_f32_bf16 v187, v53, v53, v187
	v_dot2_f32_bf16 v184, v54, s60, v184
	v_dot2_f32_bf16 v186, v54, v54, v186
	v_dot2_f32_bf16 v185, v55, s60, v185
	v_dot2_f32_bf16 v187, v55, v55, v187
	v_dot2_f32_bf16 v184, v56, s60, v184
	v_dot2_f32_bf16 v186, v56, v56, v186
	v_dot2_f32_bf16 v185, v57, s60, v185
	v_dot2_f32_bf16 v187, v57, v57, v187
	v_dot2_f32_bf16 v184, v58, s60, v184
	v_dot2_f32_bf16 v186, v58, v58, v186
	v_dot2_f32_bf16 v185, v59, s60, v185
	v_dot2_f32_bf16 v187, v59, v59, v187
	v_dot2_f32_bf16 v184, v60, s60, v184
	v_dot2_f32_bf16 v186, v60, v60, v186
	v_dot2_f32_bf16 v185, v61, s60, v185
	v_dot2_f32_bf16 v187, v61, v61, v187
	v_dot2_f32_bf16 v184, v62, s60, v184
	v_dot2_f32_bf16 v186, v62, v62, v186
	v_dot2_f32_bf16 v185, v63, s60, v185
	v_dot2_f32_bf16 v187, v63, v63, v187
	s_waitcnt vmcnt(29)
	v_permlane16_swap_b32 v64, v66
	v_permlane16_swap_b32 v65, v67
	v_permlane16_swap_b32 v68, v70
	v_permlane16_swap_b32 v69, v71
	v_permlane16_swap_b32 v72, v74
	v_permlane16_swap_b32 v73, v75
	v_permlane16_swap_b32 v76, v78
	v_permlane16_swap_b32 v77, v79
	v_dot2_f32_bf16 v184, v64, s60, v184
	v_dot2_f32_bf16 v186, v64, v64, v186
	v_dot2_f32_bf16 v185, v65, s60, v185
	v_dot2_f32_bf16 v187, v65, v65, v187
	v_dot2_f32_bf16 v184, v66, s60, v184
	v_dot2_f32_bf16 v186, v66, v66, v186
	v_dot2_f32_bf16 v185, v67, s60, v185
	v_dot2_f32_bf16 v187, v67, v67, v187
	v_dot2_f32_bf16 v184, v68, s60, v184
	v_dot2_f32_bf16 v186, v68, v68, v186
	v_dot2_f32_bf16 v185, v69, s60, v185
	v_dot2_f32_bf16 v187, v69, v69, v187
	v_dot2_f32_bf16 v184, v70, s60, v184
	v_dot2_f32_bf16 v186, v70, v70, v186
	v_dot2_f32_bf16 v185, v71, s60, v185
	v_dot2_f32_bf16 v187, v71, v71, v187
	v_dot2_f32_bf16 v184, v72, s60, v184
	v_dot2_f32_bf16 v186, v72, v72, v186
	v_dot2_f32_bf16 v185, v73, s60, v185
	v_dot2_f32_bf16 v187, v73, v73, v187
	v_dot2_f32_bf16 v184, v74, s60, v184
	v_dot2_f32_bf16 v186, v74, v74, v186
	v_dot2_f32_bf16 v185, v75, s60, v185
	v_dot2_f32_bf16 v187, v75, v75, v187
	v_dot2_f32_bf16 v184, v76, s60, v184
	v_dot2_f32_bf16 v186, v76, v76, v186
	v_dot2_f32_bf16 v185, v77, s60, v185
	v_dot2_f32_bf16 v187, v77, v77, v187
	v_dot2_f32_bf16 v184, v78, s60, v184
	v_dot2_f32_bf16 v186, v78, v78, v186
	v_dot2_f32_bf16 v185, v79, s60, v185
	v_dot2_f32_bf16 v187, v79, v79, v187
	s_waitcnt vmcnt(25)
	v_permlane16_swap_b32 v80, v82
	v_permlane16_swap_b32 v81, v83
	v_permlane16_swap_b32 v84, v86
	v_permlane16_swap_b32 v85, v87
	v_permlane16_swap_b32 v88, v90
	v_permlane16_swap_b32 v89, v91
	v_permlane16_swap_b32 v92, v94
	v_permlane16_swap_b32 v93, v95
	v_dot2_f32_bf16 v184, v80, s60, v184
	v_dot2_f32_bf16 v186, v80, v80, v186
	v_dot2_f32_bf16 v185, v81, s60, v185
	v_dot2_f32_bf16 v187, v81, v81, v187
	v_dot2_f32_bf16 v184, v82, s60, v184
	v_dot2_f32_bf16 v186, v82, v82, v186
	v_dot2_f32_bf16 v185, v83, s60, v185
	v_dot2_f32_bf16 v187, v83, v83, v187
	v_dot2_f32_bf16 v184, v84, s60, v184
	v_dot2_f32_bf16 v186, v84, v84, v186
	v_dot2_f32_bf16 v185, v85, s60, v185
	v_dot2_f32_bf16 v187, v85, v85, v187
	v_dot2_f32_bf16 v184, v86, s60, v184
	v_dot2_f32_bf16 v186, v86, v86, v186
	v_dot2_f32_bf16 v185, v87, s60, v185
	v_dot2_f32_bf16 v187, v87, v87, v187
	v_dot2_f32_bf16 v184, v88, s60, v184
	v_dot2_f32_bf16 v186, v88, v88, v186
	v_dot2_f32_bf16 v185, v89, s60, v185
	v_dot2_f32_bf16 v187, v89, v89, v187
	v_dot2_f32_bf16 v184, v90, s60, v184
	v_dot2_f32_bf16 v186, v90, v90, v186
	v_dot2_f32_bf16 v185, v91, s60, v185
	v_dot2_f32_bf16 v187, v91, v91, v187
	v_dot2_f32_bf16 v184, v92, s60, v184
	v_dot2_f32_bf16 v186, v92, v92, v186
	v_dot2_f32_bf16 v185, v93, s60, v185
	v_dot2_f32_bf16 v187, v93, v93, v187
	v_dot2_f32_bf16 v184, v94, s60, v184
	v_dot2_f32_bf16 v186, v94, v94, v186
	v_dot2_f32_bf16 v185, v95, s60, v185
	v_dot2_f32_bf16 v187, v95, v95, v187
	s_waitcnt vmcnt(21)
	v_permlane16_swap_b32 v96, v98
	v_permlane16_swap_b32 v97, v99
	v_permlane16_swap_b32 v100, v102
	v_permlane16_swap_b32 v101, v103
	v_permlane16_swap_b32 v104, v106
	v_permlane16_swap_b32 v105, v107
	v_permlane16_swap_b32 v108, v110
	v_permlane16_swap_b32 v109, v111
	v_dot2_f32_bf16 v184, v96, s60, v184
	v_dot2_f32_bf16 v186, v96, v96, v186
	v_dot2_f32_bf16 v185, v97, s60, v185
	v_dot2_f32_bf16 v187, v97, v97, v187
	v_dot2_f32_bf16 v184, v98, s60, v184
	v_dot2_f32_bf16 v186, v98, v98, v186
	v_dot2_f32_bf16 v185, v99, s60, v185
	v_dot2_f32_bf16 v187, v99, v99, v187
	v_dot2_f32_bf16 v184, v100, s60, v184
	v_dot2_f32_bf16 v186, v100, v100, v186
	v_dot2_f32_bf16 v185, v101, s60, v185
	v_dot2_f32_bf16 v187, v101, v101, v187
	v_dot2_f32_bf16 v184, v102, s60, v184
	v_dot2_f32_bf16 v186, v102, v102, v186
	v_dot2_f32_bf16 v185, v103, s60, v185
	v_dot2_f32_bf16 v187, v103, v103, v187
	v_dot2_f32_bf16 v184, v104, s60, v184
	v_dot2_f32_bf16 v186, v104, v104, v186
	v_dot2_f32_bf16 v185, v105, s60, v185
	v_dot2_f32_bf16 v187, v105, v105, v187
	v_dot2_f32_bf16 v184, v106, s60, v184
	v_dot2_f32_bf16 v186, v106, v106, v186
	v_dot2_f32_bf16 v185, v107, s60, v185
	v_dot2_f32_bf16 v187, v107, v107, v187
	v_dot2_f32_bf16 v184, v108, s60, v184
	v_dot2_f32_bf16 v186, v108, v108, v186
	v_dot2_f32_bf16 v185, v109, s60, v185
	v_dot2_f32_bf16 v187, v109, v109, v187
	v_dot2_f32_bf16 v184, v110, s60, v184
	v_dot2_f32_bf16 v186, v110, v110, v186
	v_dot2_f32_bf16 v185, v111, s60, v185
	v_dot2_f32_bf16 v187, v111, v111, v187
	s_waitcnt vmcnt(17)
	v_permlane16_swap_b32 v112, v114
	v_permlane16_swap_b32 v113, v115
	v_permlane16_swap_b32 v116, v118
	v_permlane16_swap_b32 v117, v119
	v_permlane16_swap_b32 v120, v122
	v_permlane16_swap_b32 v121, v123
	v_permlane16_swap_b32 v124, v126
	v_permlane16_swap_b32 v125, v127
	v_dot2_f32_bf16 v184, v112, s60, v184
	v_dot2_f32_bf16 v186, v112, v112, v186
	v_dot2_f32_bf16 v185, v113, s60, v185
	v_dot2_f32_bf16 v187, v113, v113, v187
	v_dot2_f32_bf16 v184, v114, s60, v184
	v_dot2_f32_bf16 v186, v114, v114, v186
	v_dot2_f32_bf16 v185, v115, s60, v185
	v_dot2_f32_bf16 v187, v115, v115, v187
	v_dot2_f32_bf16 v184, v116, s60, v184
	v_dot2_f32_bf16 v186, v116, v116, v186
	v_dot2_f32_bf16 v185, v117, s60, v185
	v_dot2_f32_bf16 v187, v117, v117, v187
	v_dot2_f32_bf16 v184, v118, s60, v184
	v_dot2_f32_bf16 v186, v118, v118, v186
	v_dot2_f32_bf16 v185, v119, s60, v185
	v_dot2_f32_bf16 v187, v119, v119, v187
	v_dot2_f32_bf16 v184, v120, s60, v184
	v_dot2_f32_bf16 v186, v120, v120, v186
	v_dot2_f32_bf16 v185, v121, s60, v185
	v_dot2_f32_bf16 v187, v121, v121, v187
	v_dot2_f32_bf16 v184, v122, s60, v184
	v_dot2_f32_bf16 v186, v122, v122, v186
	v_dot2_f32_bf16 v185, v123, s60, v185
	v_dot2_f32_bf16 v187, v123, v123, v187
	v_dot2_f32_bf16 v184, v124, s60, v184
	v_dot2_f32_bf16 v186, v124, v124, v186
	v_dot2_f32_bf16 v185, v125, s60, v185
	v_dot2_f32_bf16 v187, v125, v125, v187
	v_dot2_f32_bf16 v184, v126, s60, v184
	v_dot2_f32_bf16 v186, v126, v126, v186
	v_dot2_f32_bf16 v185, v127, s60, v185
	v_dot2_f32_bf16 v187, v127, v127, v187
	s_waitcnt vmcnt(13)
	v_permlane16_swap_b32 v128, v130
	v_permlane16_swap_b32 v129, v131
	v_permlane16_swap_b32 v132, v134
	v_permlane16_swap_b32 v133, v135
	v_permlane16_swap_b32 v136, v138
	v_permlane16_swap_b32 v137, v139
	v_permlane16_swap_b32 v140, v142
	v_permlane16_swap_b32 v141, v143
	v_dot2_f32_bf16 v184, v128, s60, v184
	v_dot2_f32_bf16 v186, v128, v128, v186
	v_dot2_f32_bf16 v185, v129, s60, v185
	v_dot2_f32_bf16 v187, v129, v129, v187
	v_dot2_f32_bf16 v184, v130, s60, v184
	v_dot2_f32_bf16 v186, v130, v130, v186
	v_dot2_f32_bf16 v185, v131, s60, v185
	v_dot2_f32_bf16 v187, v131, v131, v187
	v_dot2_f32_bf16 v184, v132, s60, v184
	v_dot2_f32_bf16 v186, v132, v132, v186
	v_dot2_f32_bf16 v185, v133, s60, v185
	v_dot2_f32_bf16 v187, v133, v133, v187
	v_dot2_f32_bf16 v184, v134, s60, v184
	v_dot2_f32_bf16 v186, v134, v134, v186
	v_dot2_f32_bf16 v185, v135, s60, v185
	v_dot2_f32_bf16 v187, v135, v135, v187
	v_dot2_f32_bf16 v184, v136, s60, v184
	v_dot2_f32_bf16 v186, v136, v136, v186
	v_dot2_f32_bf16 v185, v137, s60, v185
	v_dot2_f32_bf16 v187, v137, v137, v187
	v_dot2_f32_bf16 v184, v138, s60, v184
	v_dot2_f32_bf16 v186, v138, v138, v186
	v_dot2_f32_bf16 v185, v139, s60, v185
	v_dot2_f32_bf16 v187, v139, v139, v187
	v_dot2_f32_bf16 v184, v140, s60, v184
	v_dot2_f32_bf16 v186, v140, v140, v186
	v_dot2_f32_bf16 v185, v141, s60, v185
	v_dot2_f32_bf16 v187, v141, v141, v187
	v_dot2_f32_bf16 v184, v142, s60, v184
	v_dot2_f32_bf16 v186, v142, v142, v186
	v_dot2_f32_bf16 v185, v143, s60, v185
	v_dot2_f32_bf16 v187, v143, v143, v187
	s_waitcnt vmcnt(9)
	v_permlane16_swap_b32 v208, v210
	v_permlane16_swap_b32 v209, v211
	v_permlane16_swap_b32 v212, v214
	v_permlane16_swap_b32 v213, v215
	v_permlane16_swap_b32 v216, v218
	v_permlane16_swap_b32 v217, v219
	v_permlane16_swap_b32 v220, v222
	v_permlane16_swap_b32 v221, v223
	v_dot2_f32_bf16 v184, v208, s60, v184
	v_dot2_f32_bf16 v186, v208, v208, v186
	v_dot2_f32_bf16 v185, v209, s60, v185
	v_dot2_f32_bf16 v187, v209, v209, v187
	v_dot2_f32_bf16 v184, v210, s60, v184
	v_dot2_f32_bf16 v186, v210, v210, v186
	v_dot2_f32_bf16 v185, v211, s60, v185
	v_dot2_f32_bf16 v187, v211, v211, v187
	v_dot2_f32_bf16 v184, v212, s60, v184
	v_dot2_f32_bf16 v186, v212, v212, v186
	v_dot2_f32_bf16 v185, v213, s60, v185
	v_dot2_f32_bf16 v187, v213, v213, v187
	v_dot2_f32_bf16 v184, v214, s60, v184
	v_dot2_f32_bf16 v186, v214, v214, v186
	v_dot2_f32_bf16 v185, v215, s60, v185
	v_dot2_f32_bf16 v187, v215, v215, v187
	v_dot2_f32_bf16 v184, v216, s60, v184
	v_dot2_f32_bf16 v186, v216, v216, v186
	v_dot2_f32_bf16 v185, v217, s60, v185
	v_dot2_f32_bf16 v187, v217, v217, v187
	v_dot2_f32_bf16 v184, v218, s60, v184
	v_dot2_f32_bf16 v186, v218, v218, v186
	v_dot2_f32_bf16 v185, v219, s60, v185
	v_dot2_f32_bf16 v187, v219, v219, v187
	v_dot2_f32_bf16 v184, v220, s60, v184
	v_dot2_f32_bf16 v186, v220, v220, v186
	v_dot2_f32_bf16 v185, v221, s60, v185
	v_dot2_f32_bf16 v187, v221, v221, v187
	v_dot2_f32_bf16 v184, v222, s60, v184
	v_dot2_f32_bf16 v186, v222, v222, v186
	v_dot2_f32_bf16 v185, v223, s60, v185
	v_dot2_f32_bf16 v187, v223, v223, v187
	s_nop 1
	v_add_f32 v184, v184, v185
	v_add_f32 v186, v186, v187
	v_mov_b32 v185, v184
	v_mov_b32 v187, v186
	s_nop 0
	v_permlane32_swap_b32 v184, v185
	v_permlane32_swap_b32 v186, v187
	v_add_f32 v184, v184, v185
	v_add_f32 v186, v186, v187
	v_mul_f32 v184, 0x3ae38e39, v184
	v_mul_f32 v186, 0x3ae38e39, v186
	v_fma_f32 v186, -v184, v184, v186
	v_max_f32 v186, 0, v186
	v_cvt_pk_bf16_f32 v186, v186, v186
	v_lshlrev_b32 v186, 16, v186
	v_add_f32 v186, 0x3727c5ac, v186
	v_cvt_pk_bf16_f32 v186, v186, v186
	v_lshlrev_b32 v186, 16, v186
	v_sqrt_f32 v186, v186
	s_nop 0
	v_cvt_pk_bf16_f32 v186, v186, v186
	v_lshlrev_b32 v186, 16, v186
	v_rcp_f32 v10, v186
	v_mul_f32 v13, v186, v186
	v_mul_f32 v11, v10, v10
	v_mul_f32 v11, v11, v10
	v_mul_f32 v11, s61, v11
	v_mul_f32 v10, v14, v10
	v_cvt_pk_bf16_f32 v184, v184, v184
	v_lshlrev_b32 v184, 16, v184
	v_lshrrev_b32 v184, 16, v184
	v_xor_b32 v184, 0x8000, v184
	v_or_b32 v184, v184, v186
	v_lshrrev_b32 v193, 5, v1
	v_cmp_eq_u32 vcc, 0, v193
	v_mov_b32 v177, 0
	v_mov_b32 v178, 0
	v_mov_b32 v179, 0
	v_cndmask_b32 v176, 0, v184, vcc
	v_cndmask_b32 v12, 0, -1, vcc
	v_mov_b32 v185, 0
	v_mov_b32 v186, 0
	v_mov_b32 v187, 0
	v_mov_b32 v189, 0
	v_mov_b32 v190, 0
	v_mov_b32 v191, 0
	v_mov_b32 v200, 0xffff
	s_barrier
	ds_read_b32 v248, v9 offset:0
	ds_read_b32 v250, v9 offset:2304
	ds_read_b32 v249, v9 offset:128
	ds_read_b32 v251, v9 offset:2432
	s_waitcnt lgkmcnt(2)
	v_and_b32 v232, v224, v248
	v_and_b32 v233, v225, v248
	v_and_b32 v234, v226, v248
	v_and_b32 v235, v227, v248
	v_and_b32 v236, v228, v248
	v_and_b32 v237, v229, v248
	v_and_b32 v238, v230, v248
	v_and_b32 v239, v231, v248
	v_and_or_b32 v250, v248, v200, v250
	v_and_b32 v184, v12, v250
	s_nop 1
	v_mfma_f32_32x32x16_bf16 v[144:159], v[184:187], v[176:179], 0
	v_mfma_f32_32x32x16_bf16 v[144:159], v[232:235], v[16:19], v[144:159]
	v_mfma_f32_32x32x16_bf16 v[144:159], v[236:239], v[20:23], v[144:159]
	s_waitcnt lgkmcnt(0)
	v_and_b32 v240, v224, v249
	v_and_b32 v241, v225, v249
	v_and_b32 v242, v226, v249
	v_and_b32 v243, v227, v249
	v_and_b32 v244, v228, v249
	v_and_b32 v245, v229, v249
	v_and_b32 v246, v230, v249
	v_and_b32 v247, v231, v249
	v_and_or_b32 v251, v249, v200, v251
	v_and_b32 v188, v12, v251
	ds_read_b32 v248, v9 offset:256
	ds_read_b32 v250, v9 offset:2560
	v_mfma_f32_32x32x16_bf16 v[160:175], v[188:191], v[176:179], 0
	v_add_u32 v6, 0x144000, v6
	s_add_u32 m0, s37, 36864
	v_cvt_pk_bf16_f32 v192, v144, v145
	v_cvt_pk_bf16_f32 v193, v146, v147
	v_cvt_pk_bf16_f32 v194, v148, v149
	v_cvt_pk_bf16_f32 v195, v150, v151
	v_cvt_pk_bf16_f32 v196, v152, v153
	v_mfma_f32_32x32x16_bf16 v[160:175], v[240:243], v[24:27], v[160:175]
	v_cvt_pk_bf16_f32 v197, v154, v155
	v_cvt_pk_bf16_f32 v198, v156, v157
	v_cvt_pk_bf16_f32 v199, v158, v159
	v_accvgpr_write_b32 a0, v192
	v_accvgpr_write_b32 a1, v193
	v_accvgpr_write_b32 a2, v194
	v_mfma_f32_32x32x16_bf16 v[160:175], v[244:247], v[28:31], v[160:175]
	v_accvgpr_write_b32 a3, v195
	v_accvgpr_write_b32 a4, v196
	v_accvgpr_write_b32 a5, v197
	v_accvgpr_write_b32 a6, v198
	v_accvgpr_write_b32 a7, v199
	s_waitcnt lgkmcnt(0)
	v_and_b32 v232, v224, v248
	v_and_b32 v233, v225, v248
	v_and_b32 v234, v226, v248
	v_and_b32 v235, v227, v248
	v_and_b32 v236, v228, v248
	v_and_b32 v237, v229, v248
	v_and_b32 v238, v230, v248
	v_and_b32 v239, v231, v248
	v_and_or_b32 v250, v248, v200, v250
	v_and_b32 v184, v12, v250
	ds_read_b32 v249, v9 offset:384
	ds_read_b32 v251, v9 offset:2688
	v_mfma_f32_32x32x16_bf16 v[144:159], v[184:187], v[176:179], 0
	v_cvt_pk_bf16_f32 v192, v160, v161
	v_cvt_pk_bf16_f32 v193, v162, v163
	v_cvt_pk_bf16_f32 v194, v164, v165
	v_cvt_pk_bf16_f32 v195, v166, v167
	v_cvt_pk_bf16_f32 v196, v168, v169
	v_mfma_f32_32x32x16_bf16 v[144:159], v[232:235], v[32:35], v[144:159]
	v_cvt_pk_bf16_f32 v197, v170, v171
	v_cvt_pk_bf16_f32 v198, v172, v173
	v_cvt_pk_bf16_f32 v199, v174, v175
	v_accvgpr_write_b32 a8, v192
	v_accvgpr_write_b32 a9, v193
	v_accvgpr_write_b32 a10, v194
	v_mfma_f32_32x32x16_bf16 v[144:159], v[236:239], v[36:39], v[144:159]
	v_accvgpr_write_b32 a11, v195
	v_accvgpr_write_b32 a12, v196
	v_accvgpr_write_b32 a13, v197
	v_accvgpr_write_b32 a14, v198
	v_accvgpr_write_b32 a15, v199
	s_waitcnt lgkmcnt(0)
	v_and_b32 v240, v224, v249
	v_and_b32 v241, v225, v249
	v_and_b32 v242, v226, v249
	v_and_b32 v243, v227, v249
	v_and_b32 v244, v228, v249
	v_and_b32 v245, v229, v249
	v_and_b32 v246, v230, v249
	v_and_b32 v247, v231, v249
	v_and_or_b32 v251, v249, v200, v251
	v_and_b32 v188, v12, v251
	ds_read_b32 v248, v9 offset:512
	ds_read_b32 v250, v9 offset:2816
	v_mfma_f32_32x32x16_bf16 v[160:175], v[188:191], v[176:179], 0
	buffer_load_dwordx4 v6, s[12:15], s40 offen lds
	s_add_u32 m0, s37, 37888
	v_cvt_pk_bf16_f32 v192, v144, v145
	v_cvt_pk_bf16_f32 v193, v146, v147
	v_cvt_pk_bf16_f32 v194, v148, v149
	v_cvt_pk_bf16_f32 v195, v150, v151
	v_cvt_pk_bf16_f32 v196, v152, v153
	v_mfma_f32_32x32x16_bf16 v[160:175], v[240:243], v[40:43], v[160:175]
	v_cvt_pk_bf16_f32 v197, v154, v155
	v_cvt_pk_bf16_f32 v198, v156, v157
	v_cvt_pk_bf16_f32 v199, v158, v159
	v_accvgpr_write_b32 a16, v192
	v_accvgpr_write_b32 a17, v193
	v_accvgpr_write_b32 a18, v194
	v_mfma_f32_32x32x16_bf16 v[160:175], v[244:247], v[44:47], v[160:175]
	v_accvgpr_write_b32 a19, v195
	v_accvgpr_write_b32 a20, v196
	v_accvgpr_write_b32 a21, v197
	v_accvgpr_write_b32 a22, v198
	v_accvgpr_write_b32 a23, v199
	s_waitcnt lgkmcnt(0)
	v_and_b32 v232, v224, v248
	v_and_b32 v233, v225, v248
	v_and_b32 v234, v226, v248
	v_and_b32 v235, v227, v248
	v_and_b32 v236, v228, v248
	v_and_b32 v237, v229, v248
	v_and_b32 v238, v230, v248
	v_and_b32 v239, v231, v248
	v_and_or_b32 v250, v248, v200, v250
	v_and_b32 v184, v12, v250
	ds_read_b32 v249, v9 offset:640
	ds_read_b32 v251, v9 offset:2944
	v_mfma_f32_32x32x16_bf16 v[144:159], v[184:187], v[176:179], 0
	v_cvt_pk_bf16_f32 v192, v160, v161
	v_cvt_pk_bf16_f32 v193, v162, v163
	v_cvt_pk_bf16_f32 v194, v164, v165
	v_cvt_pk_bf16_f32 v195, v166, v167
	v_cvt_pk_bf16_f32 v196, v168, v169
	v_mfma_f32_32x32x16_bf16 v[144:159], v[232:235], v[48:51], v[144:159]
	v_cvt_pk_bf16_f32 v197, v170, v171
	v_cvt_pk_bf16_f32 v198, v172, v173
	v_cvt_pk_bf16_f32 v199, v174, v175
	v_accvgpr_write_b32 a24, v192
	v_accvgpr_write_b32 a25, v193
	v_accvgpr_write_b32 a26, v194
	v_mfma_f32_32x32x16_bf16 v[144:159], v[236:239], v[52:55], v[144:159]
	v_accvgpr_write_b32 a27, v195
	v_accvgpr_write_b32 a28, v196
	v_accvgpr_write_b32 a29, v197
	v_accvgpr_write_b32 a30, v198
	v_accvgpr_write_b32 a31, v199
	s_waitcnt lgkmcnt(0)
	v_and_b32 v240, v224, v249
	v_and_b32 v241, v225, v249
	v_and_b32 v242, v226, v249
	v_and_b32 v243, v227, v249
	v_and_b32 v244, v228, v249
	v_and_b32 v245, v229, v249
	v_and_b32 v246, v230, v249
	v_and_b32 v247, v231, v249
	v_and_or_b32 v251, v249, v200, v251
	v_and_b32 v188, v12, v251
	ds_read_b32 v248, v9 offset:768
	ds_read_b32 v250, v9 offset:3072
	v_mfma_f32_32x32x16_bf16 v[160:175], v[188:191], v[176:179], 0
	buffer_load_dwordx4 v6, s[12:15], s41 offen lds
	s_add_u32 m0, s37, 38912
	v_cvt_pk_bf16_f32 v192, v144, v145
	v_cvt_pk_bf16_f32 v193, v146, v147
	v_cvt_pk_bf16_f32 v194, v148, v149
	v_cvt_pk_bf16_f32 v195, v150, v151
	v_cvt_pk_bf16_f32 v196, v152, v153
	v_mfma_f32_32x32x16_bf16 v[160:175], v[240:243], v[56:59], v[160:175]
	v_cvt_pk_bf16_f32 v197, v154, v155
	v_cvt_pk_bf16_f32 v198, v156, v157
	v_cvt_pk_bf16_f32 v199, v158, v159
	v_accvgpr_write_b32 a32, v192
	v_accvgpr_write_b32 a33, v193
	v_accvgpr_write_b32 a34, v194
	v_mfma_f32_32x32x16_bf16 v[160:175], v[244:247], v[60:63], v[160:175]
	v_accvgpr_write_b32 a35, v195
	v_accvgpr_write_b32 a36, v196
	v_accvgpr_write_b32 a37, v197
	v_accvgpr_write_b32 a38, v198
	v_accvgpr_write_b32 a39, v199
	s_waitcnt lgkmcnt(0)
	v_and_b32 v232, v224, v248
	v_and_b32 v233, v225, v248
	v_and_b32 v234, v226, v248
	v_and_b32 v235, v227, v248
	v_and_b32 v236, v228, v248
	v_and_b32 v237, v229, v248
	v_and_b32 v238, v230, v248
	v_and_b32 v239, v231, v248
	v_and_or_b32 v250, v248, v200, v250
	v_and_b32 v184, v12, v250
	ds_read_b32 v249, v9 offset:896
	ds_read_b32 v251, v9 offset:3200
	v_mfma_f32_32x32x16_bf16 v[144:159], v[184:187], v[176:179], 0
	v_cvt_pk_bf16_f32 v192, v160, v161
	v_cvt_pk_bf16_f32 v193, v162, v163
	v_cvt_pk_bf16_f32 v194, v164, v165
	v_cvt_pk_bf16_f32 v195, v166, v167
	v_cvt_pk_bf16_f32 v196, v168, v169
	v_mfma_f32_32x32x16_bf16 v[144:159], v[232:235], v[64:67], v[144:159]
	v_cvt_pk_bf16_f32 v197, v170, v171
	v_cvt_pk_bf16_f32 v198, v172, v173
	v_cvt_pk_bf16_f32 v199, v174, v175
	v_accvgpr_write_b32 a40, v192
	v_accvgpr_write_b32 a41, v193
	v_accvgpr_write_b32 a42, v194
	v_mfma_f32_32x32x16_bf16 v[144:159], v[236:239], v[68:71], v[144:159]
	v_accvgpr_write_b32 a43, v195
	v_accvgpr_write_b32 a44, v196
	v_accvgpr_write_b32 a45, v197
	v_accvgpr_write_b32 a46, v198
	v_accvgpr_write_b32 a47, v199
	s_waitcnt lgkmcnt(0)
	v_and_b32 v240, v224, v249
	v_and_b32 v241, v225, v249
	v_and_b32 v242, v226, v249
	v_and_b32 v243, v227, v249
	v_and_b32 v244, v228, v249
	v_and_b32 v245, v229, v249
	v_and_b32 v246, v230, v249
	v_and_b32 v247, v231, v249
	v_and_or_b32 v251, v249, v200, v251
	v_and_b32 v188, v12, v251
	ds_read_b32 v248, v9 offset:1024
	ds_read_b32 v250, v9 offset:3328
	v_mfma_f32_32x32x16_bf16 v[160:175], v[188:191], v[176:179], 0
	buffer_load_dwordx4 v6, s[12:15], s42 offen lds
	s_add_u32 m0, s37, 39936
	v_cvt_pk_bf16_f32 v192, v144, v145
	v_cvt_pk_bf16_f32 v193, v146, v147
	v_cvt_pk_bf16_f32 v194, v148, v149
	v_cvt_pk_bf16_f32 v195, v150, v151
	v_cvt_pk_bf16_f32 v196, v152, v153
	v_mfma_f32_32x32x16_bf16 v[160:175], v[240:243], v[72:75], v[160:175]
	v_cvt_pk_bf16_f32 v197, v154, v155
	v_cvt_pk_bf16_f32 v198, v156, v157
	v_cvt_pk_bf16_f32 v199, v158, v159
	v_accvgpr_write_b32 a48, v192
	v_accvgpr_write_b32 a49, v193
	v_accvgpr_write_b32 a50, v194
	v_mfma_f32_32x32x16_bf16 v[160:175], v[244:247], v[76:79], v[160:175]
	v_accvgpr_write_b32 a51, v195
	v_accvgpr_write_b32 a52, v196
	v_accvgpr_write_b32 a53, v197
	v_accvgpr_write_b32 a54, v198
	v_accvgpr_write_b32 a55, v199
	s_waitcnt lgkmcnt(0)
	v_and_b32 v232, v224, v248
	v_and_b32 v233, v225, v248
	v_and_b32 v234, v226, v248
	v_and_b32 v235, v227, v248
	v_and_b32 v236, v228, v248
	v_and_b32 v237, v229, v248
	v_and_b32 v238, v230, v248
	v_and_b32 v239, v231, v248
	v_and_or_b32 v250, v248, v200, v250
	v_and_b32 v184, v12, v250
	ds_read_b32 v249, v9 offset:1152
	ds_read_b32 v251, v9 offset:3456
	v_mfma_f32_32x32x16_bf16 v[144:159], v[184:187], v[176:179], 0
	v_cvt_pk_bf16_f32 v192, v160, v161
	v_cvt_pk_bf16_f32 v193, v162, v163
	v_cvt_pk_bf16_f32 v194, v164, v165
	v_cvt_pk_bf16_f32 v195, v166, v167
	v_cvt_pk_bf16_f32 v196, v168, v169
	v_mfma_f32_32x32x16_bf16 v[144:159], v[232:235], v[80:83], v[144:159]
	v_cvt_pk_bf16_f32 v197, v170, v171
	v_cvt_pk_bf16_f32 v198, v172, v173
	v_cvt_pk_bf16_f32 v199, v174, v175
	v_accvgpr_write_b32 a56, v192
	v_accvgpr_write_b32 a57, v193
	v_accvgpr_write_b32 a58, v194
	v_mfma_f32_32x32x16_bf16 v[144:159], v[236:239], v[84:87], v[144:159]
	v_accvgpr_write_b32 a59, v195
	v_accvgpr_write_b32 a60, v196
	v_accvgpr_write_b32 a61, v197
	v_accvgpr_write_b32 a62, v198
	v_accvgpr_write_b32 a63, v199
	s_waitcnt lgkmcnt(0)
	v_and_b32 v240, v224, v249
	v_and_b32 v241, v225, v249
	v_and_b32 v242, v226, v249
	v_and_b32 v243, v227, v249
	v_and_b32 v244, v228, v249
	v_and_b32 v245, v229, v249
	v_and_b32 v246, v230, v249
	v_and_b32 v247, v231, v249
	v_and_or_b32 v251, v249, v200, v251
	v_and_b32 v188, v12, v251
	ds_read_b32 v248, v9 offset:1280
	ds_read_b32 v250, v9 offset:3584
	v_mfma_f32_32x32x16_bf16 v[160:175], v[188:191], v[176:179], 0
	buffer_load_dwordx4 v6, s[12:15], s43 offen lds
	s_add_u32 m0, s37, 40960
	v_cvt_pk_bf16_f32 v192, v144, v145
	v_cvt_pk_bf16_f32 v193, v146, v147
	v_cvt_pk_bf16_f32 v194, v148, v149
	v_cvt_pk_bf16_f32 v195, v150, v151
	v_cvt_pk_bf16_f32 v196, v152, v153
	v_mfma_f32_32x32x16_bf16 v[160:175], v[240:243], v[88:91], v[160:175]
	v_cvt_pk_bf16_f32 v197, v154, v155
	v_cvt_pk_bf16_f32 v198, v156, v157
	v_cvt_pk_bf16_f32 v199, v158, v159
	v_accvgpr_write_b32 a64, v192
	v_accvgpr_write_b32 a65, v193
	v_accvgpr_write_b32 a66, v194
	v_mfma_f32_32x32x16_bf16 v[160:175], v[244:247], v[92:95], v[160:175]
	v_accvgpr_write_b32 a67, v195
	v_accvgpr_write_b32 a68, v196
	v_accvgpr_write_b32 a69, v197
	v_accvgpr_write_b32 a70, v198
	v_accvgpr_write_b32 a71, v199
	s_waitcnt lgkmcnt(0)
	v_and_b32 v232, v224, v248
	v_and_b32 v233, v225, v248
	v_and_b32 v234, v226, v248
	v_and_b32 v235, v227, v248
	v_and_b32 v236, v228, v248
	v_and_b32 v237, v229, v248
	v_and_b32 v238, v230, v248
	v_and_b32 v239, v231, v248
	v_and_or_b32 v250, v248, v200, v250
	v_and_b32 v184, v12, v250
	ds_read_b32 v249, v9 offset:1408
	ds_read_b32 v251, v9 offset:3712
	v_mfma_f32_32x32x16_bf16 v[144:159], v[184:187], v[176:179], 0
	v_cvt_pk_bf16_f32 v192, v160, v161
	v_cvt_pk_bf16_f32 v193, v162, v163
	v_cvt_pk_bf16_f32 v194, v164, v165
	v_cvt_pk_bf16_f32 v195, v166, v167
	v_cvt_pk_bf16_f32 v196, v168, v169
	v_mfma_f32_32x32x16_bf16 v[144:159], v[232:235], v[96:99], v[144:159]
	v_cvt_pk_bf16_f32 v197, v170, v171
	v_cvt_pk_bf16_f32 v198, v172, v173
	v_cvt_pk_bf16_f32 v199, v174, v175
	v_accvgpr_write_b32 a72, v192
	v_accvgpr_write_b32 a73, v193
	v_accvgpr_write_b32 a74, v194
	v_mfma_f32_32x32x16_bf16 v[144:159], v[236:239], v[100:103], v[144:159]
	v_accvgpr_write_b32 a75, v195
	v_accvgpr_write_b32 a76, v196
	v_accvgpr_write_b32 a77, v197
	v_accvgpr_write_b32 a78, v198
	v_accvgpr_write_b32 a79, v199
	s_waitcnt lgkmcnt(0)
	v_and_b32 v240, v224, v249
	v_and_b32 v241, v225, v249
	v_and_b32 v242, v226, v249
	v_and_b32 v243, v227, v249
	v_and_b32 v244, v228, v249
	v_and_b32 v245, v229, v249
	v_and_b32 v246, v230, v249
	v_and_b32 v247, v231, v249
	v_and_or_b32 v251, v249, v200, v251
	v_and_b32 v188, v12, v251
	ds_read_b32 v248, v9 offset:1536
	ds_read_b32 v250, v9 offset:3840
	v_mfma_f32_32x32x16_bf16 v[160:175], v[188:191], v[176:179], 0
	buffer_load_dwordx4 v6, s[12:15], s44 offen lds
	s_add_u32 m0, s37, 41984
	v_cvt_pk_bf16_f32 v192, v144, v145
	v_cvt_pk_bf16_f32 v193, v146, v147
	v_cvt_pk_bf16_f32 v194, v148, v149
	v_cvt_pk_bf16_f32 v195, v150, v151
	v_cvt_pk_bf16_f32 v196, v152, v153
	v_mfma_f32_32x32x16_bf16 v[160:175], v[240:243], v[104:107], v[160:175]
	v_cvt_pk_bf16_f32 v197, v154, v155
	v_cvt_pk_bf16_f32 v198, v156, v157
	v_cvt_pk_bf16_f32 v199, v158, v159
	v_accvgpr_write_b32 a80, v192
	v_accvgpr_write_b32 a81, v193
	v_accvgpr_write_b32 a82, v194
	v_mfma_f32_32x32x16_bf16 v[160:175], v[244:247], v[108:111], v[160:175]
	v_accvgpr_write_b32 a83, v195
	v_accvgpr_write_b32 a84, v196
	v_accvgpr_write_b32 a85, v197
	v_accvgpr_write_b32 a86, v198
	v_accvgpr_write_b32 a87, v199
	s_waitcnt lgkmcnt(0)
	v_and_b32 v232, v224, v248
	v_and_b32 v233, v225, v248
	v_and_b32 v234, v226, v248
	v_and_b32 v235, v227, v248
	v_and_b32 v236, v228, v248
	v_and_b32 v237, v229, v248
	v_and_b32 v238, v230, v248
	v_and_b32 v239, v231, v248
	v_and_or_b32 v250, v248, v200, v250
	v_and_b32 v184, v12, v250
	ds_read_b32 v249, v9 offset:1664
	ds_read_b32 v251, v9 offset:3968
	v_mfma_f32_32x32x16_bf16 v[144:159], v[184:187], v[176:179], 0
	v_cvt_pk_bf16_f32 v192, v160, v161
	v_cvt_pk_bf16_f32 v193, v162, v163
	v_cvt_pk_bf16_f32 v194, v164, v165
	v_cvt_pk_bf16_f32 v195, v166, v167
	v_cvt_pk_bf16_f32 v196, v168, v169
	v_mfma_f32_32x32x16_bf16 v[144:159], v[232:235], v[112:115], v[144:159]
	v_cvt_pk_bf16_f32 v197, v170, v171
	v_cvt_pk_bf16_f32 v198, v172, v173
	v_cvt_pk_bf16_f32 v199, v174, v175
	v_accvgpr_write_b32 a88, v192
	v_accvgpr_write_b32 a89, v193
	v_accvgpr_write_b32 a90, v194
	v_mfma_f32_32x32x16_bf16 v[144:159], v[236:239], v[116:119], v[144:159]
	v_accvgpr_write_b32 a91, v195
	v_accvgpr_write_b32 a92, v196
	v_accvgpr_write_b32 a93, v197
	v_accvgpr_write_b32 a94, v198
	v_accvgpr_write_b32 a95, v199
	s_waitcnt lgkmcnt(0)
	v_and_b32 v240, v224, v249
	v_and_b32 v241, v225, v249
	v_and_b32 v242, v226, v249
	v_and_b32 v243, v227, v249
	v_and_b32 v244, v228, v249
	v_and_b32 v245, v229, v249
	v_and_b32 v246, v230, v249
	v_and_b32 v247, v231, v249
	v_and_or_b32 v251, v249, v200, v251
	v_and_b32 v188, v12, v251
	ds_read_b32 v248, v9 offset:1792
	ds_read_b32 v250, v9 offset:4096
	v_mfma_f32_32x32x16_bf16 v[160:175], v[188:191], v[176:179], 0
	buffer_load_dwordx4 v6, s[12:15], s45 offen lds
	s_add_u32 m0, s37, 43008
	v_cvt_pk_bf16_f32 v192, v144, v145
	v_cvt_pk_bf16_f32 v193, v146, v147
	v_cvt_pk_bf16_f32 v194, v148, v149
	v_cvt_pk_bf16_f32 v195, v150, v151
	v_cvt_pk_bf16_f32 v196, v152, v153
	v_mfma_f32_32x32x16_bf16 v[160:175], v[240:243], v[120:123], v[160:175]
	v_cvt_pk_bf16_f32 v197, v154, v155
	v_cvt_pk_bf16_f32 v198, v156, v157
	v_cvt_pk_bf16_f32 v199, v158, v159
	v_accvgpr_write_b32 a96, v192
	v_accvgpr_write_b32 a97, v193
	v_accvgpr_write_b32 a98, v194
	v_mfma_f32_32x32x16_bf16 v[160:175], v[244:247], v[124:127], v[160:175]
	v_accvgpr_write_b32 a99, v195
	v_accvgpr_write_b32 a100, v196
	v_accvgpr_write_b32 a101, v197
	v_accvgpr_write_b32 a102, v198
	v_accvgpr_write_b32 a103, v199
	s_waitcnt lgkmcnt(0)
	v_and_b32 v232, v224, v248
	v_and_b32 v233, v225, v248
	v_and_b32 v234, v226, v248
	v_and_b32 v235, v227, v248
	v_and_b32 v236, v228, v248
	v_and_b32 v237, v229, v248
	v_and_b32 v238, v230, v248
	v_and_b32 v239, v231, v248
	v_and_or_b32 v250, v248, v200, v250
	v_and_b32 v184, v12, v250
	ds_read_b32 v249, v9 offset:1920
	ds_read_b32 v251, v9 offset:4224
	v_mfma_f32_32x32x16_bf16 v[144:159], v[184:187], v[176:179], 0
	v_cvt_pk_bf16_f32 v192, v160, v161
	v_cvt_pk_bf16_f32 v193, v162, v163
	v_cvt_pk_bf16_f32 v194, v164, v165
	v_cvt_pk_bf16_f32 v195, v166, v167
	v_cvt_pk_bf16_f32 v196, v168, v169
	v_mfma_f32_32x32x16_bf16 v[144:159], v[232:235], v[128:131], v[144:159]
	v_cvt_pk_bf16_f32 v197, v170, v171
	v_cvt_pk_bf16_f32 v198, v172, v173
	v_cvt_pk_bf16_f32 v199, v174, v175
	v_accvgpr_write_b32 a104, v192
	v_accvgpr_write_b32 a105, v193
	v_accvgpr_write_b32 a106, v194
	v_mfma_f32_32x32x16_bf16 v[144:159], v[236:239], v[132:135], v[144:159]
	v_accvgpr_write_b32 a107, v195
	v_accvgpr_write_b32 a108, v196
	v_accvgpr_write_b32 a109, v197
	v_accvgpr_write_b32 a110, v198
	v_accvgpr_write_b32 a111, v199
	s_waitcnt lgkmcnt(0)
	v_and_b32 v240, v224, v249
	v_and_b32 v241, v225, v249
	v_and_b32 v242, v226, v249
	v_and_b32 v243, v227, v249
	v_and_b32 v244, v228, v249
	v_and_b32 v245, v229, v249
	v_and_b32 v246, v230, v249
	v_and_b32 v247, v231, v249
	v_and_or_b32 v251, v249, v200, v251
	v_and_b32 v188, v12, v251
	ds_read_b32 v248, v9 offset:2048
	ds_read_b32 v250, v9 offset:4352
	v_mfma_f32_32x32x16_bf16 v[160:175], v[188:191], v[176:179], 0
	buffer_load_dwordx4 v6, s[12:15], s46 offen lds
	s_add_u32 m0, s37, 44032
	v_cvt_pk_bf16_f32 v192, v144, v145
	v_cvt_pk_bf16_f32 v193, v146, v147
	v_cvt_pk_bf16_f32 v194, v148, v149
	v_cvt_pk_bf16_f32 v195, v150, v151
	v_cvt_pk_bf16_f32 v196, v152, v153
	v_mfma_f32_32x32x16_bf16 v[160:175], v[240:243], v[136:139], v[160:175]
	v_cvt_pk_bf16_f32 v197, v154, v155
	v_cvt_pk_bf16_f32 v198, v156, v157
	v_cvt_pk_bf16_f32 v199, v158, v159
	v_accvgpr_write_b32 a112, v192
	v_accvgpr_write_b32 a113, v193
	v_accvgpr_write_b32 a114, v194
	v_mfma_f32_32x32x16_bf16 v[160:175], v[244:247], v[140:143], v[160:175]
	v_accvgpr_write_b32 a115, v195
	v_accvgpr_write_b32 a116, v196
	v_accvgpr_write_b32 a117, v197
	v_accvgpr_write_b32 a118, v198
	v_accvgpr_write_b32 a119, v199
	s_waitcnt lgkmcnt(0)
	v_and_b32 v232, v224, v248
	v_and_b32 v233, v225, v248
	v_and_b32 v234, v226, v248
	v_and_b32 v235, v227, v248
	v_and_b32 v236, v228, v248
	v_and_b32 v237, v229, v248
	v_and_b32 v238, v230, v248
	v_and_b32 v239, v231, v248
	v_and_or_b32 v250, v248, v200, v250
	v_and_b32 v184, v12, v250
	ds_read_b32 v249, v9 offset:2176
	ds_read_b32 v251, v9 offset:4480
	v_mfma_f32_32x32x16_bf16 v[144:159], v[184:187], v[176:179], 0
	v_cvt_pk_bf16_f32 v192, v160, v161
	v_cvt_pk_bf16_f32 v193, v162, v163
	v_cvt_pk_bf16_f32 v194, v164, v165
	v_cvt_pk_bf16_f32 v195, v166, v167
	v_cvt_pk_bf16_f32 v196, v168, v169
	v_mfma_f32_32x32x16_bf16 v[144:159], v[232:235], v[208:211], v[144:159]
	v_cvt_pk_bf16_f32 v197, v170, v171
	v_cvt_pk_bf16_f32 v198, v172, v173
	v_cvt_pk_bf16_f32 v199, v174, v175
	v_accvgpr_write_b32 a120, v192
	v_accvgpr_write_b32 a121, v193
	v_accvgpr_write_b32 a122, v194
	v_mfma_f32_32x32x16_bf16 v[144:159], v[236:239], v[212:215], v[144:159]
	v_accvgpr_write_b32 a123, v195
	v_accvgpr_write_b32 a124, v196
	v_accvgpr_write_b32 a125, v197
	v_accvgpr_write_b32 a126, v198
	v_accvgpr_write_b32 a127, v199
	s_waitcnt lgkmcnt(0)
	v_and_b32 v240, v224, v249
	v_and_b32 v241, v225, v249
	v_and_b32 v242, v226, v249
	v_and_b32 v243, v227, v249
	v_and_b32 v244, v228, v249
	v_and_b32 v245, v229, v249
	v_and_b32 v246, v230, v249
	v_and_b32 v247, v231, v249
	v_and_or_b32 v251, v249, v200, v251
	v_and_b32 v188, v12, v251
	s_nop 1
	v_mfma_f32_32x32x16_bf16 v[160:175], v[188:191], v[176:179], 0
	buffer_load_dwordx4 v6, s[12:15], s47 offen lds
	s_add_u32 m0, s37, 45056
	v_cvt_pk_bf16_f32 v192, v144, v145
	v_cvt_pk_bf16_f32 v193, v146, v147
	v_cvt_pk_bf16_f32 v194, v148, v149
	v_cvt_pk_bf16_f32 v195, v150, v151
	v_cvt_pk_bf16_f32 v196, v152, v153
	v_mfma_f32_32x32x16_bf16 v[160:175], v[240:243], v[216:219], v[160:175]
	v_cvt_pk_bf16_f32 v197, v154, v155
	v_cvt_pk_bf16_f32 v198, v156, v157
	v_cvt_pk_bf16_f32 v199, v158, v159
	v_accvgpr_write_b32 a128, v192
	v_accvgpr_write_b32 a129, v193
	v_accvgpr_write_b32 a130, v194
	v_mfma_f32_32x32x16_bf16 v[160:175], v[244:247], v[220:223], v[160:175]
	v_accvgpr_write_b32 a131, v195
	v_accvgpr_write_b32 a132, v196
	v_accvgpr_write_b32 a133, v197
	v_accvgpr_write_b32 a134, v198
	v_accvgpr_write_b32 a135, v199
	buffer_load_dwordx4 v6, s[12:15], s48 offen lds
	s_nop 5
	v_cvt_pk_bf16_f32 v192, v160, v161
	v_cvt_pk_bf16_f32 v193, v162, v163
	v_cvt_pk_bf16_f32 v194, v164, v165
	v_cvt_pk_bf16_f32 v195, v166, v167
	v_cvt_pk_bf16_f32 v196, v168, v169
	v_cvt_pk_bf16_f32 v197, v170, v171
	v_cvt_pk_bf16_f32 v198, v172, v173
	v_cvt_pk_bf16_f32 v199, v174, v175
	v_accvgpr_write_b32 a136, v192
	v_accvgpr_write_b32 a137, v193
	v_accvgpr_write_b32 a138, v194
	v_accvgpr_write_b32 a139, v195
	v_accvgpr_write_b32 a140, v196
	v_accvgpr_write_b32 a141, v197
	v_accvgpr_write_b32 a142, v198
	v_accvgpr_write_b32 a143, v199
	s_waitcnt vmcnt(9)
	s_barrier
	ds_read_b64_tr_b16 v[144:145], v2 offset:0
	ds_read_b64_tr_b16 v[146:147], v2 offset:512
	ds_read_b64_tr_b16 v[148:149], v2 offset:18432
	ds_read_b64_tr_b16 v[150:151], v2 offset:18944
	ds_read_b64_tr_b16 v[152:153], v2 offset:256
	ds_read_b64_tr_b16 v[154:155], v2 offset:768
	ds_read_b64_tr_b16 v[156:157], v2 offset:18688
	ds_read_b64_tr_b16 v[158:159], v2 offset:19200
	ds_read_b64_tr_b16 v[160:161], v2 offset:2048
	ds_read_b64_tr_b16 v[162:163], v2 offset:2560
	ds_read_b64_tr_b16 v[164:165], v2 offset:20480
	ds_read_b64_tr_b16 v[166:167], v2 offset:20992
	ds_read_b64_tr_b16 v[168:169], v2 offset:2304
	ds_read_b64_tr_b16 v[170:171], v2 offset:2816
	s_waitcnt lgkmcnt(6)
	v_mfma_f32_32x32x16_bf16 v[16:31], v[144:147], a[0:3], 0
	ds_read_b64_tr_b16 v[172:173], v2 offset:20736
	ds_read_b64_tr_b16 v[174:175], v2 offset:21248
	v_add_u32 v6, 0x144000, v6
	s_add_u32 m0, s37, 73728
	v_mfma_f32_32x32x16_bf16 v[32:47], v[148:151], a[0:3], 0
	ds_read_b64_tr_b16 v[144:145], v2 offset:4096
	ds_read_b64_tr_b16 v[146:147], v2 offset:4608
	buffer_load_dwordx4 v6, s[12:15], s40 offen lds
	s_add_u32 m0, s37, 74752
	v_mfma_f32_32x32x16_bf16 v[48:63], v[152:155], a[0:3], 0
	ds_read_b64_tr_b16 v[148:149], v2 offset:22528
	ds_read_b64_tr_b16 v[150:151], v2 offset:23040
	buffer_load_dwordx4 v6, s[12:15], s41 offen lds
	s_add_u32 m0, s37, 75776
	v_mfma_f32_32x32x16_bf16 v[64:79], v[156:159], a[0:3], 0
	ds_read_b64_tr_b16 v[152:153], v2 offset:4352
	ds_read_b64_tr_b16 v[154:155], v2 offset:4864
	buffer_load_dwordx4 v6, s[12:15], s42 offen lds
	s_add_u32 m0, s37, 76800
	s_waitcnt lgkmcnt(6)
	v_mfma_f32_32x32x16_bf16 v[16:31], v[160:163], a[4:7], v[16:31]
	ds_read_b64_tr_b16 v[156:157], v2 offset:22784
	ds_read_b64_tr_b16 v[158:159], v2 offset:23296
	buffer_load_dwordx4 v6, s[12:15], s43 offen lds
	s_add_u32 m0, s37, 77824
	v_mfma_f32_32x32x16_bf16 v[32:47], v[164:167], a[4:7], v[32:47]
	ds_read_b64_tr_b16 v[160:161], v2 offset:6144
	ds_read_b64_tr_b16 v[162:163], v2 offset:6656
	buffer_load_dwordx4 v6, s[12:15], s44 offen lds
	s_add_u32 m0, s37, 78848
	v_mfma_f32_32x32x16_bf16 v[48:63], v[168:171], a[4:7], v[48:63]
	ds_read_b64_tr_b16 v[164:165], v2 offset:24576
	ds_read_b64_tr_b16 v[166:167], v2 offset:25088
	buffer_load_dwordx4 v6, s[12:15], s45 offen lds
	s_add_u32 m0, s37, 79872
	v_mfma_f32_32x32x16_bf16 v[64:79], v[172:175], a[4:7], v[64:79]
	ds_read_b64_tr_b16 v[168:169], v2 offset:6400
	ds_read_b64_tr_b16 v[170:171], v2 offset:6912
	buffer_load_dwordx4 v6, s[12:15], s46 offen lds
	s_add_u32 m0, s37, 80896
	s_waitcnt lgkmcnt(6)
	v_mfma_f32_32x32x16_bf16 v[16:31], v[144:147], a[8:11], v[16:31]
	ds_read_b64_tr_b16 v[172:173], v2 offset:24832
	ds_read_b64_tr_b16 v[174:175], v2 offset:25344
	buffer_load_dwordx4 v6, s[12:15], s47 offen lds
	s_add_u32 m0, s37, 81920
	v_mfma_f32_32x32x16_bf16 v[32:47], v[148:151], a[8:11], v[32:47]
	ds_read_b64_tr_b16 v[144:145], v2 offset:8192
	ds_read_b64_tr_b16 v[146:147], v2 offset:8704
	buffer_load_dwordx4 v6, s[12:15], s48 offen lds
	v_mfma_f32_32x32x16_bf16 v[48:63], v[152:155], a[8:11], v[48:63]
	ds_read_b64_tr_b16 v[148:149], v2 offset:26624
	ds_read_b64_tr_b16 v[150:151], v2 offset:27136
	v_mfma_f32_32x32x16_bf16 v[64:79], v[156:159], a[8:11], v[64:79]
	ds_read_b64_tr_b16 v[152:153], v2 offset:8448
	ds_read_b64_tr_b16 v[154:155], v2 offset:8960
	s_waitcnt lgkmcnt(6)
	v_mfma_f32_32x32x16_bf16 v[16:31], v[160:163], a[12:15], v[16:31]
	ds_read_b64_tr_b16 v[156:157], v2 offset:26880
	ds_read_b64_tr_b16 v[158:159], v2 offset:27392
	v_mfma_f32_32x32x16_bf16 v[32:47], v[164:167], a[12:15], v[32:47]
	ds_read_b64_tr_b16 v[160:161], v2 offset:10240
	ds_read_b64_tr_b16 v[162:163], v2 offset:10752
	v_mfma_f32_32x32x16_bf16 v[48:63], v[168:171], a[12:15], v[48:63]
	ds_read_b64_tr_b16 v[164:165], v2 offset:28672
	ds_read_b64_tr_b16 v[166:167], v2 offset:29184
	v_mfma_f32_32x32x16_bf16 v[64:79], v[172:175], a[12:15], v[64:79]
	ds_read_b64_tr_b16 v[168:169], v2 offset:10496
	ds_read_b64_tr_b16 v[170:171], v2 offset:11008
	s_waitcnt lgkmcnt(6)
	v_mfma_f32_32x32x16_bf16 v[16:31], v[144:147], a[16:19], v[16:31]
	ds_read_b64_tr_b16 v[172:173], v2 offset:28928
	ds_read_b64_tr_b16 v[174:175], v2 offset:29440
	v_mfma_f32_32x32x16_bf16 v[32:47], v[148:151], a[16:19], v[32:47]
	ds_read_b64_tr_b16 v[144:145], v2 offset:12288
	ds_read_b64_tr_b16 v[146:147], v2 offset:12800
	v_mfma_f32_32x32x16_bf16 v[48:63], v[152:155], a[16:19], v[48:63]
	ds_read_b64_tr_b16 v[148:149], v2 offset:30720
	ds_read_b64_tr_b16 v[150:151], v2 offset:31232
	s_waitcnt vmcnt(9)
	s_barrier
	v_mfma_f32_32x32x16_bf16 v[64:79], v[156:159], a[16:19], v[64:79]
	ds_read_b64_tr_b16 v[152:153], v2 offset:12544
	ds_read_b64_tr_b16 v[154:155], v2 offset:13056
	v_add_u32 v6, 0x144000, v6
	s_add_u32 m0, s37, 110592
	s_waitcnt lgkmcnt(6)
	v_mfma_f32_32x32x16_bf16 v[16:31], v[160:163], a[20:23], v[16:31]
	ds_read_b64_tr_b16 v[156:157], v2 offset:30976
	ds_read_b64_tr_b16 v[158:159], v2 offset:31488
	v_mfma_f32_32x32x16_bf16 v[32:47], v[164:167], a[20:23], v[32:47]
	ds_read_b64_tr_b16 v[160:161], v2 offset:14336
	ds_read_b64_tr_b16 v[162:163], v2 offset:14848
	buffer_load_dwordx4 v6, s[12:15], s40 offen lds
	s_add_u32 m0, s37, 111616
	v_mfma_f32_32x32x16_bf16 v[48:63], v[168:171], a[20:23], v[48:63]
	ds_read_b64_tr_b16 v[164:165], v2 offset:32768
	ds_read_b64_tr_b16 v[166:167], v2 offset:33280
	v_mfma_f32_32x32x16_bf16 v[64:79], v[172:175], a[20:23], v[64:79]
	ds_read_b64_tr_b16 v[168:169], v2 offset:14592
	ds_read_b64_tr_b16 v[170:171], v2 offset:15104
	buffer_load_dwordx4 v6, s[12:15], s41 offen lds
	s_add_u32 m0, s37, 112640
	s_waitcnt lgkmcnt(6)
	v_mfma_f32_32x32x16_bf16 v[16:31], v[144:147], a[24:27], v[16:31]
	ds_read_b64_tr_b16 v[172:173], v2 offset:33024
	ds_read_b64_tr_b16 v[174:175], v2 offset:33536
	v_mfma_f32_32x32x16_bf16 v[32:47], v[148:151], a[24:27], v[32:47]
	ds_read_b64_tr_b16 v[144:145], v2 offset:16384
	ds_read_b64_tr_b16 v[146:147], v2 offset:16896
	buffer_load_dwordx4 v6, s[12:15], s42 offen lds
	s_add_u32 m0, s37, 113664
	v_mfma_f32_32x32x16_bf16 v[48:63], v[152:155], a[24:27], v[48:63]
	ds_read_b64_tr_b16 v[148:149], v2 offset:34816
	ds_read_b64_tr_b16 v[150:151], v2 offset:35328
	v_mfma_f32_32x32x16_bf16 v[64:79], v[156:159], a[24:27], v[64:79]
	ds_read_b64_tr_b16 v[152:153], v2 offset:16640
	ds_read_b64_tr_b16 v[154:155], v2 offset:17152
	buffer_load_dwordx4 v6, s[12:15], s43 offen lds
	s_add_u32 m0, s37, 114688
	s_waitcnt lgkmcnt(6)
	v_mfma_f32_32x32x16_bf16 v[16:31], v[160:163], a[28:31], v[16:31]
	ds_read_b64_tr_b16 v[156:157], v2 offset:35072
	ds_read_b64_tr_b16 v[158:159], v2 offset:35584
	v_mfma_f32_32x32x16_bf16 v[32:47], v[164:167], a[28:31], v[32:47]
	ds_read_b64_tr_b16 v[160:161], v3 offset:0
	ds_read_b64_tr_b16 v[162:163], v3 offset:512
	buffer_load_dwordx4 v6, s[12:15], s44 offen lds
	s_add_u32 m0, s37, 115712
	v_mfma_f32_32x32x16_bf16 v[48:63], v[168:171], a[28:31], v[48:63]
	ds_read_b64_tr_b16 v[164:165], v3 offset:18432
	ds_read_b64_tr_b16 v[166:167], v3 offset:18944
	v_mfma_f32_32x32x16_bf16 v[64:79], v[172:175], a[28:31], v[64:79]
	ds_read_b64_tr_b16 v[168:169], v3 offset:256
	ds_read_b64_tr_b16 v[170:171], v3 offset:768
	buffer_load_dwordx4 v6, s[12:15], s45 offen lds
	s_add_u32 m0, s37, 116736
	s_waitcnt lgkmcnt(6)
	v_mfma_f32_32x32x16_bf16 v[16:31], v[144:147], a[32:35], v[16:31]
	ds_read_b64_tr_b16 v[172:173], v3 offset:18688
	ds_read_b64_tr_b16 v[174:175], v3 offset:19200
	v_mfma_f32_32x32x16_bf16 v[32:47], v[148:151], a[32:35], v[32:47]
	ds_read_b64_tr_b16 v[144:145], v3 offset:2048
	ds_read_b64_tr_b16 v[146:147], v3 offset:2560
	buffer_load_dwordx4 v6, s[12:15], s46 offen lds
	s_add_u32 m0, s37, 117760
	v_mfma_f32_32x32x16_bf16 v[48:63], v[152:155], a[32:35], v[48:63]
	ds_read_b64_tr_b16 v[148:149], v3 offset:20480
	ds_read_b64_tr_b16 v[150:151], v3 offset:20992
	v_mfma_f32_32x32x16_bf16 v[64:79], v[156:159], a[32:35], v[64:79]
	ds_read_b64_tr_b16 v[152:153], v3 offset:2304
	ds_read_b64_tr_b16 v[154:155], v3 offset:2816
	buffer_load_dwordx4 v6, s[12:15], s47 offen lds
	s_add_u32 m0, s37, 118784
	s_waitcnt lgkmcnt(6)
	v_mfma_f32_32x32x16_bf16 v[16:31], v[160:163], a[36:39], v[16:31]
	ds_read_b64_tr_b16 v[156:157], v3 offset:20736
	ds_read_b64_tr_b16 v[158:159], v3 offset:21248
	v_mfma_f32_32x32x16_bf16 v[32:47], v[164:167], a[36:39], v[32:47]
	ds_read_b64_tr_b16 v[160:161], v3 offset:4096
	ds_read_b64_tr_b16 v[162:163], v3 offset:4608
	buffer_load_dwordx4 v6, s[12:15], s48 offen lds
	v_mfma_f32_32x32x16_bf16 v[48:63], v[168:171], a[36:39], v[48:63]
	ds_read_b64_tr_b16 v[164:165], v3 offset:22528
	ds_read_b64_tr_b16 v[166:167], v3 offset:23040
	v_mfma_f32_32x32x16_bf16 v[64:79], v[172:175], a[36:39], v[64:79]
	ds_read_b64_tr_b16 v[168:169], v3 offset:4352
	ds_read_b64_tr_b16 v[170:171], v3 offset:4864
	s_waitcnt lgkmcnt(6)
	v_mfma_f32_32x32x16_bf16 v[16:31], v[144:147], a[40:43], v[16:31]
	ds_read_b64_tr_b16 v[172:173], v3 offset:22784
	ds_read_b64_tr_b16 v[174:175], v3 offset:23296
	v_mfma_f32_32x32x16_bf16 v[32:47], v[148:151], a[40:43], v[32:47]
	ds_read_b64_tr_b16 v[144:145], v3 offset:6144
	ds_read_b64_tr_b16 v[146:147], v3 offset:6656
	v_mfma_f32_32x32x16_bf16 v[48:63], v[152:155], a[40:43], v[48:63]
	ds_read_b64_tr_b16 v[148:149], v3 offset:24576
	ds_read_b64_tr_b16 v[150:151], v3 offset:25088
	v_mfma_f32_32x32x16_bf16 v[64:79], v[156:159], a[40:43], v[64:79]
	ds_read_b64_tr_b16 v[152:153], v3 offset:6400
	ds_read_b64_tr_b16 v[154:155], v3 offset:6912
	s_waitcnt lgkmcnt(6)
	v_mfma_f32_32x32x16_bf16 v[16:31], v[160:163], a[44:47], v[16:31]
	ds_read_b64_tr_b16 v[156:157], v3 offset:24832
	ds_read_b64_tr_b16 v[158:159], v3 offset:25344
	v_mfma_f32_32x32x16_bf16 v[32:47], v[164:167], a[44:47], v[32:47]
	ds_read_b64_tr_b16 v[160:161], v3 offset:8192
	ds_read_b64_tr_b16 v[162:163], v3 offset:8704
	v_mfma_f32_32x32x16_bf16 v[48:63], v[168:171], a[44:47], v[48:63]
	ds_read_b64_tr_b16 v[164:165], v3 offset:26624
	ds_read_b64_tr_b16 v[166:167], v3 offset:27136
	v_mfma_f32_32x32x16_bf16 v[64:79], v[172:175], a[44:47], v[64:79]
	ds_read_b64_tr_b16 v[168:169], v3 offset:8448
	ds_read_b64_tr_b16 v[170:171], v3 offset:8960
	s_waitcnt lgkmcnt(6)
	v_mfma_f32_32x32x16_bf16 v[16:31], v[144:147], a[48:51], v[16:31]
	ds_read_b64_tr_b16 v[172:173], v3 offset:26880
	ds_read_b64_tr_b16 v[174:175], v3 offset:27392
	v_mfma_f32_32x32x16_bf16 v[32:47], v[148:151], a[48:51], v[32:47]
	ds_read_b64_tr_b16 v[144:145], v3 offset:10240
	ds_read_b64_tr_b16 v[146:147], v3 offset:10752
	v_mfma_f32_32x32x16_bf16 v[48:63], v[152:155], a[48:51], v[48:63]
	ds_read_b64_tr_b16 v[148:149], v3 offset:28672
	ds_read_b64_tr_b16 v[150:151], v3 offset:29184
	v_mfma_f32_32x32x16_bf16 v[64:79], v[156:159], a[48:51], v[64:79]
	ds_read_b64_tr_b16 v[152:153], v3 offset:10496
	ds_read_b64_tr_b16 v[154:155], v3 offset:11008
	s_waitcnt lgkmcnt(6)
	v_mfma_f32_32x32x16_bf16 v[16:31], v[160:163], a[52:55], v[16:31]
	ds_read_b64_tr_b16 v[156:157], v3 offset:28928
	ds_read_b64_tr_b16 v[158:159], v3 offset:29440
	v_mfma_f32_32x32x16_bf16 v[32:47], v[164:167], a[52:55], v[32:47]
	ds_read_b64_tr_b16 v[160:161], v3 offset:12288
	ds_read_b64_tr_b16 v[162:163], v3 offset:12800
	v_mfma_f32_32x32x16_bf16 v[48:63], v[168:171], a[52:55], v[48:63]
	ds_read_b64_tr_b16 v[164:165], v3 offset:30720
	ds_read_b64_tr_b16 v[166:167], v3 offset:31232
	s_waitcnt vmcnt(9)
	s_barrier
	v_mfma_f32_32x32x16_bf16 v[64:79], v[172:175], a[52:55], v[64:79]
	ds_read_b64_tr_b16 v[168:169], v3 offset:12544
	ds_read_b64_tr_b16 v[170:171], v3 offset:13056
	v_add_u32 v6, 0xffc34080, v6
	s_add_u32 m0, s37, 0
	s_waitcnt lgkmcnt(6)
	v_mfma_f32_32x32x16_bf16 v[16:31], v[144:147], a[56:59], v[16:31]
	ds_read_b64_tr_b16 v[172:173], v3 offset:30976
	ds_read_b64_tr_b16 v[174:175], v3 offset:31488
	v_mfma_f32_32x32x16_bf16 v[32:47], v[148:151], a[56:59], v[32:47]
	ds_read_b64_tr_b16 v[144:145], v3 offset:14336
	ds_read_b64_tr_b16 v[146:147], v3 offset:14848
	buffer_load_dwordx4 v6, s[12:15], s40 offen lds
	s_add_u32 m0, s37, 1024
	v_mfma_f32_32x32x16_bf16 v[48:63], v[152:155], a[56:59], v[48:63]
	ds_read_b64_tr_b16 v[148:149], v3 offset:32768
	ds_read_b64_tr_b16 v[150:151], v3 offset:33280
	v_mfma_f32_32x32x16_bf16 v[64:79], v[156:159], a[56:59], v[64:79]
	ds_read_b64_tr_b16 v[152:153], v3 offset:14592
	ds_read_b64_tr_b16 v[154:155], v3 offset:15104
	buffer_load_dwordx4 v6, s[12:15], s41 offen lds
	s_add_u32 m0, s37, 2048
	s_waitcnt lgkmcnt(6)
	v_mfma_f32_32x32x16_bf16 v[16:31], v[160:163], a[60:63], v[16:31]
	ds_read_b64_tr_b16 v[156:157], v3 offset:33024
	ds_read_b64_tr_b16 v[158:159], v3 offset:33536
	v_mfma_f32_32x32x16_bf16 v[32:47], v[164:167], a[60:63], v[32:47]
	ds_read_b64_tr_b16 v[160:161], v3 offset:16384
	ds_read_b64_tr_b16 v[162:163], v3 offset:16896
	buffer_load_dwordx4 v6, s[12:15], s42 offen lds
	s_add_u32 m0, s37, 3072
	v_mfma_f32_32x32x16_bf16 v[48:63], v[168:171], a[60:63], v[48:63]
	ds_read_b64_tr_b16 v[164:165], v3 offset:34816
	ds_read_b64_tr_b16 v[166:167], v3 offset:35328
	v_mfma_f32_32x32x16_bf16 v[64:79], v[172:175], a[60:63], v[64:79]
	ds_read_b64_tr_b16 v[168:169], v3 offset:16640
	ds_read_b64_tr_b16 v[170:171], v3 offset:17152
	buffer_load_dwordx4 v6, s[12:15], s43 offen lds
	s_add_u32 m0, s37, 4096
	s_waitcnt lgkmcnt(6)
	v_mfma_f32_32x32x16_bf16 v[16:31], v[144:147], a[64:67], v[16:31]
	ds_read_b64_tr_b16 v[172:173], v3 offset:35072
	ds_read_b64_tr_b16 v[174:175], v3 offset:35584
	v_mfma_f32_32x32x16_bf16 v[32:47], v[148:151], a[64:67], v[32:47]
	ds_read_b64_tr_b16 v[144:145], v4 offset:0
	ds_read_b64_tr_b16 v[146:147], v4 offset:512
	buffer_load_dwordx4 v6, s[12:15], s44 offen lds
	s_add_u32 m0, s37, 5120
	v_mfma_f32_32x32x16_bf16 v[48:63], v[152:155], a[64:67], v[48:63]
	ds_read_b64_tr_b16 v[148:149], v4 offset:18432
	ds_read_b64_tr_b16 v[150:151], v4 offset:18944
	v_mfma_f32_32x32x16_bf16 v[64:79], v[156:159], a[64:67], v[64:79]
	ds_read_b64_tr_b16 v[152:153], v4 offset:256
	ds_read_b64_tr_b16 v[154:155], v4 offset:768
	buffer_load_dwordx4 v6, s[12:15], s45 offen lds
	s_add_u32 m0, s37, 6144
	s_waitcnt lgkmcnt(6)
	v_mfma_f32_32x32x16_bf16 v[16:31], v[160:163], a[68:71], v[16:31]
	ds_read_b64_tr_b16 v[156:157], v4 offset:18688
	ds_read_b64_tr_b16 v[158:159], v4 offset:19200
	v_mfma_f32_32x32x16_bf16 v[32:47], v[164:167], a[68:71], v[32:47]
	ds_read_b64_tr_b16 v[160:161], v4 offset:2048
	ds_read_b64_tr_b16 v[162:163], v4 offset:2560
	buffer_load_dwordx4 v6, s[12:15], s46 offen lds
	s_add_u32 m0, s37, 7168
	v_mfma_f32_32x32x16_bf16 v[48:63], v[168:171], a[68:71], v[48:63]
	ds_read_b64_tr_b16 v[164:165], v4 offset:20480
	ds_read_b64_tr_b16 v[166:167], v4 offset:20992
	v_mfma_f32_32x32x16_bf16 v[64:79], v[172:175], a[68:71], v[64:79]
	ds_read_b64_tr_b16 v[168:169], v4 offset:2304
	ds_read_b64_tr_b16 v[170:171], v4 offset:2816
	buffer_load_dwordx4 v6, s[12:15], s47 offen lds
	s_add_u32 m0, s37, 8192
	s_waitcnt lgkmcnt(6)
	v_mfma_f32_32x32x16_bf16 v[16:31], v[144:147], a[72:75], v[16:31]
	ds_read_b64_tr_b16 v[172:173], v4 offset:20736
	ds_read_b64_tr_b16 v[174:175], v4 offset:21248
	v_mfma_f32_32x32x16_bf16 v[32:47], v[148:151], a[72:75], v[32:47]
	ds_read_b64_tr_b16 v[144:145], v4 offset:4096
	ds_read_b64_tr_b16 v[146:147], v4 offset:4608
	buffer_load_dwordx4 v6, s[12:15], s48 offen lds
	v_mfma_f32_32x32x16_bf16 v[48:63], v[152:155], a[72:75], v[48:63]
	ds_read_b64_tr_b16 v[148:149], v4 offset:22528
	ds_read_b64_tr_b16 v[150:151], v4 offset:23040
	v_mfma_f32_32x32x16_bf16 v[64:79], v[156:159], a[72:75], v[64:79]
	ds_read_b64_tr_b16 v[152:153], v4 offset:4352
	ds_read_b64_tr_b16 v[154:155], v4 offset:4864
	s_waitcnt lgkmcnt(6)
	v_mfma_f32_32x32x16_bf16 v[16:31], v[160:163], a[76:79], v[16:31]
	ds_read_b64_tr_b16 v[156:157], v4 offset:22784
	ds_read_b64_tr_b16 v[158:159], v4 offset:23296
	v_mfma_f32_32x32x16_bf16 v[32:47], v[164:167], a[76:79], v[32:47]
	ds_read_b64_tr_b16 v[160:161], v4 offset:6144
	ds_read_b64_tr_b16 v[162:163], v4 offset:6656
	v_mfma_f32_32x32x16_bf16 v[48:63], v[168:171], a[76:79], v[48:63]
	ds_read_b64_tr_b16 v[164:165], v4 offset:24576
	ds_read_b64_tr_b16 v[166:167], v4 offset:25088
	v_mfma_f32_32x32x16_bf16 v[64:79], v[172:175], a[76:79], v[64:79]
	ds_read_b64_tr_b16 v[168:169], v4 offset:6400
	ds_read_b64_tr_b16 v[170:171], v4 offset:6912
	s_waitcnt lgkmcnt(6)
	v_mfma_f32_32x32x16_bf16 v[16:31], v[144:147], a[80:83], v[16:31]
	ds_read_b64_tr_b16 v[172:173], v4 offset:24832
	ds_read_b64_tr_b16 v[174:175], v4 offset:25344
	v_mfma_f32_32x32x16_bf16 v[32:47], v[148:151], a[80:83], v[32:47]
	ds_read_b64_tr_b16 v[144:145], v4 offset:8192
	ds_read_b64_tr_b16 v[146:147], v4 offset:8704
	v_mfma_f32_32x32x16_bf16 v[48:63], v[152:155], a[80:83], v[48:63]
	ds_read_b64_tr_b16 v[148:149], v4 offset:26624
	ds_read_b64_tr_b16 v[150:151], v4 offset:27136
	v_mfma_f32_32x32x16_bf16 v[64:79], v[156:159], a[80:83], v[64:79]
	ds_read_b64_tr_b16 v[152:153], v4 offset:8448
	ds_read_b64_tr_b16 v[154:155], v4 offset:8960
	s_waitcnt lgkmcnt(6)
	v_mfma_f32_32x32x16_bf16 v[16:31], v[160:163], a[84:87], v[16:31]
	ds_read_b64_tr_b16 v[156:157], v4 offset:26880
	ds_read_b64_tr_b16 v[158:159], v4 offset:27392
	v_mfma_f32_32x32x16_bf16 v[32:47], v[164:167], a[84:87], v[32:47]
	ds_read_b64_tr_b16 v[160:161], v4 offset:10240
	ds_read_b64_tr_b16 v[162:163], v4 offset:10752
	v_mfma_f32_32x32x16_bf16 v[48:63], v[168:171], a[84:87], v[48:63]
	ds_read_b64_tr_b16 v[164:165], v4 offset:28672
	ds_read_b64_tr_b16 v[166:167], v4 offset:29184
	v_mfma_f32_32x32x16_bf16 v[64:79], v[172:175], a[84:87], v[64:79]
	ds_read_b64_tr_b16 v[168:169], v4 offset:10496
	ds_read_b64_tr_b16 v[170:171], v4 offset:11008
	s_waitcnt lgkmcnt(6)
	v_mfma_f32_32x32x16_bf16 v[16:31], v[144:147], a[88:91], v[16:31]
	ds_read_b64_tr_b16 v[172:173], v4 offset:28928
	ds_read_b64_tr_b16 v[174:175], v4 offset:29440
	v_mfma_f32_32x32x16_bf16 v[32:47], v[148:151], a[88:91], v[32:47]
	ds_read_b64_tr_b16 v[144:145], v4 offset:12288
	ds_read_b64_tr_b16 v[146:147], v4 offset:12800
	v_mfma_f32_32x32x16_bf16 v[48:63], v[152:155], a[88:91], v[48:63]
	ds_read_b64_tr_b16 v[148:149], v4 offset:30720
	ds_read_b64_tr_b16 v[150:151], v4 offset:31232
	s_waitcnt vmcnt(9)
	s_barrier
	v_mfma_f32_32x32x16_bf16 v[64:79], v[156:159], a[88:91], v[64:79]
	ds_read_b64_tr_b16 v[152:153], v4 offset:12544
	ds_read_b64_tr_b16 v[154:155], v4 offset:13056
	v_add_u32 v6, 0x144000, v6
	s_add_u32 m0, s37, 36864
	s_waitcnt lgkmcnt(6)
	v_mfma_f32_32x32x16_bf16 v[16:31], v[160:163], a[92:95], v[16:31]
	ds_read_b64_tr_b16 v[156:157], v4 offset:30976
	ds_read_b64_tr_b16 v[158:159], v4 offset:31488
	v_mfma_f32_32x32x16_bf16 v[32:47], v[164:167], a[92:95], v[32:47]
	ds_read_b64_tr_b16 v[160:161], v4 offset:14336
	ds_read_b64_tr_b16 v[162:163], v4 offset:14848
	buffer_load_dwordx4 v6, s[12:15], s40 offen lds
	s_add_u32 m0, s37, 37888
	v_mfma_f32_32x32x16_bf16 v[48:63], v[168:171], a[92:95], v[48:63]
	ds_read_b64_tr_b16 v[164:165], v4 offset:32768
	ds_read_b64_tr_b16 v[166:167], v4 offset:33280
	v_mfma_f32_32x32x16_bf16 v[64:79], v[172:175], a[92:95], v[64:79]
	ds_read_b64_tr_b16 v[168:169], v4 offset:14592
	ds_read_b64_tr_b16 v[170:171], v4 offset:15104
	buffer_load_dwordx4 v6, s[12:15], s41 offen lds
	s_add_u32 m0, s37, 38912
	s_waitcnt lgkmcnt(6)
	v_mfma_f32_32x32x16_bf16 v[16:31], v[144:147], a[96:99], v[16:31]
	ds_read_b64_tr_b16 v[172:173], v4 offset:33024
	ds_read_b64_tr_b16 v[174:175], v4 offset:33536
	v_mfma_f32_32x32x16_bf16 v[32:47], v[148:151], a[96:99], v[32:47]
	ds_read_b64_tr_b16 v[144:145], v4 offset:16384
	ds_read_b64_tr_b16 v[146:147], v4 offset:16896
	buffer_load_dwordx4 v6, s[12:15], s42 offen lds
	s_add_u32 m0, s37, 39936
	v_mfma_f32_32x32x16_bf16 v[48:63], v[152:155], a[96:99], v[48:63]
	ds_read_b64_tr_b16 v[148:149], v4 offset:34816
	ds_read_b64_tr_b16 v[150:151], v4 offset:35328
	v_mfma_f32_32x32x16_bf16 v[64:79], v[156:159], a[96:99], v[64:79]
	ds_read_b64_tr_b16 v[152:153], v4 offset:16640
	ds_read_b64_tr_b16 v[154:155], v4 offset:17152
	buffer_load_dwordx4 v6, s[12:15], s43 offen lds
	s_add_u32 m0, s37, 40960
	s_waitcnt lgkmcnt(6)
	v_mfma_f32_32x32x16_bf16 v[16:31], v[160:163], a[100:103], v[16:31]
	ds_read_b64_tr_b16 v[156:157], v4 offset:35072
	ds_read_b64_tr_b16 v[158:159], v4 offset:35584
	v_mfma_f32_32x32x16_bf16 v[32:47], v[164:167], a[100:103], v[32:47]
	ds_read_b64_tr_b16 v[160:161], v5 offset:0
	ds_read_b64_tr_b16 v[162:163], v5 offset:512
	buffer_load_dwordx4 v6, s[12:15], s44 offen lds
	s_add_u32 m0, s37, 41984
	v_mfma_f32_32x32x16_bf16 v[48:63], v[168:171], a[100:103], v[48:63]
	ds_read_b64_tr_b16 v[164:165], v5 offset:18432
	ds_read_b64_tr_b16 v[166:167], v5 offset:18944
	v_mfma_f32_32x32x16_bf16 v[64:79], v[172:175], a[100:103], v[64:79]
	ds_read_b64_tr_b16 v[168:169], v5 offset:256
	ds_read_b64_tr_b16 v[170:171], v5 offset:768
	buffer_load_dwordx4 v6, s[12:15], s45 offen lds
	s_add_u32 m0, s37, 43008
	s_waitcnt lgkmcnt(6)
	v_mfma_f32_32x32x16_bf16 v[16:31], v[144:147], a[104:107], v[16:31]
	ds_read_b64_tr_b16 v[172:173], v5 offset:18688
	ds_read_b64_tr_b16 v[174:175], v5 offset:19200
	v_mfma_f32_32x32x16_bf16 v[32:47], v[148:151], a[104:107], v[32:47]
	ds_read_b64_tr_b16 v[144:145], v5 offset:2048
	ds_read_b64_tr_b16 v[146:147], v5 offset:2560
	buffer_load_dwordx4 v6, s[12:15], s46 offen lds
	s_add_u32 m0, s37, 44032
	v_mfma_f32_32x32x16_bf16 v[48:63], v[152:155], a[104:107], v[48:63]
	ds_read_b64_tr_b16 v[148:149], v5 offset:20480
	ds_read_b64_tr_b16 v[150:151], v5 offset:20992
	v_mfma_f32_32x32x16_bf16 v[64:79], v[156:159], a[104:107], v[64:79]
	ds_read_b64_tr_b16 v[152:153], v5 offset:2304
	ds_read_b64_tr_b16 v[154:155], v5 offset:2816
	buffer_load_dwordx4 v6, s[12:15], s47 offen lds
	s_add_u32 m0, s37, 45056
	s_waitcnt lgkmcnt(6)
	v_mfma_f32_32x32x16_bf16 v[16:31], v[160:163], a[108:111], v[16:31]
	ds_read_b64_tr_b16 v[156:157], v5 offset:20736
	ds_read_b64_tr_b16 v[158:159], v5 offset:21248
	v_mfma_f32_32x32x16_bf16 v[32:47], v[164:167], a[108:111], v[32:47]
	ds_read_b64_tr_b16 v[160:161], v5 offset:4096
	ds_read_b64_tr_b16 v[162:163], v5 offset:4608
	buffer_load_dwordx4 v6, s[12:15], s48 offen lds
	v_mfma_f32_32x32x16_bf16 v[48:63], v[168:171], a[108:111], v[48:63]
	ds_read_b64_tr_b16 v[164:165], v5 offset:22528
	ds_read_b64_tr_b16 v[166:167], v5 offset:23040
	v_mfma_f32_32x32x16_bf16 v[64:79], v[172:175], a[108:111], v[64:79]
	ds_read_b64_tr_b16 v[168:169], v5 offset:4352
	ds_read_b64_tr_b16 v[170:171], v5 offset:4864
	s_waitcnt lgkmcnt(6)
	v_mfma_f32_32x32x16_bf16 v[16:31], v[144:147], a[112:115], v[16:31]
	ds_read_b64_tr_b16 v[172:173], v5 offset:22784
	ds_read_b64_tr_b16 v[174:175], v5 offset:23296
	v_mfma_f32_32x32x16_bf16 v[32:47], v[148:151], a[112:115], v[32:47]
	ds_read_b64_tr_b16 v[144:145], v5 offset:6144
	ds_read_b64_tr_b16 v[146:147], v5 offset:6656
	v_mfma_f32_32x32x16_bf16 v[48:63], v[152:155], a[112:115], v[48:63]
	ds_read_b64_tr_b16 v[148:149], v5 offset:24576
	ds_read_b64_tr_b16 v[150:151], v5 offset:25088
	v_mfma_f32_32x32x16_bf16 v[64:79], v[156:159], a[112:115], v[64:79]
	ds_read_b64_tr_b16 v[152:153], v5 offset:6400
	ds_read_b64_tr_b16 v[154:155], v5 offset:6912
	s_waitcnt lgkmcnt(6)
	v_mfma_f32_32x32x16_bf16 v[16:31], v[160:163], a[116:119], v[16:31]
	ds_read_b64_tr_b16 v[156:157], v5 offset:24832
	ds_read_b64_tr_b16 v[158:159], v5 offset:25344
	v_mfma_f32_32x32x16_bf16 v[32:47], v[164:167], a[116:119], v[32:47]
	ds_read_b64_tr_b16 v[160:161], v5 offset:8192
	ds_read_b64_tr_b16 v[162:163], v5 offset:8704
	v_mfma_f32_32x32x16_bf16 v[48:63], v[168:171], a[116:119], v[48:63]
	ds_read_b64_tr_b16 v[164:165], v5 offset:26624
	ds_read_b64_tr_b16 v[166:167], v5 offset:27136
	v_mfma_f32_32x32x16_bf16 v[64:79], v[172:175], a[116:119], v[64:79]
	ds_read_b64_tr_b16 v[168:169], v5 offset:8448
	ds_read_b64_tr_b16 v[170:171], v5 offset:8960
	s_waitcnt lgkmcnt(6)
	v_mfma_f32_32x32x16_bf16 v[16:31], v[144:147], a[120:123], v[16:31]
	ds_read_b64_tr_b16 v[172:173], v5 offset:26880
	ds_read_b64_tr_b16 v[174:175], v5 offset:27392
	v_mfma_f32_32x32x16_bf16 v[32:47], v[148:151], a[120:123], v[32:47]
	ds_read_b64_tr_b16 v[144:145], v5 offset:10240
	ds_read_b64_tr_b16 v[146:147], v5 offset:10752
	v_mfma_f32_32x32x16_bf16 v[48:63], v[152:155], a[120:123], v[48:63]
	ds_read_b64_tr_b16 v[148:149], v5 offset:28672
	ds_read_b64_tr_b16 v[150:151], v5 offset:29184
	v_mfma_f32_32x32x16_bf16 v[64:79], v[156:159], a[120:123], v[64:79]
	ds_read_b64_tr_b16 v[152:153], v5 offset:10496
	ds_read_b64_tr_b16 v[154:155], v5 offset:11008
	s_waitcnt lgkmcnt(6)
	v_mfma_f32_32x32x16_bf16 v[16:31], v[160:163], a[124:127], v[16:31]
	ds_read_b64_tr_b16 v[156:157], v5 offset:28928
	ds_read_b64_tr_b16 v[158:159], v5 offset:29440
	v_mfma_f32_32x32x16_bf16 v[32:47], v[164:167], a[124:127], v[32:47]
	ds_read_b64_tr_b16 v[160:161], v5 offset:12288
	ds_read_b64_tr_b16 v[162:163], v5 offset:12800
	v_mfma_f32_32x32x16_bf16 v[48:63], v[168:171], a[124:127], v[48:63]
	ds_read_b64_tr_b16 v[164:165], v5 offset:30720
	ds_read_b64_tr_b16 v[166:167], v5 offset:31232
	s_waitcnt vmcnt(9)
	s_barrier
	v_mfma_f32_32x32x16_bf16 v[64:79], v[172:175], a[124:127], v[64:79]
	ds_read_b64_tr_b16 v[168:169], v5 offset:12544
	ds_read_b64_tr_b16 v[170:171], v5 offset:13056
	v_add_u32 v6, 0x144000, v6
	s_add_u32 m0, s37, 73728
	s_waitcnt lgkmcnt(6)
	v_mfma_f32_32x32x16_bf16 v[16:31], v[144:147], a[128:131], v[16:31]
	ds_read_b64_tr_b16 v[172:173], v5 offset:30976
	ds_read_b64_tr_b16 v[174:175], v5 offset:31488
	v_mfma_f32_32x32x16_bf16 v[32:47], v[148:151], a[128:131], v[32:47]
	ds_read_b64_tr_b16 v[144:145], v5 offset:14336
	ds_read_b64_tr_b16 v[146:147], v5 offset:14848
	buffer_load_dwordx4 v6, s[12:15], s40 offen lds
	s_add_u32 m0, s37, 74752
	v_mfma_f32_32x32x16_bf16 v[48:63], v[152:155], a[128:131], v[48:63]
	ds_read_b64_tr_b16 v[148:149], v5 offset:32768
	ds_read_b64_tr_b16 v[150:151], v5 offset:33280
	v_mfma_f32_32x32x16_bf16 v[64:79], v[156:159], a[128:131], v[64:79]
	ds_read_b64_tr_b16 v[152:153], v5 offset:14592
	ds_read_b64_tr_b16 v[154:155], v5 offset:15104
	buffer_load_dwordx4 v6, s[12:15], s41 offen lds
	s_add_u32 m0, s37, 75776
	s_waitcnt lgkmcnt(6)
	v_mfma_f32_32x32x16_bf16 v[16:31], v[160:163], a[132:135], v[16:31]
	ds_read_b64_tr_b16 v[156:157], v5 offset:33024
	ds_read_b64_tr_b16 v[158:159], v5 offset:33536
	v_mfma_f32_32x32x16_bf16 v[32:47], v[164:167], a[132:135], v[32:47]
	ds_read_b64_tr_b16 v[160:161], v5 offset:16384
	ds_read_b64_tr_b16 v[162:163], v5 offset:16896
	buffer_load_dwordx4 v6, s[12:15], s42 offen lds
	s_add_u32 m0, s37, 76800
	v_mfma_f32_32x32x16_bf16 v[48:63], v[168:171], a[132:135], v[48:63]
	ds_read_b64_tr_b16 v[164:165], v5 offset:34816
	ds_read_b64_tr_b16 v[166:167], v5 offset:35328
	v_mfma_f32_32x32x16_bf16 v[64:79], v[172:175], a[132:135], v[64:79]
	ds_read_b64_tr_b16 v[168:169], v5 offset:16640
	ds_read_b64_tr_b16 v[170:171], v5 offset:17152
	buffer_load_dwordx4 v6, s[12:15], s43 offen lds
	s_add_u32 m0, s37, 77824
	s_waitcnt lgkmcnt(6)
	v_mfma_f32_32x32x16_bf16 v[16:31], v[144:147], a[136:139], v[16:31]
	ds_read_b64_tr_b16 v[172:173], v5 offset:35072
	ds_read_b64_tr_b16 v[174:175], v5 offset:35584
	v_mfma_f32_32x32x16_bf16 v[32:47], v[148:151], a[136:139], v[32:47]
	ds_read_b64_tr_b16 v[144:145], v2 offset:0
	ds_read_b64_tr_b16 v[146:147], v2 offset:512
	buffer_load_dwordx4 v6, s[12:15], s44 offen lds
	s_add_u32 m0, s37, 78848
	v_mfma_f32_32x32x16_bf16 v[48:63], v[152:155], a[136:139], v[48:63]
	ds_read_b64_tr_b16 v[148:149], v2 offset:18432
	ds_read_b64_tr_b16 v[150:151], v2 offset:18944
	v_mfma_f32_32x32x16_bf16 v[64:79], v[156:159], a[136:139], v[64:79]
	ds_read_b64_tr_b16 v[152:153], v2 offset:256
	ds_read_b64_tr_b16 v[154:155], v2 offset:768
	buffer_load_dwordx4 v6, s[12:15], s45 offen lds
	s_add_u32 m0, s37, 79872
	s_waitcnt lgkmcnt(6)
	v_mfma_f32_32x32x16_bf16 v[16:31], v[160:163], a[140:143], v[16:31]
	ds_read_b64_tr_b16 v[156:157], v2 offset:18688
	ds_read_b64_tr_b16 v[158:159], v2 offset:19200
	v_mfma_f32_32x32x16_bf16 v[32:47], v[164:167], a[140:143], v[32:47]
	ds_read_b64_tr_b16 v[160:161], v2 offset:2048
	ds_read_b64_tr_b16 v[162:163], v2 offset:2560
	buffer_load_dwordx4 v6, s[12:15], s46 offen lds
	s_add_u32 m0, s37, 80896
	v_mfma_f32_32x32x16_bf16 v[48:63], v[168:171], a[140:143], v[48:63]
	ds_read_b64_tr_b16 v[164:165], v2 offset:20480
	ds_read_b64_tr_b16 v[166:167], v2 offset:20992
	v_mfma_f32_32x32x16_bf16 v[64:79], v[172:175], a[140:143], v[64:79]
	ds_read_b64_tr_b16 v[168:169], v2 offset:2304
	ds_read_b64_tr_b16 v[170:171], v2 offset:2816
	buffer_load_dwordx4 v6, s[12:15], s47 offen lds
	s_add_u32 m0, s37, 81920
	s_waitcnt lgkmcnt(6)
	v_mfma_f32_32x32x16_bf16 v[80:95], v[144:147], a[0:3], 0
	ds_read_b64_tr_b16 v[172:173], v2 offset:20736
	ds_read_b64_tr_b16 v[174:175], v2 offset:21248
	v_mfma_f32_32x32x16_bf16 v[96:111], v[148:151], a[0:3], 0
	ds_read_b64_tr_b16 v[144:145], v2 offset:4096
	ds_read_b64_tr_b16 v[146:147], v2 offset:4608
	buffer_load_dwordx4 v6, s[12:15], s48 offen lds
	v_mfma_f32_32x32x16_bf16 v[112:127], v[152:155], a[0:3], 0
	ds_read_b64_tr_b16 v[148:149], v2 offset:22528
	ds_read_b64_tr_b16 v[150:151], v2 offset:23040
	v_mfma_f32_32x32x16_bf16 v[128:143], v[156:159], a[0:3], 0
	ds_read_b64_tr_b16 v[152:153], v2 offset:4352
	ds_read_b64_tr_b16 v[154:155], v2 offset:4864
	s_waitcnt lgkmcnt(6)
	v_mfma_f32_32x32x16_bf16 v[80:95], v[160:163], a[4:7], v[80:95]
	ds_read_b64_tr_b16 v[156:157], v2 offset:22784
	ds_read_b64_tr_b16 v[158:159], v2 offset:23296
	v_mul_f32 v176, v16, v16
	v_mul_f32 v177, v17, v17
	v_fma_f32 v176, v176, v11, v10
	v_mfma_f32_32x32x16_bf16 v[96:111], v[164:167], a[4:7], v[96:111]
	ds_read_b64_tr_b16 v[160:161], v2 offset:6144
	ds_read_b64_tr_b16 v[162:163], v2 offset:6656
	v_fma_f32 v177, v177, v11, v10
	v_mul_f32 v176, v176, v16
	v_mul_f32 v177, v177, v17
	v_mfma_f32_32x32x16_bf16 v[112:127], v[168:171], a[4:7], v[112:127]
	ds_read_b64_tr_b16 v[164:165], v2 offset:24576
	ds_read_b64_tr_b16 v[166:167], v2 offset:25088
	v_exp_f32 v176, v176
	v_exp_f32 v177, v177
	v_mul_f32 v178, v16, v32
	v_mov_b32 v208, v15
	v_add_u32 v209, 36864, v15
	v_add_u32 v210, 73728, v15
	v_add_u32 v211, 110592, v15
	v_and_b32 v221, 3, v1
	v_lshlrev_b32 v221, 2, v221
	v_mfma_f32_32x32x16_bf16 v[128:143], v[172:175], a[4:7], v[128:143]
	ds_read_b64_tr_b16 v[168:169], v2 offset:6400
	ds_read_b64_tr_b16 v[170:171], v2 offset:6912
	v_mul_f32 v179, v17, v33
	v_fma_f32 v176, v176, v13, v13
	v_fma_f32 v177, v177, v13, v13
	s_waitcnt lgkmcnt(6)
	v_mfma_f32_32x32x16_bf16 v[80:95], v[144:147], a[8:11], v[80:95]
	ds_read_b64_tr_b16 v[172:173], v2 offset:24832
	ds_read_b64_tr_b16 v[174:175], v2 offset:25344
	v_rcp_f32 v176, v176
	v_rcp_f32 v177, v177
	v_mfma_f32_32x32x16_bf16 v[96:111], v[148:151], a[8:11], v[96:111]
	ds_read_b64_tr_b16 v[144:145], v2 offset:8192
	ds_read_b64_tr_b16 v[146:147], v2 offset:8704
	v_mul_f32 v178, v178, v176
	v_mul_f32 v179, v179, v177
	v_cvt_pk_bf16_f32 v192, v178, v179
	v_mul_f32 v180, v18, v18
	v_mfma_f32_32x32x16_bf16 v[112:127], v[152:155], a[8:11], v[112:127]
	ds_read_b64_tr_b16 v[148:149], v2 offset:26624
	ds_read_b64_tr_b16 v[150:151], v2 offset:27136
	v_mul_f32 v181, v19, v19
	v_fma_f32 v180, v180, v11, v10
	v_fma_f32 v181, v181, v11, v10
	v_mul_f32 v180, v180, v18
	v_mfma_f32_32x32x16_bf16 v[128:143], v[156:159], a[8:11], v[128:143]
	ds_read_b64_tr_b16 v[152:153], v2 offset:8448
	ds_read_b64_tr_b16 v[154:155], v2 offset:8960
	v_mul_f32 v181, v181, v19
	v_exp_f32 v180, v180
	s_waitcnt lgkmcnt(6)
	v_mfma_f32_32x32x16_bf16 v[80:95], v[160:163], a[12:15], v[80:95]
	ds_read_b64_tr_b16 v[156:157], v2 offset:26880
	ds_read_b64_tr_b16 v[158:159], v2 offset:27392
	v_exp_f32 v181, v181
	v_mul_f32 v182, v18, v34
	v_mul_f32 v183, v19, v35
	v_mfma_f32_32x32x16_bf16 v[96:111], v[164:167], a[12:15], v[96:111]
	ds_read_b64_tr_b16 v[160:161], v2 offset:10240
	ds_read_b64_tr_b16 v[162:163], v2 offset:10752
	v_fma_f32 v180, v180, v13, v13
	v_fma_f32 v181, v181, v13, v13
	v_rcp_f32 v180, v180
	v_mfma_f32_32x32x16_bf16 v[112:127], v[168:171], a[12:15], v[112:127]
	ds_read_b64_tr_b16 v[164:165], v2 offset:28672
	ds_read_b64_tr_b16 v[166:167], v2 offset:29184
	v_rcp_f32 v181, v181
	v_mul_f32 v182, v182, v180
	v_mul_f32 v183, v183, v181
	v_mfma_f32_32x32x16_bf16 v[128:143], v[172:175], a[12:15], v[128:143]
	ds_read_b64_tr_b16 v[168:169], v2 offset:10496
	ds_read_b64_tr_b16 v[170:171], v2 offset:11008
	v_cvt_pk_bf16_f32 v193, v182, v183
	v_mul_f32 v184, v20, v20
	v_mul_f32 v185, v21, v21
	v_fma_f32 v184, v184, v11, v10
	s_waitcnt lgkmcnt(6)
	v_mfma_f32_32x32x16_bf16 v[80:95], v[144:147], a[16:19], v[80:95]
	ds_read_b64_tr_b16 v[172:173], v2 offset:28928
	ds_read_b64_tr_b16 v[174:175], v2 offset:29440
	v_fma_f32 v185, v185, v11, v10
	v_mul_f32 v184, v184, v20
	v_mul_f32 v185, v185, v21
	v_mfma_f32_32x32x16_bf16 v[96:111], v[148:151], a[16:19], v[96:111]
	ds_read_b64_tr_b16 v[144:145], v2 offset:12288
	ds_read_b64_tr_b16 v[146:147], v2 offset:12800
	v_exp_f32 v184, v184
	v_exp_f32 v185, v185
	v_mfma_f32_32x32x16_bf16 v[112:127], v[152:155], a[16:19], v[112:127]
	ds_read_b64_tr_b16 v[148:149], v2 offset:30720
	ds_read_b64_tr_b16 v[150:151], v2 offset:31232
	s_waitcnt vmcnt(9)
	s_barrier
	v_mul_f32 v186, v20, v36
	v_mul_f32 v187, v21, v37
	v_mfma_f32_32x32x16_bf16 v[128:143], v[156:159], a[16:19], v[128:143]
	ds_read_b64_tr_b16 v[152:153], v2 offset:12544
	ds_read_b64_tr_b16 v[154:155], v2 offset:13056
	v_add_u32 v6, 0x144000, v6
	s_add_u32 m0, s37, 110592
	v_fma_f32 v184, v184, v13, v13
	v_fma_f32 v185, v185, v13, v13
	s_waitcnt lgkmcnt(6)
	v_mfma_f32_32x32x16_bf16 v[80:95], v[160:163], a[20:23], v[80:95]
	ds_read_b64_tr_b16 v[156:157], v2 offset:30976
	ds_read_b64_tr_b16 v[158:159], v2 offset:31488
	v_rcp_f32 v184, v184
	v_mfma_f32_32x32x16_bf16 v[96:111], v[164:167], a[20:23], v[96:111]
	ds_read_b64_tr_b16 v[160:161], v2 offset:14336
	ds_read_b64_tr_b16 v[162:163], v2 offset:14848
	buffer_load_dwordx4 v6, s[12:15], s40 offen lds
	s_add_u32 m0, s37, 111616
	v_rcp_f32 v185, v185
	v_mfma_f32_32x32x16_bf16 v[112:127], v[168:171], a[20:23], v[112:127]
	ds_read_b64_tr_b16 v[164:165], v2 offset:32768
	ds_read_b64_tr_b16 v[166:167], v2 offset:33280
	v_mul_f32 v186, v186, v184
	v_mul_f32 v187, v187, v185
	v_cvt_pk_bf16_f32 v194, v186, v187
	v_mul_f32 v188, v22, v22
	v_mfma_f32_32x32x16_bf16 v[128:143], v[172:175], a[20:23], v[128:143]
	ds_read_b64_tr_b16 v[168:169], v2 offset:14592
	ds_read_b64_tr_b16 v[170:171], v2 offset:15104
	buffer_load_dwordx4 v6, s[12:15], s41 offen lds
	s_add_u32 m0, s37, 112640
	v_mul_f32 v189, v23, v23
	s_waitcnt lgkmcnt(6)
	v_mfma_f32_32x32x16_bf16 v[80:95], v[144:147], a[24:27], v[80:95]
	ds_read_b64_tr_b16 v[172:173], v2 offset:33024
	ds_read_b64_tr_b16 v[174:175], v2 offset:33536
	v_fma_f32 v188, v188, v11, v10
	v_fma_f32 v189, v189, v11, v10
	v_mul_f32 v188, v188, v22
	v_mfma_f32_32x32x16_bf16 v[96:111], v[148:151], a[24:27], v[96:111]
	ds_read_b64_tr_b16 v[144:145], v2 offset:16384
	ds_read_b64_tr_b16 v[146:147], v2 offset:16896
	buffer_load_dwordx4 v6, s[12:15], s42 offen lds
	s_add_u32 m0, s37, 113664
	v_mul_f32 v189, v189, v23
	v_mfma_f32_32x32x16_bf16 v[112:127], v[152:155], a[24:27], v[112:127]
	ds_read_b64_tr_b16 v[148:149], v2 offset:34816
	ds_read_b64_tr_b16 v[150:151], v2 offset:35328
	v_exp_f32 v188, v188
	v_exp_f32 v189, v189
	v_mfma_f32_32x32x16_bf16 v[128:143], v[156:159], a[24:27], v[128:143]
	ds_read_b64_tr_b16 v[152:153], v2 offset:16640
	ds_read_b64_tr_b16 v[154:155], v2 offset:17152
	buffer_load_dwordx4 v6, s[12:15], s43 offen lds
	s_add_u32 m0, s37, 114688
	v_mul_f32 v190, v22, v38
	s_waitcnt lgkmcnt(6)
	v_mfma_f32_32x32x16_bf16 v[80:95], v[160:163], a[28:31], v[80:95]
	ds_read_b64_tr_b16 v[156:157], v2 offset:35072
	ds_read_b64_tr_b16 v[158:159], v2 offset:35584
	v_mul_f32 v191, v23, v39
	v_fma_f32 v188, v188, v13, v13
	v_fma_f32 v189, v189, v13, v13
	v_mfma_f32_32x32x16_bf16 v[96:111], v[164:167], a[28:31], v[96:111]
	ds_read_b64_tr_b16 v[160:161], v3 offset:0
	ds_read_b64_tr_b16 v[162:163], v3 offset:512
	buffer_load_dwordx4 v6, s[12:15], s44 offen lds
	s_add_u32 m0, s37, 115712
	v_mfma_f32_32x32x16_bf16 v[112:127], v[168:171], a[28:31], v[112:127]
	ds_read_b64_tr_b16 v[164:165], v3 offset:18432
	ds_read_b64_tr_b16 v[166:167], v3 offset:18944
	v_rcp_f32 v188, v188
	v_rcp_f32 v189, v189
	v_mul_f32 v190, v190, v188
	v_mfma_f32_32x32x16_bf16 v[128:143], v[172:175], a[28:31], v[128:143]
	ds_read_b64_tr_b16 v[168:169], v3 offset:256
	ds_read_b64_tr_b16 v[170:171], v3 offset:768
	buffer_load_dwordx4 v6, s[12:15], s45 offen lds
	s_add_u32 m0, s37, 116736
	v_mul_f32 v191, v191, v189
	s_waitcnt lgkmcnt(6)
	v_mfma_f32_32x32x16_bf16 v[80:95], v[144:147], a[32:35], v[80:95]
	ds_read_b64_tr_b16 v[172:173], v3 offset:18688
	ds_read_b64_tr_b16 v[174:175], v3 offset:19200
	v_cvt_pk_bf16_f32 v195, v190, v191
	s_add_u32 s65, s63, 0
	v_mfma_f32_32x32x16_bf16 v[96:111], v[148:151], a[32:35], v[96:111]
	ds_read_b64_tr_b16 v[144:145], v3 offset:2048
	ds_read_b64_tr_b16 v[146:147], v3 offset:2560
	buffer_load_dwordx4 v6, s[12:15], s46 offen lds
	s_add_u32 m0, s37, 117760
	buffer_store_dwordx4 v[192:195], v8, s[8:11], s65 offen offset:0 sc1
	v_mfma_f32_32x32x16_bf16 v[112:127], v[152:155], a[32:35], v[112:127]
	ds_read_b64_tr_b16 v[148:149], v3 offset:20480
	ds_read_b64_tr_b16 v[150:151], v3 offset:20992
	v_mul_f32 v176, v24, v24
	v_mul_f32 v177, v25, v25
	v_fma_f32 v176, v176, v11, v10
	v_fma_f32 v177, v177, v11, v10
	v_mfma_f32_32x32x16_bf16 v[128:143], v[156:159], a[32:35], v[128:143]
	ds_read_b64_tr_b16 v[152:153], v3 offset:2304
	ds_read_b64_tr_b16 v[154:155], v3 offset:2816
	buffer_load_dwordx4 v6, s[12:15], s47 offen lds
	s_add_u32 m0, s37, 118784
	v_mul_f32 v176, v176, v24
	s_waitcnt lgkmcnt(6)
	v_mfma_f32_32x32x16_bf16 v[80:95], v[160:163], a[36:39], v[80:95]
	ds_read_b64_tr_b16 v[156:157], v3 offset:20736
	ds_read_b64_tr_b16 v[158:159], v3 offset:21248
	v_mul_f32 v177, v177, v25
	v_exp_f32 v176, v176
	v_mfma_f32_32x32x16_bf16 v[96:111], v[164:167], a[36:39], v[96:111]
	ds_read_b64_tr_b16 v[160:161], v3 offset:4096
	ds_read_b64_tr_b16 v[162:163], v3 offset:4608
	buffer_load_dwordx4 v6, s[12:15], s48 offen lds
	v_exp_f32 v177, v177
	v_mfma_f32_32x32x16_bf16 v[112:127], v[168:171], a[36:39], v[112:127]
	ds_read_b64_tr_b16 v[164:165], v3 offset:22528
	ds_read_b64_tr_b16 v[166:167], v3 offset:23040
	v_mul_f32 v178, v24, v40
	v_mul_f32 v179, v25, v41
	v_fma_f32 v176, v176, v13, v13
	v_fma_f32 v177, v177, v13, v13
	v_mfma_f32_32x32x16_bf16 v[128:143], v[172:175], a[36:39], v[128:143]
	ds_read_b64_tr_b16 v[168:169], v3 offset:4352
	ds_read_b64_tr_b16 v[170:171], v3 offset:4864
	v_rcp_f32 v176, v176
	v_rcp_f32 v177, v177
	s_waitcnt lgkmcnt(6)
	v_mfma_f32_32x32x16_bf16 v[80:95], v[144:147], a[40:43], v[80:95]
	ds_read_b64_tr_b16 v[172:173], v3 offset:22784
	ds_read_b64_tr_b16 v[174:175], v3 offset:23296
	v_mul_f32 v178, v178, v176
	v_mul_f32 v179, v179, v177
	v_cvt_pk_bf16_f32 v196, v178, v179
	v_mfma_f32_32x32x16_bf16 v[96:111], v[148:151], a[40:43], v[96:111]
	ds_read_b64_tr_b16 v[144:145], v3 offset:6144
	ds_read_b64_tr_b16 v[146:147], v3 offset:6656
	v_mul_f32 v180, v26, v26
	v_mul_f32 v181, v27, v27
	v_fma_f32 v180, v180, v11, v10
	v_fma_f32 v181, v181, v11, v10
	v_mfma_f32_32x32x16_bf16 v[112:127], v[152:155], a[40:43], v[112:127]
	ds_read_b64_tr_b16 v[148:149], v3 offset:24576
	ds_read_b64_tr_b16 v[150:151], v3 offset:25088
	v_mul_f32 v180, v180, v26
	v_mul_f32 v181, v181, v27
	v_exp_f32 v180, v180
	v_mfma_f32_32x32x16_bf16 v[128:143], v[156:159], a[40:43], v[128:143]
	ds_read_b64_tr_b16 v[152:153], v3 offset:6400
	ds_read_b64_tr_b16 v[154:155], v3 offset:6912
	v_exp_f32 v181, v181
	v_mul_f32 v182, v26, v42
	v_mul_f32 v183, v27, v43
	s_waitcnt lgkmcnt(6)
	v_mfma_f32_32x32x16_bf16 v[80:95], v[160:163], a[44:47], v[80:95]
	ds_read_b64_tr_b16 v[156:157], v3 offset:24832
	ds_read_b64_tr_b16 v[158:159], v3 offset:25344
	v_fma_f32 v180, v180, v13, v13
	v_fma_f32 v181, v181, v13, v13
	v_mfma_f32_32x32x16_bf16 v[96:111], v[164:167], a[44:47], v[96:111]
	ds_read_b64_tr_b16 v[160:161], v3 offset:8192
	ds_read_b64_tr_b16 v[162:163], v3 offset:8704
	v_rcp_f32 v180, v180
	v_rcp_f32 v181, v181
	v_mul_f32 v182, v182, v180
	v_mfma_f32_32x32x16_bf16 v[112:127], v[168:171], a[44:47], v[112:127]
	ds_read_b64_tr_b16 v[164:165], v3 offset:26624
	ds_read_b64_tr_b16 v[166:167], v3 offset:27136
	v_mul_f32 v183, v183, v181
	v_cvt_pk_bf16_f32 v197, v182, v183
	v_mul_f32 v184, v28, v28
	v_mul_f32 v185, v29, v29
	v_mfma_f32_32x32x16_bf16 v[128:143], v[172:175], a[44:47], v[128:143]
	ds_read_b64_tr_b16 v[168:169], v3 offset:8448
	ds_read_b64_tr_b16 v[170:171], v3 offset:8960
	v_fma_f32 v184, v184, v11, v10
	v_fma_f32 v185, v185, v11, v10
	v_mul_f32 v184, v184, v28
	v_mul_f32 v185, v185, v29
	s_waitcnt lgkmcnt(6)
	v_mfma_f32_32x32x16_bf16 v[80:95], v[144:147], a[48:51], v[80:95]
	ds_read_b64_tr_b16 v[172:173], v3 offset:26880
	ds_read_b64_tr_b16 v[174:175], v3 offset:27392
	v_exp_f32 v184, v184
	v_mfma_f32_32x32x16_bf16 v[96:111], v[148:151], a[48:51], v[96:111]
	ds_read_b64_tr_b16 v[144:145], v3 offset:10240
	ds_read_b64_tr_b16 v[146:147], v3 offset:10752
	v_exp_f32 v185, v185
	v_mul_f32 v186, v28, v44
	v_mul_f32 v187, v29, v45
	v_fma_f32 v184, v184, v13, v13
	v_mfma_f32_32x32x16_bf16 v[112:127], v[152:155], a[48:51], v[112:127]
	ds_read_b64_tr_b16 v[148:149], v3 offset:28672
	ds_read_b64_tr_b16 v[150:151], v3 offset:29184
	v_fma_f32 v185, v185, v13, v13
	v_rcp_f32 v184, v184
	v_mfma_f32_32x32x16_bf16 v[128:143], v[156:159], a[48:51], v[128:143]
	ds_read_b64_tr_b16 v[152:153], v3 offset:10496
	ds_read_b64_tr_b16 v[154:155], v3 offset:11008
	v_rcp_f32 v185, v185
	v_mul_f32 v186, v186, v184
	v_mul_f32 v187, v187, v185
	v_cvt_pk_bf16_f32 v198, v186, v187
	s_waitcnt lgkmcnt(6)
	v_mfma_f32_32x32x16_bf16 v[80:95], v[160:163], a[52:55], v[80:95]
	ds_read_b64_tr_b16 v[156:157], v3 offset:28928
	ds_read_b64_tr_b16 v[158:159], v3 offset:29440
	v_mul_f32 v188, v30, v30
	v_mul_f32 v189, v31, v31
	v_fma_f32 v188, v188, v11, v10
	v_mfma_f32_32x32x16_bf16 v[96:111], v[164:167], a[52:55], v[96:111]
	ds_read_b64_tr_b16 v[160:161], v3 offset:12288
	ds_read_b64_tr_b16 v[162:163], v3 offset:12800
	v_fma_f32 v189, v189, v11, v10
	v_mul_f32 v188, v188, v30
	v_mul_f32 v189, v189, v31
	v_mfma_f32_32x32x16_bf16 v[112:127], v[168:171], a[52:55], v[112:127]
	ds_read_b64_tr_b16 v[164:165], v3 offset:30720
	ds_read_b64_tr_b16 v[166:167], v3 offset:31232
	s_waitcnt vmcnt(10)
	s_barrier
	v_exp_f32 v188, v188
	v_mfma_f32_32x32x16_bf16 v[128:143], v[172:175], a[52:55], v[128:143]
	ds_read_b64_tr_b16 v[168:169], v3 offset:12544
	ds_read_b64_tr_b16 v[170:171], v3 offset:13056
	v_add_u32 v6, 0xffc34080, v6
	s_add_u32 m0, s37, 0
	v_exp_f32 v189, v189
	v_mul_f32 v190, v30, v46
	s_waitcnt lgkmcnt(6)
	v_mfma_f32_32x32x16_bf16 v[80:95], v[144:147], a[56:59], v[80:95]
	ds_read_b64_tr_b16 v[172:173], v3 offset:30976
	ds_read_b64_tr_b16 v[174:175], v3 offset:31488
	v_mul_f32 v191, v31, v47
	v_fma_f32 v188, v188, v13, v13
	v_fma_f32 v189, v189, v13, v13
	v_mfma_f32_32x32x16_bf16 v[96:111], v[148:151], a[56:59], v[96:111]
	ds_read_b64_tr_b16 v[144:145], v3 offset:14336
	ds_read_b64_tr_b16 v[146:147], v3 offset:14848
	buffer_load_dwordx4 v6, s[12:15], s40 offen lds
	s_add_u32 m0, s37, 1024
	v_mfma_f32_32x32x16_bf16 v[112:127], v[152:155], a[56:59], v[112:127]
	ds_read_b64_tr_b16 v[148:149], v3 offset:32768
	ds_read_b64_tr_b16 v[150:151], v3 offset:33280
	v_rcp_f32 v188, v188
	v_rcp_f32 v189, v189
	v_mul_f32 v190, v190, v188
	v_mfma_f32_32x32x16_bf16 v[128:143], v[156:159], a[56:59], v[128:143]
	ds_read_b64_tr_b16 v[152:153], v3 offset:14592
	ds_read_b64_tr_b16 v[154:155], v3 offset:15104
	buffer_load_dwordx4 v6, s[12:15], s41 offen lds
	s_add_u32 m0, s37, 2048
	v_mul_f32 v191, v191, v189
	s_waitcnt lgkmcnt(6)
	v_mfma_f32_32x32x16_bf16 v[80:95], v[160:163], a[60:63], v[80:95]
	ds_read_b64_tr_b16 v[156:157], v3 offset:33024
	ds_read_b64_tr_b16 v[158:159], v3 offset:33536
	v_cvt_pk_bf16_f32 v199, v190, v191
	s_add_u32 s65, s63, 0
	v_mfma_f32_32x32x16_bf16 v[96:111], v[164:167], a[60:63], v[96:111]
	ds_read_b64_tr_b16 v[160:161], v3 offset:16384
	ds_read_b64_tr_b16 v[162:163], v3 offset:16896
	buffer_load_dwordx4 v6, s[12:15], s42 offen lds
	s_add_u32 m0, s37, 3072
	buffer_store_dwordx4 v[196:199], v8, s[8:11], s65 offen offset:512 sc1
	v_mfma_f32_32x32x16_bf16 v[112:127], v[168:171], a[60:63], v[112:127]
	ds_read_b64_tr_b16 v[164:165], v3 offset:34816
	ds_read_b64_tr_b16 v[166:167], v3 offset:35328
	v_mul_f32 v176, v48, v48
	v_mul_f32 v177, v49, v49
	v_fma_f32 v176, v176, v11, v10
	v_fma_f32 v177, v177, v11, v10
	v_mfma_f32_32x32x16_bf16 v[128:143], v[172:175], a[60:63], v[128:143]
	ds_read_b64_tr_b16 v[168:169], v3 offset:16640
	ds_read_b64_tr_b16 v[170:171], v3 offset:17152
	buffer_load_dwordx4 v6, s[12:15], s43 offen lds
	s_add_u32 m0, s37, 4096
	v_mul_f32 v176, v176, v48
	s_waitcnt lgkmcnt(6)
	v_mfma_f32_32x32x16_bf16 v[80:95], v[144:147], a[64:67], v[80:95]
	ds_read_b64_tr_b16 v[172:173], v3 offset:35072
	ds_read_b64_tr_b16 v[174:175], v3 offset:35584
	v_mul_f32 v177, v177, v49
	v_exp_f32 v176, v176
	v_mfma_f32_32x32x16_bf16 v[96:111], v[148:151], a[64:67], v[96:111]
	ds_read_b64_tr_b16 v[144:145], v4 offset:0
	ds_read_b64_tr_b16 v[146:147], v4 offset:512
	buffer_load_dwordx4 v6, s[12:15], s44 offen lds
	s_add_u32 m0, s37, 5120
	v_mfma_f32_32x32x16_bf16 v[112:127], v[152:155], a[64:67], v[112:127]
	ds_read_b64_tr_b16 v[148:149], v4 offset:18432
	ds_read_b64_tr_b16 v[150:151], v4 offset:18944
	v_exp_f32 v177, v177
	v_mul_f32 v178, v48, v64
	v_mul_f32 v179, v49, v65
	v_fma_f32 v176, v176, v13, v13
	v_mfma_f32_32x32x16_bf16 v[128:143], v[156:159], a[64:67], v[128:143]
	ds_read_b64_tr_b16 v[152:153], v4 offset:256
	ds_read_b64_tr_b16 v[154:155], v4 offset:768
	buffer_load_dwordx4 v6, s[12:15], s45 offen lds
	s_add_u32 m0, s37, 6144
	v_fma_f32 v177, v177, v13, v13
	s_waitcnt lgkmcnt(6)
	v_mfma_f32_32x32x16_bf16 v[80:95], v[160:163], a[68:71], v[80:95]
	ds_read_b64_tr_b16 v[156:157], v4 offset:18688
	ds_read_b64_tr_b16 v[158:159], v4 offset:19200
	v_rcp_f32 v176, v176
	v_mfma_f32_32x32x16_bf16 v[96:111], v[164:167], a[68:71], v[96:111]
	ds_read_b64_tr_b16 v[160:161], v4 offset:2048
	ds_read_b64_tr_b16 v[162:163], v4 offset:2560
	buffer_load_dwordx4 v6, s[12:15], s46 offen lds
	s_add_u32 m0, s37, 7168
	v_rcp_f32 v177, v177
	v_mfma_f32_32x32x16_bf16 v[112:127], v[168:171], a[68:71], v[112:127]
	ds_read_b64_tr_b16 v[164:165], v4 offset:20480
	ds_read_b64_tr_b16 v[166:167], v4 offset:20992
	v_mul_f32 v178, v178, v176
	v_mul_f32 v179, v179, v177
	v_cvt_pk_bf16_f32 v200, v178, v179
	v_mul_f32 v180, v50, v50
	v_mfma_f32_32x32x16_bf16 v[128:143], v[172:175], a[68:71], v[128:143]
	ds_read_b64_tr_b16 v[168:169], v4 offset:2304
	ds_read_b64_tr_b16 v[170:171], v4 offset:2816
	buffer_load_dwordx4 v6, s[12:15], s47 offen lds
	s_add_u32 m0, s37, 8192
	v_mul_f32 v181, v51, v51
	s_waitcnt lgkmcnt(6)
	v_mfma_f32_32x32x16_bf16 v[80:95], v[144:147], a[72:75], v[80:95]
	ds_read_b64_tr_b16 v[172:173], v4 offset:20736
	ds_read_b64_tr_b16 v[174:175], v4 offset:21248
	v_fma_f32 v180, v180, v11, v10
	v_fma_f32 v181, v181, v11, v10
	v_mul_f32 v180, v180, v50
	v_mfma_f32_32x32x16_bf16 v[96:111], v[148:151], a[72:75], v[96:111]
	ds_read_b64_tr_b16 v[144:145], v4 offset:4096
	ds_read_b64_tr_b16 v[146:147], v4 offset:4608
	buffer_load_dwordx4 v6, s[12:15], s48 offen lds
	v_mul_f32 v181, v181, v51
	v_mfma_f32_32x32x16_bf16 v[112:127], v[152:155], a[72:75], v[112:127]
	ds_read_b64_tr_b16 v[148:149], v4 offset:22528
	ds_read_b64_tr_b16 v[150:151], v4 offset:23040
	v_exp_f32 v180, v180
	v_exp_f32 v181, v181
	v_mul_f32 v182, v50, v66
	v_mfma_f32_32x32x16_bf16 v[128:143], v[156:159], a[72:75], v[128:143]
	ds_read_b64_tr_b16 v[152:153], v4 offset:4352
	ds_read_b64_tr_b16 v[154:155], v4 offset:4864
	v_mul_f32 v183, v51, v67
	v_fma_f32 v180, v180, v13, v13
	v_fma_f32 v181, v181, v13, v13
	s_waitcnt lgkmcnt(6)
	v_mfma_f32_32x32x16_bf16 v[80:95], v[160:163], a[76:79], v[80:95]
	ds_read_b64_tr_b16 v[156:157], v4 offset:22784
	ds_read_b64_tr_b16 v[158:159], v4 offset:23296
	v_rcp_f32 v180, v180
	v_rcp_f32 v181, v181
	v_mfma_f32_32x32x16_bf16 v[96:111], v[164:167], a[76:79], v[96:111]
	ds_read_b64_tr_b16 v[160:161], v4 offset:6144
	ds_read_b64_tr_b16 v[162:163], v4 offset:6656
	v_mul_f32 v182, v182, v180
	v_mul_f32 v183, v183, v181
	v_cvt_pk_bf16_f32 v201, v182, v183
	v_mul_f32 v184, v52, v52
	v_mfma_f32_32x32x16_bf16 v[112:127], v[168:171], a[76:79], v[112:127]
	ds_read_b64_tr_b16 v[164:165], v4 offset:24576
	ds_read_b64_tr_b16 v[166:167], v4 offset:25088
	v_mul_f32 v185, v53, v53
	v_fma_f32 v184, v184, v11, v10
	v_fma_f32 v185, v185, v11, v10
	v_mul_f32 v184, v184, v52
	v_mfma_f32_32x32x16_bf16 v[128:143], v[172:175], a[76:79], v[128:143]
	ds_read_b64_tr_b16 v[168:169], v4 offset:6400
	ds_read_b64_tr_b16 v[170:171], v4 offset:6912
	v_mul_f32 v185, v185, v53
	v_exp_f32 v184, v184
	s_waitcnt lgkmcnt(6)
	v_mfma_f32_32x32x16_bf16 v[80:95], v[144:147], a[80:83], v[80:95]
	ds_read_b64_tr_b16 v[172:173], v4 offset:24832
	ds_read_b64_tr_b16 v[174:175], v4 offset:25344
	v_exp_f32 v185, v185
	v_mul_f32 v186, v52, v68
	v_mul_f32 v187, v53, v69
	v_mfma_f32_32x32x16_bf16 v[96:111], v[148:151], a[80:83], v[96:111]
	ds_read_b64_tr_b16 v[144:145], v4 offset:8192
	ds_read_b64_tr_b16 v[146:147], v4 offset:8704
	v_fma_f32 v184, v184, v13, v13
	v_fma_f32 v185, v185, v13, v13
	v_rcp_f32 v184, v184
	v_mfma_f32_32x32x16_bf16 v[112:127], v[152:155], a[80:83], v[112:127]
	ds_read_b64_tr_b16 v[148:149], v4 offset:26624
	ds_read_b64_tr_b16 v[150:151], v4 offset:27136
	v_rcp_f32 v185, v185
	v_mul_f32 v186, v186, v184
	v_mul_f32 v187, v187, v185
	v_mfma_f32_32x32x16_bf16 v[128:143], v[156:159], a[80:83], v[128:143]
	ds_read_b64_tr_b16 v[152:153], v4 offset:8448
	ds_read_b64_tr_b16 v[154:155], v4 offset:8960
	v_cvt_pk_bf16_f32 v202, v186, v187
	v_mul_f32 v188, v54, v54
	v_mul_f32 v189, v55, v55
	v_fma_f32 v188, v188, v11, v10
	s_waitcnt lgkmcnt(6)
	v_mfma_f32_32x32x16_bf16 v[80:95], v[160:163], a[84:87], v[80:95]
	ds_read_b64_tr_b16 v[156:157], v4 offset:26880
	ds_read_b64_tr_b16 v[158:159], v4 offset:27392
	v_fma_f32 v189, v189, v11, v10
	v_mul_f32 v188, v188, v54
	v_mul_f32 v189, v189, v55
	v_mfma_f32_32x32x16_bf16 v[96:111], v[164:167], a[84:87], v[96:111]
	ds_read_b64_tr_b16 v[160:161], v4 offset:10240
	ds_read_b64_tr_b16 v[162:163], v4 offset:10752
	v_exp_f32 v188, v188
	v_exp_f32 v189, v189
	v_mfma_f32_32x32x16_bf16 v[112:127], v[168:171], a[84:87], v[112:127]
	ds_read_b64_tr_b16 v[164:165], v4 offset:28672
	ds_read_b64_tr_b16 v[166:167], v4 offset:29184
	v_mul_f32 v190, v54, v70
	v_mul_f32 v191, v55, v71
	v_fma_f32 v188, v188, v13, v13
	v_fma_f32 v189, v189, v13, v13
	v_mfma_f32_32x32x16_bf16 v[128:143], v[172:175], a[84:87], v[128:143]
	ds_read_b64_tr_b16 v[168:169], v4 offset:10496
	ds_read_b64_tr_b16 v[170:171], v4 offset:11008
	v_rcp_f32 v188, v188
	v_rcp_f32 v189, v189
	s_waitcnt lgkmcnt(6)
	v_mfma_f32_32x32x16_bf16 v[80:95], v[144:147], a[88:91], v[80:95]
	ds_read_b64_tr_b16 v[172:173], v4 offset:28928
	ds_read_b64_tr_b16 v[174:175], v4 offset:29440
	v_mul_f32 v190, v190, v188
	v_mul_f32 v191, v191, v189
	v_cvt_pk_bf16_f32 v203, v190, v191
	v_mfma_f32_32x32x16_bf16 v[96:111], v[148:151], a[88:91], v[96:111]
	ds_read_b64_tr_b16 v[144:145], v4 offset:12288
	ds_read_b64_tr_b16 v[146:147], v4 offset:12800
	s_add_u32 s65, s63, 1024
	buffer_store_dwordx4 v[200:203], v8, s[8:11], s65 offen offset:0 sc1
	v_mul_f32 v176, v56, v56
	v_mfma_f32_32x32x16_bf16 v[112:127], v[152:155], a[88:91], v[112:127]
	ds_read_b64_tr_b16 v[148:149], v4 offset:30720
	ds_read_b64_tr_b16 v[150:151], v4 offset:31232
	s_waitcnt vmcnt(11)
	s_barrier
	v_mul_f32 v177, v57, v57
	v_fma_f32 v176, v176, v11, v10
	v_mfma_f32_32x32x16_bf16 v[128:143], v[156:159], a[88:91], v[128:143]
	ds_read_b64_tr_b16 v[152:153], v4 offset:12544
	ds_read_b64_tr_b16 v[154:155], v4 offset:13056
	v_add_u32 v6, 0x144000, v6
	s_add_u32 m0, s37, 36864
	v_fma_f32 v177, v177, v11, v10
	v_mul_f32 v176, v176, v56
	s_waitcnt lgkmcnt(6)
	v_mfma_f32_32x32x16_bf16 v[80:95], v[160:163], a[92:95], v[80:95]
	ds_read_b64_tr_b16 v[156:157], v4 offset:30976
	ds_read_b64_tr_b16 v[158:159], v4 offset:31488
	v_mul_f32 v177, v177, v57
	v_exp_f32 v176, v176
	v_mfma_f32_32x32x16_bf16 v[96:111], v[164:167], a[92:95], v[96:111]
	ds_read_b64_tr_b16 v[160:161], v4 offset:14336
	ds_read_b64_tr_b16 v[162:163], v4 offset:14848
	buffer_load_dwordx4 v6, s[12:15], s40 offen lds
	s_add_u32 m0, s37, 37888
	v_mfma_f32_32x32x16_bf16 v[112:127], v[168:171], a[92:95], v[112:127]
	ds_read_b64_tr_b16 v[164:165], v4 offset:32768
	ds_read_b64_tr_b16 v[166:167], v4 offset:33280
	v_exp_f32 v177, v177
	v_mul_f32 v178, v56, v72
	v_mul_f32 v179, v57, v73
	v_fma_f32 v176, v176, v13, v13
	v_mfma_f32_32x32x16_bf16 v[128:143], v[172:175], a[92:95], v[128:143]
	ds_read_b64_tr_b16 v[168:169], v4 offset:14592
	ds_read_b64_tr_b16 v[170:171], v4 offset:15104
	buffer_load_dwordx4 v6, s[12:15], s41 offen lds
	s_add_u32 m0, s37, 38912
	v_fma_f32 v177, v177, v13, v13
	s_waitcnt lgkmcnt(6)
	v_mfma_f32_32x32x16_bf16 v[80:95], v[144:147], a[96:99], v[80:95]
	ds_read_b64_tr_b16 v[172:173], v4 offset:33024
	ds_read_b64_tr_b16 v[174:175], v4 offset:33536
	v_rcp_f32 v176, v176
	v_mfma_f32_32x32x16_bf16 v[96:111], v[148:151], a[96:99], v[96:111]
	ds_read_b64_tr_b16 v[144:145], v4 offset:16384
	ds_read_b64_tr_b16 v[146:147], v4 offset:16896
	buffer_load_dwordx4 v6, s[12:15], s42 offen lds
	s_add_u32 m0, s37, 39936
	v_rcp_f32 v177, v177
	v_mfma_f32_32x32x16_bf16 v[112:127], v[152:155], a[96:99], v[112:127]
	ds_read_b64_tr_b16 v[148:149], v4 offset:34816
	ds_read_b64_tr_b16 v[150:151], v4 offset:35328
	v_mul_f32 v178, v178, v176
	v_mul_f32 v179, v179, v177
	v_cvt_pk_bf16_f32 v204, v178, v179
	v_mul_f32 v180, v58, v58
	v_mfma_f32_32x32x16_bf16 v[128:143], v[156:159], a[96:99], v[128:143]
	ds_read_b64_tr_b16 v[152:153], v4 offset:16640
	ds_read_b64_tr_b16 v[154:155], v4 offset:17152
	buffer_load_dwordx4 v6, s[12:15], s43 offen lds
	s_add_u32 m0, s37, 40960
	v_mul_f32 v181, v59, v59
	s_waitcnt lgkmcnt(6)
	v_mfma_f32_32x32x16_bf16 v[80:95], v[160:163], a[100:103], v[80:95]
	ds_read_b64_tr_b16 v[156:157], v4 offset:35072
	ds_read_b64_tr_b16 v[158:159], v4 offset:35584
	v_fma_f32 v180, v180, v11, v10
	v_fma_f32 v181, v181, v11, v10
	v_mul_f32 v180, v180, v58
	v_mfma_f32_32x32x16_bf16 v[96:111], v[164:167], a[100:103], v[96:111]
	ds_read_b64_tr_b16 v[160:161], v5 offset:0
	ds_read_b64_tr_b16 v[162:163], v5 offset:512
	buffer_load_dwordx4 v6, s[12:15], s44 offen lds
	s_add_u32 m0, s37, 41984
	v_mul_f32 v181, v181, v59
	v_mfma_f32_32x32x16_bf16 v[112:127], v[168:171], a[100:103], v[112:127]
	ds_read_b64_tr_b16 v[164:165], v5 offset:18432
	ds_read_b64_tr_b16 v[166:167], v5 offset:18944
	v_exp_f32 v180, v180
	v_exp_f32 v181, v181
	v_mfma_f32_32x32x16_bf16 v[128:143], v[172:175], a[100:103], v[128:143]
	ds_read_b64_tr_b16 v[168:169], v5 offset:256
	ds_read_b64_tr_b16 v[170:171], v5 offset:768
	buffer_load_dwordx4 v6, s[12:15], s45 offen lds
	s_add_u32 m0, s37, 43008
	v_mul_f32 v182, v58, v74
	s_waitcnt lgkmcnt(6)
	v_mfma_f32_32x32x16_bf16 v[80:95], v[144:147], a[104:107], v[80:95]
	ds_read_b64_tr_b16 v[172:173], v5 offset:18688
	ds_read_b64_tr_b16 v[174:175], v5 offset:19200
	v_mul_f32 v183, v59, v75
	v_fma_f32 v180, v180, v13, v13
	v_fma_f32 v181, v181, v13, v13
	v_mfma_f32_32x32x16_bf16 v[96:111], v[148:151], a[104:107], v[96:111]
	ds_read_b64_tr_b16 v[144:145], v5 offset:2048
	ds_read_b64_tr_b16 v[146:147], v5 offset:2560
	buffer_load_dwordx4 v6, s[12:15], s46 offen lds
	s_add_u32 m0, s37, 44032
	v_mfma_f32_32x32x16_bf16 v[112:127], v[152:155], a[104:107], v[112:127]
	ds_read_b64_tr_b16 v[148:149], v5 offset:20480
	ds_read_b64_tr_b16 v[150:151], v5 offset:20992
	v_rcp_f32 v180, v180
	v_rcp_f32 v181, v181
	v_mul_f32 v182, v182, v180
	v_mfma_f32_32x32x16_bf16 v[128:143], v[156:159], a[104:107], v[128:143]
	ds_read_b64_tr_b16 v[152:153], v5 offset:2304
	ds_read_b64_tr_b16 v[154:155], v5 offset:2816
	buffer_load_dwordx4 v6, s[12:15], s47 offen lds
	s_add_u32 m0, s37, 45056
	v_mul_f32 v183, v183, v181
	s_waitcnt lgkmcnt(6)
	v_mfma_f32_32x32x16_bf16 v[80:95], v[160:163], a[108:111], v[80:95]
	ds_read_b64_tr_b16 v[156:157], v5 offset:20736
	ds_read_b64_tr_b16 v[158:159], v5 offset:21248
	v_cvt_pk_bf16_f32 v205, v182, v183
	v_mul_f32 v184, v60, v60
	v_mul_f32 v185, v61, v61
	v_mfma_f32_32x32x16_bf16 v[96:111], v[164:167], a[108:111], v[96:111]
	ds_read_b64_tr_b16 v[160:161], v5 offset:4096
	ds_read_b64_tr_b16 v[162:163], v5 offset:4608
	buffer_load_dwordx4 v6, s[12:15], s48 offen lds
	v_fma_f32 v184, v184, v11, v10
	v_fma_f32 v185, v185, v11, v10
	v_mfma_f32_32x32x16_bf16 v[112:127], v[168:171], a[108:111], v[112:127]
	ds_read_b64_tr_b16 v[164:165], v5 offset:22528
	ds_read_b64_tr_b16 v[166:167], v5 offset:23040
	v_mul_f32 v184, v184, v60
	v_mul_f32 v185, v185, v61
	v_exp_f32 v184, v184
	v_mfma_f32_32x32x16_bf16 v[128:143], v[172:175], a[108:111], v[128:143]
	ds_read_b64_tr_b16 v[168:169], v5 offset:4352
	ds_read_b64_tr_b16 v[170:171], v5 offset:4864
	v_exp_f32 v185, v185
	v_mul_f32 v186, v60, v76
	v_mul_f32 v187, v61, v77
	s_waitcnt lgkmcnt(6)
	v_mfma_f32_32x32x16_bf16 v[80:95], v[144:147], a[112:115], v[80:95]
	ds_read_b64_tr_b16 v[172:173], v5 offset:22784
	ds_read_b64_tr_b16 v[174:175], v5 offset:23296
	v_fma_f32 v184, v184, v13, v13
	v_fma_f32 v185, v185, v13, v13
	v_mfma_f32_32x32x16_bf16 v[96:111], v[148:151], a[112:115], v[96:111]
	ds_read_b64_tr_b16 v[144:145], v5 offset:6144
	ds_read_b64_tr_b16 v[146:147], v5 offset:6656
	v_rcp_f32 v184, v184
	v_rcp_f32 v185, v185
	v_mul_f32 v186, v186, v184
	v_mfma_f32_32x32x16_bf16 v[112:127], v[152:155], a[112:115], v[112:127]
	ds_read_b64_tr_b16 v[148:149], v5 offset:24576
	ds_read_b64_tr_b16 v[150:151], v5 offset:25088
	v_mul_f32 v187, v187, v185
	v_cvt_pk_bf16_f32 v206, v186, v187
	v_mul_f32 v188, v62, v62
	v_mul_f32 v189, v63, v63
	v_mfma_f32_32x32x16_bf16 v[128:143], v[156:159], a[112:115], v[128:143]
	ds_read_b64_tr_b16 v[152:153], v5 offset:6400
	ds_read_b64_tr_b16 v[154:155], v5 offset:6912
	v_fma_f32 v188, v188, v11, v10
	v_fma_f32 v189, v189, v11, v10
	v_mul_f32 v188, v188, v62
	v_mul_f32 v189, v189, v63
	s_waitcnt lgkmcnt(6)
	v_mfma_f32_32x32x16_bf16 v[80:95], v[160:163], a[116:119], v[80:95]
	ds_read_b64_tr_b16 v[156:157], v5 offset:24832
	ds_read_b64_tr_b16 v[158:159], v5 offset:25344
	v_exp_f32 v188, v188
	v_mfma_f32_32x32x16_bf16 v[96:111], v[164:167], a[116:119], v[96:111]
	ds_read_b64_tr_b16 v[160:161], v5 offset:8192
	ds_read_b64_tr_b16 v[162:163], v5 offset:8704
	v_exp_f32 v189, v189
	v_mul_f32 v190, v62, v78
	v_mul_f32 v191, v63, v79
	v_fma_f32 v188, v188, v13, v13
	v_mfma_f32_32x32x16_bf16 v[112:127], v[168:171], a[116:119], v[112:127]
	ds_read_b64_tr_b16 v[164:165], v5 offset:26624
	ds_read_b64_tr_b16 v[166:167], v5 offset:27136
	v_fma_f32 v189, v189, v13, v13
	v_rcp_f32 v188, v188
	v_mfma_f32_32x32x16_bf16 v[128:143], v[172:175], a[116:119], v[128:143]
	ds_read_b64_tr_b16 v[168:169], v5 offset:8448
	ds_read_b64_tr_b16 v[170:171], v5 offset:8960
	v_rcp_f32 v189, v189
	v_mul_f32 v190, v190, v188
	v_mul_f32 v191, v191, v189
	v_cvt_pk_bf16_f32 v207, v190, v191
	s_waitcnt lgkmcnt(6)
	v_mfma_f32_32x32x16_bf16 v[80:95], v[144:147], a[120:123], v[80:95]
	ds_read_b64_tr_b16 v[172:173], v5 offset:26880
	ds_read_b64_tr_b16 v[174:175], v5 offset:27392
	s_add_u32 s65, s63, 1024
	buffer_store_dwordx4 v[204:207], v8, s[8:11], s65 offen offset:512 sc1
	v_mfma_f32_32x32x16_bf16 v[96:111], v[148:151], a[120:123], v[96:111]
	ds_read_b64_tr_b16 v[144:145], v5 offset:10240
	ds_read_b64_tr_b16 v[146:147], v5 offset:10752
	v_mfma_f32_32x32x16_bf16 v[112:127], v[152:155], a[120:123], v[112:127]
	ds_read_b64_tr_b16 v[148:149], v5 offset:28672
	ds_read_b64_tr_b16 v[150:151], v5 offset:29184
	v_mfma_f32_32x32x16_bf16 v[128:143], v[156:159], a[120:123], v[128:143]
	ds_read_b64_tr_b16 v[152:153], v5 offset:10496
	ds_read_b64_tr_b16 v[154:155], v5 offset:11008
	s_waitcnt lgkmcnt(6)
	v_mfma_f32_32x32x16_bf16 v[80:95], v[160:163], a[124:127], v[80:95]
	ds_read_b64_tr_b16 v[156:157], v5 offset:28928
	ds_read_b64_tr_b16 v[158:159], v5 offset:29440
	v_mfma_f32_32x32x16_bf16 v[96:111], v[164:167], a[124:127], v[96:111]
	ds_read_b64_tr_b16 v[160:161], v5 offset:12288
	ds_read_b64_tr_b16 v[162:163], v5 offset:12800
	v_mfma_f32_32x32x16_bf16 v[112:127], v[168:171], a[124:127], v[112:127]
	ds_read_b64_tr_b16 v[164:165], v5 offset:30720
	ds_read_b64_tr_b16 v[166:167], v5 offset:31232
	s_waitcnt vmcnt(11)
	s_barrier
	v_mfma_f32_32x32x16_bf16 v[128:143], v[172:175], a[124:127], v[128:143]
	ds_read_b64_tr_b16 v[168:169], v5 offset:12544
	ds_read_b64_tr_b16 v[170:171], v5 offset:13056
	v_add_u32 v6, 0x144000, v6
	s_add_u32 m0, s37, 73728
	s_waitcnt lgkmcnt(6)
	v_mfma_f32_32x32x16_bf16 v[80:95], v[144:147], a[128:131], v[80:95]
	ds_read_b64_tr_b16 v[172:173], v5 offset:30976
	ds_read_b64_tr_b16 v[174:175], v5 offset:31488
	v_mfma_f32_32x32x16_bf16 v[96:111], v[148:151], a[128:131], v[96:111]
	ds_read_b64_tr_b16 v[144:145], v5 offset:14336
	ds_read_b64_tr_b16 v[146:147], v5 offset:14848
	buffer_load_dwordx4 v6, s[12:15], s40 offen lds
	s_add_u32 m0, s37, 74752
	v_mfma_f32_32x32x16_bf16 v[112:127], v[152:155], a[128:131], v[112:127]
	ds_read_b64_tr_b16 v[148:149], v5 offset:32768
	ds_read_b64_tr_b16 v[150:151], v5 offset:33280
	v_mfma_f32_32x32x16_bf16 v[128:143], v[156:159], a[128:131], v[128:143]
	ds_read_b64_tr_b16 v[152:153], v5 offset:14592
	ds_read_b64_tr_b16 v[154:155], v5 offset:15104
	buffer_load_dwordx4 v6, s[12:15], s41 offen lds
	s_add_u32 m0, s37, 75776
	s_waitcnt lgkmcnt(6)
	v_mfma_f32_32x32x16_bf16 v[80:95], v[160:163], a[132:135], v[80:95]
	ds_read_b64_tr_b16 v[156:157], v5 offset:33024
	ds_read_b64_tr_b16 v[158:159], v5 offset:33536
	v_mfma_f32_32x32x16_bf16 v[96:111], v[164:167], a[132:135], v[96:111]
	ds_read_b64_tr_b16 v[160:161], v5 offset:16384
	ds_read_b64_tr_b16 v[162:163], v5 offset:16896
	buffer_load_dwordx4 v6, s[12:15], s42 offen lds
	s_add_u32 m0, s37, 76800
	v_mfma_f32_32x32x16_bf16 v[112:127], v[168:171], a[132:135], v[112:127]
	ds_read_b64_tr_b16 v[164:165], v5 offset:34816
	ds_read_b64_tr_b16 v[166:167], v5 offset:35328
	v_mfma_f32_32x32x16_bf16 v[128:143], v[172:175], a[132:135], v[128:143]
	ds_read_b64_tr_b16 v[168:169], v5 offset:16640
	ds_read_b64_tr_b16 v[170:171], v5 offset:17152
	buffer_load_dwordx4 v6, s[12:15], s43 offen lds
	s_add_u32 m0, s37, 77824
	s_waitcnt lgkmcnt(6)
	v_mfma_f32_32x32x16_bf16 v[80:95], v[144:147], a[136:139], v[80:95]
	ds_read_b64_tr_b16 v[172:173], v5 offset:35072
	ds_read_b64_tr_b16 v[174:175], v5 offset:35584
	v_mfma_f32_32x32x16_bf16 v[96:111], v[148:151], a[136:139], v[96:111]
	ds_read_b64_tr_b16 v[144:145], v2 offset:0
	ds_read_b64_tr_b16 v[146:147], v2 offset:512
	buffer_load_dwordx4 v6, s[12:15], s44 offen lds
	s_add_u32 m0, s37, 78848
	v_mfma_f32_32x32x16_bf16 v[112:127], v[152:155], a[136:139], v[112:127]
	ds_read_b64_tr_b16 v[148:149], v2 offset:18432
	ds_read_b64_tr_b16 v[150:151], v2 offset:18944
	v_mfma_f32_32x32x16_bf16 v[128:143], v[156:159], a[136:139], v[128:143]
	ds_read_b64_tr_b16 v[152:153], v2 offset:256
	ds_read_b64_tr_b16 v[154:155], v2 offset:768
	buffer_load_dwordx4 v6, s[12:15], s45 offen lds
	s_add_u32 m0, s37, 79872
	s_waitcnt lgkmcnt(6)
	v_mfma_f32_32x32x16_bf16 v[80:95], v[160:163], a[140:143], v[80:95]
	ds_read_b64_tr_b16 v[156:157], v2 offset:18688
	ds_read_b64_tr_b16 v[158:159], v2 offset:19200
	v_mfma_f32_32x32x16_bf16 v[96:111], v[164:167], a[140:143], v[96:111]
	ds_read_b64_tr_b16 v[160:161], v2 offset:2048
	ds_read_b64_tr_b16 v[162:163], v2 offset:2560
	buffer_load_dwordx4 v6, s[12:15], s46 offen lds
	s_add_u32 m0, s37, 80896
	v_mfma_f32_32x32x16_bf16 v[112:127], v[168:171], a[140:143], v[112:127]
	ds_read_b64_tr_b16 v[164:165], v2 offset:20480
	ds_read_b64_tr_b16 v[166:167], v2 offset:20992
	v_mfma_f32_32x32x16_bf16 v[128:143], v[172:175], a[140:143], v[128:143]
	ds_read_b64_tr_b16 v[168:169], v2 offset:2304
	ds_read_b64_tr_b16 v[170:171], v2 offset:2816
	buffer_load_dwordx4 v6, s[12:15], s47 offen lds
	s_add_u32 m0, s37, 81920
	s_waitcnt lgkmcnt(6)
	v_mfma_f32_32x32x16_bf16 v[16:31], v[144:147], a[0:3], 0
	ds_read_b64_tr_b16 v[172:173], v2 offset:20736
	ds_read_b64_tr_b16 v[174:175], v2 offset:21248
	v_mfma_f32_32x32x16_bf16 v[32:47], v[148:151], a[0:3], 0
	ds_read_b64_tr_b16 v[144:145], v2 offset:4096
	ds_read_b64_tr_b16 v[146:147], v2 offset:4608
	buffer_load_dwordx4 v6, s[12:15], s48 offen lds
	v_mfma_f32_32x32x16_bf16 v[48:63], v[152:155], a[0:3], 0
	ds_read_b64_tr_b16 v[148:149], v2 offset:22528
	ds_read_b64_tr_b16 v[150:151], v2 offset:23040
	v_mfma_f32_32x32x16_bf16 v[64:79], v[156:159], a[0:3], 0
	ds_read_b64_tr_b16 v[152:153], v2 offset:4352
	ds_read_b64_tr_b16 v[154:155], v2 offset:4864
	s_waitcnt lgkmcnt(6)
	v_mfma_f32_32x32x16_bf16 v[16:31], v[160:163], a[4:7], v[16:31]
	ds_read_b64_tr_b16 v[156:157], v2 offset:22784
	ds_read_b64_tr_b16 v[158:159], v2 offset:23296
	v_mul_f32 v176, v80, v80
	v_mul_f32 v177, v81, v81
	v_fma_f32 v176, v176, v11, v10
	v_mfma_f32_32x32x16_bf16 v[32:47], v[164:167], a[4:7], v[32:47]
	ds_read_b64_tr_b16 v[160:161], v2 offset:6144
	ds_read_b64_tr_b16 v[162:163], v2 offset:6656
	v_fma_f32 v177, v177, v11, v10
	v_mul_f32 v176, v176, v80
	v_mul_f32 v177, v177, v81
	v_mfma_f32_32x32x16_bf16 v[48:63], v[168:171], a[4:7], v[48:63]
	ds_read_b64_tr_b16 v[164:165], v2 offset:24576
	ds_read_b64_tr_b16 v[166:167], v2 offset:25088
	v_exp_f32 v176, v176
	v_exp_f32 v177, v177
	v_mul_f32 v178, v80, v96
	v_mfma_f32_32x32x16_bf16 v[64:79], v[172:175], a[4:7], v[64:79]
	ds_read_b64_tr_b16 v[168:169], v2 offset:6400
	ds_read_b64_tr_b16 v[170:171], v2 offset:6912
	v_mul_f32 v179, v81, v97
	v_fma_f32 v176, v176, v13, v13
	v_fma_f32 v177, v177, v13, v13
	s_waitcnt lgkmcnt(6)
	v_mfma_f32_32x32x16_bf16 v[16:31], v[144:147], a[8:11], v[16:31]
	ds_read_b64_tr_b16 v[172:173], v2 offset:24832
	ds_read_b64_tr_b16 v[174:175], v2 offset:25344
	v_rcp_f32 v176, v176
	v_rcp_f32 v177, v177
	v_mfma_f32_32x32x16_bf16 v[32:47], v[148:151], a[8:11], v[32:47]
	ds_read_b64_tr_b16 v[144:145], v2 offset:8192
	ds_read_b64_tr_b16 v[146:147], v2 offset:8704
	v_mul_f32 v178, v178, v176
	v_mul_f32 v179, v179, v177
	v_cvt_pk_bf16_f32 v192, v178, v179
	v_mul_f32 v180, v82, v82
	v_mfma_f32_32x32x16_bf16 v[48:63], v[152:155], a[8:11], v[48:63]
	ds_read_b64_tr_b16 v[148:149], v2 offset:26624
	ds_read_b64_tr_b16 v[150:151], v2 offset:27136
	v_mul_f32 v181, v83, v83
	v_fma_f32 v180, v180, v11, v10
	v_fma_f32 v181, v181, v11, v10
	v_mul_f32 v180, v180, v82
	v_mfma_f32_32x32x16_bf16 v[64:79], v[156:159], a[8:11], v[64:79]
	ds_read_b64_tr_b16 v[152:153], v2 offset:8448
	ds_read_b64_tr_b16 v[154:155], v2 offset:8960
	v_mul_f32 v181, v181, v83
	v_exp_f32 v180, v180
	s_waitcnt lgkmcnt(6)
	v_mfma_f32_32x32x16_bf16 v[16:31], v[160:163], a[12:15], v[16:31]
	ds_read_b64_tr_b16 v[156:157], v2 offset:26880
	ds_read_b64_tr_b16 v[158:159], v2 offset:27392
	v_exp_f32 v181, v181
	v_mul_f32 v182, v82, v98
	v_mul_f32 v183, v83, v99
	v_mfma_f32_32x32x16_bf16 v[32:47], v[164:167], a[12:15], v[32:47]
	ds_read_b64_tr_b16 v[160:161], v2 offset:10240
	ds_read_b64_tr_b16 v[162:163], v2 offset:10752
	v_fma_f32 v180, v180, v13, v13
	v_fma_f32 v181, v181, v13, v13
	v_rcp_f32 v180, v180
	v_mfma_f32_32x32x16_bf16 v[48:63], v[168:171], a[12:15], v[48:63]
	ds_read_b64_tr_b16 v[164:165], v2 offset:28672
	ds_read_b64_tr_b16 v[166:167], v2 offset:29184
	v_rcp_f32 v181, v181
	v_mul_f32 v182, v182, v180
	v_mul_f32 v183, v183, v181
	v_mfma_f32_32x32x16_bf16 v[64:79], v[172:175], a[12:15], v[64:79]
	ds_read_b64_tr_b16 v[168:169], v2 offset:10496
	ds_read_b64_tr_b16 v[170:171], v2 offset:11008
	v_cvt_pk_bf16_f32 v193, v182, v183
	v_mul_f32 v184, v84, v84
	v_mul_f32 v185, v85, v85
	v_fma_f32 v184, v184, v11, v10
	s_waitcnt lgkmcnt(6)
	v_mfma_f32_32x32x16_bf16 v[16:31], v[144:147], a[16:19], v[16:31]
	ds_read_b64_tr_b16 v[172:173], v2 offset:28928
	ds_read_b64_tr_b16 v[174:175], v2 offset:29440
	v_fma_f32 v185, v185, v11, v10
	v_mul_f32 v184, v184, v84
	v_mul_f32 v185, v185, v85
	v_mfma_f32_32x32x16_bf16 v[32:47], v[148:151], a[16:19], v[32:47]
	ds_read_b64_tr_b16 v[144:145], v2 offset:12288
	ds_read_b64_tr_b16 v[146:147], v2 offset:12800
	v_exp_f32 v184, v184
	v_exp_f32 v185, v185
	v_mfma_f32_32x32x16_bf16 v[48:63], v[152:155], a[16:19], v[48:63]
	ds_read_b64_tr_b16 v[148:149], v2 offset:30720
	ds_read_b64_tr_b16 v[150:151], v2 offset:31232
	s_waitcnt vmcnt(10)
	s_barrier
	v_mul_f32 v186, v84, v100
	v_mul_f32 v187, v85, v101
	v_mfma_f32_32x32x16_bf16 v[64:79], v[156:159], a[16:19], v[64:79]
	ds_read_b64_tr_b16 v[152:153], v2 offset:12544
	ds_read_b64_tr_b16 v[154:155], v2 offset:13056
	v_add_u32 v6, 0x144000, v6
	s_add_u32 m0, s37, 110592
	v_fma_f32 v184, v184, v13, v13
	v_fma_f32 v185, v185, v13, v13
	s_waitcnt lgkmcnt(6)
	v_mfma_f32_32x32x16_bf16 v[16:31], v[160:163], a[20:23], v[16:31]
	ds_read_b64_tr_b16 v[156:157], v2 offset:30976
	ds_read_b64_tr_b16 v[158:159], v2 offset:31488
	v_rcp_f32 v184, v184
	v_mfma_f32_32x32x16_bf16 v[32:47], v[164:167], a[20:23], v[32:47]
	ds_read_b64_tr_b16 v[160:161], v2 offset:14336
	ds_read_b64_tr_b16 v[162:163], v2 offset:14848
	buffer_load_dwordx4 v6, s[12:15], s40 offen lds
	s_add_u32 m0, s37, 111616
	v_rcp_f32 v185, v185
	v_mfma_f32_32x32x16_bf16 v[48:63], v[168:171], a[20:23], v[48:63]
	ds_read_b64_tr_b16 v[164:165], v2 offset:32768
	ds_read_b64_tr_b16 v[166:167], v2 offset:33280
	v_mul_f32 v186, v186, v184
	v_mul_f32 v187, v187, v185
	v_cvt_pk_bf16_f32 v194, v186, v187
	v_mul_f32 v188, v86, v86
	v_mfma_f32_32x32x16_bf16 v[64:79], v[172:175], a[20:23], v[64:79]
	ds_read_b64_tr_b16 v[168:169], v2 offset:14592
	ds_read_b64_tr_b16 v[170:171], v2 offset:15104
	buffer_load_dwordx4 v6, s[12:15], s41 offen lds
	s_add_u32 m0, s37, 112640
	v_mul_f32 v189, v87, v87
	s_waitcnt lgkmcnt(6)
	v_mfma_f32_32x32x16_bf16 v[16:31], v[144:147], a[24:27], v[16:31]
	ds_read_b64_tr_b16 v[172:173], v2 offset:33024
	ds_read_b64_tr_b16 v[174:175], v2 offset:33536
	v_fma_f32 v188, v188, v11, v10
	v_fma_f32 v189, v189, v11, v10
	v_mul_f32 v188, v188, v86
	v_mfma_f32_32x32x16_bf16 v[32:47], v[148:151], a[24:27], v[32:47]
	ds_read_b64_tr_b16 v[144:145], v2 offset:16384
	ds_read_b64_tr_b16 v[146:147], v2 offset:16896
	buffer_load_dwordx4 v6, s[12:15], s42 offen lds
	s_add_u32 m0, s37, 113664
	v_mul_f32 v189, v189, v87
	v_mfma_f32_32x32x16_bf16 v[48:63], v[152:155], a[24:27], v[48:63]
	ds_read_b64_tr_b16 v[148:149], v2 offset:34816
	ds_read_b64_tr_b16 v[150:151], v2 offset:35328
	v_exp_f32 v188, v188
	v_exp_f32 v189, v189
	v_mfma_f32_32x32x16_bf16 v[64:79], v[156:159], a[24:27], v[64:79]
	ds_read_b64_tr_b16 v[152:153], v2 offset:16640
	ds_read_b64_tr_b16 v[154:155], v2 offset:17152
	buffer_load_dwordx4 v6, s[12:15], s43 offen lds
	s_add_u32 m0, s37, 114688
	v_mul_f32 v190, v86, v102
	s_waitcnt lgkmcnt(6)
	v_mfma_f32_32x32x16_bf16 v[16:31], v[160:163], a[28:31], v[16:31]
	ds_read_b64_tr_b16 v[156:157], v2 offset:35072
	ds_read_b64_tr_b16 v[158:159], v2 offset:35584
	v_mul_f32 v191, v87, v103
	v_fma_f32 v188, v188, v13, v13
	v_fma_f32 v189, v189, v13, v13
	v_mfma_f32_32x32x16_bf16 v[32:47], v[164:167], a[28:31], v[32:47]
	ds_read_b64_tr_b16 v[160:161], v3 offset:0
	ds_read_b64_tr_b16 v[162:163], v3 offset:512
	buffer_load_dwordx4 v6, s[12:15], s44 offen lds
	s_add_u32 m0, s37, 115712
	v_mfma_f32_32x32x16_bf16 v[48:63], v[168:171], a[28:31], v[48:63]
	ds_read_b64_tr_b16 v[164:165], v3 offset:18432
	ds_read_b64_tr_b16 v[166:167], v3 offset:18944
	v_rcp_f32 v188, v188
	v_rcp_f32 v189, v189
	v_mul_f32 v190, v190, v188
	v_mfma_f32_32x32x16_bf16 v[64:79], v[172:175], a[28:31], v[64:79]
	ds_read_b64_tr_b16 v[168:169], v3 offset:256
	ds_read_b64_tr_b16 v[170:171], v3 offset:768
	buffer_load_dwordx4 v6, s[12:15], s45 offen lds
	s_add_u32 m0, s37, 116736
	v_mul_f32 v191, v191, v189
	s_waitcnt lgkmcnt(6)
	v_mfma_f32_32x32x16_bf16 v[16:31], v[144:147], a[32:35], v[16:31]
	ds_read_b64_tr_b16 v[172:173], v3 offset:18688
	ds_read_b64_tr_b16 v[174:175], v3 offset:19200
	v_cvt_pk_bf16_f32 v195, v190, v191
	s_add_u32 s65, s63, 2048
	v_mfma_f32_32x32x16_bf16 v[32:47], v[148:151], a[32:35], v[32:47]
	ds_read_b64_tr_b16 v[144:145], v3 offset:2048
	ds_read_b64_tr_b16 v[146:147], v3 offset:2560
	buffer_load_dwordx4 v6, s[12:15], s46 offen lds
	s_add_u32 m0, s37, 117760
	buffer_store_dwordx4 v[192:195], v8, s[8:11], s65 offen offset:0 sc1
	v_mfma_f32_32x32x16_bf16 v[48:63], v[152:155], a[32:35], v[48:63]
	ds_read_b64_tr_b16 v[148:149], v3 offset:20480
	ds_read_b64_tr_b16 v[150:151], v3 offset:20992
	v_mul_f32 v176, v88, v88
	v_mul_f32 v177, v89, v89
	v_fma_f32 v176, v176, v11, v10
	v_fma_f32 v177, v177, v11, v10
	v_mfma_f32_32x32x16_bf16 v[64:79], v[156:159], a[32:35], v[64:79]
	ds_read_b64_tr_b16 v[152:153], v3 offset:2304
	ds_read_b64_tr_b16 v[154:155], v3 offset:2816
	buffer_load_dwordx4 v6, s[12:15], s47 offen lds
	s_add_u32 m0, s37, 118784
	v_mul_f32 v176, v176, v88
	s_waitcnt lgkmcnt(6)
	v_mfma_f32_32x32x16_bf16 v[16:31], v[160:163], a[36:39], v[16:31]
	ds_read_b64_tr_b16 v[156:157], v3 offset:20736
	ds_read_b64_tr_b16 v[158:159], v3 offset:21248
	v_mul_f32 v177, v177, v89
	v_exp_f32 v176, v176
	v_mfma_f32_32x32x16_bf16 v[32:47], v[164:167], a[36:39], v[32:47]
	ds_read_b64_tr_b16 v[160:161], v3 offset:4096
	ds_read_b64_tr_b16 v[162:163], v3 offset:4608
	buffer_load_dwordx4 v6, s[12:15], s48 offen lds
	v_exp_f32 v177, v177
	v_mfma_f32_32x32x16_bf16 v[48:63], v[168:171], a[36:39], v[48:63]
	ds_read_b64_tr_b16 v[164:165], v3 offset:22528
	ds_read_b64_tr_b16 v[166:167], v3 offset:23040
	v_mul_f32 v178, v88, v104
	v_mul_f32 v179, v89, v105
	v_fma_f32 v176, v176, v13, v13
	v_fma_f32 v177, v177, v13, v13
	v_mfma_f32_32x32x16_bf16 v[64:79], v[172:175], a[36:39], v[64:79]
	ds_read_b64_tr_b16 v[168:169], v3 offset:4352
	ds_read_b64_tr_b16 v[170:171], v3 offset:4864
	v_rcp_f32 v176, v176
	v_rcp_f32 v177, v177
	s_waitcnt lgkmcnt(6)
	v_mfma_f32_32x32x16_bf16 v[16:31], v[144:147], a[40:43], v[16:31]
	ds_read_b64_tr_b16 v[172:173], v3 offset:22784
	ds_read_b64_tr_b16 v[174:175], v3 offset:23296
	v_mul_f32 v178, v178, v176
	v_mul_f32 v179, v179, v177
	v_cvt_pk_bf16_f32 v196, v178, v179
	v_mfma_f32_32x32x16_bf16 v[32:47], v[148:151], a[40:43], v[32:47]
	ds_read_b64_tr_b16 v[144:145], v3 offset:6144
	ds_read_b64_tr_b16 v[146:147], v3 offset:6656
	v_mul_f32 v180, v90, v90
	v_mul_f32 v181, v91, v91
	v_fma_f32 v180, v180, v11, v10
	v_fma_f32 v181, v181, v11, v10
	v_mfma_f32_32x32x16_bf16 v[48:63], v[152:155], a[40:43], v[48:63]
	ds_read_b64_tr_b16 v[148:149], v3 offset:24576
	ds_read_b64_tr_b16 v[150:151], v3 offset:25088
	v_mul_f32 v180, v180, v90
	v_mul_f32 v181, v181, v91
	v_exp_f32 v180, v180
	v_mfma_f32_32x32x16_bf16 v[64:79], v[156:159], a[40:43], v[64:79]
	ds_read_b64_tr_b16 v[152:153], v3 offset:6400
	ds_read_b64_tr_b16 v[154:155], v3 offset:6912
	v_exp_f32 v181, v181
	v_mul_f32 v182, v90, v106
	v_mul_f32 v183, v91, v107
	s_waitcnt lgkmcnt(6)
	v_mfma_f32_32x32x16_bf16 v[16:31], v[160:163], a[44:47], v[16:31]
	ds_read_b64_tr_b16 v[156:157], v3 offset:24832
	ds_read_b64_tr_b16 v[158:159], v3 offset:25344
	v_fma_f32 v180, v180, v13, v13
	v_fma_f32 v181, v181, v13, v13
	v_mfma_f32_32x32x16_bf16 v[32:47], v[164:167], a[44:47], v[32:47]
	ds_read_b64_tr_b16 v[160:161], v3 offset:8192
	ds_read_b64_tr_b16 v[162:163], v3 offset:8704
	v_rcp_f32 v180, v180
	v_rcp_f32 v181, v181
	v_mul_f32 v182, v182, v180
	v_mfma_f32_32x32x16_bf16 v[48:63], v[168:171], a[44:47], v[48:63]
	ds_read_b64_tr_b16 v[164:165], v3 offset:26624
	ds_read_b64_tr_b16 v[166:167], v3 offset:27136
	v_mul_f32 v183, v183, v181
	v_cvt_pk_bf16_f32 v197, v182, v183
	v_mul_f32 v184, v92, v92
	v_mul_f32 v185, v93, v93
	v_mfma_f32_32x32x16_bf16 v[64:79], v[172:175], a[44:47], v[64:79]
	ds_read_b64_tr_b16 v[168:169], v3 offset:8448
	ds_read_b64_tr_b16 v[170:171], v3 offset:8960
	v_fma_f32 v184, v184, v11, v10
	v_fma_f32 v185, v185, v11, v10
	v_mul_f32 v184, v184, v92
	v_mul_f32 v185, v185, v93
	s_waitcnt lgkmcnt(6)
	v_mfma_f32_32x32x16_bf16 v[16:31], v[144:147], a[48:51], v[16:31]
	ds_read_b64_tr_b16 v[172:173], v3 offset:26880
	ds_read_b64_tr_b16 v[174:175], v3 offset:27392
	v_exp_f32 v184, v184
	v_mfma_f32_32x32x16_bf16 v[32:47], v[148:151], a[48:51], v[32:47]
	ds_read_b64_tr_b16 v[144:145], v3 offset:10240
	ds_read_b64_tr_b16 v[146:147], v3 offset:10752
	v_exp_f32 v185, v185
	v_mul_f32 v186, v92, v108
	v_mul_f32 v187, v93, v109
	v_fma_f32 v184, v184, v13, v13
	v_mfma_f32_32x32x16_bf16 v[48:63], v[152:155], a[48:51], v[48:63]
	ds_read_b64_tr_b16 v[148:149], v3 offset:28672
	ds_read_b64_tr_b16 v[150:151], v3 offset:29184
	v_fma_f32 v185, v185, v13, v13
	v_rcp_f32 v184, v184
	v_mfma_f32_32x32x16_bf16 v[64:79], v[156:159], a[48:51], v[64:79]
	ds_read_b64_tr_b16 v[152:153], v3 offset:10496
	ds_read_b64_tr_b16 v[154:155], v3 offset:11008
	v_rcp_f32 v185, v185
	v_mul_f32 v186, v186, v184
	v_mul_f32 v187, v187, v185
	v_cvt_pk_bf16_f32 v198, v186, v187
	s_waitcnt lgkmcnt(6)
	v_mfma_f32_32x32x16_bf16 v[16:31], v[160:163], a[52:55], v[16:31]
	ds_read_b64_tr_b16 v[156:157], v3 offset:28928
	ds_read_b64_tr_b16 v[158:159], v3 offset:29440
	v_mul_f32 v188, v94, v94
	v_mul_f32 v189, v95, v95
	v_fma_f32 v188, v188, v11, v10
	v_mfma_f32_32x32x16_bf16 v[32:47], v[164:167], a[52:55], v[32:47]
	ds_read_b64_tr_b16 v[160:161], v3 offset:12288
	ds_read_b64_tr_b16 v[162:163], v3 offset:12800
	v_fma_f32 v189, v189, v11, v10
	v_mul_f32 v188, v188, v94
	v_mul_f32 v189, v189, v95
	v_mfma_f32_32x32x16_bf16 v[48:63], v[168:171], a[52:55], v[48:63]
	ds_read_b64_tr_b16 v[164:165], v3 offset:30720
	ds_read_b64_tr_b16 v[166:167], v3 offset:31232
	s_waitcnt vmcnt(10)
	s_barrier
	v_mov_b32 v222, 1
	v_mov_b32 v223, 0
	s_mov_b64 exec, 1
	buffer_store_dword v222, v223, s[8:11], s30 offen sc1
	s_mov_b64 exec, -1
	v_mfma_f32_32x32x16_bf16 v[64:79], v[172:175], a[52:55], v[64:79]
	ds_read_b64_tr_b16 v[168:169], v3 offset:12544
	ds_read_b64_tr_b16 v[170:171], v3 offset:13056
	v_add_u32 v6, 0xffc34080, v6
	s_add_u32 m0, s37, 0
	s_waitcnt lgkmcnt(6)
	v_mfma_f32_32x32x16_bf16 v[16:31], v[144:147], a[56:59], v[16:31]
	ds_read_b64_tr_b16 v[172:173], v3 offset:30976
	ds_read_b64_tr_b16 v[174:175], v3 offset:31488
	v_exp_f32 v188, v188
	v_mfma_f32_32x32x16_bf16 v[32:47], v[148:151], a[56:59], v[32:47]
	ds_read_b64_tr_b16 v[144:145], v3 offset:14336
	ds_read_b64_tr_b16 v[146:147], v3 offset:14848
	buffer_load_dwordx4 v6, s[12:15], s40 offen lds
	s_add_u32 m0, s37, 1024
	v_exp_f32 v189, v189
	v_mfma_f32_32x32x16_bf16 v[48:63], v[152:155], a[56:59], v[48:63]
	ds_read_b64_tr_b16 v[148:149], v3 offset:32768
	ds_read_b64_tr_b16 v[150:151], v3 offset:33280
	v_mul_f32 v190, v94, v110
	v_mul_f32 v191, v95, v111
	v_fma_f32 v188, v188, v13, v13
	v_fma_f32 v189, v189, v13, v13
	v_mfma_f32_32x32x16_bf16 v[64:79], v[156:159], a[56:59], v[64:79]
	ds_read_b64_tr_b16 v[152:153], v3 offset:14592
	ds_read_b64_tr_b16 v[154:155], v3 offset:15104
	buffer_load_dwordx4 v6, s[12:15], s41 offen lds
	s_add_u32 m0, s37, 2048
	s_waitcnt lgkmcnt(6)
	v_mfma_f32_32x32x16_bf16 v[16:31], v[160:163], a[60:63], v[16:31]
	ds_read_b64_tr_b16 v[156:157], v3 offset:33024
	ds_read_b64_tr_b16 v[158:159], v3 offset:33536
	v_rcp_f32 v188, v188
	v_rcp_f32 v189, v189
	v_mfma_f32_32x32x16_bf16 v[32:47], v[164:167], a[60:63], v[32:47]
	ds_read_b64_tr_b16 v[160:161], v3 offset:16384
	ds_read_b64_tr_b16 v[162:163], v3 offset:16896
	buffer_load_dwordx4 v6, s[12:15], s42 offen lds
	s_add_u32 m0, s37, 3072
	v_mul_f32 v190, v190, v188
	v_mfma_f32_32x32x16_bf16 v[48:63], v[168:171], a[60:63], v[48:63]
	ds_read_b64_tr_b16 v[164:165], v3 offset:34816
	ds_read_b64_tr_b16 v[166:167], v3 offset:35328
	v_mul_f32 v191, v191, v189
	v_cvt_pk_bf16_f32 v199, v190, v191
	s_add_u32 s65, s63, 2048
	v_mfma_f32_32x32x16_bf16 v[64:79], v[172:175], a[60:63], v[64:79]
	ds_read_b64_tr_b16 v[168:169], v3 offset:16640
	ds_read_b64_tr_b16 v[170:171], v3 offset:17152
	buffer_load_dwordx4 v6, s[12:15], s43 offen lds
	s_add_u32 m0, s37, 4096
	buffer_store_dwordx4 v[196:199], v8, s[8:11], s65 offen offset:512 sc1
	s_waitcnt lgkmcnt(6)
	v_mfma_f32_32x32x16_bf16 v[16:31], v[144:147], a[64:67], v[16:31]
	ds_read_b64_tr_b16 v[172:173], v3 offset:35072
	ds_read_b64_tr_b16 v[174:175], v3 offset:35584
	v_mul_f32 v176, v112, v112
	v_mul_f32 v177, v113, v113
	v_fma_f32 v176, v176, v11, v10
	v_mfma_f32_32x32x16_bf16 v[32:47], v[148:151], a[64:67], v[32:47]
	ds_read_b64_tr_b16 v[144:145], v4 offset:0
	ds_read_b64_tr_b16 v[146:147], v4 offset:512
	buffer_load_dwordx4 v6, s[12:15], s44 offen lds
	s_add_u32 m0, s37, 5120
	v_fma_f32 v177, v177, v11, v10
	v_mfma_f32_32x32x16_bf16 v[48:63], v[152:155], a[64:67], v[48:63]
	ds_read_b64_tr_b16 v[148:149], v4 offset:18432
	ds_read_b64_tr_b16 v[150:151], v4 offset:18944
	v_mul_f32 v176, v176, v112
	v_mul_f32 v177, v177, v113
	v_exp_f32 v176, v176
	v_mfma_f32_32x32x16_bf16 v[64:79], v[156:159], a[64:67], v[64:79]
	ds_read_b64_tr_b16 v[152:153], v4 offset:256
	ds_read_b64_tr_b16 v[154:155], v4 offset:768
	buffer_load_dwordx4 v6, s[12:15], s45 offen lds
	s_add_u32 m0, s37, 6144
	s_waitcnt lgkmcnt(6)
	v_mfma_f32_32x32x16_bf16 v[16:31], v[160:163], a[68:71], v[16:31]
	ds_read_b64_tr_b16 v[156:157], v4 offset:18688
	ds_read_b64_tr_b16 v[158:159], v4 offset:19200
	v_exp_f32 v177, v177
	v_mul_f32 v178, v112, v128
	v_mul_f32 v179, v113, v129
	v_mfma_f32_32x32x16_bf16 v[32:47], v[164:167], a[68:71], v[32:47]
	ds_read_b64_tr_b16 v[160:161], v4 offset:2048
	ds_read_b64_tr_b16 v[162:163], v4 offset:2560
	buffer_load_dwordx4 v6, s[12:15], s46 offen lds
	s_add_u32 m0, s37, 7168
	v_fma_f32 v176, v176, v13, v13
	v_mfma_f32_32x32x16_bf16 v[48:63], v[168:171], a[68:71], v[48:63]
	ds_read_b64_tr_b16 v[164:165], v4 offset:20480
	ds_read_b64_tr_b16 v[166:167], v4 offset:20992
	v_fma_f32 v177, v177, v13, v13
	v_rcp_f32 v176, v176
	v_mfma_f32_32x32x16_bf16 v[64:79], v[172:175], a[68:71], v[64:79]
	ds_read_b64_tr_b16 v[168:169], v4 offset:2304
	ds_read_b64_tr_b16 v[170:171], v4 offset:2816
	buffer_load_dwordx4 v6, s[12:15], s47 offen lds
	s_add_u32 m0, s37, 8192
	v_rcp_f32 v177, v177
	s_waitcnt lgkmcnt(6)
	v_mfma_f32_32x32x16_bf16 v[16:31], v[144:147], a[72:75], v[16:31]
	ds_read_b64_tr_b16 v[172:173], v4 offset:20736
	ds_read_b64_tr_b16 v[174:175], v4 offset:21248
	v_mul_f32 v178, v178, v176
	v_mul_f32 v179, v179, v177
	v_cvt_pk_bf16_f32 v200, v178, v179
	v_mfma_f32_32x32x16_bf16 v[32:47], v[148:151], a[72:75], v[32:47]
	ds_read_b64_tr_b16 v[144:145], v4 offset:4096
	ds_read_b64_tr_b16 v[146:147], v4 offset:4608
	buffer_load_dwordx4 v6, s[12:15], s48 offen lds
	v_mul_f32 v180, v114, v114
	v_mul_f32 v181, v115, v115
	v_mfma_f32_32x32x16_bf16 v[48:63], v[152:155], a[72:75], v[48:63]
	ds_read_b64_tr_b16 v[148:149], v4 offset:22528
	ds_read_b64_tr_b16 v[150:151], v4 offset:23040
	v_fma_f32 v180, v180, v11, v10
	v_fma_f32 v181, v181, v11, v10
	v_mul_f32 v180, v180, v114
	v_mul_f32 v181, v181, v115
	v_mfma_f32_32x32x16_bf16 v[64:79], v[156:159], a[72:75], v[64:79]
	ds_read_b64_tr_b16 v[152:153], v4 offset:4352
	ds_read_b64_tr_b16 v[154:155], v4 offset:4864
	v_exp_f32 v180, v180
	v_exp_f32 v181, v181
	s_waitcnt lgkmcnt(6)
	v_mfma_f32_32x32x16_bf16 v[16:31], v[160:163], a[76:79], v[16:31]
	ds_read_b64_tr_b16 v[156:157], v4 offset:22784
	ds_read_b64_tr_b16 v[158:159], v4 offset:23296
	v_mul_f32 v182, v114, v130
	v_mul_f32 v183, v115, v131
	v_fma_f32 v180, v180, v13, v13
	v_mfma_f32_32x32x16_bf16 v[32:47], v[164:167], a[76:79], v[32:47]
	ds_read_b64_tr_b16 v[160:161], v4 offset:6144
	ds_read_b64_tr_b16 v[162:163], v4 offset:6656
	v_fma_f32 v181, v181, v13, v13
	v_rcp_f32 v180, v180
	v_mfma_f32_32x32x16_bf16 v[48:63], v[168:171], a[76:79], v[48:63]
	ds_read_b64_tr_b16 v[164:165], v4 offset:24576
	ds_read_b64_tr_b16 v[166:167], v4 offset:25088
	v_rcp_f32 v181, v181
	v_mul_f32 v182, v182, v180
	v_mul_f32 v183, v183, v181
	v_cvt_pk_bf16_f32 v201, v182, v183
	v_mfma_f32_32x32x16_bf16 v[64:79], v[172:175], a[76:79], v[64:79]
	ds_read_b64_tr_b16 v[168:169], v4 offset:6400
	ds_read_b64_tr_b16 v[170:171], v4 offset:6912
	v_mul_f32 v184, v116, v116
	v_mul_f32 v185, v117, v117
	v_fma_f32 v184, v184, v11, v10
	v_fma_f32 v185, v185, v11, v10
	s_waitcnt lgkmcnt(6)
	v_mfma_f32_32x32x16_bf16 v[16:31], v[144:147], a[80:83], v[16:31]
	ds_read_b64_tr_b16 v[172:173], v4 offset:24832
	ds_read_b64_tr_b16 v[174:175], v4 offset:25344
	v_mul_f32 v184, v184, v116
	v_mul_f32 v185, v185, v117
	v_mfma_f32_32x32x16_bf16 v[32:47], v[148:151], a[80:83], v[32:47]
	ds_read_b64_tr_b16 v[144:145], v4 offset:8192
	ds_read_b64_tr_b16 v[146:147], v4 offset:8704
	v_exp_f32 v184, v184
	v_exp_f32 v185, v185
	v_mul_f32 v186, v116, v132
	v_mfma_f32_32x32x16_bf16 v[48:63], v[152:155], a[80:83], v[48:63]
	ds_read_b64_tr_b16 v[148:149], v4 offset:26624
	ds_read_b64_tr_b16 v[150:151], v4 offset:27136
	v_mul_f32 v187, v117, v133
	v_fma_f32 v184, v184, v13, v13
	v_fma_f32 v185, v185, v13, v13
	v_mfma_f32_32x32x16_bf16 v[64:79], v[156:159], a[80:83], v[64:79]
	ds_read_b64_tr_b16 v[152:153], v4 offset:8448
	ds_read_b64_tr_b16 v[154:155], v4 offset:8960
	v_rcp_f32 v184, v184
	v_rcp_f32 v185, v185
	v_mul_f32 v186, v186, v184
	s_waitcnt lgkmcnt(6)
	v_mfma_f32_32x32x16_bf16 v[16:31], v[160:163], a[84:87], v[16:31]
	ds_read_b64_tr_b16 v[156:157], v4 offset:26880
	ds_read_b64_tr_b16 v[158:159], v4 offset:27392
	v_mul_f32 v187, v187, v185
	v_cvt_pk_bf16_f32 v202, v186, v187
	v_mul_f32 v188, v118, v118
	v_mfma_f32_32x32x16_bf16 v[32:47], v[164:167], a[84:87], v[32:47]
	ds_read_b64_tr_b16 v[160:161], v4 offset:10240
	ds_read_b64_tr_b16 v[162:163], v4 offset:10752
	v_mul_f32 v189, v119, v119
	v_fma_f32 v188, v188, v11, v10
	v_fma_f32 v189, v189, v11, v10
	v_mul_f32 v188, v188, v118
	v_mfma_f32_32x32x16_bf16 v[48:63], v[168:171], a[84:87], v[48:63]
	ds_read_b64_tr_b16 v[164:165], v4 offset:28672
	ds_read_b64_tr_b16 v[166:167], v4 offset:29184
	v_mul_f32 v189, v189, v119
	v_exp_f32 v188, v188
	v_mfma_f32_32x32x16_bf16 v[64:79], v[172:175], a[84:87], v[64:79]
	ds_read_b64_tr_b16 v[168:169], v4 offset:10496
	ds_read_b64_tr_b16 v[170:171], v4 offset:11008
	v_exp_f32 v189, v189
	v_mul_f32 v190, v118, v134
	v_mul_f32 v191, v119, v135
	v_fma_f32 v188, v188, v13, v13
	s_waitcnt lgkmcnt(6)
	v_mfma_f32_32x32x16_bf16 v[16:31], v[144:147], a[88:91], v[16:31]
	ds_read_b64_tr_b16 v[172:173], v4 offset:28928
	ds_read_b64_tr_b16 v[174:175], v4 offset:29440
	v_fma_f32 v189, v189, v13, v13
	v_rcp_f32 v188, v188
	v_mfma_f32_32x32x16_bf16 v[32:47], v[148:151], a[88:91], v[32:47]
	ds_read_b64_tr_b16 v[144:145], v4 offset:12288
	ds_read_b64_tr_b16 v[146:147], v4 offset:12800
	v_rcp_f32 v189, v189
	v_mul_f32 v190, v190, v188
	v_mul_f32 v191, v191, v189
	v_mfma_f32_32x32x16_bf16 v[48:63], v[152:155], a[88:91], v[48:63]
	ds_read_b64_tr_b16 v[148:149], v4 offset:30720
	ds_read_b64_tr_b16 v[150:151], v4 offset:31232
	s_waitcnt vmcnt(11)
	s_barrier
	v_cvt_pk_bf16_f32 v203, v190, v191
	s_add_u32 s65, s63, 3072
	v_mfma_f32_32x32x16_bf16 v[64:79], v[156:159], a[88:91], v[64:79]
	ds_read_b64_tr_b16 v[152:153], v4 offset:12544
	ds_read_b64_tr_b16 v[154:155], v4 offset:13056
	v_add_u32 v6, 0x144000, v6
	s_add_u32 m0, s37, 36864
	buffer_store_dwordx4 v[200:203], v8, s[8:11], s65 offen offset:0 sc1
	s_waitcnt lgkmcnt(6)
	v_mfma_f32_32x32x16_bf16 v[16:31], v[160:163], a[92:95], v[16:31]
	ds_read_b64_tr_b16 v[156:157], v4 offset:30976
	ds_read_b64_tr_b16 v[158:159], v4 offset:31488
	v_mul_f32 v176, v120, v120
	v_mul_f32 v177, v121, v121
	v_fma_f32 v176, v176, v11, v10
	v_mfma_f32_32x32x16_bf16 v[32:47], v[164:167], a[92:95], v[32:47]
	ds_read_b64_tr_b16 v[160:161], v4 offset:14336
	ds_read_b64_tr_b16 v[162:163], v4 offset:14848
	buffer_load_dwordx4 v6, s[12:15], s40 offen lds
	s_add_u32 m0, s37, 37888
	v_fma_f32 v177, v177, v11, v10
	v_mfma_f32_32x32x16_bf16 v[48:63], v[168:171], a[92:95], v[48:63]
	ds_read_b64_tr_b16 v[164:165], v4 offset:32768
	ds_read_b64_tr_b16 v[166:167], v4 offset:33280
	v_mul_f32 v176, v176, v120
	v_mul_f32 v177, v177, v121
	v_exp_f32 v176, v176
	v_mfma_f32_32x32x16_bf16 v[64:79], v[172:175], a[92:95], v[64:79]
	ds_read_b64_tr_b16 v[168:169], v4 offset:14592
	ds_read_b64_tr_b16 v[170:171], v4 offset:15104
	buffer_load_dwordx4 v6, s[12:15], s41 offen lds
	s_add_u32 m0, s37, 38912
	s_waitcnt lgkmcnt(6)
	v_mfma_f32_32x32x16_bf16 v[16:31], v[144:147], a[96:99], v[16:31]
	ds_read_b64_tr_b16 v[172:173], v4 offset:33024
	ds_read_b64_tr_b16 v[174:175], v4 offset:33536
	v_exp_f32 v177, v177
	v_mul_f32 v178, v120, v136
	v_mul_f32 v179, v121, v137
	v_mfma_f32_32x32x16_bf16 v[32:47], v[148:151], a[96:99], v[32:47]
	ds_read_b64_tr_b16 v[144:145], v4 offset:16384
	ds_read_b64_tr_b16 v[146:147], v4 offset:16896
	buffer_load_dwordx4 v6, s[12:15], s42 offen lds
	s_add_u32 m0, s37, 39936
	v_fma_f32 v176, v176, v13, v13
	v_mfma_f32_32x32x16_bf16 v[48:63], v[152:155], a[96:99], v[48:63]
	ds_read_b64_tr_b16 v[148:149], v4 offset:34816
	ds_read_b64_tr_b16 v[150:151], v4 offset:35328
	v_fma_f32 v177, v177, v13, v13
	v_rcp_f32 v176, v176
	v_mfma_f32_32x32x16_bf16 v[64:79], v[156:159], a[96:99], v[64:79]
	ds_read_b64_tr_b16 v[152:153], v4 offset:16640
	ds_read_b64_tr_b16 v[154:155], v4 offset:17152
	buffer_load_dwordx4 v6, s[12:15], s43 offen lds
	s_add_u32 m0, s37, 40960
	v_rcp_f32 v177, v177
	s_waitcnt lgkmcnt(6)
	v_mfma_f32_32x32x16_bf16 v[16:31], v[160:163], a[100:103], v[16:31]
	ds_read_b64_tr_b16 v[156:157], v4 offset:35072
	ds_read_b64_tr_b16 v[158:159], v4 offset:35584
	v_mul_f32 v178, v178, v176
	v_mul_f32 v179, v179, v177
	v_cvt_pk_bf16_f32 v204, v178, v179
	v_mfma_f32_32x32x16_bf16 v[32:47], v[164:167], a[100:103], v[32:47]
	ds_read_b64_tr_b16 v[160:161], v5 offset:0
	ds_read_b64_tr_b16 v[162:163], v5 offset:512
	buffer_load_dwordx4 v6, s[12:15], s44 offen lds
	s_add_u32 m0, s37, 41984
	v_mul_f32 v180, v122, v122
	v_mfma_f32_32x32x16_bf16 v[48:63], v[168:171], a[100:103], v[48:63]
	ds_read_b64_tr_b16 v[164:165], v5 offset:18432
	ds_read_b64_tr_b16 v[166:167], v5 offset:18944
	v_mul_f32 v181, v123, v123
	v_fma_f32 v180, v180, v11, v10
	v_fma_f32 v181, v181, v11, v10
	v_mul_f32 v180, v180, v122
	v_mfma_f32_32x32x16_bf16 v[64:79], v[172:175], a[100:103], v[64:79]
	ds_read_b64_tr_b16 v[168:169], v5 offset:256
	ds_read_b64_tr_b16 v[170:171], v5 offset:768
	buffer_load_dwordx4 v6, s[12:15], s45 offen lds
	s_add_u32 m0, s37, 43008
	v_mul_f32 v181, v181, v123
	s_waitcnt lgkmcnt(6)
	v_mfma_f32_32x32x16_bf16 v[16:31], v[144:147], a[104:107], v[16:31]
	ds_read_b64_tr_b16 v[172:173], v5 offset:18688
	ds_read_b64_tr_b16 v[174:175], v5 offset:19200
	v_exp_f32 v180, v180
	v_mfma_f32_32x32x16_bf16 v[32:47], v[148:151], a[104:107], v[32:47]
	ds_read_b64_tr_b16 v[144:145], v5 offset:2048
	ds_read_b64_tr_b16 v[146:147], v5 offset:2560
	buffer_load_dwordx4 v6, s[12:15], s46 offen lds
	s_add_u32 m0, s37, 44032
	v_exp_f32 v181, v181
	v_mfma_f32_32x32x16_bf16 v[48:63], v[152:155], a[104:107], v[48:63]
	ds_read_b64_tr_b16 v[148:149], v5 offset:20480
	ds_read_b64_tr_b16 v[150:151], v5 offset:20992
	v_mul_f32 v182, v122, v138
	v_mul_f32 v183, v123, v139
	v_fma_f32 v180, v180, v13, v13
	v_fma_f32 v181, v181, v13, v13
	v_mfma_f32_32x32x16_bf16 v[64:79], v[156:159], a[104:107], v[64:79]
	ds_read_b64_tr_b16 v[152:153], v5 offset:2304
	ds_read_b64_tr_b16 v[154:155], v5 offset:2816
	buffer_load_dwordx4 v6, s[12:15], s47 offen lds
	s_add_u32 m0, s37, 45056
	s_waitcnt lgkmcnt(6)
	v_mfma_f32_32x32x16_bf16 v[16:31], v[160:163], a[108:111], v[16:31]
	ds_read_b64_tr_b16 v[156:157], v5 offset:20736
	ds_read_b64_tr_b16 v[158:159], v5 offset:21248
	v_rcp_f32 v180, v180
	v_rcp_f32 v181, v181
	v_mfma_f32_32x32x16_bf16 v[32:47], v[164:167], a[108:111], v[32:47]
	ds_read_b64_tr_b16 v[160:161], v5 offset:4096
	ds_read_b64_tr_b16 v[162:163], v5 offset:4608
	buffer_load_dwordx4 v6, s[12:15], s48 offen lds
	v_mul_f32 v182, v182, v180
	v_mul_f32 v183, v183, v181
	v_mfma_f32_32x32x16_bf16 v[48:63], v[168:171], a[108:111], v[48:63]
	ds_read_b64_tr_b16 v[164:165], v5 offset:22528
	ds_read_b64_tr_b16 v[166:167], v5 offset:23040
	v_cvt_pk_bf16_f32 v205, v182, v183
	v_mul_f32 v184, v124, v124
	v_mul_f32 v185, v125, v125
	v_fma_f32 v184, v184, v11, v10
	v_mfma_f32_32x32x16_bf16 v[64:79], v[172:175], a[108:111], v[64:79]
	ds_read_b64_tr_b16 v[168:169], v5 offset:4352
	ds_read_b64_tr_b16 v[170:171], v5 offset:4864
	v_fma_f32 v185, v185, v11, v10
	v_mul_f32 v184, v184, v124
	v_mul_f32 v185, v185, v125
	s_waitcnt lgkmcnt(6)
	v_mfma_f32_32x32x16_bf16 v[16:31], v[144:147], a[112:115], v[16:31]
	ds_read_b64_tr_b16 v[172:173], v5 offset:22784
	ds_read_b64_tr_b16 v[174:175], v5 offset:23296
	v_exp_f32 v184, v184
	v_exp_f32 v185, v185
	v_mfma_f32_32x32x16_bf16 v[32:47], v[148:151], a[112:115], v[32:47]
	ds_read_b64_tr_b16 v[144:145], v5 offset:6144
	ds_read_b64_tr_b16 v[146:147], v5 offset:6656
	v_mul_f32 v186, v124, v140
	v_mul_f32 v187, v125, v141
	v_fma_f32 v184, v184, v13, v13
	v_fma_f32 v185, v185, v13, v13
	v_mfma_f32_32x32x16_bf16 v[48:63], v[152:155], a[112:115], v[48:63]
	ds_read_b64_tr_b16 v[148:149], v5 offset:24576
	ds_read_b64_tr_b16 v[150:151], v5 offset:25088
	v_rcp_f32 v184, v184
	v_rcp_f32 v185, v185
	v_mfma_f32_32x32x16_bf16 v[64:79], v[156:159], a[112:115], v[64:79]
	ds_read_b64_tr_b16 v[152:153], v5 offset:6400
	ds_read_b64_tr_b16 v[154:155], v5 offset:6912
	v_mul_f32 v186, v186, v184
	v_mul_f32 v187, v187, v185
	v_cvt_pk_bf16_f32 v206, v186, v187
	v_mul_f32 v188, v126, v126
	s_waitcnt lgkmcnt(6)
	v_mfma_f32_32x32x16_bf16 v[16:31], v[160:163], a[116:119], v[16:31]
	ds_read_b64_tr_b16 v[156:157], v5 offset:24832
	ds_read_b64_tr_b16 v[158:159], v5 offset:25344
	v_mul_f32 v189, v127, v127
	v_fma_f32 v188, v188, v11, v10
	v_fma_f32 v189, v189, v11, v10
	v_mfma_f32_32x32x16_bf16 v[32:47], v[164:167], a[116:119], v[32:47]
	ds_read_b64_tr_b16 v[160:161], v5 offset:8192
	ds_read_b64_tr_b16 v[162:163], v5 offset:8704
	v_mul_f32 v188, v188, v126
	v_mul_f32 v189, v189, v127
	v_exp_f32 v188, v188
	v_mfma_f32_32x32x16_bf16 v[48:63], v[168:171], a[116:119], v[48:63]
	ds_read_b64_tr_b16 v[164:165], v5 offset:26624
	ds_read_b64_tr_b16 v[166:167], v5 offset:27136
	v_exp_f32 v189, v189
	v_mul_f32 v190, v126, v142
	v_mul_f32 v191, v127, v143
	v_mfma_f32_32x32x16_bf16 v[64:79], v[172:175], a[116:119], v[64:79]
	ds_read_b64_tr_b16 v[168:169], v5 offset:8448
	ds_read_b64_tr_b16 v[170:171], v5 offset:8960
	v_fma_f32 v188, v188, v13, v13
	v_fma_f32 v189, v189, v13, v13
	v_rcp_f32 v188, v188
	s_waitcnt lgkmcnt(6)
	v_mfma_f32_32x32x16_bf16 v[16:31], v[144:147], a[120:123], v[16:31]
	ds_read_b64_tr_b16 v[172:173], v5 offset:26880
	ds_read_b64_tr_b16 v[174:175], v5 offset:27392
	v_rcp_f32 v189, v189
	v_mul_f32 v190, v190, v188
	v_mfma_f32_32x32x16_bf16 v[32:47], v[148:151], a[120:123], v[32:47]
	ds_read_b64_tr_b16 v[144:145], v5 offset:10240
	ds_read_b64_tr_b16 v[146:147], v5 offset:10752
	v_mul_f32 v191, v191, v189
	v_cvt_pk_bf16_f32 v207, v190, v191
	s_add_u32 s65, s63, 3072
	v_mfma_f32_32x32x16_bf16 v[48:63], v[152:155], a[120:123], v[48:63]
	ds_read_b64_tr_b16 v[148:149], v5 offset:28672
	ds_read_b64_tr_b16 v[150:151], v5 offset:29184
	buffer_store_dwordx4 v[204:207], v8, s[8:11], s65 offen offset:512 sc1
	v_mfma_f32_32x32x16_bf16 v[64:79], v[156:159], a[120:123], v[64:79]
	ds_read_b64_tr_b16 v[152:153], v5 offset:10496
	ds_read_b64_tr_b16 v[154:155], v5 offset:11008
	s_waitcnt lgkmcnt(6)
	v_mfma_f32_32x32x16_bf16 v[16:31], v[160:163], a[124:127], v[16:31]
	ds_read_b64_tr_b16 v[156:157], v5 offset:28928
	ds_read_b64_tr_b16 v[158:159], v5 offset:29440
	v_mfma_f32_32x32x16_bf16 v[32:47], v[164:167], a[124:127], v[32:47]
	ds_read_b64_tr_b16 v[160:161], v5 offset:12288
	ds_read_b64_tr_b16 v[162:163], v5 offset:12800
	v_mfma_f32_32x32x16_bf16 v[48:63], v[168:171], a[124:127], v[48:63]
	ds_read_b64_tr_b16 v[164:165], v5 offset:30720
	ds_read_b64_tr_b16 v[166:167], v5 offset:31232
	s_waitcnt vmcnt(11)
	s_barrier
	v_mfma_f32_32x32x16_bf16 v[64:79], v[172:175], a[124:127], v[64:79]
	ds_read_b64_tr_b16 v[168:169], v5 offset:12544
	ds_read_b64_tr_b16 v[170:171], v5 offset:13056
	v_add_u32 v6, 0x144000, v6
	s_add_u32 m0, s37, 73728
	s_waitcnt lgkmcnt(6)
	v_mfma_f32_32x32x16_bf16 v[16:31], v[144:147], a[128:131], v[16:31]
	ds_read_b64_tr_b16 v[172:173], v5 offset:30976
	ds_read_b64_tr_b16 v[174:175], v5 offset:31488
	v_mfma_f32_32x32x16_bf16 v[32:47], v[148:151], a[128:131], v[32:47]
	ds_read_b64_tr_b16 v[144:145], v5 offset:14336
	ds_read_b64_tr_b16 v[146:147], v5 offset:14848
	buffer_load_dwordx4 v6, s[12:15], s40 offen lds
	s_add_u32 m0, s37, 74752
	v_mfma_f32_32x32x16_bf16 v[48:63], v[152:155], a[128:131], v[48:63]
	ds_read_b64_tr_b16 v[148:149], v5 offset:32768
	ds_read_b64_tr_b16 v[150:151], v5 offset:33280
	v_mfma_f32_32x32x16_bf16 v[64:79], v[156:159], a[128:131], v[64:79]
	ds_read_b64_tr_b16 v[152:153], v5 offset:14592
	ds_read_b64_tr_b16 v[154:155], v5 offset:15104
	buffer_load_dwordx4 v6, s[12:15], s41 offen lds
	s_add_u32 m0, s37, 75776
	s_waitcnt lgkmcnt(6)
	v_mfma_f32_32x32x16_bf16 v[16:31], v[160:163], a[132:135], v[16:31]
	ds_read_b64_tr_b16 v[156:157], v5 offset:33024
	ds_read_b64_tr_b16 v[158:159], v5 offset:33536
	v_mfma_f32_32x32x16_bf16 v[32:47], v[164:167], a[132:135], v[32:47]
	ds_read_b64_tr_b16 v[160:161], v5 offset:16384
	ds_read_b64_tr_b16 v[162:163], v5 offset:16896
	buffer_load_dwordx4 v6, s[12:15], s42 offen lds
	s_add_u32 m0, s37, 76800
	v_mfma_f32_32x32x16_bf16 v[48:63], v[168:171], a[132:135], v[48:63]
	ds_read_b64_tr_b16 v[164:165], v5 offset:34816
	ds_read_b64_tr_b16 v[166:167], v5 offset:35328
	v_mfma_f32_32x32x16_bf16 v[64:79], v[172:175], a[132:135], v[64:79]
	ds_read_b64_tr_b16 v[168:169], v5 offset:16640
	ds_read_b64_tr_b16 v[170:171], v5 offset:17152
	buffer_load_dwordx4 v6, s[12:15], s43 offen lds
	s_add_u32 m0, s37, 77824
	s_waitcnt lgkmcnt(6)
	v_mfma_f32_32x32x16_bf16 v[16:31], v[144:147], a[136:139], v[16:31]
	ds_read_b64_tr_b16 v[172:173], v5 offset:35072
	ds_read_b64_tr_b16 v[174:175], v5 offset:35584
	v_mfma_f32_32x32x16_bf16 v[32:47], v[148:151], a[136:139], v[32:47]
	ds_read_b64_tr_b16 v[144:145], v2 offset:0
	ds_read_b64_tr_b16 v[146:147], v2 offset:512
	buffer_load_dwordx4 v6, s[12:15], s44 offen lds
	s_add_u32 m0, s37, 78848
	v_mfma_f32_32x32x16_bf16 v[48:63], v[152:155], a[136:139], v[48:63]
	ds_read_b64_tr_b16 v[148:149], v2 offset:18432
	ds_read_b64_tr_b16 v[150:151], v2 offset:18944
	v_mfma_f32_32x32x16_bf16 v[64:79], v[156:159], a[136:139], v[64:79]
	ds_read_b64_tr_b16 v[152:153], v2 offset:256
	ds_read_b64_tr_b16 v[154:155], v2 offset:768
	buffer_load_dwordx4 v6, s[12:15], s45 offen lds
	s_add_u32 m0, s37, 79872
	s_waitcnt lgkmcnt(6)
	v_mfma_f32_32x32x16_bf16 v[16:31], v[160:163], a[140:143], v[16:31]
	ds_read_b64_tr_b16 v[156:157], v2 offset:18688
	ds_read_b64_tr_b16 v[158:159], v2 offset:19200
	v_mfma_f32_32x32x16_bf16 v[32:47], v[164:167], a[140:143], v[32:47]
	ds_read_b64_tr_b16 v[160:161], v2 offset:2048
	ds_read_b64_tr_b16 v[162:163], v2 offset:2560
	buffer_load_dwordx4 v6, s[12:15], s46 offen lds
	s_add_u32 m0, s37, 80896
	v_mfma_f32_32x32x16_bf16 v[48:63], v[168:171], a[140:143], v[48:63]
	ds_read_b64_tr_b16 v[164:165], v2 offset:20480
	ds_read_b64_tr_b16 v[166:167], v2 offset:20992
	v_mfma_f32_32x32x16_bf16 v[64:79], v[172:175], a[140:143], v[64:79]
	ds_read_b64_tr_b16 v[168:169], v2 offset:2304
	ds_read_b64_tr_b16 v[170:171], v2 offset:2816
	buffer_load_dwordx4 v6, s[12:15], s47 offen lds
	s_add_u32 m0, s37, 81920
	s_waitcnt lgkmcnt(6)
	v_mfma_f32_32x32x16_bf16 v[80:95], v[144:147], a[0:3], 0
	ds_read_b64_tr_b16 v[172:173], v2 offset:20736
	ds_read_b64_tr_b16 v[174:175], v2 offset:21248
	v_mfma_f32_32x32x16_bf16 v[96:111], v[148:151], a[0:3], 0
	ds_read_b64_tr_b16 v[144:145], v2 offset:4096
	ds_read_b64_tr_b16 v[146:147], v2 offset:4608
	buffer_load_dwordx4 v6, s[12:15], s48 offen lds
	v_mfma_f32_32x32x16_bf16 v[112:127], v[152:155], a[0:3], 0
	ds_read_b64_tr_b16 v[148:149], v2 offset:22528
	ds_read_b64_tr_b16 v[150:151], v2 offset:23040
	v_mfma_f32_32x32x16_bf16 v[128:143], v[156:159], a[0:3], 0
	ds_read_b64_tr_b16 v[152:153], v2 offset:4352
	ds_read_b64_tr_b16 v[154:155], v2 offset:4864
	s_waitcnt lgkmcnt(6)
	v_mfma_f32_32x32x16_bf16 v[80:95], v[160:163], a[4:7], v[80:95]
	ds_read_b64_tr_b16 v[156:157], v2 offset:22784
	ds_read_b64_tr_b16 v[158:159], v2 offset:23296
	v_mul_f32 v176, v16, v16
	v_mul_f32 v177, v17, v17
	v_fma_f32 v176, v176, v11, v10
	v_fma_f32 v177, v177, v11, v10
	v_mfma_f32_32x32x16_bf16 v[96:111], v[164:167], a[4:7], v[96:111]
	ds_read_b64_tr_b16 v[160:161], v2 offset:6144
	ds_read_b64_tr_b16 v[162:163], v2 offset:6656
	v_mul_f32 v176, v176, v16
	v_mul_f32 v177, v177, v17
	v_exp_f32 v176, v176
	v_mfma_f32_32x32x16_bf16 v[112:127], v[168:171], a[4:7], v[112:127]
	ds_read_b64_tr_b16 v[164:165], v2 offset:24576
	ds_read_b64_tr_b16 v[166:167], v2 offset:25088
	v_exp_f32 v177, v177
	v_mul_f32 v178, v16, v32
	v_mul_f32 v179, v17, v33
	v_mfma_f32_32x32x16_bf16 v[128:143], v[172:175], a[4:7], v[128:143]
	ds_read_b64_tr_b16 v[168:169], v2 offset:6400
	ds_read_b64_tr_b16 v[170:171], v2 offset:6912
	v_fma_f32 v176, v176, v13, v13
	v_fma_f32 v177, v177, v13, v13
	v_rcp_f32 v176, v176
	s_waitcnt lgkmcnt(6)
	v_mfma_f32_32x32x16_bf16 v[80:95], v[144:147], a[8:11], v[80:95]
	ds_read_b64_tr_b16 v[172:173], v2 offset:24832
	ds_read_b64_tr_b16 v[174:175], v2 offset:25344
	v_rcp_f32 v177, v177
	v_mul_f32 v178, v178, v176
	v_mfma_f32_32x32x16_bf16 v[96:111], v[148:151], a[8:11], v[96:111]
	ds_read_b64_tr_b16 v[144:145], v2 offset:8192
	ds_read_b64_tr_b16 v[146:147], v2 offset:8704
	v_mul_f32 v179, v179, v177
	v_cvt_pk_bf16_f32 v192, v178, v179
	v_mul_f32 v180, v18, v18
	v_mul_f32 v181, v19, v19
	v_mfma_f32_32x32x16_bf16 v[112:127], v[152:155], a[8:11], v[112:127]
	ds_read_b64_tr_b16 v[148:149], v2 offset:26624
	ds_read_b64_tr_b16 v[150:151], v2 offset:27136
	v_fma_f32 v180, v180, v11, v10
	v_fma_f32 v181, v181, v11, v10
	v_mul_f32 v180, v180, v18
	v_mul_f32 v181, v181, v19
	v_mfma_f32_32x32x16_bf16 v[128:143], v[156:159], a[8:11], v[128:143]
	ds_read_b64_tr_b16 v[152:153], v2 offset:8448
	ds_read_b64_tr_b16 v[154:155], v2 offset:8960
	v_exp_f32 v180, v180
	v_exp_f32 v181, v181
	s_waitcnt lgkmcnt(6)
	v_mfma_f32_32x32x16_bf16 v[80:95], v[160:163], a[12:15], v[80:95]
	ds_read_b64_tr_b16 v[156:157], v2 offset:26880
	ds_read_b64_tr_b16 v[158:159], v2 offset:27392
	v_mul_f32 v182, v18, v34
	v_mul_f32 v183, v19, v35
	v_fma_f32 v180, v180, v13, v13
	v_mfma_f32_32x32x16_bf16 v[96:111], v[164:167], a[12:15], v[96:111]
	ds_read_b64_tr_b16 v[160:161], v2 offset:10240
	ds_read_b64_tr_b16 v[162:163], v2 offset:10752
	v_fma_f32 v181, v181, v13, v13
	v_rcp_f32 v180, v180
	v_mfma_f32_32x32x16_bf16 v[112:127], v[168:171], a[12:15], v[112:127]
	ds_read_b64_tr_b16 v[164:165], v2 offset:28672
	ds_read_b64_tr_b16 v[166:167], v2 offset:29184
	v_rcp_f32 v181, v181
	v_mul_f32 v182, v182, v180
	v_mul_f32 v183, v183, v181
	v_cvt_pk_bf16_f32 v193, v182, v183
	v_mfma_f32_32x32x16_bf16 v[128:143], v[172:175], a[12:15], v[128:143]
	ds_read_b64_tr_b16 v[168:169], v2 offset:10496
	ds_read_b64_tr_b16 v[170:171], v2 offset:11008
	v_mul_f32 v184, v20, v20
	v_mul_f32 v185, v21, v21
	v_fma_f32 v184, v184, v11, v10
	v_fma_f32 v185, v185, v11, v10
	s_waitcnt lgkmcnt(6)
	v_mfma_f32_32x32x16_bf16 v[80:95], v[144:147], a[16:19], v[80:95]
	ds_read_b64_tr_b16 v[172:173], v2 offset:28928
	ds_read_b64_tr_b16 v[174:175], v2 offset:29440
	v_mul_f32 v184, v184, v20
	v_mul_f32 v185, v185, v21
	v_mfma_f32_32x32x16_bf16 v[96:111], v[148:151], a[16:19], v[96:111]
	ds_read_b64_tr_b16 v[144:145], v2 offset:12288
	ds_read_b64_tr_b16 v[146:147], v2 offset:12800
	v_exp_f32 v184, v184
	v_exp_f32 v185, v185
	v_mul_f32 v186, v20, v36
	v_mfma_f32_32x32x16_bf16 v[112:127], v[152:155], a[16:19], v[112:127]
	ds_read_b64_tr_b16 v[148:149], v2 offset:30720
	ds_read_b64_tr_b16 v[150:151], v2 offset:31232
	s_waitcnt vmcnt(10)
	s_barrier
	v_mul_f32 v187, v21, v37
	v_fma_f32 v184, v184, v13, v13
	v_mfma_f32_32x32x16_bf16 v[128:143], v[156:159], a[16:19], v[128:143]
	ds_read_b64_tr_b16 v[152:153], v2 offset:12544
	ds_read_b64_tr_b16 v[154:155], v2 offset:13056
	v_add_u32 v6, 0x144000, v6
	s_add_u32 m0, s37, 110592
	v_fma_f32 v185, v185, v13, v13
	s_waitcnt lgkmcnt(6)
	v_mfma_f32_32x32x16_bf16 v[80:95], v[160:163], a[20:23], v[80:95]
	ds_read_b64_tr_b16 v[156:157], v2 offset:30976
	ds_read_b64_tr_b16 v[158:159], v2 offset:31488
	v_rcp_f32 v184, v184
	v_rcp_f32 v185, v185
	v_mfma_f32_32x32x16_bf16 v[96:111], v[164:167], a[20:23], v[96:111]
	ds_read_b64_tr_b16 v[160:161], v2 offset:14336
	ds_read_b64_tr_b16 v[162:163], v2 offset:14848
	buffer_load_dwordx4 v6, s[12:15], s40 offen lds
	s_add_u32 m0, s37, 111616
	v_mul_f32 v186, v186, v184
	v_mfma_f32_32x32x16_bf16 v[112:127], v[168:171], a[20:23], v[112:127]
	ds_read_b64_tr_b16 v[164:165], v2 offset:32768
	ds_read_b64_tr_b16 v[166:167], v2 offset:33280
	v_mul_f32 v187, v187, v185
	v_cvt_pk_bf16_f32 v194, v186, v187
	v_mul_f32 v188, v22, v22
	v_mul_f32 v189, v23, v23
	v_mfma_f32_32x32x16_bf16 v[128:143], v[172:175], a[20:23], v[128:143]
	ds_read_b64_tr_b16 v[168:169], v2 offset:14592
	ds_read_b64_tr_b16 v[170:171], v2 offset:15104
	buffer_load_dwordx4 v6, s[12:15], s41 offen lds
	s_add_u32 m0, s37, 112640
	v_fma_f32 v188, v188, v11, v10
	s_waitcnt lgkmcnt(6)
	v_mfma_f32_32x32x16_bf16 v[80:95], v[144:147], a[24:27], v[80:95]
	ds_read_b64_tr_b16 v[172:173], v2 offset:33024
	ds_read_b64_tr_b16 v[174:175], v2 offset:33536
	v_fma_f32 v189, v189, v11, v10
	v_mul_f32 v188, v188, v22
	v_mul_f32 v189, v189, v23
	v_mfma_f32_32x32x16_bf16 v[96:111], v[148:151], a[24:27], v[96:111]
	ds_read_b64_tr_b16 v[144:145], v2 offset:16384
	ds_read_b64_tr_b16 v[146:147], v2 offset:16896
	buffer_load_dwordx4 v6, s[12:15], s42 offen lds
	s_add_u32 m0, s37, 113664
	v_mfma_f32_32x32x16_bf16 v[112:127], v[152:155], a[24:27], v[112:127]
	ds_read_b64_tr_b16 v[148:149], v2 offset:34816
	ds_read_b64_tr_b16 v[150:151], v2 offset:35328
	v_exp_f32 v188, v188
	v_exp_f32 v189, v189
	v_mul_f32 v190, v22, v38
	v_mfma_f32_32x32x16_bf16 v[128:143], v[156:159], a[24:27], v[128:143]
	ds_read_b64_tr_b16 v[152:153], v2 offset:16640
	ds_read_b64_tr_b16 v[154:155], v2 offset:17152
	buffer_load_dwordx4 v6, s[12:15], s43 offen lds
	s_add_u32 m0, s37, 114688
	v_mul_f32 v191, v23, v39
	s_waitcnt lgkmcnt(6)
	v_mfma_f32_32x32x16_bf16 v[80:95], v[160:163], a[28:31], v[80:95]
	ds_read_b64_tr_b16 v[156:157], v2 offset:35072
	ds_read_b64_tr_b16 v[158:159], v2 offset:35584
	v_fma_f32 v188, v188, v13, v13
	v_fma_f32 v189, v189, v13, v13
	v_mfma_f32_32x32x16_bf16 v[96:111], v[164:167], a[28:31], v[96:111]
	ds_read_b64_tr_b16 v[160:161], v3 offset:0
	ds_read_b64_tr_b16 v[162:163], v3 offset:512
	buffer_load_dwordx4 v6, s[12:15], s44 offen lds
	s_add_u32 m0, s37, 115712
	v_rcp_f32 v188, v188
	v_mfma_f32_32x32x16_bf16 v[112:127], v[168:171], a[28:31], v[112:127]
	ds_read_b64_tr_b16 v[164:165], v3 offset:18432
	ds_read_b64_tr_b16 v[166:167], v3 offset:18944
	v_rcp_f32 v189, v189
	v_mul_f32 v190, v190, v188
	v_mul_f32 v191, v191, v189
	v_mfma_f32_32x32x16_bf16 v[128:143], v[172:175], a[28:31], v[128:143]
	ds_read_b64_tr_b16 v[168:169], v3 offset:256
	ds_read_b64_tr_b16 v[170:171], v3 offset:768
	buffer_load_dwordx4 v6, s[12:15], s45 offen lds
	s_add_u32 m0, s37, 116736
	v_cvt_pk_bf16_f32 v195, v190, v191
	s_waitcnt lgkmcnt(6)
	v_mfma_f32_32x32x16_bf16 v[80:95], v[144:147], a[32:35], v[80:95]
	ds_read_b64_tr_b16 v[172:173], v3 offset:18688
	ds_read_b64_tr_b16 v[174:175], v3 offset:19200
	s_add_u32 s65, s63, 4096
	buffer_store_dwordx4 v[192:195], v8, s[8:11], s65 offen offset:0 sc1
	v_mfma_f32_32x32x16_bf16 v[96:111], v[148:151], a[32:35], v[96:111]
	ds_read_b64_tr_b16 v[144:145], v3 offset:2048
	ds_read_b64_tr_b16 v[146:147], v3 offset:2560
	buffer_load_dwordx4 v6, s[12:15], s46 offen lds
	s_add_u32 m0, s37, 117760
	v_mul_f32 v176, v24, v24
	v_mfma_f32_32x32x16_bf16 v[112:127], v[152:155], a[32:35], v[112:127]
	ds_read_b64_tr_b16 v[148:149], v3 offset:20480
	ds_read_b64_tr_b16 v[150:151], v3 offset:20992
	v_mul_f32 v177, v25, v25
	v_fma_f32 v176, v176, v11, v10
	v_fma_f32 v177, v177, v11, v10
	v_mul_f32 v176, v176, v24
	v_mfma_f32_32x32x16_bf16 v[128:143], v[156:159], a[32:35], v[128:143]
	ds_read_b64_tr_b16 v[152:153], v3 offset:2304
	ds_read_b64_tr_b16 v[154:155], v3 offset:2816
	buffer_load_dwordx4 v6, s[12:15], s47 offen lds
	s_add_u32 m0, s37, 118784
	v_mul_f32 v177, v177, v25
	s_waitcnt lgkmcnt(6)
	v_mfma_f32_32x32x16_bf16 v[80:95], v[160:163], a[36:39], v[80:95]
	ds_read_b64_tr_b16 v[156:157], v3 offset:20736
	ds_read_b64_tr_b16 v[158:159], v3 offset:21248
	v_exp_f32 v176, v176
	v_mfma_f32_32x32x16_bf16 v[96:111], v[164:167], a[36:39], v[96:111]
	ds_read_b64_tr_b16 v[160:161], v3 offset:4096
	ds_read_b64_tr_b16 v[162:163], v3 offset:4608
	buffer_load_dwordx4 v6, s[12:15], s48 offen lds
	v_exp_f32 v177, v177
	v_mul_f32 v178, v24, v40
	v_mfma_f32_32x32x16_bf16 v[112:127], v[168:171], a[36:39], v[112:127]
	ds_read_b64_tr_b16 v[164:165], v3 offset:22528
	ds_read_b64_tr_b16 v[166:167], v3 offset:23040
	v_mul_f32 v179, v25, v41
	v_fma_f32 v176, v176, v13, v13
	v_fma_f32 v177, v177, v13, v13
	v_mfma_f32_32x32x16_bf16 v[128:143], v[172:175], a[36:39], v[128:143]
	ds_read_b64_tr_b16 v[168:169], v3 offset:4352
	ds_read_b64_tr_b16 v[170:171], v3 offset:4864
	v_rcp_f32 v176, v176
	v_rcp_f32 v177, v177
	v_mul_f32 v178, v178, v176
	s_waitcnt lgkmcnt(6)
	v_mfma_f32_32x32x16_bf16 v[80:95], v[144:147], a[40:43], v[80:95]
	ds_read_b64_tr_b16 v[172:173], v3 offset:22784
	ds_read_b64_tr_b16 v[174:175], v3 offset:23296
	v_mul_f32 v179, v179, v177
	v_cvt_pk_bf16_f32 v196, v178, v179
	v_mul_f32 v180, v26, v26
	v_mfma_f32_32x32x16_bf16 v[96:111], v[148:151], a[40:43], v[96:111]
	ds_read_b64_tr_b16 v[144:145], v3 offset:6144
	ds_read_b64_tr_b16 v[146:147], v3 offset:6656
	v_mul_f32 v181, v27, v27
	v_fma_f32 v180, v180, v11, v10
	v_fma_f32 v181, v181, v11, v10
	v_mul_f32 v180, v180, v26
	v_mfma_f32_32x32x16_bf16 v[112:127], v[152:155], a[40:43], v[112:127]
	ds_read_b64_tr_b16 v[148:149], v3 offset:24576
	ds_read_b64_tr_b16 v[150:151], v3 offset:25088
	v_mul_f32 v181, v181, v27
	v_exp_f32 v180, v180
	v_mfma_f32_32x32x16_bf16 v[128:143], v[156:159], a[40:43], v[128:143]
	ds_read_b64_tr_b16 v[152:153], v3 offset:6400
	ds_read_b64_tr_b16 v[154:155], v3 offset:6912
	v_exp_f32 v181, v181
	v_mul_f32 v182, v26, v42
	v_mul_f32 v183, v27, v43
	v_fma_f32 v180, v180, v13, v13
	s_waitcnt lgkmcnt(6)
	v_mfma_f32_32x32x16_bf16 v[80:95], v[160:163], a[44:47], v[80:95]
	ds_read_b64_tr_b16 v[156:157], v3 offset:24832
	ds_read_b64_tr_b16 v[158:159], v3 offset:25344
	v_fma_f32 v181, v181, v13, v13
	v_rcp_f32 v180, v180
	v_mfma_f32_32x32x16_bf16 v[96:111], v[164:167], a[44:47], v[96:111]
	ds_read_b64_tr_b16 v[160:161], v3 offset:8192
	ds_read_b64_tr_b16 v[162:163], v3 offset:8704
	v_rcp_f32 v181, v181
	v_mul_f32 v182, v182, v180
	v_mul_f32 v183, v183, v181
	v_mfma_f32_32x32x16_bf16 v[112:127], v[168:171], a[44:47], v[112:127]
	ds_read_b64_tr_b16 v[164:165], v3 offset:26624
	ds_read_b64_tr_b16 v[166:167], v3 offset:27136
	v_cvt_pk_bf16_f32 v197, v182, v183
	v_mul_f32 v184, v28, v28
	v_mul_f32 v185, v29, v29
	v_fma_f32 v184, v184, v11, v10
	v_mfma_f32_32x32x16_bf16 v[128:143], v[172:175], a[44:47], v[128:143]
	ds_read_b64_tr_b16 v[168:169], v3 offset:8448
	ds_read_b64_tr_b16 v[170:171], v3 offset:8960
	v_fma_f32 v185, v185, v11, v10
	v_mul_f32 v184, v184, v28
	v_mul_f32 v185, v185, v29
	s_waitcnt lgkmcnt(6)
	v_mfma_f32_32x32x16_bf16 v[80:95], v[144:147], a[48:51], v[80:95]
	ds_read_b64_tr_b16 v[172:173], v3 offset:26880
	ds_read_b64_tr_b16 v[174:175], v3 offset:27392
	v_exp_f32 v184, v184
	v_exp_f32 v185, v185
	v_mfma_f32_32x32x16_bf16 v[96:111], v[148:151], a[48:51], v[96:111]
	ds_read_b64_tr_b16 v[144:145], v3 offset:10240
	ds_read_b64_tr_b16 v[146:147], v3 offset:10752
	v_mul_f32 v186, v28, v44
	v_mul_f32 v187, v29, v45
	v_fma_f32 v184, v184, v13, v13
	v_fma_f32 v185, v185, v13, v13
	v_mfma_f32_32x32x16_bf16 v[112:127], v[152:155], a[48:51], v[112:127]
	ds_read_b64_tr_b16 v[148:149], v3 offset:28672
	ds_read_b64_tr_b16 v[150:151], v3 offset:29184
	v_rcp_f32 v184, v184
	v_rcp_f32 v185, v185
	v_mfma_f32_32x32x16_bf16 v[128:143], v[156:159], a[48:51], v[128:143]
	ds_read_b64_tr_b16 v[152:153], v3 offset:10496
	ds_read_b64_tr_b16 v[154:155], v3 offset:11008
	v_mul_f32 v186, v186, v184
	v_mul_f32 v187, v187, v185
	v_cvt_pk_bf16_f32 v198, v186, v187
	v_mul_f32 v188, v30, v30
	s_waitcnt lgkmcnt(6)
	v_mfma_f32_32x32x16_bf16 v[80:95], v[160:163], a[52:55], v[80:95]
	ds_read_b64_tr_b16 v[156:157], v3 offset:28928
	ds_read_b64_tr_b16 v[158:159], v3 offset:29440
	v_mul_f32 v189, v31, v31
	v_fma_f32 v188, v188, v11, v10
	v_fma_f32 v189, v189, v11, v10
	v_mfma_f32_32x32x16_bf16 v[96:111], v[164:167], a[52:55], v[96:111]
	ds_read_b64_tr_b16 v[160:161], v3 offset:12288
	ds_read_b64_tr_b16 v[162:163], v3 offset:12800
	v_mul_f32 v188, v188, v30
	v_mul_f32 v189, v189, v31
	v_exp_f32 v188, v188
	v_mfma_f32_32x32x16_bf16 v[112:127], v[168:171], a[52:55], v[112:127]
	ds_read_b64_tr_b16 v[164:165], v3 offset:30720
	ds_read_b64_tr_b16 v[166:167], v3 offset:31232
	s_waitcnt vmcnt(10)
	s_barrier
	v_mov_b32 v222, 2
	v_mov_b32 v223, 0
	s_mov_b64 exec, 1
	buffer_store_dword v222, v223, s[8:11], s30 offen sc1
	s_mov_b64 exec, -1
	v_mfma_f32_32x32x16_bf16 v[128:143], v[172:175], a[52:55], v[128:143]
	ds_read_b64_tr_b16 v[168:169], v3 offset:12544
	ds_read_b64_tr_b16 v[170:171], v3 offset:13056
	s_add_u32 m0, s37, 0
	s_waitcnt lgkmcnt(6)
	v_mfma_f32_32x32x16_bf16 v[80:95], v[144:147], a[56:59], v[80:95]
	ds_read_b64_tr_b16 v[172:173], v3 offset:30976
	ds_read_b64_tr_b16 v[174:175], v3 offset:31488
	v_exp_f32 v189, v189
	v_mul_f32 v190, v30, v46
	v_mul_f32 v191, v31, v47
	v_mfma_f32_32x32x16_bf16 v[96:111], v[148:151], a[56:59], v[96:111]
	ds_read_b64_tr_b16 v[144:145], v3 offset:14336
	ds_read_b64_tr_b16 v[146:147], v3 offset:14848
	buffer_load_dwordx4 v7, s[12:15], s50 offen lds
	s_add_u32 m0, s37, 1024
	v_fma_f32 v188, v188, v13, v13
	v_mfma_f32_32x32x16_bf16 v[112:127], v[152:155], a[56:59], v[112:127]
	ds_read_b64_tr_b16 v[148:149], v3 offset:32768
	ds_read_b64_tr_b16 v[150:151], v3 offset:33280
	v_fma_f32 v189, v189, v13, v13
	v_rcp_f32 v188, v188
	v_mfma_f32_32x32x16_bf16 v[128:143], v[156:159], a[56:59], v[128:143]
	ds_read_b64_tr_b16 v[152:153], v3 offset:14592
	ds_read_b64_tr_b16 v[154:155], v3 offset:15104
	buffer_load_dwordx4 v7, s[12:15], s51 offen lds
	s_add_u32 m0, s37, 2048
	v_rcp_f32 v189, v189
	s_waitcnt lgkmcnt(6)
	v_mfma_f32_32x32x16_bf16 v[80:95], v[160:163], a[60:63], v[80:95]
	ds_read_b64_tr_b16 v[156:157], v3 offset:33024
	ds_read_b64_tr_b16 v[158:159], v3 offset:33536
	v_mul_f32 v190, v190, v188
	v_mul_f32 v191, v191, v189
	v_cvt_pk_bf16_f32 v199, v190, v191
	v_mfma_f32_32x32x16_bf16 v[96:111], v[164:167], a[60:63], v[96:111]
	ds_read_b64_tr_b16 v[160:161], v3 offset:16384
	ds_read_b64_tr_b16 v[162:163], v3 offset:16896
	buffer_load_dwordx4 v7, s[12:15], s52 offen lds
	s_add_u32 m0, s37, 3072
	s_add_u32 s65, s63, 4096
	v_mfma_f32_32x32x16_bf16 v[112:127], v[168:171], a[60:63], v[112:127]
	ds_read_b64_tr_b16 v[164:165], v3 offset:34816
	ds_read_b64_tr_b16 v[166:167], v3 offset:35328
	buffer_store_dwordx4 v[196:199], v8, s[8:11], s65 offen offset:512 sc1
	v_mul_f32 v176, v48, v48
	v_mul_f32 v177, v49, v49
	v_mfma_f32_32x32x16_bf16 v[128:143], v[172:175], a[60:63], v[128:143]
	ds_read_b64_tr_b16 v[168:169], v3 offset:16640
	ds_read_b64_tr_b16 v[170:171], v3 offset:17152
	buffer_load_dwordx4 v7, s[12:15], s53 offen lds
	s_add_u32 m0, s37, 4096
	v_fma_f32 v176, v176, v11, v10
	s_waitcnt lgkmcnt(6)
	v_mfma_f32_32x32x16_bf16 v[80:95], v[144:147], a[64:67], v[80:95]
	ds_read_b64_tr_b16 v[172:173], v3 offset:35072
	ds_read_b64_tr_b16 v[174:175], v3 offset:35584
	v_fma_f32 v177, v177, v11, v10
	v_mul_f32 v176, v176, v48
	v_mul_f32 v177, v177, v49
	v_mfma_f32_32x32x16_bf16 v[96:111], v[148:151], a[64:67], v[96:111]
	ds_read_b64_tr_b16 v[144:145], v4 offset:0
	ds_read_b64_tr_b16 v[146:147], v4 offset:512
	buffer_load_dwordx4 v7, s[12:15], s54 offen lds
	s_add_u32 m0, s37, 5120
	v_mfma_f32_32x32x16_bf16 v[112:127], v[152:155], a[64:67], v[112:127]
	ds_read_b64_tr_b16 v[148:149], v4 offset:18432
	ds_read_b64_tr_b16 v[150:151], v4 offset:18944
	v_exp_f32 v176, v176
	v_exp_f32 v177, v177
	v_mul_f32 v178, v48, v64
	v_mfma_f32_32x32x16_bf16 v[128:143], v[156:159], a[64:67], v[128:143]
	ds_read_b64_tr_b16 v[152:153], v4 offset:256
	ds_read_b64_tr_b16 v[154:155], v4 offset:768
	buffer_load_dwordx4 v7, s[12:15], s55 offen lds
	s_add_u32 m0, s37, 6144
	v_mul_f32 v179, v49, v65
	s_waitcnt lgkmcnt(6)
	v_mfma_f32_32x32x16_bf16 v[80:95], v[160:163], a[68:71], v[80:95]
	ds_read_b64_tr_b16 v[156:157], v4 offset:18688
	ds_read_b64_tr_b16 v[158:159], v4 offset:19200
	v_fma_f32 v176, v176, v13, v13
	v_fma_f32 v177, v177, v13, v13
	v_mfma_f32_32x32x16_bf16 v[96:111], v[164:167], a[68:71], v[96:111]
	ds_read_b64_tr_b16 v[160:161], v4 offset:2048
	ds_read_b64_tr_b16 v[162:163], v4 offset:2560
	buffer_load_dwordx4 v7, s[12:15], s56 offen lds
	s_add_u32 m0, s37, 7168
	v_rcp_f32 v176, v176
	v_mfma_f32_32x32x16_bf16 v[112:127], v[168:171], a[68:71], v[112:127]
	ds_read_b64_tr_b16 v[164:165], v4 offset:20480
	ds_read_b64_tr_b16 v[166:167], v4 offset:20992
	v_rcp_f32 v177, v177
	v_mul_f32 v178, v178, v176
	v_mul_f32 v179, v179, v177
	v_mfma_f32_32x32x16_bf16 v[128:143], v[172:175], a[68:71], v[128:143]
	ds_read_b64_tr_b16 v[168:169], v4 offset:2304
	ds_read_b64_tr_b16 v[170:171], v4 offset:2816
	buffer_load_dwordx4 v7, s[12:15], s57 offen lds
	s_add_u32 m0, s37, 8192
	v_cvt_pk_bf16_f32 v200, v178, v179
	s_waitcnt lgkmcnt(6)
	v_mfma_f32_32x32x16_bf16 v[80:95], v[144:147], a[72:75], v[80:95]
	ds_read_b64_tr_b16 v[172:173], v4 offset:20736
	ds_read_b64_tr_b16 v[174:175], v4 offset:21248
	v_mul_f32 v180, v50, v50
	v_mul_f32 v181, v51, v51
	v_fma_f32 v180, v180, v11, v10
	v_mfma_f32_32x32x16_bf16 v[96:111], v[148:151], a[72:75], v[96:111]
	ds_read_b64_tr_b16 v[144:145], v4 offset:4096
	ds_read_b64_tr_b16 v[146:147], v4 offset:4608
	buffer_load_dwordx4 v7, s[12:15], s58 offen lds
	v_fma_f32 v181, v181, v11, v10
	v_mul_f32 v180, v180, v50
	v_mfma_f32_32x32x16_bf16 v[112:127], v[152:155], a[72:75], v[112:127]
	ds_read_b64_tr_b16 v[148:149], v4 offset:22528
	ds_read_b64_tr_b16 v[150:151], v4 offset:23040
	v_mul_f32 v181, v181, v51
	v_exp_f32 v180, v180
	v_mfma_f32_32x32x16_bf16 v[128:143], v[156:159], a[72:75], v[128:143]
	ds_read_b64_tr_b16 v[152:153], v4 offset:4352
	ds_read_b64_tr_b16 v[154:155], v4 offset:4864
	v_exp_f32 v181, v181
	v_mul_f32 v182, v50, v66
	v_mul_f32 v183, v51, v67
	v_fma_f32 v180, v180, v13, v13
	s_waitcnt lgkmcnt(6)
	v_mfma_f32_32x32x16_bf16 v[80:95], v[160:163], a[76:79], v[80:95]
	ds_read_b64_tr_b16 v[156:157], v4 offset:22784
	ds_read_b64_tr_b16 v[158:159], v4 offset:23296
	v_fma_f32 v181, v181, v13, v13
	v_rcp_f32 v180, v180
	v_mfma_f32_32x32x16_bf16 v[96:111], v[164:167], a[76:79], v[96:111]
	ds_read_b64_tr_b16 v[160:161], v4 offset:6144
	ds_read_b64_tr_b16 v[162:163], v4 offset:6656
	v_rcp_f32 v181, v181
	v_mul_f32 v182, v182, v180
	v_mul_f32 v183, v183, v181
	v_mfma_f32_32x32x16_bf16 v[112:127], v[168:171], a[76:79], v[112:127]
	ds_read_b64_tr_b16 v[164:165], v4 offset:24576
	ds_read_b64_tr_b16 v[166:167], v4 offset:25088
	v_cvt_pk_bf16_f32 v201, v182, v183
	v_mul_f32 v184, v52, v52
	v_mul_f32 v185, v53, v53
	v_fma_f32 v184, v184, v11, v10
	v_mfma_f32_32x32x16_bf16 v[128:143], v[172:175], a[76:79], v[128:143]
	ds_read_b64_tr_b16 v[168:169], v4 offset:6400
	ds_read_b64_tr_b16 v[170:171], v4 offset:6912
	v_fma_f32 v185, v185, v11, v10
	v_mul_f32 v184, v184, v52
	v_mul_f32 v185, v185, v53
	s_waitcnt lgkmcnt(6)
	v_mfma_f32_32x32x16_bf16 v[80:95], v[144:147], a[80:83], v[80:95]
	ds_read_b64_tr_b16 v[172:173], v4 offset:24832
	ds_read_b64_tr_b16 v[174:175], v4 offset:25344
	v_exp_f32 v184, v184
	v_exp_f32 v185, v185
	v_mfma_f32_32x32x16_bf16 v[96:111], v[148:151], a[80:83], v[96:111]
	ds_read_b64_tr_b16 v[144:145], v4 offset:8192
	ds_read_b64_tr_b16 v[146:147], v4 offset:8704
	v_mul_f32 v186, v52, v68
	v_mul_f32 v187, v53, v69
	v_fma_f32 v184, v184, v13, v13
	v_fma_f32 v185, v185, v13, v13
	v_mfma_f32_32x32x16_bf16 v[112:127], v[152:155], a[80:83], v[112:127]
	ds_read_b64_tr_b16 v[148:149], v4 offset:26624
	ds_read_b64_tr_b16 v[150:151], v4 offset:27136
	v_rcp_f32 v184, v184
	v_rcp_f32 v185, v185
	v_mfma_f32_32x32x16_bf16 v[128:143], v[156:159], a[80:83], v[128:143]
	ds_read_b64_tr_b16 v[152:153], v4 offset:8448
	ds_read_b64_tr_b16 v[154:155], v4 offset:8960
	v_mul_f32 v186, v186, v184
	v_mul_f32 v187, v187, v185
	v_cvt_pk_bf16_f32 v202, v186, v187
	v_mul_f32 v188, v54, v54
	s_waitcnt lgkmcnt(6)
	v_mfma_f32_32x32x16_bf16 v[80:95], v[160:163], a[84:87], v[80:95]
	ds_read_b64_tr_b16 v[156:157], v4 offset:26880
	ds_read_b64_tr_b16 v[158:159], v4 offset:27392
	v_mul_f32 v189, v55, v55
	v_fma_f32 v188, v188, v11, v10
	v_fma_f32 v189, v189, v11, v10
	v_mfma_f32_32x32x16_bf16 v[96:111], v[164:167], a[84:87], v[96:111]
	ds_read_b64_tr_b16 v[160:161], v4 offset:10240
	ds_read_b64_tr_b16 v[162:163], v4 offset:10752
	v_mul_f32 v188, v188, v54
	v_mul_f32 v189, v189, v55
	v_exp_f32 v188, v188
	v_mfma_f32_32x32x16_bf16 v[112:127], v[168:171], a[84:87], v[112:127]
	ds_read_b64_tr_b16 v[164:165], v4 offset:28672
	ds_read_b64_tr_b16 v[166:167], v4 offset:29184
	v_exp_f32 v189, v189
	v_mul_f32 v190, v54, v70
	v_mul_f32 v191, v55, v71
	v_mfma_f32_32x32x16_bf16 v[128:143], v[172:175], a[84:87], v[128:143]
	ds_read_b64_tr_b16 v[168:169], v4 offset:10496
	ds_read_b64_tr_b16 v[170:171], v4 offset:11008
	v_fma_f32 v188, v188, v13, v13
	v_fma_f32 v189, v189, v13, v13
	v_rcp_f32 v188, v188
	s_waitcnt lgkmcnt(6)
	v_mfma_f32_32x32x16_bf16 v[80:95], v[144:147], a[88:91], v[80:95]
	ds_read_b64_tr_b16 v[172:173], v4 offset:28928
	ds_read_b64_tr_b16 v[174:175], v4 offset:29440
	v_rcp_f32 v189, v189
	v_mul_f32 v190, v190, v188
	v_mfma_f32_32x32x16_bf16 v[96:111], v[148:151], a[88:91], v[96:111]
	ds_read_b64_tr_b16 v[144:145], v4 offset:12288
	ds_read_b64_tr_b16 v[146:147], v4 offset:12800
	v_mul_f32 v191, v191, v189
	v_cvt_pk_bf16_f32 v203, v190, v191
	s_add_u32 s65, s63, 5120
	v_mfma_f32_32x32x16_bf16 v[112:127], v[152:155], a[88:91], v[112:127]
	ds_read_b64_tr_b16 v[148:149], v4 offset:30720
	ds_read_b64_tr_b16 v[150:151], v4 offset:31232
	s_waitcnt vmcnt(11)
	s_barrier
	buffer_store_dwordx4 v[200:203], v8, s[8:11], s65 offen offset:0 sc1
	v_mul_f32 v176, v56, v56
	v_mfma_f32_32x32x16_bf16 v[128:143], v[156:159], a[88:91], v[128:143]
	ds_read_b64_tr_b16 v[152:153], v4 offset:12544
	ds_read_b64_tr_b16 v[154:155], v4 offset:13056
	v_add_u32 v7, 0x288000, v7
	s_add_u32 m0, s37, 36864
	v_mul_f32 v177, v57, v57
	v_fma_f32 v176, v176, v11, v10
	s_waitcnt lgkmcnt(6)
	v_mfma_f32_32x32x16_bf16 v[80:95], v[160:163], a[92:95], v[80:95]
	ds_read_b64_tr_b16 v[156:157], v4 offset:30976
	ds_read_b64_tr_b16 v[158:159], v4 offset:31488
	v_fma_f32 v177, v177, v11, v10
	v_mul_f32 v176, v176, v56
	v_mul_f32 v177, v177, v57
	v_mfma_f32_32x32x16_bf16 v[96:111], v[164:167], a[92:95], v[96:111]
	ds_read_b64_tr_b16 v[160:161], v4 offset:14336
	ds_read_b64_tr_b16 v[162:163], v4 offset:14848
	buffer_load_dwordx4 v7, s[12:15], s50 offen lds
	s_add_u32 m0, s37, 37888
	v_mfma_f32_32x32x16_bf16 v[112:127], v[168:171], a[92:95], v[112:127]
	ds_read_b64_tr_b16 v[164:165], v4 offset:32768
	ds_read_b64_tr_b16 v[166:167], v4 offset:33280
	v_exp_f32 v176, v176
	v_exp_f32 v177, v177
	v_mul_f32 v178, v56, v72
	v_mfma_f32_32x32x16_bf16 v[128:143], v[172:175], a[92:95], v[128:143]
	ds_read_b64_tr_b16 v[168:169], v4 offset:14592
	ds_read_b64_tr_b16 v[170:171], v4 offset:15104
	buffer_load_dwordx4 v7, s[12:15], s51 offen lds
	s_add_u32 m0, s37, 38912
	v_mul_f32 v179, v57, v73
	s_waitcnt lgkmcnt(6)
	v_mfma_f32_32x32x16_bf16 v[80:95], v[144:147], a[96:99], v[80:95]
	ds_read_b64_tr_b16 v[172:173], v4 offset:33024
	ds_read_b64_tr_b16 v[174:175], v4 offset:33536
	v_fma_f32 v176, v176, v13, v13
	v_fma_f32 v177, v177, v13, v13
	v_mfma_f32_32x32x16_bf16 v[96:111], v[148:151], a[96:99], v[96:111]
	ds_read_b64_tr_b16 v[144:145], v4 offset:16384
	ds_read_b64_tr_b16 v[146:147], v4 offset:16896
	buffer_load_dwordx4 v7, s[12:15], s52 offen lds
	s_add_u32 m0, s37, 39936
	v_rcp_f32 v176, v176
	v_mfma_f32_32x32x16_bf16 v[112:127], v[152:155], a[96:99], v[112:127]
	ds_read_b64_tr_b16 v[148:149], v4 offset:34816
	ds_read_b64_tr_b16 v[150:151], v4 offset:35328
	v_rcp_f32 v177, v177
	v_mul_f32 v178, v178, v176
	v_mul_f32 v179, v179, v177
	v_mfma_f32_32x32x16_bf16 v[128:143], v[156:159], a[96:99], v[128:143]
	ds_read_b64_tr_b16 v[152:153], v4 offset:16640
	ds_read_b64_tr_b16 v[154:155], v4 offset:17152
	buffer_load_dwordx4 v7, s[12:15], s53 offen lds
	s_add_u32 m0, s37, 40960
	v_cvt_pk_bf16_f32 v204, v178, v179
	s_waitcnt lgkmcnt(6)
	v_mfma_f32_32x32x16_bf16 v[80:95], v[160:163], a[100:103], v[80:95]
	ds_read_b64_tr_b16 v[156:157], v4 offset:35072
	ds_read_b64_tr_b16 v[158:159], v4 offset:35584
	v_mul_f32 v180, v58, v58
	v_mul_f32 v181, v59, v59
	v_fma_f32 v180, v180, v11, v10
	v_mfma_f32_32x32x16_bf16 v[96:111], v[164:167], a[100:103], v[96:111]
	ds_read_b64_tr_b16 v[160:161], v5 offset:0
	ds_read_b64_tr_b16 v[162:163], v5 offset:512
	buffer_load_dwordx4 v7, s[12:15], s54 offen lds
	s_add_u32 m0, s37, 41984
	v_fma_f32 v181, v181, v11, v10
	v_mfma_f32_32x32x16_bf16 v[112:127], v[168:171], a[100:103], v[112:127]
	ds_read_b64_tr_b16 v[164:165], v5 offset:18432
	ds_read_b64_tr_b16 v[166:167], v5 offset:18944
	v_mul_f32 v180, v180, v58
	v_mul_f32 v181, v181, v59
	v_exp_f32 v180, v180
	v_mfma_f32_32x32x16_bf16 v[128:143], v[172:175], a[100:103], v[128:143]
	ds_read_b64_tr_b16 v[168:169], v5 offset:256
	ds_read_b64_tr_b16 v[170:171], v5 offset:768
	buffer_load_dwordx4 v7, s[12:15], s55 offen lds
	s_add_u32 m0, s37, 43008
	s_waitcnt lgkmcnt(6)
	v_mfma_f32_32x32x16_bf16 v[80:95], v[144:147], a[104:107], v[80:95]
	ds_read_b64_tr_b16 v[172:173], v5 offset:18688
	ds_read_b64_tr_b16 v[174:175], v5 offset:19200
	v_exp_f32 v181, v181
	v_mul_f32 v182, v58, v74
	v_mul_f32 v183, v59, v75
	v_mfma_f32_32x32x16_bf16 v[96:111], v[148:151], a[104:107], v[96:111]
	ds_read_b64_tr_b16 v[144:145], v5 offset:2048
	ds_read_b64_tr_b16 v[146:147], v5 offset:2560
	buffer_load_dwordx4 v7, s[12:15], s56 offen lds
	s_add_u32 m0, s37, 44032
	v_fma_f32 v180, v180, v13, v13
	v_mfma_f32_32x32x16_bf16 v[112:127], v[152:155], a[104:107], v[112:127]
	ds_read_b64_tr_b16 v[148:149], v5 offset:20480
	ds_read_b64_tr_b16 v[150:151], v5 offset:20992
	v_fma_f32 v181, v181, v13, v13
	v_rcp_f32 v180, v180
	v_mfma_f32_32x32x16_bf16 v[128:143], v[156:159], a[104:107], v[128:143]
	ds_read_b64_tr_b16 v[152:153], v5 offset:2304
	ds_read_b64_tr_b16 v[154:155], v5 offset:2816
	buffer_load_dwordx4 v7, s[12:15], s57 offen lds
	s_add_u32 m0, s37, 45056
	v_rcp_f32 v181, v181
	s_waitcnt lgkmcnt(6)
	v_mfma_f32_32x32x16_bf16 v[80:95], v[160:163], a[108:111], v[80:95]
	ds_read_b64_tr_b16 v[156:157], v5 offset:20736
	ds_read_b64_tr_b16 v[158:159], v5 offset:21248
	v_mul_f32 v182, v182, v180
	v_mul_f32 v183, v183, v181
	v_cvt_pk_bf16_f32 v205, v182, v183
	v_mfma_f32_32x32x16_bf16 v[96:111], v[164:167], a[108:111], v[96:111]
	ds_read_b64_tr_b16 v[160:161], v5 offset:4096
	ds_read_b64_tr_b16 v[162:163], v5 offset:4608
	buffer_load_dwordx4 v7, s[12:15], s58 offen lds
	v_mul_f32 v184, v60, v60
	v_mul_f32 v185, v61, v61
	v_mfma_f32_32x32x16_bf16 v[112:127], v[168:171], a[108:111], v[112:127]
	ds_read_b64_tr_b16 v[164:165], v5 offset:22528
	ds_read_b64_tr_b16 v[166:167], v5 offset:23040
	v_fma_f32 v184, v184, v11, v10
	v_fma_f32 v185, v185, v11, v10
	v_mul_f32 v184, v184, v60
	v_mul_f32 v185, v185, v61
	v_mfma_f32_32x32x16_bf16 v[128:143], v[172:175], a[108:111], v[128:143]
	ds_read_b64_tr_b16 v[168:169], v5 offset:4352
	ds_read_b64_tr_b16 v[170:171], v5 offset:4864
	v_exp_f32 v184, v184
	v_exp_f32 v185, v185
	s_waitcnt lgkmcnt(6)
	v_mfma_f32_32x32x16_bf16 v[80:95], v[144:147], a[112:115], v[80:95]
	ds_read_b64_tr_b16 v[172:173], v5 offset:22784
	ds_read_b64_tr_b16 v[174:175], v5 offset:23296
	v_mul_f32 v186, v60, v76
	v_mul_f32 v187, v61, v77
	v_fma_f32 v184, v184, v13, v13
	v_mfma_f32_32x32x16_bf16 v[96:111], v[148:151], a[112:115], v[96:111]
	ds_read_b64_tr_b16 v[144:145], v5 offset:6144
	ds_read_b64_tr_b16 v[146:147], v5 offset:6656
	v_fma_f32 v185, v185, v13, v13
	v_rcp_f32 v184, v184
	v_mfma_f32_32x32x16_bf16 v[112:127], v[152:155], a[112:115], v[112:127]
	ds_read_b64_tr_b16 v[148:149], v5 offset:24576
	ds_read_b64_tr_b16 v[150:151], v5 offset:25088
	v_rcp_f32 v185, v185
	v_mul_f32 v186, v186, v184
	v_mul_f32 v187, v187, v185
	v_cvt_pk_bf16_f32 v206, v186, v187
	v_mfma_f32_32x32x16_bf16 v[128:143], v[156:159], a[112:115], v[128:143]
	ds_read_b64_tr_b16 v[152:153], v5 offset:6400
	ds_read_b64_tr_b16 v[154:155], v5 offset:6912
	v_mul_f32 v188, v62, v62
	v_mul_f32 v189, v63, v63
	v_fma_f32 v188, v188, v11, v10
	v_fma_f32 v189, v189, v11, v10
	s_waitcnt lgkmcnt(6)
	v_mfma_f32_32x32x16_bf16 v[80:95], v[160:163], a[116:119], v[80:95]
	ds_read_b64_tr_b16 v[156:157], v5 offset:24832
	ds_read_b64_tr_b16 v[158:159], v5 offset:25344
	v_mul_f32 v188, v188, v62
	v_mul_f32 v189, v189, v63
	v_mfma_f32_32x32x16_bf16 v[96:111], v[164:167], a[116:119], v[96:111]
	ds_read_b64_tr_b16 v[160:161], v5 offset:8192
	ds_read_b64_tr_b16 v[162:163], v5 offset:8704
	v_exp_f32 v188, v188
	v_exp_f32 v189, v189
	v_mul_f32 v190, v62, v78
	v_mfma_f32_32x32x16_bf16 v[112:127], v[168:171], a[116:119], v[112:127]
	ds_read_b64_tr_b16 v[164:165], v5 offset:26624
	ds_read_b64_tr_b16 v[166:167], v5 offset:27136
	v_mul_f32 v191, v63, v79
	v_fma_f32 v188, v188, v13, v13
	v_fma_f32 v189, v189, v13, v13
	v_mfma_f32_32x32x16_bf16 v[128:143], v[172:175], a[116:119], v[128:143]
	ds_read_b64_tr_b16 v[168:169], v5 offset:8448
	ds_read_b64_tr_b16 v[170:171], v5 offset:8960
	v_rcp_f32 v188, v188
	v_rcp_f32 v189, v189
	v_mul_f32 v190, v190, v188
	s_waitcnt lgkmcnt(6)
	v_mfma_f32_32x32x16_bf16 v[80:95], v[144:147], a[120:123], v[80:95]
	ds_read_b64_tr_b16 v[172:173], v5 offset:26880
	ds_read_b64_tr_b16 v[174:175], v5 offset:27392
	v_mul_f32 v191, v191, v189
	v_cvt_pk_bf16_f32 v207, v190, v191
	s_add_u32 s65, s63, 5120
	v_mfma_f32_32x32x16_bf16 v[96:111], v[148:151], a[120:123], v[96:111]
	ds_read_b64_tr_b16 v[144:145], v5 offset:10240
	ds_read_b64_tr_b16 v[146:147], v5 offset:10752
	buffer_store_dwordx4 v[204:207], v8, s[8:11], s65 offen offset:512 sc1
	v_mfma_f32_32x32x16_bf16 v[112:127], v[152:155], a[120:123], v[112:127]
	ds_read_b64_tr_b16 v[148:149], v5 offset:28672
	ds_read_b64_tr_b16 v[150:151], v5 offset:29184
	v_mfma_f32_32x32x16_bf16 v[128:143], v[156:159], a[120:123], v[128:143]
	ds_read_b64_tr_b16 v[152:153], v5 offset:10496
	ds_read_b64_tr_b16 v[154:155], v5 offset:11008
	s_waitcnt lgkmcnt(6)
	v_mfma_f32_32x32x16_bf16 v[80:95], v[160:163], a[124:127], v[80:95]
	ds_read_b64_tr_b16 v[156:157], v5 offset:28928
	ds_read_b64_tr_b16 v[158:159], v5 offset:29440
	v_mfma_f32_32x32x16_bf16 v[96:111], v[164:167], a[124:127], v[96:111]
	ds_read_b64_tr_b16 v[160:161], v5 offset:12288
	ds_read_b64_tr_b16 v[162:163], v5 offset:12800
	v_mfma_f32_32x32x16_bf16 v[112:127], v[168:171], a[124:127], v[112:127]
	ds_read_b64_tr_b16 v[164:165], v5 offset:30720
	ds_read_b64_tr_b16 v[166:167], v5 offset:31232
	s_waitcnt vmcnt(11)
	s_barrier
	v_mfma_f32_32x32x16_bf16 v[128:143], v[172:175], a[124:127], v[128:143]
	ds_read_b64_tr_b16 v[168:169], v5 offset:12544
	ds_read_b64_tr_b16 v[170:171], v5 offset:13056
	s_add_u32 m0, s37, 73728
	s_add_u32 s33, s26, 0
	s_waitcnt lgkmcnt(6)
	v_mfma_f32_32x32x16_bf16 v[80:95], v[144:147], a[128:131], v[80:95]
	ds_read_b64_tr_b16 v[172:173], v5 offset:30976
	ds_read_b64_tr_b16 v[174:175], v5 offset:31488
	v_mfma_f32_32x32x16_bf16 v[96:111], v[148:151], a[128:131], v[96:111]
	ds_read_b64_tr_b16 v[144:145], v5 offset:14336
	ds_read_b64_tr_b16 v[146:147], v5 offset:14848
	buffer_load_dwordx4 v15, s[8:11], s33 offen offset:0 lds
	v_mfma_f32_32x32x16_bf16 v[112:127], v[152:155], a[128:131], v[112:127]
	ds_read_b64_tr_b16 v[148:149], v5 offset:32768
	ds_read_b64_tr_b16 v[150:151], v5 offset:33280
	v_mfma_f32_32x32x16_bf16 v[128:143], v[156:159], a[128:131], v[128:143]
	ds_read_b64_tr_b16 v[152:153], v5 offset:14592
	ds_read_b64_tr_b16 v[154:155], v5 offset:15104
	buffer_load_dwordx4 v15, s[8:11], s33 offen offset:1024 lds
	s_waitcnt lgkmcnt(6)
	v_mfma_f32_32x32x16_bf16 v[80:95], v[160:163], a[132:135], v[80:95]
	ds_read_b64_tr_b16 v[156:157], v5 offset:33024
	ds_read_b64_tr_b16 v[158:159], v5 offset:33536
	v_mfma_f32_32x32x16_bf16 v[96:111], v[164:167], a[132:135], v[96:111]
	ds_read_b64_tr_b16 v[160:161], v5 offset:16384
	ds_read_b64_tr_b16 v[162:163], v5 offset:16896
	buffer_load_dwordx4 v15, s[8:11], s33 offen offset:2048 lds
	v_mfma_f32_32x32x16_bf16 v[112:127], v[168:171], a[132:135], v[112:127]
	ds_read_b64_tr_b16 v[164:165], v5 offset:34816
	ds_read_b64_tr_b16 v[166:167], v5 offset:35328
	v_mfma_f32_32x32x16_bf16 v[128:143], v[172:175], a[132:135], v[128:143]
	ds_read_b64_tr_b16 v[168:169], v5 offset:16640
	ds_read_b64_tr_b16 v[170:171], v5 offset:17152
	buffer_load_dwordx4 v15, s[8:11], s33 offen offset:3072 lds
	s_waitcnt lgkmcnt(6)
	v_mfma_f32_32x32x16_bf16 v[80:95], v[144:147], a[136:139], v[80:95]
	ds_read_b64_tr_b16 v[172:173], v5 offset:35072
	ds_read_b64_tr_b16 v[174:175], v5 offset:35584
	v_mfma_f32_32x32x16_bf16 v[96:111], v[148:151], a[136:139], v[96:111]
	ds_read_b64_tr_b16 v[144:145], v2 offset:0
	ds_read_b64_tr_b16 v[146:147], v2 offset:512
	s_add_u32 m0, s37, 77824
	s_add_u32 s33, s26, 4096
	buffer_load_dwordx4 v15, s[8:11], s33 offen offset:0 lds
	v_mfma_f32_32x32x16_bf16 v[112:127], v[152:155], a[136:139], v[112:127]
	ds_read_b64_tr_b16 v[148:149], v2 offset:18432
	ds_read_b64_tr_b16 v[150:151], v2 offset:18944
	v_mfma_f32_32x32x16_bf16 v[128:143], v[156:159], a[136:139], v[128:143]
	ds_read_b64_tr_b16 v[152:153], v2 offset:256
	ds_read_b64_tr_b16 v[154:155], v2 offset:768
	buffer_load_dwordx4 v15, s[8:11], s33 offen offset:1024 lds
	s_waitcnt lgkmcnt(6)
	v_mfma_f32_32x32x16_bf16 v[80:95], v[160:163], a[140:143], v[80:95]
	ds_read_b64_tr_b16 v[156:157], v2 offset:18688
	ds_read_b64_tr_b16 v[158:159], v2 offset:19200
	v_mfma_f32_32x32x16_bf16 v[96:111], v[164:167], a[140:143], v[96:111]
	ds_read_b64_tr_b16 v[160:161], v2 offset:2048
	ds_read_b64_tr_b16 v[162:163], v2 offset:2560
	buffer_load_dwordx4 v15, s[8:11], s33 offen offset:2048 lds
	v_mfma_f32_32x32x16_bf16 v[112:127], v[168:171], a[140:143], v[112:127]
	ds_read_b64_tr_b16 v[164:165], v2 offset:20480
	ds_read_b64_tr_b16 v[166:167], v2 offset:20992
	v_mfma_f32_32x32x16_bf16 v[128:143], v[172:175], a[140:143], v[128:143]
	ds_read_b64_tr_b16 v[168:169], v2 offset:2304
	ds_read_b64_tr_b16 v[170:171], v2 offset:2816
	buffer_load_dwordx4 v15, s[8:11], s33 offen offset:3072 lds
	s_waitcnt lgkmcnt(6)
	v_mfma_f32_32x32x16_bf16 v[16:31], v[144:147], a[0:3], 0
	ds_read_b64_tr_b16 v[172:173], v2 offset:20736
	ds_read_b64_tr_b16 v[174:175], v2 offset:21248
	v_mfma_f32_32x32x16_bf16 v[32:47], v[148:151], a[0:3], 0
	ds_read_b64_tr_b16 v[144:145], v2 offset:4096
	ds_read_b64_tr_b16 v[146:147], v2 offset:4608
	s_add_u32 m0, s37, 81920
	s_add_u32 s33, s26, 8192
	buffer_load_dwordx4 v15, s[8:11], s33 offen offset:0 lds
	v_mfma_f32_32x32x16_bf16 v[16:31], v[152:155], a[4:7], v[16:31]
	ds_read_b64_tr_b16 v[148:149], v2 offset:22528
	ds_read_b64_tr_b16 v[150:151], v2 offset:23040
	v_mfma_f32_32x32x16_bf16 v[32:47], v[156:159], a[4:7], v[32:47]
	ds_read_b64_tr_b16 v[152:153], v2 offset:4352
	ds_read_b64_tr_b16 v[154:155], v2 offset:4864
	s_waitcnt lgkmcnt(6)
	v_mfma_f32_32x32x16_bf16 v[16:31], v[160:163], a[8:11], v[16:31]
	ds_read_b64_tr_b16 v[156:157], v2 offset:22784
	ds_read_b64_tr_b16 v[158:159], v2 offset:23296
	v_mul_f32 v176, v80, v80
	v_mul_f32 v177, v81, v81
	v_fma_f32 v176, v176, v11, v10
	v_fma_f32 v177, v177, v11, v10
	v_mfma_f32_32x32x16_bf16 v[32:47], v[164:167], a[8:11], v[32:47]
	ds_read_b64_tr_b16 v[160:161], v2 offset:6144
	ds_read_b64_tr_b16 v[162:163], v2 offset:6656
	v_mul_f32 v176, v176, v80
	v_mul_f32 v177, v177, v81
	v_exp_f32 v176, v176
	v_mfma_f32_32x32x16_bf16 v[16:31], v[168:171], a[12:15], v[16:31]
	ds_read_b64_tr_b16 v[164:165], v2 offset:24576
	ds_read_b64_tr_b16 v[166:167], v2 offset:25088
	v_exp_f32 v177, v177
	v_mul_f32 v178, v80, v96
	v_mul_f32 v179, v81, v97
	v_mfma_f32_32x32x16_bf16 v[32:47], v[172:175], a[12:15], v[32:47]
	ds_read_b64_tr_b16 v[168:169], v2 offset:6400
	ds_read_b64_tr_b16 v[170:171], v2 offset:6912
	v_fma_f32 v176, v176, v13, v13
	v_fma_f32 v177, v177, v13, v13
	v_rcp_f32 v176, v176
	s_waitcnt lgkmcnt(6)
	v_mfma_f32_32x32x16_bf16 v[16:31], v[144:147], a[16:19], v[16:31]
	ds_read_b64_tr_b16 v[172:173], v2 offset:24832
	ds_read_b64_tr_b16 v[174:175], v2 offset:25344
	v_rcp_f32 v177, v177
	v_mul_f32 v178, v178, v176
	v_mfma_f32_32x32x16_bf16 v[32:47], v[148:151], a[16:19], v[32:47]
	ds_read_b64_tr_b16 v[144:145], v2 offset:8192
	ds_read_b64_tr_b16 v[146:147], v2 offset:8704
	v_mul_f32 v179, v179, v177
	v_cvt_pk_bf16_f32 v192, v178, v179
	v_mul_f32 v180, v82, v82
	v_mul_f32 v181, v83, v83
	v_mfma_f32_32x32x16_bf16 v[16:31], v[152:155], a[20:23], v[16:31]
	ds_read_b64_tr_b16 v[148:149], v2 offset:26624
	ds_read_b64_tr_b16 v[150:151], v2 offset:27136
	v_fma_f32 v180, v180, v11, v10
	v_fma_f32 v181, v181, v11, v10
	v_mul_f32 v180, v180, v82
	v_mul_f32 v181, v181, v83
	buffer_load_dword v220, v221, s[8:11], s29 offen sc1
	v_mfma_f32_32x32x16_bf16 v[32:47], v[156:159], a[20:23], v[32:47]
	ds_read_b64_tr_b16 v[152:153], v2 offset:8448
	ds_read_b64_tr_b16 v[154:155], v2 offset:8960
	v_exp_f32 v180, v180
	v_exp_f32 v181, v181
	s_waitcnt lgkmcnt(6)
	v_mfma_f32_32x32x16_bf16 v[16:31], v[160:163], a[24:27], v[16:31]
	ds_read_b64_tr_b16 v[156:157], v2 offset:26880
	ds_read_b64_tr_b16 v[158:159], v2 offset:27392
	v_mul_f32 v182, v82, v98
	v_mul_f32 v183, v83, v99
	v_fma_f32 v180, v180, v13, v13
	v_mfma_f32_32x32x16_bf16 v[32:47], v[164:167], a[24:27], v[32:47]
	ds_read_b64_tr_b16 v[160:161], v2 offset:10240
	ds_read_b64_tr_b16 v[162:163], v2 offset:10752
	v_fma_f32 v181, v181, v13, v13
	v_rcp_f32 v180, v180
	v_mfma_f32_32x32x16_bf16 v[16:31], v[168:171], a[28:31], v[16:31]
	ds_read_b64_tr_b16 v[164:165], v2 offset:28672
	ds_read_b64_tr_b16 v[166:167], v2 offset:29184
	v_rcp_f32 v181, v181
	v_mul_f32 v182, v182, v180
	v_mul_f32 v183, v183, v181
	v_cvt_pk_bf16_f32 v193, v182, v183
	v_mfma_f32_32x32x16_bf16 v[32:47], v[172:175], a[28:31], v[32:47]
	ds_read_b64_tr_b16 v[168:169], v2 offset:10496
	ds_read_b64_tr_b16 v[170:171], v2 offset:11008
	v_mul_f32 v184, v84, v84
	v_mul_f32 v185, v85, v85
	v_fma_f32 v184, v184, v11, v10
	v_fma_f32 v185, v185, v11, v10
	s_waitcnt lgkmcnt(6)
	v_mfma_f32_32x32x16_bf16 v[16:31], v[144:147], a[32:35], v[16:31]
	ds_read_b64_tr_b16 v[172:173], v2 offset:28928
	ds_read_b64_tr_b16 v[174:175], v2 offset:29440
	v_mul_f32 v184, v184, v84
	v_mul_f32 v185, v185, v85
	v_mfma_f32_32x32x16_bf16 v[32:47], v[148:151], a[32:35], v[32:47]
	ds_read_b64_tr_b16 v[144:145], v2 offset:12288
	ds_read_b64_tr_b16 v[146:147], v2 offset:12800
	v_exp_f32 v184, v184
	v_exp_f32 v185, v185
	v_mul_f32 v186, v84, v100
	v_mfma_f32_32x32x16_bf16 v[16:31], v[152:155], a[36:39], v[16:31]
	ds_read_b64_tr_b16 v[148:149], v2 offset:30720
	ds_read_b64_tr_b16 v[150:151], v2 offset:31232
	s_waitcnt vmcnt(11)
	s_barrier
	v_mul_f32 v187, v85, v101
	v_fma_f32 v184, v184, v13, v13
	v_mfma_f32_32x32x16_bf16 v[32:47], v[156:159], a[36:39], v[32:47]
	ds_read_b64_tr_b16 v[152:153], v2 offset:12544
	ds_read_b64_tr_b16 v[154:155], v2 offset:13056
	s_add_u32 m0, s37, 110592
	s_add_u32 s33, s27, 0
	v_fma_f32 v185, v185, v13, v13
	s_waitcnt lgkmcnt(6)
	v_mfma_f32_32x32x16_bf16 v[16:31], v[160:163], a[40:43], v[16:31]
	ds_read_b64_tr_b16 v[156:157], v2 offset:30976
	ds_read_b64_tr_b16 v[158:159], v2 offset:31488
	v_rcp_f32 v184, v184
	v_rcp_f32 v185, v185
	v_mfma_f32_32x32x16_bf16 v[32:47], v[164:167], a[40:43], v[32:47]
	ds_read_b64_tr_b16 v[160:161], v2 offset:14336
	ds_read_b64_tr_b16 v[162:163], v2 offset:14848
	buffer_load_dwordx4 v15, s[8:11], s33 offen offset:0 lds
	v_mul_f32 v186, v186, v184
	v_mul_f32 v187, v187, v185
	v_mfma_f32_32x32x16_bf16 v[16:31], v[168:171], a[44:47], v[16:31]
	ds_read_b64_tr_b16 v[164:165], v2 offset:32768
	ds_read_b64_tr_b16 v[166:167], v2 offset:33280
	v_cvt_pk_bf16_f32 v194, v186, v187
	v_mul_f32 v188, v86, v86
	v_mul_f32 v189, v87, v87
	v_fma_f32 v188, v188, v11, v10
	v_mfma_f32_32x32x16_bf16 v[32:47], v[172:175], a[44:47], v[32:47]
	ds_read_b64_tr_b16 v[168:169], v2 offset:14592
	ds_read_b64_tr_b16 v[170:171], v2 offset:15104
	buffer_load_dwordx4 v15, s[8:11], s33 offen offset:1024 lds
	v_fma_f32 v189, v189, v11, v10
	v_mul_f32 v188, v188, v86
	s_waitcnt lgkmcnt(6)
	v_mfma_f32_32x32x16_bf16 v[16:31], v[144:147], a[48:51], v[16:31]
	ds_read_b64_tr_b16 v[172:173], v2 offset:33024
	ds_read_b64_tr_b16 v[174:175], v2 offset:33536
	v_mul_f32 v189, v189, v87
	v_exp_f32 v188, v188
	v_mfma_f32_32x32x16_bf16 v[32:47], v[148:151], a[48:51], v[32:47]
	ds_read_b64_tr_b16 v[144:145], v2 offset:16384
	ds_read_b64_tr_b16 v[146:147], v2 offset:16896
	buffer_load_dwordx4 v15, s[8:11], s33 offen offset:2048 lds
	v_exp_f32 v189, v189
	v_mfma_f32_32x32x16_bf16 v[16:31], v[152:155], a[52:55], v[16:31]
	ds_read_b64_tr_b16 v[148:149], v2 offset:34816
	ds_read_b64_tr_b16 v[150:151], v2 offset:35328
	v_mul_f32 v190, v86, v102
	v_mul_f32 v191, v87, v103
	v_fma_f32 v188, v188, v13, v13
	v_fma_f32 v189, v189, v13, v13
	v_mfma_f32_32x32x16_bf16 v[32:47], v[156:159], a[52:55], v[32:47]
	ds_read_b64_tr_b16 v[152:153], v2 offset:16640
	ds_read_b64_tr_b16 v[154:155], v2 offset:17152
	buffer_load_dwordx4 v15, s[8:11], s33 offen offset:3072 lds
	v_rcp_f32 v188, v188
	s_waitcnt lgkmcnt(6)
	v_mfma_f32_32x32x16_bf16 v[16:31], v[160:163], a[56:59], v[16:31]
	ds_read_b64_tr_b16 v[156:157], v2 offset:35072
	ds_read_b64_tr_b16 v[158:159], v2 offset:35584
	v_rcp_f32 v189, v189
	v_mul_f32 v190, v190, v188
	v_mfma_f32_32x32x16_bf16 v[32:47], v[164:167], a[56:59], v[32:47]
	ds_read_b64_tr_b16 v[160:161], v3 offset:0
	ds_read_b64_tr_b16 v[162:163], v3 offset:512
	s_add_u32 m0, s37, 114688
	s_add_u32 s33, s27, 4096
	buffer_load_dwordx4 v15, s[8:11], s33 offen offset:0 lds
	v_mfma_f32_32x32x16_bf16 v[16:31], v[168:171], a[60:63], v[16:31]
	ds_read_b64_tr_b16 v[164:165], v3 offset:18432
	ds_read_b64_tr_b16 v[166:167], v3 offset:18944
	v_mul_f32 v191, v191, v189
	v_cvt_pk_bf16_f32 v195, v190, v191
	s_add_u32 s65, s63, 6144
	v_mfma_f32_32x32x16_bf16 v[32:47], v[172:175], a[60:63], v[32:47]
	ds_read_b64_tr_b16 v[168:169], v3 offset:256
	ds_read_b64_tr_b16 v[170:171], v3 offset:768
	buffer_load_dwordx4 v15, s[8:11], s33 offen offset:1024 lds
	buffer_store_dwordx4 v[192:195], v8, s[8:11], s65 offen offset:0 sc1
	v_mul_f32 v176, v88, v88
	s_waitcnt lgkmcnt(6)
	v_mfma_f32_32x32x16_bf16 v[16:31], v[144:147], a[64:67], v[16:31]
	ds_read_b64_tr_b16 v[172:173], v3 offset:18688
	ds_read_b64_tr_b16 v[174:175], v3 offset:19200
	v_mul_f32 v177, v89, v89
	v_fma_f32 v176, v176, v11, v10
	v_fma_f32 v177, v177, v11, v10
	v_mfma_f32_32x32x16_bf16 v[32:47], v[148:151], a[64:67], v[32:47]
	ds_read_b64_tr_b16 v[144:145], v3 offset:2048
	ds_read_b64_tr_b16 v[146:147], v3 offset:2560
	buffer_load_dwordx4 v15, s[8:11], s33 offen offset:2048 lds
	v_mul_f32 v176, v176, v88
	v_mul_f32 v177, v177, v89
	v_mfma_f32_32x32x16_bf16 v[16:31], v[152:155], a[68:71], v[16:31]
	ds_read_b64_tr_b16 v[148:149], v3 offset:20480
	ds_read_b64_tr_b16 v[150:151], v3 offset:20992
	v_exp_f32 v176, v176
	v_exp_f32 v177, v177
	v_mfma_f32_32x32x16_bf16 v[32:47], v[156:159], a[68:71], v[32:47]
	ds_read_b64_tr_b16 v[152:153], v3 offset:2304
	ds_read_b64_tr_b16 v[154:155], v3 offset:2816
	buffer_load_dwordx4 v15, s[8:11], s33 offen offset:3072 lds
	v_mul_f32 v178, v88, v104
	v_mul_f32 v179, v89, v105
	s_waitcnt vmcnt(9)
	v_cmp_gt_u32 vcc, 2, v220
	s_waitcnt lgkmcnt(6)
	v_mfma_f32_32x32x16_bf16 v[16:31], v[160:163], a[72:75], v[16:31]
	ds_read_b64_tr_b16 v[156:157], v3 offset:20736
	ds_read_b64_tr_b16 v[158:159], v3 offset:21248
	v_fma_f32 v176, v176, v13, v13
	v_fma_f32 v177, v177, v13, v13
	v_mfma_f32_32x32x16_bf16 v[32:47], v[164:167], a[72:75], v[32:47]
	ds_read_b64_tr_b16 v[160:161], v3 offset:4096
	ds_read_b64_tr_b16 v[162:163], v3 offset:4608
	s_add_u32 m0, s37, 118784
	s_add_u32 s33, s27, 8192
	buffer_load_dwordx4 v15, s[8:11], s33 offen offset:0 lds
	s_cbranch_vccnz L_k3_spin1
L_k3_back1:
	v_mfma_f32_32x32x16_bf16 v[16:31], v[168:171], a[76:79], v[16:31]
	ds_read_b64_tr_b16 v[164:165], v3 offset:22528
	ds_read_b64_tr_b16 v[166:167], v3 offset:23040
	v_rcp_f32 v176, v176
	v_rcp_f32 v177, v177
	v_mul_f32 v178, v178, v176
	v_mfma_f32_32x32x16_bf16 v[32:47], v[172:175], a[76:79], v[32:47]
	ds_read_b64_tr_b16 v[168:169], v3 offset:4352
	ds_read_b64_tr_b16 v[170:171], v3 offset:4864
	v_mul_f32 v179, v179, v177
	v_cvt_pk_bf16_f32 v196, v178, v179
	v_mul_f32 v180, v90, v90
	v_mul_f32 v181, v91, v91
	s_add_u32 s34, s23, 0
	buffer_load_dwordx4 a[0:3], v15, s[8:11], s34 offen sc1
	s_waitcnt lgkmcnt(6)
	v_mfma_f32_32x32x16_bf16 v[16:31], v[144:147], a[80:83], v[16:31]
	ds_read_b64_tr_b16 v[172:173], v3 offset:22784
	ds_read_b64_tr_b16 v[174:175], v3 offset:23296
	v_fma_f32 v180, v180, v11, v10
	v_fma_f32 v181, v181, v11, v10
	v_mul_f32 v180, v180, v90
	v_mfma_f32_32x32x16_bf16 v[32:47], v[148:151], a[80:83], v[32:47]
	ds_read_b64_tr_b16 v[144:145], v3 offset:6144
	ds_read_b64_tr_b16 v[146:147], v3 offset:6656
	v_mul_f32 v181, v181, v91
	v_exp_f32 v180, v180
	v_mfma_f32_32x32x16_bf16 v[16:31], v[152:155], a[84:87], v[16:31]
	ds_read_b64_tr_b16 v[148:149], v3 offset:24576
	ds_read_b64_tr_b16 v[150:151], v3 offset:25088
	v_exp_f32 v181, v181
	v_mul_f32 v182, v90, v106
	v_mul_f32 v183, v91, v107
	v_fma_f32 v180, v180, v13, v13
	s_add_u32 s34, s25, 0
	buffer_load_dwordx4 a[4:7], v15, s[8:11], s34 offen sc1
	v_mfma_f32_32x32x16_bf16 v[32:47], v[156:159], a[84:87], v[32:47]
	ds_read_b64_tr_b16 v[152:153], v3 offset:6400
	ds_read_b64_tr_b16 v[154:155], v3 offset:6912
	v_fma_f32 v181, v181, v13, v13
	v_rcp_f32 v180, v180
	s_waitcnt lgkmcnt(6)
	v_mfma_f32_32x32x16_bf16 v[16:31], v[160:163], a[88:91], v[16:31]
	ds_read_b64_tr_b16 v[156:157], v3 offset:24832
	ds_read_b64_tr_b16 v[158:159], v3 offset:25344
	v_rcp_f32 v181, v181
	v_mul_f32 v182, v182, v180
	v_mul_f32 v183, v183, v181
	v_mfma_f32_32x32x16_bf16 v[32:47], v[164:167], a[88:91], v[32:47]
	ds_read_b64_tr_b16 v[160:161], v3 offset:8192
	ds_read_b64_tr_b16 v[162:163], v3 offset:8704
	v_cvt_pk_bf16_f32 v197, v182, v183
	v_mul_f32 v184, v92, v92
	v_mul_f32 v185, v93, v93
	v_fma_f32 v184, v184, v11, v10
	s_add_u32 s34, s23, 1024
	buffer_load_dwordx4 a[8:11], v15, s[8:11], s34 offen sc1
	v_mfma_f32_32x32x16_bf16 v[16:31], v[168:171], a[92:95], v[16:31]
	ds_read_b64_tr_b16 v[164:165], v3 offset:26624
	ds_read_b64_tr_b16 v[166:167], v3 offset:27136
	v_fma_f32 v185, v185, v11, v10
	v_mul_f32 v184, v184, v92
	v_mul_f32 v185, v185, v93
	v_mfma_f32_32x32x16_bf16 v[32:47], v[172:175], a[92:95], v[32:47]
	ds_read_b64_tr_b16 v[168:169], v3 offset:8448
	ds_read_b64_tr_b16 v[170:171], v3 offset:8960
	v_exp_f32 v184, v184
	v_exp_f32 v185, v185
	v_mul_f32 v186, v92, v108
	s_waitcnt lgkmcnt(6)
	v_mfma_f32_32x32x16_bf16 v[16:31], v[144:147], a[96:99], v[16:31]
	ds_read_b64_tr_b16 v[172:173], v3 offset:26880
	ds_read_b64_tr_b16 v[174:175], v3 offset:27392
	v_mul_f32 v187, v93, v109
	v_fma_f32 v184, v184, v13, v13
	v_fma_f32 v185, v185, v13, v13
	s_add_u32 s34, s25, 1024
	buffer_load_dwordx4 a[12:15], v15, s[8:11], s34 offen sc1
	v_mfma_f32_32x32x16_bf16 v[32:47], v[148:151], a[96:99], v[32:47]
	ds_read_b64_tr_b16 v[144:145], v3 offset:10240
	ds_read_b64_tr_b16 v[146:147], v3 offset:10752
	v_rcp_f32 v184, v184
	v_rcp_f32 v185, v185
	v_mfma_f32_32x32x16_bf16 v[16:31], v[152:155], a[100:103], v[16:31]
	ds_read_b64_tr_b16 v[148:149], v3 offset:28672
	ds_read_b64_tr_b16 v[150:151], v3 offset:29184
	v_mul_f32 v186, v186, v184
	v_mul_f32 v187, v187, v185
	v_cvt_pk_bf16_f32 v198, v186, v187
	v_mul_f32 v188, v94, v94
	v_mfma_f32_32x32x16_bf16 v[32:47], v[156:159], a[100:103], v[32:47]
	ds_read_b64_tr_b16 v[152:153], v3 offset:10496
	ds_read_b64_tr_b16 v[154:155], v3 offset:11008
	v_mul_f32 v189, v95, v95
	v_fma_f32 v188, v188, v11, v10
	v_fma_f32 v189, v189, v11, v10
	v_mul_f32 v188, v188, v94
	s_add_u32 s34, s23, 10240
	buffer_load_dwordx4 a[16:19], v15, s[8:11], s34 offen sc1
	s_waitcnt lgkmcnt(6)
	v_mfma_f32_32x32x16_bf16 v[16:31], v[160:163], a[104:107], v[16:31]
	ds_read_b64_tr_b16 v[156:157], v3 offset:28928
	ds_read_b64_tr_b16 v[158:159], v3 offset:29440
	v_mul_f32 v189, v189, v95
	v_exp_f32 v188, v188
	v_mfma_f32_32x32x16_bf16 v[32:47], v[164:167], a[104:107], v[32:47]
	ds_read_b64_tr_b16 v[160:161], v3 offset:12288
	ds_read_b64_tr_b16 v[162:163], v3 offset:12800
	v_exp_f32 v189, v189
	v_mul_f32 v190, v94, v110
	v_mul_f32 v191, v95, v111
	v_mfma_f32_32x32x16_bf16 v[16:31], v[168:171], a[108:111], v[16:31]
	ds_read_b64_tr_b16 v[164:165], v3 offset:30720
	ds_read_b64_tr_b16 v[166:167], v3 offset:31232
	s_barrier
	v_mov_b32 v222, 3
	v_mov_b32 v223, 0
	s_mov_b64 exec, 1
	buffer_store_dword v222, v223, s[8:11], s30 offen sc1
	s_mov_b64 exec, -1
	s_add_u32 s34, s25, 10240
	buffer_load_dwordx4 a[20:23], v15, s[8:11], s34 offen sc1
	v_mfma_f32_32x32x16_bf16 v[32:47], v[172:175], a[108:111], v[32:47]
	ds_read_b64_tr_b16 v[168:169], v3 offset:12544
	ds_read_b64_tr_b16 v[170:171], v3 offset:13056
	s_add_u32 m0, s37, 0
	s_add_u32 s33, s26, 18432
	s_waitcnt lgkmcnt(6)
	v_mfma_f32_32x32x16_bf16 v[16:31], v[144:147], a[112:115], v[16:31]
	ds_read_b64_tr_b16 v[172:173], v3 offset:30976
	ds_read_b64_tr_b16 v[174:175], v3 offset:31488
	v_fma_f32 v188, v188, v13, v13
	v_fma_f32 v189, v189, v13, v13
	v_mfma_f32_32x32x16_bf16 v[32:47], v[148:151], a[112:115], v[32:47]
	ds_read_b64_tr_b16 v[144:145], v3 offset:14336
	ds_read_b64_tr_b16 v[146:147], v3 offset:14848
	buffer_load_dwordx4 v15, s[8:11], s33 offen offset:0 lds
	v_rcp_f32 v188, v188
	s_add_u32 s34, s23, 11264
	buffer_load_dwordx4 a[24:27], v15, s[8:11], s34 offen sc1
	v_mfma_f32_32x32x16_bf16 v[16:31], v[152:155], a[116:119], v[16:31]
	ds_read_b64_tr_b16 v[148:149], v3 offset:32768
	ds_read_b64_tr_b16 v[150:151], v3 offset:33280
	v_rcp_f32 v189, v189
	v_mul_f32 v190, v190, v188
	v_mul_f32 v191, v191, v189
	v_cvt_pk_bf16_f32 v199, v190, v191
	v_mfma_f32_32x32x16_bf16 v[32:47], v[156:159], a[116:119], v[32:47]
	ds_read_b64_tr_b16 v[152:153], v3 offset:14592
	ds_read_b64_tr_b16 v[154:155], v3 offset:15104
	buffer_load_dwordx4 v15, s[8:11], s33 offen offset:1024 lds
	s_add_u32 s65, s63, 6144
	s_waitcnt lgkmcnt(6)
	v_mfma_f32_32x32x16_bf16 v[16:31], v[160:163], a[120:123], v[16:31]
	ds_read_b64_tr_b16 v[156:157], v3 offset:33024
	ds_read_b64_tr_b16 v[158:159], v3 offset:33536
	buffer_store_dwordx4 v[196:199], v8, s[8:11], s65 offen offset:512 sc1
	v_mul_f32 v176, v112, v112
	v_mul_f32 v177, v113, v113
	s_add_u32 s34, s25, 11264
	buffer_load_dwordx4 a[28:31], v15, s[8:11], s34 offen sc1
	v_mfma_f32_32x32x16_bf16 v[32:47], v[164:167], a[120:123], v[32:47]
	ds_read_b64_tr_b16 v[160:161], v3 offset:16384
	ds_read_b64_tr_b16 v[162:163], v3 offset:16896
	buffer_load_dwordx4 v15, s[8:11], s33 offen offset:2048 lds
	v_fma_f32 v176, v176, v11, v10
	v_fma_f32 v177, v177, v11, v10
	v_mfma_f32_32x32x16_bf16 v[16:31], v[168:171], a[124:127], v[16:31]
	ds_read_b64_tr_b16 v[164:165], v3 offset:34816
	ds_read_b64_tr_b16 v[166:167], v3 offset:35328
	v_mul_f32 v176, v176, v112
	v_mul_f32 v177, v177, v113
	v_exp_f32 v176, v176
	v_mfma_f32_32x32x16_bf16 v[32:47], v[172:175], a[124:127], v[32:47]
	ds_read_b64_tr_b16 v[168:169], v3 offset:16640
	ds_read_b64_tr_b16 v[170:171], v3 offset:17152
	buffer_load_dwordx4 v15, s[8:11], s33 offen offset:3072 lds
	v_exp_f32 v177, v177
	s_add_u32 s34, s23, 18432
	buffer_load_dwordx4 a[32:35], v15, s[8:11], s34 offen sc1
	s_waitcnt lgkmcnt(6)
	v_mfma_f32_32x32x16_bf16 v[16:31], v[144:147], a[128:131], v[16:31]
	ds_read_b64_tr_b16 v[172:173], v3 offset:35072
	ds_read_b64_tr_b16 v[174:175], v3 offset:35584
	v_mul_f32 v178, v112, v128
	v_mul_f32 v179, v113, v129
	v_fma_f32 v176, v176, v13, v13
	v_mfma_f32_32x32x16_bf16 v[32:47], v[148:151], a[128:131], v[32:47]
	ds_read_b128 v[144:147], v210 offset:0
	s_add_u32 m0, s37, 4096
	s_add_u32 s33, s26, 22528
	buffer_load_dwordx4 v15, s[8:11], s33 offen offset:0 lds
	v_fma_f32 v177, v177, v13, v13
	v_mfma_f32_32x32x16_bf16 v[16:31], v[152:155], a[132:135], v[16:31]
	ds_read_b128 v[148:151], v210 offset:1024
	v_rcp_f32 v176, v176
	v_rcp_f32 v177, v177
	v_mul_f32 v178, v178, v176
	s_add_u32 s34, s25, 18432
	buffer_load_dwordx4 a[36:39], v15, s[8:11], s34 offen sc1
	v_mfma_f32_32x32x16_bf16 v[32:47], v[156:159], a[132:135], v[32:47]
	ds_read_b128 v[152:155], v210 offset:2048
	buffer_load_dwordx4 v15, s[8:11], s33 offen offset:1024 lds
	v_mul_f32 v179, v179, v177
	v_cvt_pk_bf16_f32 v200, v178, v179
	v_mul_f32 v180, v114, v114
	s_waitcnt lgkmcnt(3)
	v_mfma_f32_32x32x16_bf16 v[16:31], v[160:163], a[136:139], v[16:31]
	ds_read_b128 v[156:159], v210 offset:3072
	v_mul_f32 v181, v115, v115
	v_fma_f32 v180, v180, v11, v10
	v_fma_f32 v181, v181, v11, v10
	v_mul_f32 v180, v180, v114
	v_mfma_f32_32x32x16_bf16 v[32:47], v[164:167], a[136:139], v[32:47]
	ds_read_b128 v[160:163], v210 offset:4096
	buffer_load_dwordx4 v15, s[8:11], s33 offen offset:2048 lds
	v_mul_f32 v181, v181, v115
	v_exp_f32 v180, v180
	v_mfma_f32_32x32x16_bf16 v[16:31], v[168:171], a[140:143], v[16:31]
	ds_read_b128 v[164:167], v210 offset:5120
	v_exp_f32 v181, v181
	v_mul_f32 v182, v114, v130
	v_mul_f32 v183, v115, v131
	v_fma_f32 v180, v180, v13, v13
	v_mfma_f32_32x32x16_bf16 v[32:47], v[172:175], a[140:143], v[32:47]
	ds_read_b128 v[168:171], v210 offset:6144
	buffer_load_dwordx4 v15, s[8:11], s33 offen offset:3072 lds
	v_fma_f32 v181, v181, v13, v13
	v_rcp_f32 v180, v180
	s_waitcnt vmcnt(18)
	s_waitcnt lgkmcnt(5)
	v_mfma_f32_16x16x32_bf16 v[48:51], v[144:147], a[0:3], 0
	ds_read_b128 v[172:175], v210 offset:7168
	v_mfma_f32_16x16x32_bf16 v[52:55], v[144:147], a[4:7], 0
	v_mfma_f32_16x16x32_bf16 v[56:59], v[148:151], a[0:3], 0
	ds_read_b128 v[144:147], v210 offset:8192
	v_mfma_f32_16x16x32_bf16 v[60:63], v[148:151], a[4:7], 0
	v_rcp_f32 v181, v181
	s_add_u32 m0, s37, 8192
	s_add_u32 s33, s26, 26624
	buffer_load_dwordx4 v15, s[8:11], s33 offen offset:0 lds
	s_waitcnt lgkmcnt(5)
	v_mfma_f32_16x16x32_bf16 v[64:67], v[152:155], a[0:3], 0
	ds_read_b128 v[148:151], v210 offset:9216
	v_mul_f32 v182, v182, v180
	v_mfma_f32_16x16x32_bf16 v[68:71], v[152:155], a[4:7], 0
	v_mul_f32 v183, v183, v181
	s_add_u32 s34, s23, 19456
	buffer_load_dwordx4 a[40:43], v15, s[8:11], s34 offen sc1
	v_mfma_f32_16x16x32_bf16 v[72:75], v[156:159], a[0:3], 0
	ds_read_b128 v[152:155], v210 offset:10240
	v_cvt_pk_bf16_f32 v201, v182, v183
	v_mfma_f32_16x16x32_bf16 v[76:79], v[156:159], a[4:7], 0
	v_mul_f32 v184, v116, v116
	s_waitcnt lgkmcnt(5)
	v_mfma_f32_16x16x32_bf16 v[224:227], v[160:163], a[0:3], 0
	ds_read_b128 v[156:159], v210 offset:11264
	v_mul_f32 v185, v117, v117
	v_mfma_f32_16x16x32_bf16 v[228:231], v[160:163], a[4:7], 0
	v_fma_f32 v184, v184, v11, v10
	v_mfma_f32_16x16x32_bf16 v[232:235], v[164:167], a[0:3], 0
	ds_read_b128 v[160:163], v210 offset:12288
	v_fma_f32 v185, v185, v11, v10
	v_mfma_f32_16x16x32_bf16 v[236:239], v[164:167], a[4:7], 0
	v_mul_f32 v184, v184, v116
	s_add_u32 s34, s25, 19456
	buffer_load_dwordx4 a[44:47], v15, s[8:11], s34 offen sc1
	s_waitcnt lgkmcnt(5)
	v_mfma_f32_16x16x32_bf16 v[240:243], v[168:171], a[0:3], 0
	ds_read_b128 v[164:167], v210 offset:13312
	v_mul_f32 v185, v185, v117
	v_mfma_f32_16x16x32_bf16 v[244:247], v[168:171], a[4:7], 0
	v_exp_f32 v184, v184
	v_mfma_f32_16x16x32_bf16 v[248:251], v[172:175], a[0:3], 0
	ds_read_b128 v[168:171], v210 offset:14336
	v_exp_f32 v185, v185
	v_mfma_f32_16x16x32_bf16 v[252:255], v[172:175], a[4:7], 0
	v_mul_f32 v186, v116, v132
	s_waitcnt lgkmcnt(5)
	v_mfma_f32_16x16x32_bf16 v[212:215], v[144:147], a[0:3], 0
	ds_read_b128 v[172:175], v210 offset:15360
	v_mul_f32 v187, v117, v133
	v_mfma_f32_16x16x32_bf16 v[216:219], v[144:147], a[4:7], 0
	v_fma_f32 v184, v184, v13, v13
	s_waitcnt vmcnt(19)
	v_mfma_f32_16x16x32_bf16 v[48:51], v[148:151], a[8:11], v[48:51]
	ds_read_b128 v[144:147], v210 offset:16384
	v_fma_f32 v185, v185, v13, v13
	v_mfma_f32_16x16x32_bf16 v[52:55], v[148:151], a[12:15], v[52:55]
	v_rcp_f32 v184, v184
	s_waitcnt lgkmcnt(5)
	v_mfma_f32_16x16x32_bf16 v[56:59], v[152:155], a[8:11], v[56:59]
	ds_read_b128 v[148:151], v210 offset:17408
	v_rcp_f32 v185, v185
	v_mfma_f32_16x16x32_bf16 v[60:63], v[152:155], a[12:15], v[60:63]
	v_mul_f32 v186, v186, v184
	v_mfma_f32_16x16x32_bf16 v[64:67], v[156:159], a[8:11], v[64:67]
	ds_read_b128 v[152:155], v210 offset:18432
	v_mul_f32 v187, v187, v185
	v_mfma_f32_16x16x32_bf16 v[68:71], v[156:159], a[12:15], v[68:71]
	v_cvt_pk_bf16_f32 v202, v186, v187
	s_add_u32 s34, s23, 28672
	buffer_load_dwordx4 a[48:51], v15, s[8:11], s34 offen sc1
	s_waitcnt lgkmcnt(5)
	v_mfma_f32_16x16x32_bf16 v[72:75], v[160:163], a[8:11], v[72:75]
	ds_read_b128 v[156:159], v210 offset:19456
	v_mul_f32 v188, v118, v118
	v_mfma_f32_16x16x32_bf16 v[76:79], v[160:163], a[12:15], v[76:79]
	v_mul_f32 v189, v119, v119
	v_mfma_f32_16x16x32_bf16 v[224:227], v[164:167], a[8:11], v[224:227]
	ds_read_b128 v[160:163], v210 offset:20480
	v_fma_f32 v188, v188, v11, v10
	v_mfma_f32_16x16x32_bf16 v[228:231], v[164:167], a[12:15], v[228:231]
	v_fma_f32 v189, v189, v11, v10
	s_waitcnt lgkmcnt(5)
	v_mfma_f32_16x16x32_bf16 v[232:235], v[168:171], a[8:11], v[232:235]
	ds_read_b128 v[164:167], v210 offset:21504
	v_mul_f32 v188, v188, v118
	v_mfma_f32_16x16x32_bf16 v[236:239], v[168:171], a[12:15], v[236:239]
	v_mul_f32 v189, v189, v119
	s_add_u32 s34, s25, 28672
	buffer_load_dwordx4 a[52:55], v15, s[8:11], s34 offen sc1
	v_mfma_f32_16x16x32_bf16 v[240:243], v[172:175], a[8:11], v[240:243]
	ds_read_b128 v[168:171], v210 offset:22528
	v_exp_f32 v188, v188
	v_mfma_f32_16x16x32_bf16 v[244:247], v[172:175], a[12:15], v[244:247]
	v_exp_f32 v189, v189
	s_waitcnt lgkmcnt(5)
	v_mfma_f32_16x16x32_bf16 v[248:251], v[144:147], a[8:11], v[248:251]
	ds_read_b128 v[172:175], v210 offset:23552
	v_mul_f32 v190, v118, v134
	v_mfma_f32_16x16x32_bf16 v[252:255], v[144:147], a[12:15], v[252:255]
	v_mul_f32 v191, v119, v135
	v_mfma_f32_16x16x32_bf16 v[212:215], v[148:151], a[8:11], v[212:215]
	ds_read_b128 v[144:147], v210 offset:24576
	v_fma_f32 v188, v188, v13, v13
	v_mfma_f32_16x16x32_bf16 v[216:219], v[148:151], a[12:15], v[216:219]
	v_fma_f32 v189, v189, v13, v13
	s_waitcnt vmcnt(18)
	s_waitcnt lgkmcnt(5)
	v_mfma_f32_16x16x32_bf16 v[48:51], v[152:155], a[16:19], v[48:51]
	ds_read_b128 v[148:151], v210 offset:25600
	v_rcp_f32 v188, v188
	v_mfma_f32_16x16x32_bf16 v[52:55], v[152:155], a[20:23], v[52:55]
	v_rcp_f32 v189, v189
	s_barrier
	v_mfma_f32_16x16x32_bf16 v[56:59], v[156:159], a[16:19], v[56:59]
	ds_read_b128 v[152:155], v210 offset:26624
	v_mul_f32 v190, v190, v188
	v_mfma_f32_16x16x32_bf16 v[60:63], v[156:159], a[20:23], v[60:63]
	v_mul_f32 v191, v191, v189
	s_add_u32 m0, s37, 36864
	s_add_u32 s33, s27, 18432
	s_waitcnt lgkmcnt(5)
	v_mfma_f32_16x16x32_bf16 v[64:67], v[160:163], a[16:19], v[64:67]
	ds_read_b128 v[156:159], v210 offset:27648
	v_cvt_pk_bf16_f32 v203, v190, v191
	v_mfma_f32_16x16x32_bf16 v[68:71], v[160:163], a[20:23], v[68:71]
	s_add_u32 s65, s63, 7168
	s_add_u32 s34, s23, 29696
	buffer_load_dwordx4 a[56:59], v15, s[8:11], s34 offen sc1
	v_mfma_f32_16x16x32_bf16 v[72:75], v[164:167], a[16:19], v[72:75]
	ds_read_b128 v[160:163], v210 offset:28672
	buffer_store_dwordx4 v[200:203], v8, s[8:11], s65 offen offset:0 sc1
	v_mfma_f32_16x16x32_bf16 v[76:79], v[164:167], a[20:23], v[76:79]
	v_mul_f32 v176, v120, v120
	buffer_load_dwordx4 v15, s[8:11], s33 offen offset:0 lds
	s_waitcnt lgkmcnt(5)
	v_mfma_f32_16x16x32_bf16 v[224:227], v[168:171], a[16:19], v[224:227]
	ds_read_b128 v[164:167], v210 offset:29696
	v_mul_f32 v177, v121, v121
	v_mfma_f32_16x16x32_bf16 v[228:231], v[168:171], a[20:23], v[228:231]
	v_fma_f32 v176, v176, v11, v10
	v_mfma_f32_16x16x32_bf16 v[232:235], v[172:175], a[16:19], v[232:235]
	ds_read_b128 v[168:171], v210 offset:30720
	v_fma_f32 v177, v177, v11, v10
	v_mfma_f32_16x16x32_bf16 v[236:239], v[172:175], a[20:23], v[236:239]
	v_mul_f32 v176, v176, v120
	s_add_u32 s34, s25, 29696
	buffer_load_dwordx4 a[60:63], v15, s[8:11], s34 offen sc1
	s_waitcnt lgkmcnt(5)
	v_mfma_f32_16x16x32_bf16 v[240:243], v[144:147], a[16:19], v[240:243]
	ds_read_b128 v[172:175], v210 offset:31744
	v_mul_f32 v177, v177, v121
	v_mfma_f32_16x16x32_bf16 v[244:247], v[144:147], a[20:23], v[244:247]
	v_exp_f32 v176, v176
	v_mfma_f32_16x16x32_bf16 v[248:251], v[148:151], a[16:19], v[248:251]
	ds_read_b128 v[144:147], v210 offset:32768
	v_exp_f32 v177, v177
	v_mfma_f32_16x16x32_bf16 v[252:255], v[148:151], a[20:23], v[252:255]
	v_mul_f32 v178, v120, v136
	buffer_load_dwordx4 v15, s[8:11], s33 offen offset:1024 lds
	s_waitcnt lgkmcnt(5)
	v_mfma_f32_16x16x32_bf16 v[212:215], v[152:155], a[16:19], v[212:215]
	ds_read_b128 v[148:151], v210 offset:33792
	v_mul_f32 v179, v121, v137
	v_mfma_f32_16x16x32_bf16 v[216:219], v[152:155], a[20:23], v[216:219]
	v_fma_f32 v176, v176, v13, v13
	s_waitcnt vmcnt(18)
	v_mfma_f32_16x16x32_bf16 v[48:51], v[156:159], a[24:27], v[48:51]
	ds_read_b128 v[152:155], v210 offset:34816
	v_fma_f32 v177, v177, v13, v13
	v_mfma_f32_16x16x32_bf16 v[52:55], v[156:159], a[28:31], v[52:55]
	v_rcp_f32 v176, v176
	buffer_load_dwordx4 v15, s[8:11], s33 offen offset:2048 lds
	s_waitcnt lgkmcnt(5)
	v_mfma_f32_16x16x32_bf16 v[56:59], v[160:163], a[24:27], v[56:59]
	ds_read_b128 v[156:159], v210 offset:35840
	v_rcp_f32 v177, v177
	v_mfma_f32_16x16x32_bf16 v[60:63], v[160:163], a[28:31], v[60:63]
	v_mul_f32 v178, v178, v176
	v_mfma_f32_16x16x32_bf16 v[64:67], v[164:167], a[24:27], v[64:67]
	ds_read_b128 v[160:163], v211 offset:0
	v_mul_f32 v179, v179, v177
	v_mfma_f32_16x16x32_bf16 v[68:71], v[164:167], a[28:31], v[68:71]
	v_cvt_pk_bf16_f32 v204, v178, v179
	s_add_u32 s34, s23, 2048
	buffer_load_dwordx4 a[0:3], v15, s[8:11], s34 offen sc1
	s_waitcnt lgkmcnt(5)
	v_mfma_f32_16x16x32_bf16 v[72:75], v[168:171], a[24:27], v[72:75]
	ds_read_b128 v[164:167], v211 offset:1024
	v_mul_f32 v180, v122, v122
	v_mfma_f32_16x16x32_bf16 v[76:79], v[168:171], a[28:31], v[76:79]
	v_mul_f32 v181, v123, v123
	v_mfma_f32_16x16x32_bf16 v[224:227], v[172:175], a[24:27], v[224:227]
	ds_read_b128 v[168:171], v211 offset:2048
	v_fma_f32 v180, v180, v11, v10
	v_mfma_f32_16x16x32_bf16 v[228:231], v[172:175], a[28:31], v[228:231]
	v_fma_f32 v181, v181, v11, v10
	buffer_load_dwordx4 v15, s[8:11], s33 offen offset:3072 lds
	s_waitcnt lgkmcnt(5)
	v_mfma_f32_16x16x32_bf16 v[232:235], v[144:147], a[24:27], v[232:235]
	ds_read_b128 v[172:175], v211 offset:3072
	v_mul_f32 v180, v180, v122
	v_mfma_f32_16x16x32_bf16 v[236:239], v[144:147], a[28:31], v[236:239]
	v_mul_f32 v181, v181, v123
	s_add_u32 s34, s25, 2048
	buffer_load_dwordx4 a[4:7], v15, s[8:11], s34 offen sc1
	v_mfma_f32_16x16x32_bf16 v[240:243], v[148:151], a[24:27], v[240:243]
	ds_read_b128 v[144:147], v211 offset:4096
	v_exp_f32 v180, v180
	v_mfma_f32_16x16x32_bf16 v[244:247], v[148:151], a[28:31], v[244:247]
	v_exp_f32 v181, v181
	s_add_u32 m0, s37, 40960
	s_add_u32 s33, s27, 22528
	buffer_load_dwordx4 v15, s[8:11], s33 offen offset:0 lds
	s_waitcnt lgkmcnt(5)
	v_mfma_f32_16x16x32_bf16 v[248:251], v[152:155], a[24:27], v[248:251]
	ds_read_b128 v[148:151], v211 offset:5120
	v_mul_f32 v182, v122, v138
	v_mfma_f32_16x16x32_bf16 v[252:255], v[152:155], a[28:31], v[252:255]
	v_mul_f32 v183, v123, v139
	v_mfma_f32_16x16x32_bf16 v[212:215], v[156:159], a[24:27], v[212:215]
	ds_read_b128 v[152:155], v211 offset:6144
	v_fma_f32 v180, v180, v13, v13
	v_mfma_f32_16x16x32_bf16 v[216:219], v[156:159], a[28:31], v[216:219]
	v_fma_f32 v181, v181, v13, v13
	buffer_load_dwordx4 v15, s[8:11], s33 offen offset:1024 lds
	s_waitcnt vmcnt(19)
	s_waitcnt lgkmcnt(5)
	v_mfma_f32_16x16x32_bf16 v[48:51], v[160:163], a[32:35], v[48:51]
	ds_read_b128 v[156:159], v211 offset:7168
	v_rcp_f32 v180, v180
	v_mfma_f32_16x16x32_bf16 v[52:55], v[160:163], a[36:39], v[52:55]
	v_rcp_f32 v181, v181
	v_mfma_f32_16x16x32_bf16 v[56:59], v[164:167], a[32:35], v[56:59]
	ds_read_b128 v[160:163], v211 offset:8192
	v_mul_f32 v182, v182, v180
	v_mfma_f32_16x16x32_bf16 v[60:63], v[164:167], a[36:39], v[60:63]
	v_mul_f32 v183, v183, v181
	buffer_load_dwordx4 v15, s[8:11], s33 offen offset:2048 lds
	s_waitcnt lgkmcnt(5)
	v_mfma_f32_16x16x32_bf16 v[64:67], v[168:171], a[32:35], v[64:67]
	ds_read_b128 v[164:167], v211 offset:9216
	v_cvt_pk_bf16_f32 v205, v182, v183
	v_mfma_f32_16x16x32_bf16 v[68:71], v[168:171], a[36:39], v[68:71]
	v_mul_f32 v184, v124, v124
	s_add_u32 s34, s23, 3072
	buffer_load_dwordx4 a[8:11], v15, s[8:11], s34 offen sc1
	v_mfma_f32_16x16x32_bf16 v[72:75], v[172:175], a[32:35], v[72:75]
	ds_read_b128 v[168:171], v211 offset:10240
	v_mul_f32 v185, v125, v125
	v_mfma_f32_16x16x32_bf16 v[76:79], v[172:175], a[36:39], v[76:79]
	v_fma_f32 v184, v184, v11, v10
	buffer_load_dwordx4 v15, s[8:11], s33 offen offset:3072 lds
	s_waitcnt lgkmcnt(5)
	v_mfma_f32_16x16x32_bf16 v[224:227], v[144:147], a[32:35], v[224:227]
	ds_read_b128 v[172:175], v211 offset:11264
	v_fma_f32 v185, v185, v11, v10
	v_mfma_f32_16x16x32_bf16 v[228:231], v[144:147], a[36:39], v[228:231]
	v_mul_f32 v184, v184, v124
	v_mfma_f32_16x16x32_bf16 v[232:235], v[148:151], a[32:35], v[232:235]
	ds_read_b128 v[144:147], v211 offset:12288
	v_mul_f32 v185, v185, v125
	v_mfma_f32_16x16x32_bf16 v[236:239], v[148:151], a[36:39], v[236:239]
	v_exp_f32 v184, v184
	s_add_u32 s34, s25, 3072
	buffer_load_dwordx4 a[12:15], v15, s[8:11], s34 offen sc1
	s_waitcnt lgkmcnt(5)
	v_mfma_f32_16x16x32_bf16 v[240:243], v[152:155], a[32:35], v[240:243]
	ds_read_b128 v[148:151], v211 offset:13312
	v_exp_f32 v185, v185
	v_mfma_f32_16x16x32_bf16 v[244:247], v[152:155], a[36:39], v[244:247]
	v_mul_f32 v186, v124, v140
	v_mfma_f32_16x16x32_bf16 v[248:251], v[156:159], a[32:35], v[248:251]
	ds_read_b128 v[152:155], v211 offset:14336
	v_mul_f32 v187, v125, v141
	v_mfma_f32_16x16x32_bf16 v[252:255], v[156:159], a[36:39], v[252:255]
	v_fma_f32 v184, v184, v13, v13
	s_add_u32 m0, s37, 45056
	s_add_u32 s33, s27, 26624
	buffer_load_dwordx4 v15, s[8:11], s33 offen offset:0 lds
	s_waitcnt lgkmcnt(5)
	v_mfma_f32_16x16x32_bf16 v[212:215], v[160:163], a[32:35], v[212:215]
	ds_read_b128 v[156:159], v211 offset:15360
	v_fma_f32 v185, v185, v13, v13
	v_mfma_f32_16x16x32_bf16 v[216:219], v[160:163], a[36:39], v[216:219]
	v_rcp_f32 v184, v184
	s_waitcnt vmcnt(18)
	v_mfma_f32_16x16x32_bf16 v[48:51], v[164:167], a[40:43], v[48:51]
	ds_read_b128 v[160:163], v211 offset:16384
	v_rcp_f32 v185, v185
	v_mfma_f32_16x16x32_bf16 v[52:55], v[164:167], a[44:47], v[52:55]
	v_mul_f32 v186, v186, v184
	s_waitcnt lgkmcnt(5)
	v_mfma_f32_16x16x32_bf16 v[56:59], v[168:171], a[40:43], v[56:59]
	ds_read_b128 v[164:167], v211 offset:17408
	v_mul_f32 v187, v187, v185
	v_mfma_f32_16x16x32_bf16 v[60:63], v[168:171], a[44:47], v[60:63]
	v_cvt_pk_bf16_f32 v206, v186, v187
	v_mfma_f32_16x16x32_bf16 v[64:67], v[172:175], a[40:43], v[64:67]
	ds_read_b128 v[168:171], v211 offset:18432
	v_mul_f32 v188, v126, v126
	v_mfma_f32_16x16x32_bf16 v[68:71], v[172:175], a[44:47], v[68:71]
	v_mul_f32 v189, v127, v127
	s_add_u32 s34, s23, 12288
	buffer_load_dwordx4 a[16:19], v15, s[8:11], s34 offen sc1
	s_waitcnt lgkmcnt(5)
	v_mfma_f32_16x16x32_bf16 v[72:75], v[144:147], a[40:43], v[72:75]
	ds_read_b128 v[172:175], v211 offset:19456
	v_fma_f32 v188, v188, v11, v10
	v_mfma_f32_16x16x32_bf16 v[76:79], v[144:147], a[44:47], v[76:79]
	v_fma_f32 v189, v189, v11, v10
	v_mfma_f32_16x16x32_bf16 v[224:227], v[148:151], a[40:43], v[224:227]
	ds_read_b128 v[144:147], v211 offset:20480
	v_mul_f32 v188, v188, v126
	v_mfma_f32_16x16x32_bf16 v[228:231], v[148:151], a[44:47], v[228:231]
	v_mul_f32 v189, v189, v127
	s_waitcnt lgkmcnt(5)
	v_mfma_f32_16x16x32_bf16 v[232:235], v[152:155], a[40:43], v[232:235]
	ds_read_b128 v[148:151], v211 offset:21504
	v_exp_f32 v188, v188
	v_mfma_f32_16x16x32_bf16 v[236:239], v[152:155], a[44:47], v[236:239]
	v_exp_f32 v189, v189
	s_add_u32 s34, s25, 12288
	buffer_load_dwordx4 a[20:23], v15, s[8:11], s34 offen sc1
	v_mfma_f32_16x16x32_bf16 v[240:243], v[156:159], a[40:43], v[240:243]
	ds_read_b128 v[152:155], v211 offset:22528
	v_mul_f32 v190, v126, v142
	v_mfma_f32_16x16x32_bf16 v[244:247], v[156:159], a[44:47], v[244:247]
	v_mul_f32 v191, v127, v143
	s_waitcnt lgkmcnt(5)
	v_mfma_f32_16x16x32_bf16 v[248:251], v[160:163], a[40:43], v[248:251]
	ds_read_b128 v[156:159], v211 offset:23552
	v_fma_f32 v188, v188, v13, v13
	v_mfma_f32_16x16x32_bf16 v[252:255], v[160:163], a[44:47], v[252:255]
	v_fma_f32 v189, v189, v13, v13
	v_mfma_f32_16x16x32_bf16 v[212:215], v[164:167], a[40:43], v[212:215]
	ds_read_b128 v[160:163], v211 offset:24576
	v_rcp_f32 v188, v188
	v_mfma_f32_16x16x32_bf16 v[216:219], v[164:167], a[44:47], v[216:219]
	v_rcp_f32 v189, v189
	s_waitcnt vmcnt(18)
	s_waitcnt lgkmcnt(5)
	v_mfma_f32_16x16x32_bf16 v[48:51], v[168:171], a[48:51], v[48:51]
	ds_read_b128 v[164:167], v211 offset:25600
	v_mul_f32 v190, v190, v188
	v_mfma_f32_16x16x32_bf16 v[52:55], v[168:171], a[52:55], v[52:55]
	v_mul_f32 v191, v191, v189
	s_barrier
	v_mfma_f32_16x16x32_bf16 v[56:59], v[172:175], a[48:51], v[56:59]
	ds_read_b128 v[168:171], v211 offset:26624
	v_cvt_pk_bf16_f32 v207, v190, v191
	v_mfma_f32_16x16x32_bf16 v[60:63], v[172:175], a[52:55], v[60:63]
	s_add_u32 s65, s63, 7168
	s_add_u32 m0, s37, 73728
	s_add_u32 s33, s26, 36864
	s_waitcnt lgkmcnt(5)
	v_mfma_f32_16x16x32_bf16 v[64:67], v[144:147], a[48:51], v[64:67]
	ds_read_b128 v[172:175], v211 offset:27648
	buffer_store_dwordx4 v[204:207], v8, s[8:11], s65 offen offset:512 sc1
	v_mfma_f32_16x16x32_bf16 v[68:71], v[144:147], a[52:55], v[68:71]
	v_mul_f32 v176, v16, v16
	s_add_u32 s34, s23, 13312
	buffer_load_dwordx4 a[24:27], v15, s[8:11], s34 offen sc1
	v_mfma_f32_16x16x32_bf16 v[72:75], v[148:151], a[48:51], v[72:75]
	ds_read_b128 v[144:147], v211 offset:28672
	v_mul_f32 v177, v17, v17
	v_mfma_f32_16x16x32_bf16 v[76:79], v[148:151], a[52:55], v[76:79]
	v_fma_f32 v176, v176, v11, v10
	buffer_load_dwordx4 v15, s[8:11], s33 offen offset:0 lds
	s_waitcnt lgkmcnt(5)
	v_mfma_f32_16x16x32_bf16 v[224:227], v[152:155], a[48:51], v[224:227]
	ds_read_b128 v[148:151], v211 offset:29696
	v_fma_f32 v177, v177, v11, v10
	v_mfma_f32_16x16x32_bf16 v[228:231], v[152:155], a[52:55], v[228:231]
	v_mul_f32 v176, v176, v16
	v_mfma_f32_16x16x32_bf16 v[232:235], v[156:159], a[48:51], v[232:235]
	ds_read_b128 v[152:155], v211 offset:30720
	v_mul_f32 v177, v177, v17
	v_mfma_f32_16x16x32_bf16 v[236:239], v[156:159], a[52:55], v[236:239]
	v_exp_f32 v176, v176
	s_add_u32 s34, s25, 13312
	buffer_load_dwordx4 a[28:31], v15, s[8:11], s34 offen sc1
	s_waitcnt lgkmcnt(5)
	v_mfma_f32_16x16x32_bf16 v[240:243], v[160:163], a[48:51], v[240:243]
	ds_read_b128 v[156:159], v211 offset:31744
	v_exp_f32 v177, v177
	v_mfma_f32_16x16x32_bf16 v[244:247], v[160:163], a[52:55], v[244:247]
	v_mul_f32 v178, v16, v32
	v_mfma_f32_16x16x32_bf16 v[248:251], v[164:167], a[48:51], v[248:251]
	ds_read_b128 v[160:163], v211 offset:32768
	v_mul_f32 v179, v17, v33
	v_mfma_f32_16x16x32_bf16 v[252:255], v[164:167], a[52:55], v[252:255]
	v_fma_f32 v176, v176, v13, v13
	buffer_load_dwordx4 v15, s[8:11], s33 offen offset:1024 lds
	s_waitcnt lgkmcnt(5)
	v_mfma_f32_16x16x32_bf16 v[212:215], v[168:171], a[48:51], v[212:215]
	ds_read_b128 v[164:167], v211 offset:33792
	v_fma_f32 v177, v177, v13, v13
	v_mfma_f32_16x16x32_bf16 v[216:219], v[168:171], a[52:55], v[216:219]
	v_rcp_f32 v176, v176
	s_waitcnt vmcnt(19)
	v_mfma_f32_16x16x32_bf16 v[48:51], v[172:175], a[56:59], v[48:51]
	ds_read_b128 v[168:171], v211 offset:34816
	v_rcp_f32 v177, v177
	v_mfma_f32_16x16x32_bf16 v[52:55], v[172:175], a[60:63], v[52:55]
	v_mul_f32 v178, v178, v176
	buffer_load_dwordx4 v15, s[8:11], s33 offen offset:2048 lds
	s_waitcnt lgkmcnt(5)
	v_mfma_f32_16x16x32_bf16 v[56:59], v[144:147], a[56:59], v[56:59]
	ds_read_b128 v[172:175], v211 offset:35840
	v_mul_f32 v179, v179, v177
	v_mfma_f32_16x16x32_bf16 v[60:63], v[144:147], a[60:63], v[60:63]
	v_cvt_pk_bf16_f32 v192, v178, v179
	v_mfma_f32_16x16x32_bf16 v[64:67], v[148:151], a[56:59], v[64:67]
	ds_read_b128 v[144:147], v208 offset:0
	v_mul_f32 v180, v18, v18
	v_mfma_f32_16x16x32_bf16 v[68:71], v[148:151], a[60:63], v[68:71]
	v_mul_f32 v181, v19, v19
	s_add_u32 s34, s23, 20480
	buffer_load_dwordx4 a[32:35], v15, s[8:11], s34 offen sc1
	s_waitcnt lgkmcnt(5)
	v_mfma_f32_16x16x32_bf16 v[72:75], v[152:155], a[56:59], v[72:75]
	ds_read_b128 v[148:151], v208 offset:1024
	v_fma_f32 v180, v180, v11, v10
	v_mfma_f32_16x16x32_bf16 v[76:79], v[152:155], a[60:63], v[76:79]
	v_fma_f32 v181, v181, v11, v10
	v_mfma_f32_16x16x32_bf16 v[224:227], v[156:159], a[56:59], v[224:227]
	ds_read_b128 v[152:155], v208 offset:2048
	v_mul_f32 v180, v180, v18
	v_mfma_f32_16x16x32_bf16 v[228:231], v[156:159], a[60:63], v[228:231]
	v_mul_f32 v181, v181, v19
	buffer_load_dwordx4 v15, s[8:11], s33 offen offset:3072 lds
	s_waitcnt lgkmcnt(5)
	v_mfma_f32_16x16x32_bf16 v[232:235], v[160:163], a[56:59], v[232:235]
	ds_read_b128 v[156:159], v208 offset:3072
	v_exp_f32 v180, v180
	v_mfma_f32_16x16x32_bf16 v[236:239], v[160:163], a[60:63], v[236:239]
	v_exp_f32 v181, v181
	s_add_u32 s34, s25, 20480
	buffer_load_dwordx4 a[36:39], v15, s[8:11], s34 offen sc1
	v_mfma_f32_16x16x32_bf16 v[240:243], v[164:167], a[56:59], v[240:243]
	ds_read_b128 v[160:163], v208 offset:4096
	v_mul_f32 v182, v18, v34
	v_mfma_f32_16x16x32_bf16 v[244:247], v[164:167], a[60:63], v[244:247]
	v_mul_f32 v183, v19, v35
	s_add_u32 m0, s37, 77824
	s_add_u32 s33, s26, 40960
	buffer_load_dwordx4 v15, s[8:11], s33 offen offset:0 lds
	s_waitcnt lgkmcnt(5)
	v_mfma_f32_16x16x32_bf16 v[248:251], v[168:171], a[56:59], v[248:251]
	ds_read_b128 v[164:167], v208 offset:5120
	v_fma_f32 v180, v180, v13, v13
	v_mfma_f32_16x16x32_bf16 v[252:255], v[168:171], a[60:63], v[252:255]
	v_fma_f32 v181, v181, v13, v13
	v_mfma_f32_16x16x32_bf16 v[212:215], v[172:175], a[56:59], v[212:215]
	ds_read_b128 v[168:171], v208 offset:6144
	v_rcp_f32 v180, v180
	v_mfma_f32_16x16x32_bf16 v[216:219], v[172:175], a[60:63], v[216:219]
	v_rcp_f32 v181, v181
	buffer_load_dwordx4 v15, s[8:11], s33 offen offset:1024 lds
	s_waitcnt vmcnt(20)
	s_waitcnt lgkmcnt(5)
	v_mfma_f32_16x16x32_bf16 v[48:51], v[144:147], a[0:3], v[48:51]
	ds_read_b128 v[172:175], v208 offset:7168
	v_mul_f32 v182, v182, v180
	v_mfma_f32_16x16x32_bf16 v[52:55], v[144:147], a[4:7], v[52:55]
	v_mul_f32 v183, v183, v181
	v_mfma_f32_16x16x32_bf16 v[56:59], v[148:151], a[0:3], v[56:59]
	ds_read_b128 v[144:147], v208 offset:8192
	v_cvt_pk_bf16_f32 v193, v182, v183
	v_mfma_f32_16x16x32_bf16 v[60:63], v[148:151], a[4:7], v[60:63]
	v_mul_f32 v184, v20, v20
	buffer_load_dwordx4 v15, s[8:11], s33 offen offset:2048 lds
	s_waitcnt lgkmcnt(5)
	v_mfma_f32_16x16x32_bf16 v[64:67], v[152:155], a[0:3], v[64:67]
	ds_read_b128 v[148:151], v208 offset:9216
	v_mul_f32 v185, v21, v21
	v_mfma_f32_16x16x32_bf16 v[68:71], v[152:155], a[4:7], v[68:71]
	v_fma_f32 v184, v184, v11, v10
	s_add_u32 s34, s23, 21504
	buffer_load_dwordx4 a[40:43], v15, s[8:11], s34 offen sc1
	v_mfma_f32_16x16x32_bf16 v[72:75], v[156:159], a[0:3], v[72:75]
	ds_read_b128 v[152:155], v208 offset:10240
	v_fma_f32 v185, v185, v11, v10
	v_mfma_f32_16x16x32_bf16 v[76:79], v[156:159], a[4:7], v[76:79]
	v_mul_f32 v184, v184, v20
	buffer_load_dwordx4 v15, s[8:11], s33 offen offset:3072 lds
	s_waitcnt lgkmcnt(5)
	v_mfma_f32_16x16x32_bf16 v[224:227], v[160:163], a[0:3], v[224:227]
	ds_read_b128 v[156:159], v208 offset:11264
	v_mul_f32 v185, v185, v21
	v_mfma_f32_16x16x32_bf16 v[228:231], v[160:163], a[4:7], v[228:231]
	v_exp_f32 v184, v184
	v_mfma_f32_16x16x32_bf16 v[232:235], v[164:167], a[0:3], v[232:235]
	ds_read_b128 v[160:163], v208 offset:12288
	v_exp_f32 v185, v185
	v_mfma_f32_16x16x32_bf16 v[236:239], v[164:167], a[4:7], v[236:239]
	v_mul_f32 v186, v20, v36
	s_add_u32 s34, s25, 21504
	buffer_load_dwordx4 a[44:47], v15, s[8:11], s34 offen sc1
	s_waitcnt lgkmcnt(5)
	v_mfma_f32_16x16x32_bf16 v[240:243], v[168:171], a[0:3], v[240:243]
	ds_read_b128 v[164:167], v208 offset:13312
	v_mul_f32 v187, v21, v37
	v_mfma_f32_16x16x32_bf16 v[244:247], v[168:171], a[4:7], v[244:247]
	v_fma_f32 v184, v184, v13, v13
	v_mfma_f32_16x16x32_bf16 v[248:251], v[172:175], a[0:3], v[248:251]
	ds_read_b128 v[168:171], v208 offset:14336
	v_fma_f32 v185, v185, v13, v13
	v_mfma_f32_16x16x32_bf16 v[252:255], v[172:175], a[4:7], v[252:255]
	v_rcp_f32 v184, v184
	buffer_load_dword v220, v221, s[8:11], s29 offen sc1
	s_add_u32 m0, s37, 81920
	s_add_u32 s33, s26, 45056
	buffer_load_dwordx4 v15, s[8:11], s33 offen offset:0 lds
	s_waitcnt lgkmcnt(5)
	v_mfma_f32_16x16x32_bf16 v[212:215], v[144:147], a[0:3], v[212:215]
	ds_read_b128 v[172:175], v208 offset:15360
	v_rcp_f32 v185, v185
	v_mfma_f32_16x16x32_bf16 v[216:219], v[144:147], a[4:7], v[216:219]
	v_mul_f32 v186, v186, v184
	s_waitcnt vmcnt(20)
	v_mfma_f32_16x16x32_bf16 v[48:51], v[148:151], a[8:11], v[48:51]
	ds_read_b128 v[144:147], v208 offset:16384
	v_mul_f32 v187, v187, v185
	v_mfma_f32_16x16x32_bf16 v[52:55], v[148:151], a[12:15], v[52:55]
	v_cvt_pk_bf16_f32 v194, v186, v187
	s_waitcnt lgkmcnt(5)
	v_mfma_f32_16x16x32_bf16 v[56:59], v[152:155], a[8:11], v[56:59]
	ds_read_b128 v[148:151], v208 offset:17408
	v_mul_f32 v188, v22, v22
	v_mfma_f32_16x16x32_bf16 v[60:63], v[152:155], a[12:15], v[60:63]
	v_mul_f32 v189, v23, v23
	v_mfma_f32_16x16x32_bf16 v[64:67], v[156:159], a[8:11], v[64:67]
	ds_read_b128 v[152:155], v208 offset:18432
	v_fma_f32 v188, v188, v11, v10
	v_mfma_f32_16x16x32_bf16 v[68:71], v[156:159], a[12:15], v[68:71]
	v_fma_f32 v189, v189, v11, v10
	s_add_u32 s34, s23, 30720
	buffer_load_dwordx4 a[48:51], v15, s[8:11], s34 offen sc1
	s_waitcnt lgkmcnt(5)
	v_mfma_f32_16x16x32_bf16 v[72:75], v[160:163], a[8:11], v[72:75]
	ds_read_b128 v[156:159], v208 offset:19456
	v_mul_f32 v188, v188, v22
	v_mfma_f32_16x16x32_bf16 v[76:79], v[160:163], a[12:15], v[76:79]
	v_mul_f32 v189, v189, v23
	v_mfma_f32_16x16x32_bf16 v[224:227], v[164:167], a[8:11], v[224:227]
	ds_read_b128 v[160:163], v208 offset:20480
	v_exp_f32 v188, v188
	v_mfma_f32_16x16x32_bf16 v[228:231], v[164:167], a[12:15], v[228:231]
	v_exp_f32 v189, v189
	s_waitcnt lgkmcnt(5)
	v_mfma_f32_16x16x32_bf16 v[232:235], v[168:171], a[8:11], v[232:235]
	ds_read_b128 v[164:167], v208 offset:21504
	v_mul_f32 v190, v22, v38
	v_mfma_f32_16x16x32_bf16 v[236:239], v[168:171], a[12:15], v[236:239]
	v_mul_f32 v191, v23, v39
	s_add_u32 s34, s25, 30720
	buffer_load_dwordx4 a[52:55], v15, s[8:11], s34 offen sc1
	v_mfma_f32_16x16x32_bf16 v[240:243], v[172:175], a[8:11], v[240:243]
	ds_read_b128 v[168:171], v208 offset:22528
	v_fma_f32 v188, v188, v13, v13
	v_mfma_f32_16x16x32_bf16 v[244:247], v[172:175], a[12:15], v[244:247]
	v_fma_f32 v189, v189, v13, v13
	s_waitcnt lgkmcnt(5)
	v_mfma_f32_16x16x32_bf16 v[248:251], v[144:147], a[8:11], v[248:251]
	ds_read_b128 v[172:175], v208 offset:23552
	v_rcp_f32 v188, v188
	v_mfma_f32_16x16x32_bf16 v[252:255], v[144:147], a[12:15], v[252:255]
	v_rcp_f32 v189, v189
	v_mfma_f32_16x16x32_bf16 v[212:215], v[148:151], a[8:11], v[212:215]
	ds_read_b128 v[144:147], v208 offset:24576
	v_mul_f32 v190, v190, v188
	v_mfma_f32_16x16x32_bf16 v[216:219], v[148:151], a[12:15], v[216:219]
	v_mul_f32 v191, v191, v189
	s_waitcnt vmcnt(19)
	s_waitcnt lgkmcnt(5)
	v_mfma_f32_16x16x32_bf16 v[48:51], v[152:155], a[16:19], v[48:51]
	ds_read_b128 v[148:151], v208 offset:25600
	v_cvt_pk_bf16_f32 v195, v190, v191
	v_mfma_f32_16x16x32_bf16 v[52:55], v[152:155], a[20:23], v[52:55]
	s_add_u32 s65, s64, 0
	s_barrier
	v_mfma_f32_16x16x32_bf16 v[56:59], v[156:159], a[16:19], v[56:59]
	ds_read_b128 v[152:155], v208 offset:26624
	buffer_store_dwordx4 v[192:195], v8, s[8:11], s65 offen offset:0 sc1
	v_mfma_f32_16x16x32_bf16 v[60:63], v[156:159], a[20:23], v[60:63]
	v_mul_f32 v176, v24, v24
	s_add_u32 m0, s37, 110592
	s_add_u32 s33, s27, 36864
	s_waitcnt lgkmcnt(5)
	v_mfma_f32_16x16x32_bf16 v[64:67], v[160:163], a[16:19], v[64:67]
	ds_read_b128 v[156:159], v208 offset:27648
	v_mul_f32 v177, v25, v25
	v_mfma_f32_16x16x32_bf16 v[68:71], v[160:163], a[20:23], v[68:71]
	v_fma_f32 v176, v176, v11, v10
	s_add_u32 s34, s23, 31744
	buffer_load_dwordx4 a[56:59], v15, s[8:11], s34 offen sc1
	v_mfma_f32_16x16x32_bf16 v[72:75], v[164:167], a[16:19], v[72:75]
	ds_read_b128 v[160:163], v208 offset:28672
	v_fma_f32 v177, v177, v11, v10
	v_mfma_f32_16x16x32_bf16 v[76:79], v[164:167], a[20:23], v[76:79]
	v_mul_f32 v176, v176, v24
	buffer_load_dwordx4 v15, s[8:11], s33 offen offset:0 lds
	s_waitcnt lgkmcnt(5)
	v_mfma_f32_16x16x32_bf16 v[224:227], v[168:171], a[16:19], v[224:227]
	ds_read_b128 v[164:167], v208 offset:29696
	v_mul_f32 v177, v177, v25
	v_mfma_f32_16x16x32_bf16 v[228:231], v[168:171], a[20:23], v[228:231]
	v_exp_f32 v176, v176
	v_mfma_f32_16x16x32_bf16 v[232:235], v[172:175], a[16:19], v[232:235]
	ds_read_b128 v[168:171], v208 offset:30720
	v_exp_f32 v177, v177
	v_mfma_f32_16x16x32_bf16 v[236:239], v[172:175], a[20:23], v[236:239]
	v_mul_f32 v178, v24, v40
	s_add_u32 s34, s25, 31744
	buffer_load_dwordx4 a[60:63], v15, s[8:11], s34 offen sc1
	s_waitcnt lgkmcnt(5)
	v_mfma_f32_16x16x32_bf16 v[240:243], v[144:147], a[16:19], v[240:243]
	ds_read_b128 v[172:175], v208 offset:31744
	v_mul_f32 v179, v25, v41
	v_mfma_f32_16x16x32_bf16 v[244:247], v[144:147], a[20:23], v[244:247]
	v_fma_f32 v176, v176, v13, v13
	v_mfma_f32_16x16x32_bf16 v[248:251], v[148:151], a[16:19], v[248:251]
	ds_read_b128 v[144:147], v208 offset:32768
	v_fma_f32 v177, v177, v13, v13
	v_mfma_f32_16x16x32_bf16 v[252:255], v[148:151], a[20:23], v[252:255]
	v_rcp_f32 v176, v176
	buffer_load_dwordx4 v15, s[8:11], s33 offen offset:1024 lds
	s_waitcnt lgkmcnt(5)
	v_mfma_f32_16x16x32_bf16 v[212:215], v[152:155], a[16:19], v[212:215]
	ds_read_b128 v[148:151], v208 offset:33792
	v_rcp_f32 v177, v177
	v_mfma_f32_16x16x32_bf16 v[216:219], v[152:155], a[20:23], v[216:219]
	v_mul_f32 v178, v178, v176
	s_waitcnt vmcnt(20)
	v_mfma_f32_16x16x32_bf16 v[48:51], v[156:159], a[24:27], v[48:51]
	ds_read_b128 v[152:155], v208 offset:34816
	v_mul_f32 v179, v179, v177
	v_mfma_f32_16x16x32_bf16 v[52:55], v[156:159], a[28:31], v[52:55]
	v_cvt_pk_bf16_f32 v196, v178, v179
	s_waitcnt vmcnt(8)
	v_cmp_gt_u32 vcc, 3, v220
	buffer_load_dwordx4 v15, s[8:11], s33 offen offset:2048 lds
	s_waitcnt lgkmcnt(5)
	v_mfma_f32_16x16x32_bf16 v[56:59], v[160:163], a[24:27], v[56:59]
	ds_read_b128 v[156:159], v208 offset:35840
	v_mul_f32 v180, v26, v26
	v_mfma_f32_16x16x32_bf16 v[60:63], v[160:163], a[28:31], v[60:63]
	v_mul_f32 v181, v27, v27
	s_cbranch_vccnz L_k3_spin2
L_k3_back2:
	v_mfma_f32_16x16x32_bf16 v[64:67], v[164:167], a[24:27], v[64:67]
	ds_read_b128 v[160:163], v209 offset:0
	v_fma_f32 v180, v180, v11, v10
	v_mfma_f32_16x16x32_bf16 v[68:71], v[164:167], a[28:31], v[68:71]
	v_fma_f32 v181, v181, v11, v10
	s_add_u32 s34, s23, 4096
	buffer_load_dwordx4 a[0:3], v15, s[8:11], s34 offen sc1
	s_waitcnt lgkmcnt(5)
	v_mfma_f32_16x16x32_bf16 v[72:75], v[168:171], a[24:27], v[72:75]
	ds_read_b128 v[164:167], v209 offset:1024
	v_mul_f32 v180, v180, v26
	v_mfma_f32_16x16x32_bf16 v[76:79], v[168:171], a[28:31], v[76:79]
	v_mul_f32 v181, v181, v27
	v_mfma_f32_16x16x32_bf16 v[224:227], v[172:175], a[24:27], v[224:227]
	ds_read_b128 v[168:171], v209 offset:2048
	v_exp_f32 v180, v180
	v_mfma_f32_16x16x32_bf16 v[228:231], v[172:175], a[28:31], v[228:231]
	v_exp_f32 v181, v181
	buffer_load_dwordx4 v15, s[8:11], s33 offen offset:3072 lds
	s_waitcnt lgkmcnt(5)
	v_mfma_f32_16x16x32_bf16 v[232:235], v[144:147], a[24:27], v[232:235]
	ds_read_b128 v[172:175], v209 offset:3072
	v_mul_f32 v182, v26, v42
	v_mfma_f32_16x16x32_bf16 v[236:239], v[144:147], a[28:31], v[236:239]
	v_mul_f32 v183, v27, v43
	s_add_u32 s34, s25, 4096
	buffer_load_dwordx4 a[4:7], v15, s[8:11], s34 offen sc1
	v_mfma_f32_16x16x32_bf16 v[240:243], v[148:151], a[24:27], v[240:243]
	ds_read_b128 v[144:147], v209 offset:4096
	v_fma_f32 v180, v180, v13, v13
	v_mfma_f32_16x16x32_bf16 v[244:247], v[148:151], a[28:31], v[244:247]
	v_fma_f32 v181, v181, v13, v13
	s_add_u32 m0, s37, 114688
	s_add_u32 s33, s27, 40960
	buffer_load_dwordx4 v15, s[8:11], s33 offen offset:0 lds
	s_waitcnt lgkmcnt(5)
	v_mfma_f32_16x16x32_bf16 v[248:251], v[152:155], a[24:27], v[248:251]
	ds_read_b128 v[148:151], v209 offset:5120
	v_rcp_f32 v180, v180
	v_mfma_f32_16x16x32_bf16 v[252:255], v[152:155], a[28:31], v[252:255]
	v_rcp_f32 v181, v181
	v_mfma_f32_16x16x32_bf16 v[212:215], v[156:159], a[24:27], v[212:215]
	ds_read_b128 v[152:155], v209 offset:6144
	v_mul_f32 v182, v182, v180
	v_mfma_f32_16x16x32_bf16 v[216:219], v[156:159], a[28:31], v[216:219]
	v_mul_f32 v183, v183, v181
	buffer_load_dwordx4 v15, s[8:11], s33 offen offset:1024 lds
	s_waitcnt lgkmcnt(5)
	v_mfma_f32_16x16x32_bf16 v[48:51], v[160:163], a[32:35], v[48:51]
	ds_read_b128 v[156:159], v209 offset:7168
	v_cvt_pk_bf16_f32 v197, v182, v183
	v_mfma_f32_16x16x32_bf16 v[52:55], v[160:163], a[36:39], v[52:55]
	v_mul_f32 v184, v28, v28
	v_mfma_f32_16x16x32_bf16 v[56:59], v[164:167], a[32:35], v[56:59]
	ds_read_b128 v[160:163], v209 offset:8192
	v_mul_f32 v185, v29, v29
	v_mfma_f32_16x16x32_bf16 v[60:63], v[164:167], a[36:39], v[60:63]
	v_fma_f32 v184, v184, v11, v10
	buffer_load_dwordx4 v15, s[8:11], s33 offen offset:2048 lds
	s_waitcnt lgkmcnt(5)
	v_mfma_f32_16x16x32_bf16 v[64:67], v[168:171], a[32:35], v[64:67]
	ds_read_b128 v[164:167], v209 offset:9216
	v_fma_f32 v185, v185, v11, v10
	v_mfma_f32_16x16x32_bf16 v[68:71], v[168:171], a[36:39], v[68:71]
	v_mul_f32 v184, v184, v28
	s_add_u32 s34, s23, 5120
	buffer_load_dwordx4 a[8:11], v15, s[8:11], s34 offen sc1
	v_mfma_f32_16x16x32_bf16 v[72:75], v[172:175], a[32:35], v[72:75]
	ds_read_b128 v[168:171], v209 offset:10240
	v_mul_f32 v185, v185, v29
	v_mfma_f32_16x16x32_bf16 v[76:79], v[172:175], a[36:39], v[76:79]
	v_exp_f32 v184, v184
	buffer_load_dwordx4 v15, s[8:11], s33 offen offset:3072 lds
	s_waitcnt lgkmcnt(5)
	v_mfma_f32_16x16x32_bf16 v[224:227], v[144:147], a[32:35], v[224:227]
	ds_read_b128 v[172:175], v209 offset:11264
	v_exp_f32 v185, v185
	v_mfma_f32_16x16x32_bf16 v[228:231], v[144:147], a[36:39], v[228:231]
	v_mul_f32 v186, v28, v44
	v_mfma_f32_16x16x32_bf16 v[232:235], v[148:151], a[32:35], v[232:235]
	ds_read_b128 v[144:147], v209 offset:12288
	v_mul_f32 v187, v29, v45
	v_mfma_f32_16x16x32_bf16 v[236:239], v[148:151], a[36:39], v[236:239]
	v_fma_f32 v184, v184, v13, v13
	s_add_u32 s34, s25, 5120
	buffer_load_dwordx4 a[12:15], v15, s[8:11], s34 offen sc1
	s_waitcnt lgkmcnt(5)
	v_mfma_f32_16x16x32_bf16 v[240:243], v[152:155], a[32:35], v[240:243]
	ds_read_b128 v[148:151], v209 offset:13312
	v_fma_f32 v185, v185, v13, v13
	v_mfma_f32_16x16x32_bf16 v[244:247], v[152:155], a[36:39], v[244:247]
	v_rcp_f32 v184, v184
	v_mfma_f32_16x16x32_bf16 v[248:251], v[156:159], a[32:35], v[248:251]
	ds_read_b128 v[152:155], v209 offset:14336
	v_rcp_f32 v185, v185
	v_mfma_f32_16x16x32_bf16 v[252:255], v[156:159], a[36:39], v[252:255]
	v_mul_f32 v186, v186, v184
	s_add_u32 m0, s37, 118784
	s_add_u32 s33, s27, 45056
	buffer_load_dwordx4 v15, s[8:11], s33 offen offset:0 lds
	s_waitcnt lgkmcnt(5)
	v_mfma_f32_16x16x32_bf16 v[212:215], v[160:163], a[32:35], v[212:215]
	ds_read_b128 v[156:159], v209 offset:15360
	v_mul_f32 v187, v187, v185
	v_mfma_f32_16x16x32_bf16 v[216:219], v[160:163], a[36:39], v[216:219]
	v_cvt_pk_bf16_f32 v198, v186, v187
	v_mfma_f32_16x16x32_bf16 v[48:51], v[164:167], a[40:43], v[48:51]
	ds_read_b128 v[160:163], v209 offset:16384
	v_mul_f32 v188, v30, v30
	v_mfma_f32_16x16x32_bf16 v[52:55], v[164:167], a[44:47], v[52:55]
	v_mul_f32 v189, v31, v31
	s_waitcnt lgkmcnt(5)
	v_mfma_f32_16x16x32_bf16 v[56:59], v[168:171], a[40:43], v[56:59]
	ds_read_b128 v[164:167], v209 offset:17408
	v_fma_f32 v188, v188, v11, v10
	v_mfma_f32_16x16x32_bf16 v[60:63], v[168:171], a[44:47], v[60:63]
	v_fma_f32 v189, v189, v11, v10
	v_mfma_f32_16x16x32_bf16 v[64:67], v[172:175], a[40:43], v[64:67]
	ds_read_b128 v[168:171], v209 offset:18432
	v_mul_f32 v188, v188, v30
	v_mfma_f32_16x16x32_bf16 v[68:71], v[172:175], a[44:47], v[68:71]
	v_mul_f32 v189, v189, v31
	s_add_u32 s34, s23, 14336
	buffer_load_dwordx4 a[16:19], v15, s[8:11], s34 offen sc1
	s_waitcnt lgkmcnt(5)
	v_mfma_f32_16x16x32_bf16 v[72:75], v[144:147], a[40:43], v[72:75]
	ds_read_b128 v[172:175], v209 offset:19456
	v_exp_f32 v188, v188
	v_mfma_f32_16x16x32_bf16 v[76:79], v[144:147], a[44:47], v[76:79]
	v_exp_f32 v189, v189
	v_mfma_f32_16x16x32_bf16 v[224:227], v[148:151], a[40:43], v[224:227]
	ds_read_b128 v[144:147], v209 offset:20480
	v_mul_f32 v190, v30, v46
	v_mfma_f32_16x16x32_bf16 v[228:231], v[148:151], a[44:47], v[228:231]
	v_mul_f32 v191, v31, v47
	s_waitcnt lgkmcnt(5)
	v_mfma_f32_16x16x32_bf16 v[232:235], v[152:155], a[40:43], v[232:235]
	ds_read_b128 v[148:151], v209 offset:21504
	v_fma_f32 v188, v188, v13, v13
	v_mfma_f32_16x16x32_bf16 v[236:239], v[152:155], a[44:47], v[236:239]
	v_fma_f32 v189, v189, v13, v13
	s_add_u32 s34, s25, 14336
	buffer_load_dwordx4 a[20:23], v15, s[8:11], s34 offen sc1
	v_mfma_f32_16x16x32_bf16 v[240:243], v[156:159], a[40:43], v[240:243]
	ds_read_b128 v[152:155], v209 offset:22528
	v_rcp_f32 v188, v188
	v_mfma_f32_16x16x32_bf16 v[244:247], v[156:159], a[44:47], v[244:247]
	v_rcp_f32 v189, v189
	s_waitcnt lgkmcnt(5)
	v_mfma_f32_16x16x32_bf16 v[248:251], v[160:163], a[40:43], v[248:251]
	ds_read_b128 v[156:159], v209 offset:23552
	v_mul_f32 v190, v190, v188
	v_mfma_f32_16x16x32_bf16 v[252:255], v[160:163], a[44:47], v[252:255]
	v_mul_f32 v191, v191, v189
	v_mfma_f32_16x16x32_bf16 v[212:215], v[164:167], a[40:43], v[212:215]
	ds_read_b128 v[160:163], v209 offset:24576
	v_cvt_pk_bf16_f32 v199, v190, v191
	v_mfma_f32_16x16x32_bf16 v[216:219], v[164:167], a[44:47], v[216:219]
	s_add_u32 s65, s64, 0
	s_waitcnt vmcnt(18)
	s_waitcnt lgkmcnt(5)
	v_mfma_f32_16x16x32_bf16 v[48:51], v[168:171], a[48:51], v[48:51]
	ds_read_b128 v[164:167], v209 offset:25600
	buffer_store_dwordx4 v[196:199], v8, s[8:11], s65 offen offset:512 sc1
	v_mfma_f32_16x16x32_bf16 v[52:55], v[168:171], a[52:55], v[52:55]
	s_barrier
	v_mov_b32 v222, 4
	v_mov_b32 v223, 0
	s_mov_b64 exec, 1
	buffer_store_dword v222, v223, s[8:11], s30 offen sc1
	s_mov_b64 exec, -1
	v_mfma_f32_16x16x32_bf16 v[56:59], v[172:175], a[48:51], v[56:59]
	ds_read_b128 v[168:171], v209 offset:26624
	v_mfma_f32_16x16x32_bf16 v[60:63], v[172:175], a[52:55], v[60:63]
	s_add_u32 m0, s37, 0
	s_add_u32 s33, s26, 55296
	s_waitcnt lgkmcnt(5)
	v_mfma_f32_16x16x32_bf16 v[64:67], v[144:147], a[48:51], v[64:67]
	ds_read_b128 v[172:175], v209 offset:27648
	v_mfma_f32_16x16x32_bf16 v[68:71], v[144:147], a[52:55], v[68:71]
	s_add_u32 s34, s23, 15360
	buffer_load_dwordx4 a[24:27], v15, s[8:11], s34 offen sc1
	v_mfma_f32_16x16x32_bf16 v[72:75], v[148:151], a[48:51], v[72:75]
	ds_read_b128 v[144:147], v209 offset:28672
	v_mfma_f32_16x16x32_bf16 v[76:79], v[148:151], a[52:55], v[76:79]
	buffer_load_dwordx4 v15, s[8:11], s33 offen offset:0 lds
	s_waitcnt lgkmcnt(5)
	v_mfma_f32_16x16x32_bf16 v[224:227], v[152:155], a[48:51], v[224:227]
	ds_read_b128 v[148:151], v209 offset:29696
	v_mfma_f32_16x16x32_bf16 v[228:231], v[152:155], a[52:55], v[228:231]
	v_mfma_f32_16x16x32_bf16 v[232:235], v[156:159], a[48:51], v[232:235]
	ds_read_b128 v[152:155], v209 offset:30720
	v_mfma_f32_16x16x32_bf16 v[236:239], v[156:159], a[52:55], v[236:239]
	s_add_u32 s34, s25, 15360
	buffer_load_dwordx4 a[28:31], v15, s[8:11], s34 offen sc1
	s_waitcnt lgkmcnt(5)
	v_mfma_f32_16x16x32_bf16 v[240:243], v[160:163], a[48:51], v[240:243]
	ds_read_b128 v[156:159], v209 offset:31744
	v_mfma_f32_16x16x32_bf16 v[244:247], v[160:163], a[52:55], v[244:247]
	v_mfma_f32_16x16x32_bf16 v[248:251], v[164:167], a[48:51], v[248:251]
	ds_read_b128 v[160:163], v209 offset:32768
	v_mfma_f32_16x16x32_bf16 v[252:255], v[164:167], a[52:55], v[252:255]
	buffer_load_dwordx4 v15, s[8:11], s33 offen offset:1024 lds
	s_waitcnt lgkmcnt(5)
	v_mfma_f32_16x16x32_bf16 v[212:215], v[168:171], a[48:51], v[212:215]
	ds_read_b128 v[164:167], v209 offset:33792
	v_mfma_f32_16x16x32_bf16 v[216:219], v[168:171], a[52:55], v[216:219]
	s_waitcnt vmcnt(20)
	v_mfma_f32_16x16x32_bf16 v[48:51], v[172:175], a[56:59], v[48:51]
	ds_read_b128 v[168:171], v209 offset:34816
	v_mfma_f32_16x16x32_bf16 v[52:55], v[172:175], a[60:63], v[52:55]
	buffer_load_dwordx4 v15, s[8:11], s33 offen offset:2048 lds
	s_waitcnt lgkmcnt(5)
	v_mfma_f32_16x16x32_bf16 v[56:59], v[144:147], a[56:59], v[56:59]
	ds_read_b128 v[172:175], v209 offset:35840
	v_mfma_f32_16x16x32_bf16 v[60:63], v[144:147], a[60:63], v[60:63]
	v_mfma_f32_16x16x32_bf16 v[64:67], v[148:151], a[56:59], v[64:67]
	ds_read_b128 v[144:147], v210 offset:0
	v_mfma_f32_16x16x32_bf16 v[68:71], v[148:151], a[60:63], v[68:71]
	s_add_u32 s34, s23, 22528
	buffer_load_dwordx4 a[32:35], v15, s[8:11], s34 offen sc1
	s_waitcnt lgkmcnt(5)
	v_mfma_f32_16x16x32_bf16 v[72:75], v[152:155], a[56:59], v[72:75]
	ds_read_b128 v[148:151], v210 offset:1024
	v_mfma_f32_16x16x32_bf16 v[76:79], v[152:155], a[60:63], v[76:79]
	v_mfma_f32_16x16x32_bf16 v[224:227], v[156:159], a[56:59], v[224:227]
	ds_read_b128 v[152:155], v210 offset:2048
	v_mfma_f32_16x16x32_bf16 v[228:231], v[156:159], a[60:63], v[228:231]
	buffer_load_dwordx4 v15, s[8:11], s33 offen offset:3072 lds
	s_waitcnt lgkmcnt(5)
	v_mfma_f32_16x16x32_bf16 v[232:235], v[160:163], a[56:59], v[232:235]
	ds_read_b128 v[156:159], v210 offset:3072
	v_mfma_f32_16x16x32_bf16 v[236:239], v[160:163], a[60:63], v[236:239]
	s_add_u32 s34, s25, 22528
	buffer_load_dwordx4 a[36:39], v15, s[8:11], s34 offen sc1
	v_mfma_f32_16x16x32_bf16 v[240:243], v[164:167], a[56:59], v[240:243]
	ds_read_b128 v[160:163], v210 offset:4096
	v_mfma_f32_16x16x32_bf16 v[244:247], v[164:167], a[60:63], v[244:247]
	s_add_u32 m0, s37, 4096
	s_add_u32 s33, s26, 59392
	buffer_load_dwordx4 v15, s[8:11], s33 offen offset:0 lds
	s_waitcnt lgkmcnt(5)
	v_mfma_f32_16x16x32_bf16 v[248:251], v[168:171], a[56:59], v[248:251]
	ds_read_b128 v[164:167], v210 offset:5120
	v_mfma_f32_16x16x32_bf16 v[252:255], v[168:171], a[60:63], v[252:255]
	v_mfma_f32_16x16x32_bf16 v[212:215], v[172:175], a[56:59], v[212:215]
	ds_read_b128 v[168:171], v210 offset:6144
	v_mfma_f32_16x16x32_bf16 v[216:219], v[172:175], a[60:63], v[216:219]
	buffer_load_dwordx4 v15, s[8:11], s33 offen offset:1024 lds
	s_waitcnt vmcnt(21)
	s_waitcnt lgkmcnt(5)
	v_mfma_f32_16x16x32_bf16 v[48:51], v[144:147], a[0:3], v[48:51]
	ds_read_b128 v[172:175], v210 offset:7168
	v_mfma_f32_16x16x32_bf16 v[52:55], v[144:147], a[4:7], v[52:55]
	v_mfma_f32_16x16x32_bf16 v[56:59], v[148:151], a[0:3], v[56:59]
	ds_read_b128 v[144:147], v210 offset:8192
	v_mfma_f32_16x16x32_bf16 v[60:63], v[148:151], a[4:7], v[60:63]
	buffer_load_dwordx4 v15, s[8:11], s33 offen offset:2048 lds
	s_waitcnt lgkmcnt(5)
	v_mfma_f32_16x16x32_bf16 v[64:67], v[152:155], a[0:3], v[64:67]
	ds_read_b128 v[148:151], v210 offset:9216
	v_mfma_f32_16x16x32_bf16 v[68:71], v[152:155], a[4:7], v[68:71]
	s_add_u32 s34, s23, 23552
	buffer_load_dwordx4 a[40:43], v15, s[8:11], s34 offen sc1
	v_mfma_f32_16x16x32_bf16 v[72:75], v[156:159], a[0:3], v[72:75]
	ds_read_b128 v[152:155], v210 offset:10240
	v_mfma_f32_16x16x32_bf16 v[76:79], v[156:159], a[4:7], v[76:79]
	buffer_load_dwordx4 v15, s[8:11], s33 offen offset:3072 lds
	s_waitcnt lgkmcnt(5)
	v_mfma_f32_16x16x32_bf16 v[224:227], v[160:163], a[0:3], v[224:227]
	ds_read_b128 v[156:159], v210 offset:11264
	v_mfma_f32_16x16x32_bf16 v[228:231], v[160:163], a[4:7], v[228:231]
	v_mfma_f32_16x16x32_bf16 v[232:235], v[164:167], a[0:3], v[232:235]
	ds_read_b128 v[160:163], v210 offset:12288
	v_mfma_f32_16x16x32_bf16 v[236:239], v[164:167], a[4:7], v[236:239]
	s_add_u32 s34, s25, 23552
	buffer_load_dwordx4 a[44:47], v15, s[8:11], s34 offen sc1
	s_waitcnt lgkmcnt(5)
	v_mfma_f32_16x16x32_bf16 v[240:243], v[168:171], a[0:3], v[240:243]
	ds_read_b128 v[164:167], v210 offset:13312
	v_mfma_f32_16x16x32_bf16 v[244:247], v[168:171], a[4:7], v[244:247]
	v_mfma_f32_16x16x32_bf16 v[248:251], v[172:175], a[0:3], v[248:251]
	ds_read_b128 v[168:171], v210 offset:14336
	v_mfma_f32_16x16x32_bf16 v[252:255], v[172:175], a[4:7], v[252:255]
	buffer_load_dword v220, v221, s[8:11], s29 offen sc1
	s_add_u32 m0, s37, 8192
	s_add_u32 s33, s26, 63488
	buffer_load_dwordx4 v15, s[8:11], s33 offen offset:0 lds
	s_waitcnt lgkmcnt(5)
	v_mfma_f32_16x16x32_bf16 v[212:215], v[144:147], a[0:3], v[212:215]
	ds_read_b128 v[172:175], v210 offset:15360
	v_mfma_f32_16x16x32_bf16 v[216:219], v[144:147], a[4:7], v[216:219]
	s_waitcnt vmcnt(21)
	v_mfma_f32_16x16x32_bf16 v[48:51], v[148:151], a[8:11], v[48:51]
	ds_read_b128 v[144:147], v210 offset:16384
	v_mfma_f32_16x16x32_bf16 v[52:55], v[148:151], a[12:15], v[52:55]
	s_waitcnt lgkmcnt(5)
	v_mfma_f32_16x16x32_bf16 v[56:59], v[152:155], a[8:11], v[56:59]
	ds_read_b128 v[148:151], v210 offset:17408
	v_mfma_f32_16x16x32_bf16 v[60:63], v[152:155], a[12:15], v[60:63]
	v_mfma_f32_16x16x32_bf16 v[64:67], v[156:159], a[8:11], v[64:67]
	ds_read_b128 v[152:155], v210 offset:18432
	v_mfma_f32_16x16x32_bf16 v[68:71], v[156:159], a[12:15], v[68:71]
	s_add_u32 s34, s23, 32768
	buffer_load_dwordx4 a[48:51], v15, s[8:11], s34 offen sc1
	s_waitcnt lgkmcnt(5)
	v_mfma_f32_16x16x32_bf16 v[72:75], v[160:163], a[8:11], v[72:75]
	ds_read_b128 v[156:159], v210 offset:19456
	v_mfma_f32_16x16x32_bf16 v[76:79], v[160:163], a[12:15], v[76:79]
	v_mfma_f32_16x16x32_bf16 v[224:227], v[164:167], a[8:11], v[224:227]
	ds_read_b128 v[160:163], v210 offset:20480
	v_mfma_f32_16x16x32_bf16 v[228:231], v[164:167], a[12:15], v[228:231]
	s_waitcnt lgkmcnt(5)
	v_mfma_f32_16x16x32_bf16 v[232:235], v[168:171], a[8:11], v[232:235]
	ds_read_b128 v[164:167], v210 offset:21504
	v_mfma_f32_16x16x32_bf16 v[236:239], v[168:171], a[12:15], v[236:239]
	s_add_u32 s34, s25, 32768
	buffer_load_dwordx4 a[52:55], v15, s[8:11], s34 offen sc1
	v_mfma_f32_16x16x32_bf16 v[240:243], v[172:175], a[8:11], v[240:243]
	ds_read_b128 v[168:171], v210 offset:22528
	v_mfma_f32_16x16x32_bf16 v[244:247], v[172:175], a[12:15], v[244:247]
	s_waitcnt lgkmcnt(5)
	v_mfma_f32_16x16x32_bf16 v[248:251], v[144:147], a[8:11], v[248:251]
	ds_read_b128 v[172:175], v210 offset:23552
	v_mfma_f32_16x16x32_bf16 v[252:255], v[144:147], a[12:15], v[252:255]
	v_mfma_f32_16x16x32_bf16 v[212:215], v[148:151], a[8:11], v[212:215]
	ds_read_b128 v[144:147], v210 offset:24576
	v_mfma_f32_16x16x32_bf16 v[216:219], v[148:151], a[12:15], v[216:219]
	s_waitcnt vmcnt(20)
	s_waitcnt lgkmcnt(5)
	v_mfma_f32_16x16x32_bf16 v[48:51], v[152:155], a[16:19], v[48:51]
	ds_read_b128 v[148:151], v210 offset:25600
	v_mfma_f32_16x16x32_bf16 v[52:55], v[152:155], a[20:23], v[52:55]
	s_barrier
	v_mfma_f32_16x16x32_bf16 v[56:59], v[156:159], a[16:19], v[56:59]
	ds_read_b128 v[152:155], v210 offset:26624
	v_mfma_f32_16x16x32_bf16 v[60:63], v[156:159], a[20:23], v[60:63]
	s_add_u32 m0, s37, 36864
	s_add_u32 s33, s27, 55296
	s_waitcnt lgkmcnt(5)
	v_mfma_f32_16x16x32_bf16 v[64:67], v[160:163], a[16:19], v[64:67]
	ds_read_b128 v[156:159], v210 offset:27648
	v_mfma_f32_16x16x32_bf16 v[68:71], v[160:163], a[20:23], v[68:71]
	s_add_u32 s34, s23, 33792
	buffer_load_dwordx4 a[56:59], v15, s[8:11], s34 offen sc1
	v_mfma_f32_16x16x32_bf16 v[72:75], v[164:167], a[16:19], v[72:75]
	ds_read_b128 v[160:163], v210 offset:28672
	v_mfma_f32_16x16x32_bf16 v[76:79], v[164:167], a[20:23], v[76:79]
	buffer_load_dwordx4 v15, s[8:11], s33 offen offset:0 lds
	s_waitcnt lgkmcnt(5)
	v_mfma_f32_16x16x32_bf16 v[224:227], v[168:171], a[16:19], v[224:227]
	ds_read_b128 v[164:167], v210 offset:29696
	v_mfma_f32_16x16x32_bf16 v[228:231], v[168:171], a[20:23], v[228:231]
	v_mfma_f32_16x16x32_bf16 v[232:235], v[172:175], a[16:19], v[232:235]
	ds_read_b128 v[168:171], v210 offset:30720
	v_mfma_f32_16x16x32_bf16 v[236:239], v[172:175], a[20:23], v[236:239]
	s_add_u32 s34, s25, 33792
	buffer_load_dwordx4 a[60:63], v15, s[8:11], s34 offen sc1
	s_waitcnt lgkmcnt(5)
	v_mfma_f32_16x16x32_bf16 v[240:243], v[144:147], a[16:19], v[240:243]
	ds_read_b128 v[172:175], v210 offset:31744
	v_mfma_f32_16x16x32_bf16 v[244:247], v[144:147], a[20:23], v[244:247]
	v_mfma_f32_16x16x32_bf16 v[248:251], v[148:151], a[16:19], v[248:251]
	ds_read_b128 v[144:147], v210 offset:32768
	v_mfma_f32_16x16x32_bf16 v[252:255], v[148:151], a[20:23], v[252:255]
	buffer_load_dwordx4 v15, s[8:11], s33 offen offset:1024 lds
	s_waitcnt lgkmcnt(5)
	v_mfma_f32_16x16x32_bf16 v[212:215], v[152:155], a[16:19], v[212:215]
	ds_read_b128 v[148:151], v210 offset:33792
	v_mfma_f32_16x16x32_bf16 v[216:219], v[152:155], a[20:23], v[216:219]
	s_waitcnt vmcnt(19)
	v_mfma_f32_16x16x32_bf16 v[48:51], v[156:159], a[24:27], v[48:51]
	ds_read_b128 v[152:155], v210 offset:34816
	v_mfma_f32_16x16x32_bf16 v[52:55], v[156:159], a[28:31], v[52:55]
	s_waitcnt vmcnt(7)
	v_cmp_gt_u32 vcc, 4, v220
	buffer_load_dwordx4 v15, s[8:11], s33 offen offset:2048 lds
	s_waitcnt lgkmcnt(5)
	v_mfma_f32_16x16x32_bf16 v[56:59], v[160:163], a[24:27], v[56:59]
	ds_read_b128 v[156:159], v210 offset:35840
	v_mfma_f32_16x16x32_bf16 v[60:63], v[160:163], a[28:31], v[60:63]
	s_cbranch_vccnz L_k3_spin3
L_k3_back3:
	v_mfma_f32_16x16x32_bf16 v[64:67], v[164:167], a[24:27], v[64:67]
	ds_read_b128 v[160:163], v211 offset:0
	v_mfma_f32_16x16x32_bf16 v[68:71], v[164:167], a[28:31], v[68:71]
	s_add_u32 s34, s23, 6144
	buffer_load_dwordx4 a[0:3], v15, s[8:11], s34 offen sc1
	s_waitcnt lgkmcnt(5)
	v_mfma_f32_16x16x32_bf16 v[72:75], v[168:171], a[24:27], v[72:75]
	ds_read_b128 v[164:167], v211 offset:1024
	v_mfma_f32_16x16x32_bf16 v[76:79], v[168:171], a[28:31], v[76:79]
	v_mfma_f32_16x16x32_bf16 v[224:227], v[172:175], a[24:27], v[224:227]
	ds_read_b128 v[168:171], v211 offset:2048
	v_mfma_f32_16x16x32_bf16 v[228:231], v[172:175], a[28:31], v[228:231]
	buffer_load_dwordx4 v15, s[8:11], s33 offen offset:3072 lds
	s_waitcnt lgkmcnt(5)
	v_mfma_f32_16x16x32_bf16 v[232:235], v[144:147], a[24:27], v[232:235]
	ds_read_b128 v[172:175], v211 offset:3072
	v_mfma_f32_16x16x32_bf16 v[236:239], v[144:147], a[28:31], v[236:239]
	s_add_u32 s34, s25, 6144
	buffer_load_dwordx4 a[4:7], v15, s[8:11], s34 offen sc1
	v_mfma_f32_16x16x32_bf16 v[240:243], v[148:151], a[24:27], v[240:243]
	ds_read_b128 v[144:147], v211 offset:4096
	v_mfma_f32_16x16x32_bf16 v[244:247], v[148:151], a[28:31], v[244:247]
	s_add_u32 m0, s37, 40960
	s_add_u32 s33, s27, 59392
	buffer_load_dwordx4 v15, s[8:11], s33 offen offset:0 lds
	s_waitcnt lgkmcnt(5)
	v_mfma_f32_16x16x32_bf16 v[248:251], v[152:155], a[24:27], v[248:251]
	ds_read_b128 v[148:151], v211 offset:5120
	v_mfma_f32_16x16x32_bf16 v[252:255], v[152:155], a[28:31], v[252:255]
	v_mfma_f32_16x16x32_bf16 v[212:215], v[156:159], a[24:27], v[212:215]
	ds_read_b128 v[152:155], v211 offset:6144
	v_mfma_f32_16x16x32_bf16 v[216:219], v[156:159], a[28:31], v[216:219]
	buffer_load_dwordx4 v15, s[8:11], s33 offen offset:1024 lds
	s_waitcnt lgkmcnt(5)
	v_mfma_f32_16x16x32_bf16 v[48:51], v[160:163], a[32:35], v[48:51]
	ds_read_b128 v[156:159], v211 offset:7168
	v_mfma_f32_16x16x32_bf16 v[52:55], v[160:163], a[36:39], v[52:55]
	v_mfma_f32_16x16x32_bf16 v[56:59], v[164:167], a[32:35], v[56:59]
	ds_read_b128 v[160:163], v211 offset:8192
	v_mfma_f32_16x16x32_bf16 v[60:63], v[164:167], a[36:39], v[60:63]
	buffer_load_dwordx4 v15, s[8:11], s33 offen offset:2048 lds
	s_waitcnt lgkmcnt(5)
	v_mfma_f32_16x16x32_bf16 v[64:67], v[168:171], a[32:35], v[64:67]
	ds_read_b128 v[164:167], v211 offset:9216
	v_mfma_f32_16x16x32_bf16 v[68:71], v[168:171], a[36:39], v[68:71]
	s_add_u32 s34, s23, 7168
	buffer_load_dwordx4 a[8:11], v15, s[8:11], s34 offen sc1
	v_mfma_f32_16x16x32_bf16 v[72:75], v[172:175], a[32:35], v[72:75]
	ds_read_b128 v[168:171], v211 offset:10240
	v_mfma_f32_16x16x32_bf16 v[76:79], v[172:175], a[36:39], v[76:79]
	buffer_load_dwordx4 v15, s[8:11], s33 offen offset:3072 lds
	s_waitcnt lgkmcnt(5)
	v_mfma_f32_16x16x32_bf16 v[224:227], v[144:147], a[32:35], v[224:227]
	ds_read_b128 v[172:175], v211 offset:11264
	v_mfma_f32_16x16x32_bf16 v[228:231], v[144:147], a[36:39], v[228:231]
	v_mfma_f32_16x16x32_bf16 v[232:235], v[148:151], a[32:35], v[232:235]
	ds_read_b128 v[144:147], v211 offset:12288
	v_mfma_f32_16x16x32_bf16 v[236:239], v[148:151], a[36:39], v[236:239]
	s_add_u32 s34, s25, 7168
	buffer_load_dwordx4 a[12:15], v15, s[8:11], s34 offen sc1
	s_waitcnt lgkmcnt(5)
	v_mfma_f32_16x16x32_bf16 v[240:243], v[152:155], a[32:35], v[240:243]
	ds_read_b128 v[148:151], v211 offset:13312
	v_mfma_f32_16x16x32_bf16 v[244:247], v[152:155], a[36:39], v[244:247]
	v_mfma_f32_16x16x32_bf16 v[248:251], v[156:159], a[32:35], v[248:251]
	ds_read_b128 v[152:155], v211 offset:14336
	v_mfma_f32_16x16x32_bf16 v[252:255], v[156:159], a[36:39], v[252:255]
	s_add_u32 m0, s37, 45056
	s_add_u32 s33, s27, 63488
	buffer_load_dwordx4 v15, s[8:11], s33 offen offset:0 lds
	s_waitcnt lgkmcnt(5)
	v_mfma_f32_16x16x32_bf16 v[212:215], v[160:163], a[32:35], v[212:215]
	ds_read_b128 v[156:159], v211 offset:15360
	v_mfma_f32_16x16x32_bf16 v[216:219], v[160:163], a[36:39], v[216:219]
	v_mfma_f32_16x16x32_bf16 v[48:51], v[164:167], a[40:43], v[48:51]
	ds_read_b128 v[160:163], v211 offset:16384
	v_mfma_f32_16x16x32_bf16 v[52:55], v[164:167], a[44:47], v[52:55]
	s_waitcnt lgkmcnt(5)
	v_mfma_f32_16x16x32_bf16 v[56:59], v[168:171], a[40:43], v[56:59]
	ds_read_b128 v[164:167], v211 offset:17408
	v_mfma_f32_16x16x32_bf16 v[60:63], v[168:171], a[44:47], v[60:63]
	v_mfma_f32_16x16x32_bf16 v[64:67], v[172:175], a[40:43], v[64:67]
	ds_read_b128 v[168:171], v211 offset:18432
	v_mfma_f32_16x16x32_bf16 v[68:71], v[172:175], a[44:47], v[68:71]
	s_add_u32 s34, s23, 16384
	buffer_load_dwordx4 a[16:19], v15, s[8:11], s34 offen sc1
	s_waitcnt lgkmcnt(5)
	v_mfma_f32_16x16x32_bf16 v[72:75], v[144:147], a[40:43], v[72:75]
	ds_read_b128 v[172:175], v211 offset:19456
	v_mfma_f32_16x16x32_bf16 v[76:79], v[144:147], a[44:47], v[76:79]
	v_mfma_f32_16x16x32_bf16 v[224:227], v[148:151], a[40:43], v[224:227]
	ds_read_b128 v[144:147], v211 offset:20480
	v_mfma_f32_16x16x32_bf16 v[228:231], v[148:151], a[44:47], v[228:231]
	s_waitcnt lgkmcnt(5)
	v_mfma_f32_16x16x32_bf16 v[232:235], v[152:155], a[40:43], v[232:235]
	ds_read_b128 v[148:151], v211 offset:21504
	v_mfma_f32_16x16x32_bf16 v[236:239], v[152:155], a[44:47], v[236:239]
	s_add_u32 s34, s25, 16384
	buffer_load_dwordx4 a[20:23], v15, s[8:11], s34 offen sc1
	v_mfma_f32_16x16x32_bf16 v[240:243], v[156:159], a[40:43], v[240:243]
	ds_read_b128 v[152:155], v211 offset:22528
	v_mfma_f32_16x16x32_bf16 v[244:247], v[156:159], a[44:47], v[244:247]
	s_waitcnt lgkmcnt(5)
	v_mfma_f32_16x16x32_bf16 v[248:251], v[160:163], a[40:43], v[248:251]
	ds_read_b128 v[156:159], v211 offset:23552
	v_mfma_f32_16x16x32_bf16 v[252:255], v[160:163], a[44:47], v[252:255]
	v_mfma_f32_16x16x32_bf16 v[212:215], v[164:167], a[40:43], v[212:215]
	ds_read_b128 v[160:163], v211 offset:24576
	v_mfma_f32_16x16x32_bf16 v[216:219], v[164:167], a[44:47], v[216:219]
	s_waitcnt vmcnt(17)
	s_waitcnt lgkmcnt(5)
	v_mfma_f32_16x16x32_bf16 v[48:51], v[168:171], a[48:51], v[48:51]
	ds_read_b128 v[164:167], v211 offset:25600
	v_mfma_f32_16x16x32_bf16 v[52:55], v[168:171], a[52:55], v[52:55]
	s_barrier
	v_mov_b32 v222, 5
	v_mov_b32 v223, 0
	s_mov_b64 exec, 1
	buffer_store_dword v222, v223, s[8:11], s30 offen sc1
	s_mov_b64 exec, -1
	v_mfma_f32_16x16x32_bf16 v[56:59], v[172:175], a[48:51], v[56:59]
	ds_read_b128 v[168:171], v211 offset:26624
	v_mfma_f32_16x16x32_bf16 v[60:63], v[172:175], a[52:55], v[60:63]
	s_add_u32 m0, s37, 73728
	s_add_u32 s33, s28, 0
	s_waitcnt lgkmcnt(5)
	v_mfma_f32_16x16x32_bf16 v[64:67], v[144:147], a[48:51], v[64:67]
	ds_read_b128 v[172:175], v211 offset:27648
	v_mfma_f32_16x16x32_bf16 v[68:71], v[144:147], a[52:55], v[68:71]
	s_add_u32 s34, s23, 17408
	buffer_load_dwordx4 a[24:27], v15, s[8:11], s34 offen sc1
	v_mfma_f32_16x16x32_bf16 v[72:75], v[148:151], a[48:51], v[72:75]
	ds_read_b128 v[144:147], v211 offset:28672
	v_mfma_f32_16x16x32_bf16 v[76:79], v[148:151], a[52:55], v[76:79]
	buffer_load_dwordx4 v15, s[8:11], s33 offen offset:0 lds
	s_waitcnt lgkmcnt(5)
	v_mfma_f32_16x16x32_bf16 v[224:227], v[152:155], a[48:51], v[224:227]
	ds_read_b128 v[148:151], v211 offset:29696
	v_mfma_f32_16x16x32_bf16 v[228:231], v[152:155], a[52:55], v[228:231]
	v_mfma_f32_16x16x32_bf16 v[232:235], v[156:159], a[48:51], v[232:235]
	ds_read_b128 v[152:155], v211 offset:30720
	v_mfma_f32_16x16x32_bf16 v[236:239], v[156:159], a[52:55], v[236:239]
	s_add_u32 s34, s25, 17408
	buffer_load_dwordx4 a[28:31], v15, s[8:11], s34 offen sc1
	s_waitcnt lgkmcnt(5)
	v_mfma_f32_16x16x32_bf16 v[240:243], v[160:163], a[48:51], v[240:243]
	ds_read_b128 v[156:159], v211 offset:31744
	v_mfma_f32_16x16x32_bf16 v[244:247], v[160:163], a[52:55], v[244:247]
	v_mfma_f32_16x16x32_bf16 v[248:251], v[164:167], a[48:51], v[248:251]
	ds_read_b128 v[160:163], v211 offset:32768
	v_mfma_f32_16x16x32_bf16 v[252:255], v[164:167], a[52:55], v[252:255]
	buffer_load_dwordx4 v15, s[8:11], s33 offen offset:1024 lds
	s_waitcnt lgkmcnt(5)
	v_mfma_f32_16x16x32_bf16 v[212:215], v[168:171], a[48:51], v[212:215]
	ds_read_b128 v[164:167], v211 offset:33792
	v_mfma_f32_16x16x32_bf16 v[216:219], v[168:171], a[52:55], v[216:219]
	s_waitcnt vmcnt(19)
	v_mfma_f32_16x16x32_bf16 v[48:51], v[172:175], a[56:59], v[48:51]
	ds_read_b128 v[168:171], v211 offset:34816
	v_mfma_f32_16x16x32_bf16 v[52:55], v[172:175], a[60:63], v[52:55]
	buffer_load_dwordx4 v15, s[8:11], s33 offen offset:2048 lds
	s_waitcnt lgkmcnt(5)
	v_mfma_f32_16x16x32_bf16 v[56:59], v[144:147], a[56:59], v[56:59]
	ds_read_b128 v[172:175], v211 offset:35840
	v_mfma_f32_16x16x32_bf16 v[60:63], v[144:147], a[60:63], v[60:63]
	v_mfma_f32_16x16x32_bf16 v[64:67], v[148:151], a[56:59], v[64:67]
	ds_read_b128 v[144:147], v208 offset:0
	v_mfma_f32_16x16x32_bf16 v[68:71], v[148:151], a[60:63], v[68:71]
	s_add_u32 s34, s23, 24576
	buffer_load_dwordx4 a[32:35], v15, s[8:11], s34 offen sc1
	s_waitcnt lgkmcnt(5)
	v_mfma_f32_16x16x32_bf16 v[72:75], v[152:155], a[56:59], v[72:75]
	ds_read_b128 v[148:151], v208 offset:1024
	v_mfma_f32_16x16x32_bf16 v[76:79], v[152:155], a[60:63], v[76:79]
	v_mfma_f32_16x16x32_bf16 v[224:227], v[156:159], a[56:59], v[224:227]
	ds_read_b128 v[152:155], v208 offset:2048
	v_mfma_f32_16x16x32_bf16 v[228:231], v[156:159], a[60:63], v[228:231]
	buffer_load_dwordx4 v15, s[8:11], s33 offen offset:3072 lds
	s_waitcnt lgkmcnt(5)
	v_mfma_f32_16x16x32_bf16 v[232:235], v[160:163], a[56:59], v[232:235]
	ds_read_b128 v[156:159], v208 offset:3072
	v_mfma_f32_16x16x32_bf16 v[236:239], v[160:163], a[60:63], v[236:239]
	s_add_u32 s34, s25, 24576
	buffer_load_dwordx4 a[36:39], v15, s[8:11], s34 offen sc1
	v_mfma_f32_16x16x32_bf16 v[240:243], v[164:167], a[56:59], v[240:243]
	ds_read_b128 v[160:163], v208 offset:4096
	v_mfma_f32_16x16x32_bf16 v[244:247], v[164:167], a[60:63], v[244:247]
	s_add_u32 m0, s37, 77824
	s_add_u32 s33, s28, 4096
	buffer_load_dwordx4 v15, s[8:11], s33 offen offset:0 lds
	s_waitcnt lgkmcnt(5)
	v_mfma_f32_16x16x32_bf16 v[248:251], v[168:171], a[56:59], v[248:251]
	ds_read_b128 v[164:167], v208 offset:5120
	v_mfma_f32_16x16x32_bf16 v[252:255], v[168:171], a[60:63], v[252:255]
	v_mfma_f32_16x16x32_bf16 v[212:215], v[172:175], a[56:59], v[212:215]
	ds_read_b128 v[168:171], v208 offset:6144
	v_mfma_f32_16x16x32_bf16 v[216:219], v[172:175], a[60:63], v[216:219]
	buffer_load_dwordx4 v15, s[8:11], s33 offen offset:1024 lds
	s_waitcnt vmcnt(20)
	s_waitcnt lgkmcnt(5)
	v_mfma_f32_16x16x32_bf16 v[48:51], v[144:147], a[0:3], v[48:51]
	ds_read_b128 v[172:175], v208 offset:7168
	v_mfma_f32_16x16x32_bf16 v[52:55], v[144:147], a[4:7], v[52:55]
	v_mfma_f32_16x16x32_bf16 v[56:59], v[148:151], a[0:3], v[56:59]
	ds_read_b128 v[144:147], v208 offset:8192
	v_mfma_f32_16x16x32_bf16 v[60:63], v[148:151], a[4:7], v[60:63]
	buffer_load_dwordx4 v15, s[8:11], s33 offen offset:2048 lds
	s_waitcnt lgkmcnt(5)
	v_mfma_f32_16x16x32_bf16 v[64:67], v[152:155], a[0:3], v[64:67]
	ds_read_b128 v[148:151], v208 offset:9216
	v_mfma_f32_16x16x32_bf16 v[68:71], v[152:155], a[4:7], v[68:71]
	s_add_u32 s34, s23, 25600
	buffer_load_dwordx4 a[40:43], v15, s[8:11], s34 offen sc1
	v_mfma_f32_16x16x32_bf16 v[72:75], v[156:159], a[0:3], v[72:75]
	ds_read_b128 v[152:155], v208 offset:10240
	v_mfma_f32_16x16x32_bf16 v[76:79], v[156:159], a[4:7], v[76:79]
	buffer_load_dwordx4 v15, s[8:11], s33 offen offset:3072 lds
	s_waitcnt lgkmcnt(5)
	v_mfma_f32_16x16x32_bf16 v[224:227], v[160:163], a[0:3], v[224:227]
	ds_read_b128 v[156:159], v208 offset:11264
	v_mfma_f32_16x16x32_bf16 v[228:231], v[160:163], a[4:7], v[228:231]
	v_mfma_f32_16x16x32_bf16 v[232:235], v[164:167], a[0:3], v[232:235]
	ds_read_b128 v[160:163], v208 offset:12288
	v_mfma_f32_16x16x32_bf16 v[236:239], v[164:167], a[4:7], v[236:239]
	s_add_u32 s34, s25, 25600
	buffer_load_dwordx4 a[44:47], v15, s[8:11], s34 offen sc1
	s_waitcnt lgkmcnt(5)
	v_mfma_f32_16x16x32_bf16 v[240:243], v[168:171], a[0:3], v[240:243]
	ds_read_b128 v[164:167], v208 offset:13312
	v_mfma_f32_16x16x32_bf16 v[244:247], v[168:171], a[4:7], v[244:247]
	v_mfma_f32_16x16x32_bf16 v[248:251], v[172:175], a[0:3], v[248:251]
	ds_read_b128 v[168:171], v208 offset:14336
	v_mfma_f32_16x16x32_bf16 v[252:255], v[172:175], a[4:7], v[252:255]
	buffer_load_dword v220, v221, s[8:11], s29 offen sc1
	s_add_u32 m0, s37, 81920
	s_add_u32 s33, s28, 8192
	buffer_load_dwordx4 v15, s[8:11], s33 offen offset:0 lds
	s_waitcnt lgkmcnt(5)
	v_mfma_f32_16x16x32_bf16 v[212:215], v[144:147], a[0:3], v[212:215]
	ds_read_b128 v[172:175], v208 offset:15360
	v_mfma_f32_16x16x32_bf16 v[216:219], v[144:147], a[4:7], v[216:219]
	s_waitcnt vmcnt(20)
	v_mfma_f32_16x16x32_bf16 v[48:51], v[148:151], a[8:11], v[48:51]
	ds_read_b128 v[144:147], v208 offset:16384
	v_mfma_f32_16x16x32_bf16 v[52:55], v[148:151], a[12:15], v[52:55]
	s_waitcnt lgkmcnt(5)
	v_mfma_f32_16x16x32_bf16 v[56:59], v[152:155], a[8:11], v[56:59]
	ds_read_b128 v[148:151], v208 offset:17408
	v_mfma_f32_16x16x32_bf16 v[60:63], v[152:155], a[12:15], v[60:63]
	v_mfma_f32_16x16x32_bf16 v[64:67], v[156:159], a[8:11], v[64:67]
	ds_read_b128 v[152:155], v208 offset:18432
	v_mfma_f32_16x16x32_bf16 v[68:71], v[156:159], a[12:15], v[68:71]
	s_add_u32 s34, s23, 34816
	buffer_load_dwordx4 a[48:51], v15, s[8:11], s34 offen sc1
	s_waitcnt lgkmcnt(5)
	v_mfma_f32_16x16x32_bf16 v[72:75], v[160:163], a[8:11], v[72:75]
	ds_read_b128 v[156:159], v208 offset:19456
	v_mfma_f32_16x16x32_bf16 v[76:79], v[160:163], a[12:15], v[76:79]
	v_mfma_f32_16x16x32_bf16 v[224:227], v[164:167], a[8:11], v[224:227]
	ds_read_b128 v[160:163], v208 offset:20480
	v_mfma_f32_16x16x32_bf16 v[228:231], v[164:167], a[12:15], v[228:231]
	s_waitcnt lgkmcnt(5)
	v_mfma_f32_16x16x32_bf16 v[232:235], v[168:171], a[8:11], v[232:235]
	ds_read_b128 v[164:167], v208 offset:21504
	v_mfma_f32_16x16x32_bf16 v[236:239], v[168:171], a[12:15], v[236:239]
	s_add_u32 s34, s25, 34816
	buffer_load_dwordx4 a[52:55], v15, s[8:11], s34 offen sc1
	v_mfma_f32_16x16x32_bf16 v[240:243], v[172:175], a[8:11], v[240:243]
	ds_read_b128 v[168:171], v208 offset:22528
	v_mfma_f32_16x16x32_bf16 v[244:247], v[172:175], a[12:15], v[244:247]
	s_waitcnt lgkmcnt(5)
	v_mfma_f32_16x16x32_bf16 v[248:251], v[144:147], a[8:11], v[248:251]
	ds_read_b128 v[172:175], v208 offset:23552
	v_mfma_f32_16x16x32_bf16 v[252:255], v[144:147], a[12:15], v[252:255]
	v_mfma_f32_16x16x32_bf16 v[212:215], v[148:151], a[8:11], v[212:215]
	ds_read_b128 v[144:147], v208 offset:24576
	v_mfma_f32_16x16x32_bf16 v[216:219], v[148:151], a[12:15], v[216:219]
	s_waitcnt vmcnt(19)
	s_waitcnt lgkmcnt(5)
	v_mfma_f32_16x16x32_bf16 v[48:51], v[152:155], a[16:19], v[48:51]
	ds_read_b128 v[148:151], v208 offset:25600
	v_mfma_f32_16x16x32_bf16 v[52:55], v[152:155], a[20:23], v[52:55]
	s_barrier
	v_mfma_f32_16x16x32_bf16 v[56:59], v[156:159], a[16:19], v[56:59]
	ds_read_b128 v[152:155], v208 offset:26624
	v_mfma_f32_16x16x32_bf16 v[60:63], v[156:159], a[20:23], v[60:63]
	s_waitcnt lgkmcnt(5)
	v_mfma_f32_16x16x32_bf16 v[64:67], v[160:163], a[16:19], v[64:67]
	ds_read_b128 v[156:159], v208 offset:27648
	v_mfma_f32_16x16x32_bf16 v[68:71], v[160:163], a[20:23], v[68:71]
	s_add_u32 s34, s23, 35840
	buffer_load_dwordx4 a[56:59], v15, s[8:11], s34 offen sc1
	v_mfma_f32_16x16x32_bf16 v[72:75], v[164:167], a[16:19], v[72:75]
	ds_read_b128 v[160:163], v208 offset:28672
	v_mfma_f32_16x16x32_bf16 v[76:79], v[164:167], a[20:23], v[76:79]
	s_waitcnt lgkmcnt(5)
	v_mfma_f32_16x16x32_bf16 v[224:227], v[168:171], a[16:19], v[224:227]
	ds_read_b128 v[164:167], v208 offset:29696
	v_mfma_f32_16x16x32_bf16 v[228:231], v[168:171], a[20:23], v[228:231]
	v_mfma_f32_16x16x32_bf16 v[232:235], v[172:175], a[16:19], v[232:235]
	ds_read_b128 v[168:171], v208 offset:30720
	v_mfma_f32_16x16x32_bf16 v[236:239], v[172:175], a[20:23], v[236:239]
	s_add_u32 s34, s25, 35840
	buffer_load_dwordx4 a[60:63], v15, s[8:11], s34 offen sc1
	s_waitcnt lgkmcnt(5)
	v_mfma_f32_16x16x32_bf16 v[240:243], v[144:147], a[16:19], v[240:243]
	ds_read_b128 v[172:175], v208 offset:31744
	v_mfma_f32_16x16x32_bf16 v[244:247], v[144:147], a[20:23], v[244:247]
	v_mfma_f32_16x16x32_bf16 v[248:251], v[148:151], a[16:19], v[248:251]
	ds_read_b128 v[144:147], v208 offset:32768
	v_mfma_f32_16x16x32_bf16 v[252:255], v[148:151], a[20:23], v[252:255]
	s_waitcnt lgkmcnt(5)
	v_mfma_f32_16x16x32_bf16 v[212:215], v[152:155], a[16:19], v[212:215]
	ds_read_b128 v[148:151], v208 offset:33792
	v_mfma_f32_16x16x32_bf16 v[216:219], v[152:155], a[20:23], v[216:219]
	s_waitcnt vmcnt(17)
	v_mfma_f32_16x16x32_bf16 v[48:51], v[156:159], a[24:27], v[48:51]
	ds_read_b128 v[152:155], v208 offset:34816
	v_mfma_f32_16x16x32_bf16 v[52:55], v[156:159], a[28:31], v[52:55]
	s_waitcnt vmcnt(5)
	v_cmp_gt_u32 vcc, 5, v220
	s_waitcnt lgkmcnt(5)
	v_mfma_f32_16x16x32_bf16 v[56:59], v[160:163], a[24:27], v[56:59]
	ds_read_b128 v[156:159], v208 offset:35840
	v_mfma_f32_16x16x32_bf16 v[60:63], v[160:163], a[28:31], v[60:63]
	s_nop 0
	s_cbranch_vccnz L_k3_spin4
L_k3_back4:
	v_mfma_f32_16x16x32_bf16 v[64:67], v[164:167], a[24:27], v[64:67]
	ds_read_b128 v[160:163], v209 offset:0
	v_mfma_f32_16x16x32_bf16 v[68:71], v[164:167], a[28:31], v[68:71]
	s_add_u32 s34, s23, 8192
	buffer_load_dwordx4 a[0:3], v15, s[8:11], s34 offen sc1
	s_waitcnt lgkmcnt(5)
	v_mfma_f32_16x16x32_bf16 v[72:75], v[168:171], a[24:27], v[72:75]
	ds_read_b128 v[164:167], v209 offset:1024
	v_mfma_f32_16x16x32_bf16 v[76:79], v[168:171], a[28:31], v[76:79]
	v_mfma_f32_16x16x32_bf16 v[224:227], v[172:175], a[24:27], v[224:227]
	ds_read_b128 v[168:171], v209 offset:2048
	v_mfma_f32_16x16x32_bf16 v[228:231], v[172:175], a[28:31], v[228:231]
	s_waitcnt lgkmcnt(5)
	v_mfma_f32_16x16x32_bf16 v[232:235], v[144:147], a[24:27], v[232:235]
	ds_read_b128 v[172:175], v209 offset:3072
	v_mfma_f32_16x16x32_bf16 v[236:239], v[144:147], a[28:31], v[236:239]
	s_add_u32 s34, s25, 8192
	buffer_load_dwordx4 a[4:7], v15, s[8:11], s34 offen sc1
	v_mfma_f32_16x16x32_bf16 v[240:243], v[148:151], a[24:27], v[240:243]
	ds_read_b128 v[144:147], v209 offset:4096
	v_mfma_f32_16x16x32_bf16 v[244:247], v[148:151], a[28:31], v[244:247]
	s_waitcnt lgkmcnt(5)
	v_mfma_f32_16x16x32_bf16 v[248:251], v[152:155], a[24:27], v[248:251]
	ds_read_b128 v[148:151], v209 offset:5120
	v_mfma_f32_16x16x32_bf16 v[252:255], v[152:155], a[28:31], v[252:255]
	v_mfma_f32_16x16x32_bf16 v[212:215], v[156:159], a[24:27], v[212:215]
	ds_read_b128 v[152:155], v209 offset:6144
	v_mfma_f32_16x16x32_bf16 v[216:219], v[156:159], a[28:31], v[216:219]
	s_waitcnt lgkmcnt(5)
	v_mfma_f32_16x16x32_bf16 v[48:51], v[160:163], a[32:35], v[48:51]
	ds_read_b128 v[156:159], v209 offset:7168
	v_mfma_f32_16x16x32_bf16 v[52:55], v[160:163], a[36:39], v[52:55]
	v_mfma_f32_16x16x32_bf16 v[56:59], v[164:167], a[32:35], v[56:59]
	ds_read_b128 v[160:163], v209 offset:8192
	v_mfma_f32_16x16x32_bf16 v[60:63], v[164:167], a[36:39], v[60:63]
	s_waitcnt lgkmcnt(5)
	v_mfma_f32_16x16x32_bf16 v[64:67], v[168:171], a[32:35], v[64:67]
	ds_read_b128 v[164:167], v209 offset:9216
	v_mfma_f32_16x16x32_bf16 v[68:71], v[168:171], a[36:39], v[68:71]
	s_add_u32 s34, s23, 9216
	buffer_load_dwordx4 a[8:11], v15, s[8:11], s34 offen sc1
	v_mfma_f32_16x16x32_bf16 v[72:75], v[172:175], a[32:35], v[72:75]
	ds_read_b128 v[168:171], v209 offset:10240
	v_mfma_f32_16x16x32_bf16 v[76:79], v[172:175], a[36:39], v[76:79]
	s_waitcnt lgkmcnt(5)
	v_mfma_f32_16x16x32_bf16 v[224:227], v[144:147], a[32:35], v[224:227]
	ds_read_b128 v[172:175], v209 offset:11264
	v_mfma_f32_16x16x32_bf16 v[228:231], v[144:147], a[36:39], v[228:231]
	v_mfma_f32_16x16x32_bf16 v[232:235], v[148:151], a[32:35], v[232:235]
	ds_read_b128 v[144:147], v209 offset:12288
	v_mfma_f32_16x16x32_bf16 v[236:239], v[148:151], a[36:39], v[236:239]
	s_add_u32 s34, s25, 9216
	buffer_load_dwordx4 a[12:15], v15, s[8:11], s34 offen sc1
	s_waitcnt lgkmcnt(5)
	v_mfma_f32_16x16x32_bf16 v[240:243], v[152:155], a[32:35], v[240:243]
	ds_read_b128 v[148:151], v209 offset:13312
	v_mfma_f32_16x16x32_bf16 v[244:247], v[152:155], a[36:39], v[244:247]
	v_mfma_f32_16x16x32_bf16 v[248:251], v[156:159], a[32:35], v[248:251]
	ds_read_b128 v[152:155], v209 offset:14336
	v_mfma_f32_16x16x32_bf16 v[252:255], v[156:159], a[36:39], v[252:255]
	s_add_u32 s34, s23, 26624
	buffer_load_dwordx4 a[16:19], v15, s[8:11], s34 offen sc1
	s_waitcnt lgkmcnt(5)
	v_mfma_f32_16x16x32_bf16 v[212:215], v[160:163], a[32:35], v[212:215]
	ds_read_b128 v[156:159], v209 offset:15360
	v_mfma_f32_16x16x32_bf16 v[216:219], v[160:163], a[36:39], v[216:219]
	s_add_u32 s34, s25, 26624
	buffer_load_dwordx4 a[20:23], v15, s[8:11], s34 offen sc1
	v_mfma_f32_16x16x32_bf16 v[48:51], v[164:167], a[40:43], v[48:51]
	ds_read_b128 v[160:163], v209 offset:16384
	v_mfma_f32_16x16x32_bf16 v[52:55], v[164:167], a[44:47], v[52:55]
	s_waitcnt lgkmcnt(5)
	v_mfma_f32_16x16x32_bf16 v[56:59], v[168:171], a[40:43], v[56:59]
	ds_read_b128 v[164:167], v209 offset:17408
	v_mfma_f32_16x16x32_bf16 v[60:63], v[168:171], a[44:47], v[60:63]
	v_mfma_f32_16x16x32_bf16 v[64:67], v[172:175], a[40:43], v[64:67]
	ds_read_b128 v[168:171], v209 offset:18432
	v_mfma_f32_16x16x32_bf16 v[68:71], v[172:175], a[44:47], v[68:71]
	s_waitcnt lgkmcnt(5)
	v_mfma_f32_16x16x32_bf16 v[72:75], v[144:147], a[40:43], v[72:75]
	ds_read_b128 v[172:175], v209 offset:19456
	v_mfma_f32_16x16x32_bf16 v[76:79], v[144:147], a[44:47], v[76:79]
	v_mfma_f32_16x16x32_bf16 v[224:227], v[148:151], a[40:43], v[224:227]
	ds_read_b128 v[144:147], v209 offset:20480
	v_mfma_f32_16x16x32_bf16 v[228:231], v[148:151], a[44:47], v[228:231]
	s_waitcnt lgkmcnt(5)
	v_mfma_f32_16x16x32_bf16 v[232:235], v[152:155], a[40:43], v[232:235]
	ds_read_b128 v[148:151], v209 offset:21504
	v_mfma_f32_16x16x32_bf16 v[236:239], v[152:155], a[44:47], v[236:239]
	v_mfma_f32_16x16x32_bf16 v[240:243], v[156:159], a[40:43], v[240:243]
	ds_read_b128 v[152:155], v209 offset:22528
	v_mfma_f32_16x16x32_bf16 v[244:247], v[156:159], a[44:47], v[244:247]
	s_waitcnt lgkmcnt(5)
	v_mfma_f32_16x16x32_bf16 v[248:251], v[160:163], a[40:43], v[248:251]
	ds_read_b128 v[156:159], v209 offset:23552
	v_mfma_f32_16x16x32_bf16 v[252:255], v[160:163], a[44:47], v[252:255]
	s_add_u32 s34, s23, 27648
	buffer_load_dwordx4 a[24:27], v15, s[8:11], s34 offen sc1
	v_mfma_f32_16x16x32_bf16 v[212:215], v[164:167], a[40:43], v[212:215]
	ds_read_b128 v[160:163], v209 offset:24576
	v_mfma_f32_16x16x32_bf16 v[216:219], v[164:167], a[44:47], v[216:219]
	s_add_u32 s34, s25, 27648
	buffer_load_dwordx4 a[28:31], v15, s[8:11], s34 offen sc1
	s_waitcnt vmcnt(10)
	s_waitcnt lgkmcnt(5)
	v_mfma_f32_16x16x32_bf16 v[48:51], v[168:171], a[48:51], v[48:51]
	ds_read_b128 v[164:167], v209 offset:25600
	v_mfma_f32_16x16x32_bf16 v[52:55], v[168:171], a[52:55], v[52:55]
	s_barrier
	v_mfma_f32_16x16x32_bf16 v[56:59], v[172:175], a[48:51], v[56:59]
	ds_read_b128 v[168:171], v209 offset:26624
	v_mfma_f32_16x16x32_bf16 v[60:63], v[172:175], a[52:55], v[60:63]
	s_waitcnt lgkmcnt(5)
	v_mfma_f32_16x16x32_bf16 v[64:67], v[144:147], a[48:51], v[64:67]
	ds_read_b128 v[172:175], v209 offset:27648
	v_mfma_f32_16x16x32_bf16 v[68:71], v[144:147], a[52:55], v[68:71]
	v_mfma_f32_16x16x32_bf16 v[72:75], v[148:151], a[48:51], v[72:75]
	ds_read_b128 v[144:147], v209 offset:28672
	v_mfma_f32_16x16x32_bf16 v[76:79], v[148:151], a[52:55], v[76:79]
	v_and_b32 v2, 15, v1
	v_lshrrev_b32 v3, 4, v1
	v_mul_u32_u24 v5, 2304, v2
	v_and_b32 v6, 1, v3
	v_lshlrev_b32 v6, 5, v6
	v_lshrrev_b32 v7, 1, v3
	v_lshl_add_u32 v6, v7, 4, v6
	v_lshlrev_b32 v8, 1, v6
	v_add_u32 v6, v5, v6
	v_lshl_add_u32 v7, v3, 3, v5
	v_lshlrev_b32 v9, 4, v3
	v_lshlrev_b32 v10, 3, v1
	v_and_b32 v11, 1, v3
	v_lshlrev_b32 v11, 10, v11
	v_lshrrev_b32 v12, 1, v3
	v_lshl_add_u32 v11, v12, 9, v11
	v_lshl_add_u32 v11, v2, 4, v11
	v_lshlrev_b32 v12, 8, v3
	v_lshl_add_u32 v12, v2, 4, v12
	s_lshl_b32 s44, s22, 2
	s_add_u32 s44, s44, s49
	s_lshl_b32 s45, s44, 2
	s_add_u32 s46, s45, s3
	s_lshl_b32 s46, s46, 2
	s_add_u32 s46, s46, s20
	s_mul_i32 s46, s46, 9216
	s_add_u32 s46, s46, 33390592
	s_lshl_b32 s47, s45, 2
	s_add_u32 s47, s47, s20
	s_mul_i32 s47, s47, 9216
	s_add_u32 s47, s47, 33390592
	s_lshl_b32 s48, s44, 7
	s_add_u32 s48, s48, 48136192
	s_lshl_b32 s50, s22, 7
	s_lshl_b32 s51, s20, 5
	s_add_u32 s50, s50, s51
	s_mul_i32 s50, s50, 1152
	s_mul_i32 s51, s49, 288
	s_add_u32 s50, s50, s51
	s_lshl_b32 s51, s3, 6
	s_add_u32 s51, s51, s50
	s_mul_i32 s52, s49, 576
	s_add_u32 s52, s52, 61952
	s_lshl_b32 s53, s3, 7
	s_add_u32 s53, s53, s52
	s_mul_i32 s54, s24, 36864
	s_mul_i32 s55, s49, 9216
	s_add_u32 s54, s54, s55
	s_add_u32 s54, s54, 9797632
	s_lshl_b32 s55, s3, 11
	s_add_u32 s55, s55, s54
	s_and_b32 s56, s3, 1
	s_lshl_b32 s57, s56, 3
	s_add_u32 s57, s57, s54
	s_add_u32 s57, s57, 8192
	s_mul_i32 s56, s56, 1152
	s_add_u32 s56, s56, s50
	s_add_u32 s56, s56, 256
	s_add_u32 s58, s52, 512
	s_waitcnt lgkmcnt(5)
	v_mfma_f32_16x16x32_bf16 v[224:227], v[152:155], a[48:51], v[224:227]
	ds_read_b128 v[148:151], v209 offset:29696
	v_mfma_f32_16x16x32_bf16 v[228:231], v[152:155], a[52:55], v[228:231]
	v_mfma_f32_16x16x32_bf16 v[232:235], v[156:159], a[48:51], v[232:235]
	ds_read_b128 v[152:155], v209 offset:30720
	v_mfma_f32_16x16x32_bf16 v[236:239], v[156:159], a[52:55], v[236:239]
	s_waitcnt lgkmcnt(5)
	v_mfma_f32_16x16x32_bf16 v[240:243], v[160:163], a[48:51], v[240:243]
	ds_read_b128 v[156:159], v209 offset:31744
	v_mfma_f32_16x16x32_bf16 v[244:247], v[160:163], a[52:55], v[244:247]
	v_mfma_f32_16x16x32_bf16 v[248:251], v[164:167], a[48:51], v[248:251]
	ds_read_b128 v[160:163], v209 offset:32768
	v_mfma_f32_16x16x32_bf16 v[252:255], v[164:167], a[52:55], v[252:255]
	s_waitcnt lgkmcnt(5)
	v_mfma_f32_16x16x32_bf16 v[212:215], v[168:171], a[48:51], v[212:215]
	ds_read_b128 v[164:167], v209 offset:33792
	v_mfma_f32_16x16x32_bf16 v[216:219], v[168:171], a[52:55], v[216:219]
	s_waitcnt vmcnt(8)
	v_mfma_f32_16x16x32_bf16 v[48:51], v[172:175], a[56:59], v[48:51]
	ds_read_b128 v[168:171], v209 offset:34816
	v_mfma_f32_16x16x32_bf16 v[52:55], v[172:175], a[60:63], v[52:55]
	s_waitcnt lgkmcnt(5)
	v_mfma_f32_16x16x32_bf16 v[56:59], v[144:147], a[56:59], v[56:59]
	ds_read_b128 v[172:175], v209 offset:35840
	v_mfma_f32_16x16x32_bf16 v[60:63], v[144:147], a[60:63], v[60:63]
	v_mfma_f32_16x16x32_bf16 v[64:67], v[148:151], a[56:59], v[64:67]
	ds_read_b128 v[144:147], v210 offset:0
	v_mfma_f32_16x16x32_bf16 v[68:71], v[148:151], a[60:63], v[68:71]
	s_waitcnt lgkmcnt(5)
	v_mfma_f32_16x16x32_bf16 v[72:75], v[152:155], a[56:59], v[72:75]
	ds_read_b128 v[148:151], v210 offset:9216
	v_mfma_f32_16x16x32_bf16 v[76:79], v[152:155], a[60:63], v[76:79]
	buffer_load_dwordx2 v[116:117], v11, s[8:11], s55 offen offset:0
	buffer_load_dwordx2 v[118:119], v11, s[8:11], s55 offen offset:256
	buffer_load_dwordx2 v[120:121], v11, s[8:11], s55 offen offset:8
	buffer_load_dwordx2 v[122:123], v11, s[8:11], s55 offen offset:264
	buffer_load_dwordx2 v[124:125], v12, s[8:11], s57 offen
	buffer_load_dwordx4 v[128:131], v8, s[8:11], s53 offen
	buffer_load_dwordx4 v[132:135], v8, s[8:11], s53 offen offset:16
	buffer_load_dwordx4 v[136:139], v9, s[8:11], s58 offen
	v_mfma_f32_16x16x32_bf16 v[224:227], v[156:159], a[56:59], v[224:227]
	ds_read_b128 v[152:155], v210 offset:18432
	v_mfma_f32_16x16x32_bf16 v[228:231], v[156:159], a[60:63], v[228:231]
	s_waitcnt lgkmcnt(5)
	v_mfma_f32_16x16x32_bf16 v[232:235], v[160:163], a[56:59], v[232:235]
	ds_read_b128 v[156:159], v210 offset:27648
	v_mfma_f32_16x16x32_bf16 v[236:239], v[160:163], a[60:63], v[236:239]
	v_mfma_f32_16x16x32_bf16 v[240:243], v[164:167], a[56:59], v[240:243]
	ds_read_b128 v[160:163], v210 offset:1024
	v_mfma_f32_16x16x32_bf16 v[244:247], v[164:167], a[60:63], v[244:247]
	s_waitcnt lgkmcnt(5)
	v_mfma_f32_16x16x32_bf16 v[248:251], v[168:171], a[56:59], v[248:251]
	ds_read_b128 v[164:167], v210 offset:10240
	v_mfma_f32_16x16x32_bf16 v[252:255], v[168:171], a[60:63], v[252:255]
	v_mfma_f32_16x16x32_bf16 v[212:215], v[172:175], a[56:59], v[212:215]
	ds_read_b128 v[168:171], v210 offset:19456
	v_mfma_f32_16x16x32_bf16 v[216:219], v[172:175], a[60:63], v[216:219]
	s_waitcnt vmcnt(8)
	s_waitcnt lgkmcnt(5)
	v_mfma_f32_16x16x32_bf16 v[48:51], v[144:147], a[0:3], v[48:51]
	ds_read_b128 v[172:175], v210 offset:28672
	v_mfma_f32_16x16x32_bf16 v[52:55], v[144:147], a[4:7], v[52:55]
	v_mfma_f32_16x16x32_bf16 v[48:51], v[148:151], a[8:11], v[48:51]
	ds_read_b128 v[144:147], v210 offset:2048
	v_mfma_f32_16x16x32_bf16 v[52:55], v[148:151], a[12:15], v[52:55]
	s_waitcnt lgkmcnt(5)
	v_mfma_f32_16x16x32_bf16 v[48:51], v[152:155], a[16:19], v[48:51]
	ds_read_b128 v[148:151], v210 offset:11264
	v_mfma_f32_16x16x32_bf16 v[52:55], v[152:155], a[20:23], v[52:55]
	v_mfma_f32_16x16x32_bf16 v[48:51], v[156:159], a[24:27], v[48:51]
	ds_read_b128 v[152:155], v210 offset:20480
	v_mfma_f32_16x16x32_bf16 v[52:55], v[156:159], a[28:31], v[52:55]
	s_waitcnt lgkmcnt(5)
	v_mfma_f32_16x16x32_bf16 v[56:59], v[160:163], a[0:3], v[56:59]
	ds_read_b128 v[156:159], v210 offset:29696
	v_mfma_f32_16x16x32_bf16 v[60:63], v[160:163], a[4:7], v[60:63]
	v_mfma_f32_16x16x32_bf16 v[56:59], v[164:167], a[8:11], v[56:59]
	ds_read_b128 v[160:163], v210 offset:3072
	v_mfma_f32_16x16x32_bf16 v[60:63], v[164:167], a[12:15], v[60:63]
	s_waitcnt lgkmcnt(5)
	v_mfma_f32_16x16x32_bf16 v[56:59], v[168:171], a[16:19], v[56:59]
	ds_read_b128 v[164:167], v210 offset:12288
	v_mfma_f32_16x16x32_bf16 v[60:63], v[168:171], a[20:23], v[60:63]
	v_mfma_f32_16x16x32_bf16 v[56:59], v[172:175], a[24:27], v[56:59]
	ds_read_b128 v[168:171], v210 offset:21504
	v_mfma_f32_16x16x32_bf16 v[60:63], v[172:175], a[28:31], v[60:63]
	s_waitcnt lgkmcnt(5)
	v_mfma_f32_16x16x32_bf16 v[64:67], v[144:147], a[0:3], v[64:67]
	ds_read_b128 v[172:175], v210 offset:30720
	v_cvt_pk_bf16_f32 v80, v48, v49
	v_cvt_pk_bf16_f32 v81, v50, v51
	v_mfma_f32_16x16x32_bf16 v[68:71], v[144:147], a[4:7], v[68:71]
	v_cvt_pk_bf16_f32 v82, v56, v57
	v_cvt_pk_bf16_f32 v83, v58, v59
	v_mfma_f32_16x16x32_bf16 v[64:67], v[148:151], a[8:11], v[64:67]
	ds_read_b128 v[144:147], v210 offset:4096
	v_cvt_pk_bf16_f32 v96, v52, v53
	v_cvt_pk_bf16_f32 v97, v54, v55
	v_mfma_f32_16x16x32_bf16 v[68:71], v[148:151], a[12:15], v[68:71]
	v_cvt_pk_bf16_f32 v98, v60, v61
	v_cvt_pk_bf16_f32 v99, v62, v63
	s_waitcnt lgkmcnt(5)
	v_mfma_f32_16x16x32_bf16 v[64:67], v[152:155], a[16:19], v[64:67]
	ds_read_b128 v[148:151], v210 offset:13312
	v_permlane16_swap_b32 v80, v82
	v_permlane16_swap_b32 v81, v83
	v_mfma_f32_16x16x32_bf16 v[68:71], v[152:155], a[20:23], v[68:71]
	v_permlane16_swap_b32 v96, v98
	v_permlane16_swap_b32 v97, v99
	v_mfma_f32_16x16x32_bf16 v[64:67], v[156:159], a[24:27], v[64:67]
	ds_read_b128 v[152:155], v210 offset:22528
	s_cmp_eq_u32 s3, 0
	s_cbranch_scc1 L_k3_own0
	s_add_u32 s35, s46, 0
	buffer_store_dwordx4 v[80:83], v15, s[8:11], s35 offen sc1
	s_add_u32 s35, s46, 4096
	buffer_store_dwordx4 v[96:99], v15, s[8:11], s35 offen sc1
	s_branch L_k3_next0
L_k3_own0:
	v_mov_b32 v184, v80
	v_mov_b32 v185, v81
	v_mov_b32 v186, v82
	v_mov_b32 v187, v83
	v_mov_b32 v188, v96
	v_mov_b32 v189, v97
	v_mov_b32 v190, v98
	v_mov_b32 v191, v99
L_k3_next0:
	v_mfma_f32_16x16x32_bf16 v[68:71], v[156:159], a[28:31], v[68:71]
	s_waitcnt lgkmcnt(5)
	v_mfma_f32_16x16x32_bf16 v[72:75], v[160:163], a[0:3], v[72:75]
	ds_read_b128 v[156:159], v210 offset:31744
	v_mfma_f32_16x16x32_bf16 v[76:79], v[160:163], a[4:7], v[76:79]
	v_mfma_f32_16x16x32_bf16 v[72:75], v[164:167], a[8:11], v[72:75]
	ds_read_b128 v[160:163], v210 offset:5120
	v_mfma_f32_16x16x32_bf16 v[76:79], v[164:167], a[12:15], v[76:79]
	s_waitcnt lgkmcnt(5)
	v_mfma_f32_16x16x32_bf16 v[72:75], v[168:171], a[16:19], v[72:75]
	ds_read_b128 v[164:167], v210 offset:14336
	v_mfma_f32_16x16x32_bf16 v[76:79], v[168:171], a[20:23], v[76:79]
	v_mfma_f32_16x16x32_bf16 v[72:75], v[172:175], a[24:27], v[72:75]
	ds_read_b128 v[168:171], v210 offset:23552
	v_mfma_f32_16x16x32_bf16 v[76:79], v[172:175], a[28:31], v[76:79]
	s_waitcnt lgkmcnt(5)
	v_mfma_f32_16x16x32_bf16 v[224:227], v[144:147], a[0:3], v[224:227]
	ds_read_b128 v[172:175], v210 offset:32768
	v_cvt_pk_bf16_f32 v84, v64, v65
	v_cvt_pk_bf16_f32 v85, v66, v67
	v_mfma_f32_16x16x32_bf16 v[228:231], v[144:147], a[4:7], v[228:231]
	v_cvt_pk_bf16_f32 v86, v72, v73
	v_cvt_pk_bf16_f32 v87, v74, v75
	v_mfma_f32_16x16x32_bf16 v[224:227], v[148:151], a[8:11], v[224:227]
	ds_read_b128 v[144:147], v210 offset:6144
	v_cvt_pk_bf16_f32 v100, v68, v69
	v_cvt_pk_bf16_f32 v101, v70, v71
	v_mfma_f32_16x16x32_bf16 v[228:231], v[148:151], a[12:15], v[228:231]
	v_cvt_pk_bf16_f32 v102, v76, v77
	v_cvt_pk_bf16_f32 v103, v78, v79
	s_waitcnt lgkmcnt(5)
	v_mfma_f32_16x16x32_bf16 v[224:227], v[152:155], a[16:19], v[224:227]
	ds_read_b128 v[148:151], v210 offset:15360
	v_permlane16_swap_b32 v84, v86
	v_permlane16_swap_b32 v85, v87
	v_mfma_f32_16x16x32_bf16 v[228:231], v[152:155], a[20:23], v[228:231]
	v_permlane16_swap_b32 v100, v102
	v_permlane16_swap_b32 v101, v103
	v_mfma_f32_16x16x32_bf16 v[224:227], v[156:159], a[24:27], v[224:227]
	ds_read_b128 v[152:155], v210 offset:24576
	s_cmp_eq_u32 s3, 1
	s_cbranch_scc1 L_k3_own1
	s_add_u32 s35, s46, 1024
	buffer_store_dwordx4 v[84:87], v15, s[8:11], s35 offen sc1
	s_add_u32 s35, s46, 5120
	buffer_store_dwordx4 v[100:103], v15, s[8:11], s35 offen sc1
	s_branch L_k3_next1
L_k3_own1:
	v_mov_b32 v184, v84
	v_mov_b32 v185, v85
	v_mov_b32 v186, v86
	v_mov_b32 v187, v87
	v_mov_b32 v188, v100
	v_mov_b32 v189, v101
	v_mov_b32 v190, v102
	v_mov_b32 v191, v103
L_k3_next1:
	v_mfma_f32_16x16x32_bf16 v[228:231], v[156:159], a[28:31], v[228:231]
	s_waitcnt lgkmcnt(5)
	v_mfma_f32_16x16x32_bf16 v[232:235], v[160:163], a[0:3], v[232:235]
	ds_read_b128 v[156:159], v210 offset:33792
	v_mfma_f32_16x16x32_bf16 v[236:239], v[160:163], a[4:7], v[236:239]
	v_mfma_f32_16x16x32_bf16 v[232:235], v[164:167], a[8:11], v[232:235]
	ds_read_b128 v[160:163], v210 offset:7168
	v_mfma_f32_16x16x32_bf16 v[236:239], v[164:167], a[12:15], v[236:239]
	s_waitcnt lgkmcnt(5)
	v_mfma_f32_16x16x32_bf16 v[232:235], v[168:171], a[16:19], v[232:235]
	ds_read_b128 v[164:167], v210 offset:16384
	v_mfma_f32_16x16x32_bf16 v[236:239], v[168:171], a[20:23], v[236:239]
	v_mfma_f32_16x16x32_bf16 v[232:235], v[172:175], a[24:27], v[232:235]
	ds_read_b128 v[168:171], v210 offset:25600
	v_mfma_f32_16x16x32_bf16 v[236:239], v[172:175], a[28:31], v[236:239]
	s_waitcnt lgkmcnt(5)
	v_mfma_f32_16x16x32_bf16 v[240:243], v[144:147], a[0:3], v[240:243]
	ds_read_b128 v[172:175], v210 offset:34816
	v_cvt_pk_bf16_f32 v88, v224, v225
	v_cvt_pk_bf16_f32 v89, v226, v227
	v_mfma_f32_16x16x32_bf16 v[244:247], v[144:147], a[4:7], v[244:247]
	v_cvt_pk_bf16_f32 v90, v232, v233
	v_cvt_pk_bf16_f32 v91, v234, v235
	v_mfma_f32_16x16x32_bf16 v[240:243], v[148:151], a[8:11], v[240:243]
	ds_read_b128 v[144:147], v210 offset:8192
	v_cvt_pk_bf16_f32 v104, v228, v229
	v_cvt_pk_bf16_f32 v105, v230, v231
	v_mfma_f32_16x16x32_bf16 v[244:247], v[148:151], a[12:15], v[244:247]
	v_cvt_pk_bf16_f32 v106, v236, v237
	v_cvt_pk_bf16_f32 v107, v238, v239
	s_waitcnt lgkmcnt(5)
	v_mfma_f32_16x16x32_bf16 v[240:243], v[152:155], a[16:19], v[240:243]
	ds_read_b128 v[148:151], v210 offset:17408
	v_permlane16_swap_b32 v88, v90
	v_permlane16_swap_b32 v89, v91
	v_mfma_f32_16x16x32_bf16 v[244:247], v[152:155], a[20:23], v[244:247]
	v_permlane16_swap_b32 v104, v106
	v_permlane16_swap_b32 v105, v107
	v_mfma_f32_16x16x32_bf16 v[240:243], v[156:159], a[24:27], v[240:243]
	ds_read_b128 v[152:155], v210 offset:26624
	s_cmp_eq_u32 s3, 2
	s_cbranch_scc1 L_k3_own2
	s_add_u32 s35, s46, 2048
	buffer_store_dwordx4 v[88:91], v15, s[8:11], s35 offen sc1
	s_add_u32 s35, s46, 6144
	buffer_store_dwordx4 v[104:107], v15, s[8:11], s35 offen sc1
	s_branch L_k3_next2
L_k3_own2:
	v_mov_b32 v184, v88
	v_mov_b32 v185, v89
	v_mov_b32 v186, v90
	v_mov_b32 v187, v91
	v_mov_b32 v188, v104
	v_mov_b32 v189, v105
	v_mov_b32 v190, v106
	v_mov_b32 v191, v107
L_k3_next2:
	v_mfma_f32_16x16x32_bf16 v[244:247], v[156:159], a[28:31], v[244:247]
	s_waitcnt lgkmcnt(5)
	v_mfma_f32_16x16x32_bf16 v[248:251], v[160:163], a[0:3], v[248:251]
	ds_read_b128 v[156:159], v210 offset:35840
	v_mfma_f32_16x16x32_bf16 v[252:255], v[160:163], a[4:7], v[252:255]
	v_mfma_f32_16x16x32_bf16 v[248:251], v[164:167], a[8:11], v[248:251]
	v_mfma_f32_16x16x32_bf16 v[252:255], v[164:167], a[12:15], v[252:255]
	s_waitcnt lgkmcnt(4)
	v_mfma_f32_16x16x32_bf16 v[248:251], v[168:171], a[16:19], v[248:251]
	v_mfma_f32_16x16x32_bf16 v[252:255], v[168:171], a[20:23], v[252:255]
	v_mfma_f32_16x16x32_bf16 v[248:251], v[172:175], a[24:27], v[248:251]
	v_mfma_f32_16x16x32_bf16 v[252:255], v[172:175], a[28:31], v[252:255]
	s_waitcnt lgkmcnt(2)
	v_mfma_f32_16x16x32_bf16 v[212:215], v[144:147], a[0:3], v[212:215]
	v_cvt_pk_bf16_f32 v92, v240, v241
	v_cvt_pk_bf16_f32 v93, v242, v243
	v_mfma_f32_16x16x32_bf16 v[216:219], v[144:147], a[4:7], v[216:219]
	s_nop 1
	v_cvt_pk_bf16_f32 v94, v248, v249
	v_cvt_pk_bf16_f32 v95, v250, v251
	v_mfma_f32_16x16x32_bf16 v[212:215], v[148:151], a[8:11], v[212:215]
	v_cvt_pk_bf16_f32 v108, v244, v245
	v_cvt_pk_bf16_f32 v109, v246, v247
	v_mfma_f32_16x16x32_bf16 v[216:219], v[148:151], a[12:15], v[216:219]
	v_cvt_pk_bf16_f32 v110, v252, v253
	v_cvt_pk_bf16_f32 v111, v254, v255
	s_waitcnt lgkmcnt(0)
	v_mfma_f32_16x16x32_bf16 v[212:215], v[152:155], a[16:19], v[212:215]
	v_permlane16_swap_b32 v92, v94
	v_permlane16_swap_b32 v93, v95
	v_mfma_f32_16x16x32_bf16 v[216:219], v[152:155], a[20:23], v[216:219]
	v_permlane16_swap_b32 v108, v110
	v_permlane16_swap_b32 v109, v111
	v_mfma_f32_16x16x32_bf16 v[212:215], v[156:159], a[24:27], v[212:215]
	s_cmp_eq_u32 s3, 3
	s_cbranch_scc1 L_k3_own3
	s_add_u32 s35, s46, 3072
	buffer_store_dwordx4 v[92:95], v15, s[8:11], s35 offen sc1
	s_add_u32 s35, s46, 7168
	buffer_store_dwordx4 v[108:111], v15, s[8:11], s35 offen sc1
	s_branch L_k3_next3
L_k3_own3:
	v_mov_b32 v184, v92
	v_mov_b32 v185, v93
	v_mov_b32 v186, v94
	v_mov_b32 v187, v95
	v_mov_b32 v188, v108
	v_mov_b32 v189, v109
	v_mov_b32 v190, v110
	v_mov_b32 v191, v111
L_k3_next3:
	v_mfma_f32_16x16x32_bf16 v[216:219], v[156:159], a[28:31], v[216:219]
	v_cvt_pk_bf16_f32 v112, v212, v213
	v_cvt_pk_bf16_f32 v113, v214, v215
	s_nop 5
	v_cvt_pk_bf16_f32 v114, v216, v217
	v_cvt_pk_bf16_f32 v115, v218, v219
	s_cmp_eq_u32 s3, 0
	s_cbranch_scc1 L_k3_sown0
	s_add_u32 s35, s46, 8192
	buffer_store_dwordx2 v[112:113], v10, s[8:11], s35 offen sc1
	s_branch L_k3_snext0
L_k3_sown0:
	v_mov_b32 v192, v112
	v_mov_b32 v193, v113
L_k3_snext0:
	s_cmp_eq_u32 s3, 1
	s_cbranch_scc1 L_k3_sown1
	s_add_u32 s35, s46, 8704
	buffer_store_dwordx2 v[114:115], v10, s[8:11], s35 offen sc1
	s_branch L_k3_snext1
L_k3_sown1:
	v_mov_b32 v192, v114
	v_mov_b32 v193, v115
L_k3_snext1:
	s_waitcnt vmcnt(0)
	s_barrier
	s_lshl_b32 s35, s3, 2
	s_add_u32 s35, s35, s48
	v_mov_b32 v222, 1
	v_mov_b32 v223, 0
	s_mov_b64 exec, 1
	buffer_store_dword v222, v223, s[8:11], s35 offen sc1
	s_mov_b64 exec, -1
	s_add_u32 s38, s3, 1
	s_and_b32 s38, s38, 3
	s_mul_i32 s38, s38, 36864
	s_add_u32 s38, s38, s47
	s_add_u32 s39, s3, 2
	s_and_b32 s39, s39, 3
	s_mul_i32 s39, s39, 36864
	s_add_u32 s39, s39, s47
	s_add_u32 s40, s3, 3
	s_and_b32 s40, s40, 3
	s_mul_i32 s40, s40, 36864
	s_add_u32 s40, s40, s47
	s_lshl_b32 s41, s3, 10
	s_and_b32 s42, s3, 1
	s_lshl_b32 s42, s42, 9
	s_add_u32 s42, s42, 8192
	s_mov_b32 s36, 0x40000
L_k3_rpoll:
	buffer_load_dword v220, v221, s[8:11], s48 offen sc1
	s_sub_u32 s36, s36, 1
	s_waitcnt vmcnt(0)
	v_cmp_ne_u32 vcc, 1, v220
	s_cmp_eq_u32 s36, 0
	s_cbranch_scc1 L_k3_rgot
	s_nop 2
	s_cbranch_vccnz L_k3_rpoll
L_k3_rgot:
	s_add_u32 s35, s38, s41
	buffer_load_dwordx4 v[144:147], v15, s[8:11], s35 offen offset:0 sc1
	s_add_u32 s35, s38, s41
	s_add_u32 s35, s35, 4096
	buffer_load_dwordx4 v[148:151], v15, s[8:11], s35 offen sc1
	s_add_u32 s35, s39, s41
	buffer_load_dwordx4 v[152:155], v15, s[8:11], s35 offen offset:0 sc1
	s_add_u32 s35, s39, s41
	s_add_u32 s35, s35, 4096
	buffer_load_dwordx4 v[156:159], v15, s[8:11], s35 offen sc1
	s_add_u32 s35, s40, s41
	buffer_load_dwordx4 v[160:163], v15, s[8:11], s35 offen offset:0 sc1
	s_add_u32 s35, s40, s41
	s_add_u32 s35, s35, 4096
	buffer_load_dwordx4 v[164:167], v15, s[8:11], s35 offen sc1
	s_add_u32 s35, s38, s42
	buffer_load_dwordx2 v[168:169], v10, s[8:11], s35 offen sc1
	s_add_u32 s35, s39, s42
	buffer_load_dwordx2 v[170:171], v10, s[8:11], s35 offen sc1
	s_add_u32 s35, s40, s42
	buffer_load_dwordx2 v[172:173], v10, s[8:11], s35 offen sc1
	s_waitcnt vmcnt(0)
	v_lshlrev_b32 v16, 16, v184
	v_and_b32 v17, s59, v184
	v_lshlrev_b32 v18, 16, v185
	v_and_b32 v19, s59, v185
	v_lshlrev_b32 v20, 16, v186
	v_and_b32 v21, s59, v186
	v_lshlrev_b32 v22, 16, v187
	v_and_b32 v23, s59, v187
	v_lshlrev_b32 v24, 16, v144
	v_and_b32 v25, s59, v144
	v_lshlrev_b32 v26, 16, v145
	v_and_b32 v27, s59, v145
	v_lshlrev_b32 v28, 16, v146
	v_and_b32 v29, s59, v146
	v_lshlrev_b32 v30, 16, v147
	v_and_b32 v31, s59, v147
	v_pk_add_f32 v[16:17], v[16:17], v[24:25]
	v_pk_add_f32 v[18:19], v[18:19], v[26:27]
	v_pk_add_f32 v[20:21], v[20:21], v[28:29]
	v_pk_add_f32 v[22:23], v[22:23], v[30:31]
	v_lshlrev_b32 v24, 16, v152
	v_and_b32 v25, s59, v152
	v_lshlrev_b32 v26, 16, v153
	v_and_b32 v27, s59, v153
	v_lshlrev_b32 v28, 16, v154
	v_and_b32 v29, s59, v154
	v_lshlrev_b32 v30, 16, v155
	v_and_b32 v31, s59, v155
	v_pk_add_f32 v[16:17], v[16:17], v[24:25]
	v_pk_add_f32 v[18:19], v[18:19], v[26:27]
	v_pk_add_f32 v[20:21], v[20:21], v[28:29]
	v_pk_add_f32 v[22:23], v[22:23], v[30:31]
	v_lshlrev_b32 v24, 16, v160
	v_and_b32 v25, s59, v160
	v_lshlrev_b32 v26, 16, v161
	v_and_b32 v27, s59, v161
	v_lshlrev_b32 v28, 16, v162
	v_and_b32 v29, s59, v162
	v_lshlrev_b32 v30, 16, v163
	v_and_b32 v31, s59, v163
	v_pk_add_f32 v[16:17], v[16:17], v[24:25]
	v_pk_add_f32 v[18:19], v[18:19], v[26:27]
	v_pk_add_f32 v[20:21], v[20:21], v[28:29]
	v_pk_add_f32 v[22:23], v[22:23], v[30:31]
	v_lshlrev_b32 v24, 16, v116
	v_and_b32 v25, s59, v116
	v_lshlrev_b32 v26, 16, v117
	v_and_b32 v27, s59, v117
	v_lshlrev_b32 v28, 16, v118
	v_and_b32 v29, s59, v118
	v_lshlrev_b32 v30, 16, v119
	v_and_b32 v31, s59, v119
	v_pk_fma_f32 v[16:17], v[16:17], v[128:129], v[24:25]
	v_pk_fma_f32 v[18:19], v[18:19], v[130:131], v[26:27]
	v_pk_fma_f32 v[20:21], v[20:21], v[132:133], v[28:29]
	v_pk_fma_f32 v[22:23], v[22:23], v[134:135], v[30:31]
	v_cvt_pk_bf16_f32 v200, v16, v17
	v_cvt_pk_bf16_f32 v201, v18, v19
	v_cvt_pk_bf16_f32 v202, v20, v21
	v_cvt_pk_bf16_f32 v203, v22, v23
	s_add_u32 s35, s51, 0
	buffer_store_dwordx4 v[200:203], v6, s[16:19], s35 offen sc1
	v_lshlrev_b32 v16, 16, v188
	v_and_b32 v17, s59, v188
	v_lshlrev_b32 v18, 16, v189
	v_and_b32 v19, s59, v189
	v_lshlrev_b32 v20, 16, v190
	v_and_b32 v21, s59, v190
	v_lshlrev_b32 v22, 16, v191
	v_and_b32 v23, s59, v191
	v_lshlrev_b32 v24, 16, v148
	v_and_b32 v25, s59, v148
	v_lshlrev_b32 v26, 16, v149
	v_and_b32 v27, s59, v149
	v_lshlrev_b32 v28, 16, v150
	v_and_b32 v29, s59, v150
	v_lshlrev_b32 v30, 16, v151
	v_and_b32 v31, s59, v151
	v_pk_add_f32 v[16:17], v[16:17], v[24:25]
	v_pk_add_f32 v[18:19], v[18:19], v[26:27]
	v_pk_add_f32 v[20:21], v[20:21], v[28:29]
	v_pk_add_f32 v[22:23], v[22:23], v[30:31]
	v_lshlrev_b32 v24, 16, v156
	v_and_b32 v25, s59, v156
	v_lshlrev_b32 v26, 16, v157
	v_and_b32 v27, s59, v157
	v_lshlrev_b32 v28, 16, v158
	v_and_b32 v29, s59, v158
	v_lshlrev_b32 v30, 16, v159
	v_and_b32 v31, s59, v159
	v_pk_add_f32 v[16:17], v[16:17], v[24:25]
	v_pk_add_f32 v[18:19], v[18:19], v[26:27]
	v_pk_add_f32 v[20:21], v[20:21], v[28:29]
	v_pk_add_f32 v[22:23], v[22:23], v[30:31]
	v_lshlrev_b32 v24, 16, v164
	v_and_b32 v25, s59, v164
	v_lshlrev_b32 v26, 16, v165
	v_and_b32 v27, s59, v165
	v_lshlrev_b32 v28, 16, v166
	v_and_b32 v29, s59, v166
	v_lshlrev_b32 v30, 16, v167
	v_and_b32 v31, s59, v167
	v_pk_add_f32 v[16:17], v[16:17], v[24:25]
	v_pk_add_f32 v[18:19], v[18:19], v[26:27]
	v_pk_add_f32 v[20:21], v[20:21], v[28:29]
	v_pk_add_f32 v[22:23], v[22:23], v[30:31]
	v_lshlrev_b32 v24, 16, v120
	v_and_b32 v25, s59, v120
	v_lshlrev_b32 v26, 16, v121
	v_and_b32 v27, s59, v121
	v_lshlrev_b32 v28, 16, v122
	v_and_b32 v29, s59, v122
	v_lshlrev_b32 v30, 16, v123
	v_and_b32 v31, s59, v123
	v_pk_fma_f32 v[16:17], v[16:17], v[128:129], v[24:25]
	v_pk_fma_f32 v[18:19], v[18:19], v[130:131], v[26:27]
	v_pk_fma_f32 v[20:21], v[20:21], v[132:133], v[28:29]
	v_pk_fma_f32 v[22:23], v[22:23], v[134:135], v[30:31]
	v_cvt_pk_bf16_f32 v204, v16, v17
	v_cvt_pk_bf16_f32 v205, v18, v19
	v_cvt_pk_bf16_f32 v206, v20, v21
	v_cvt_pk_bf16_f32 v207, v22, v23
	s_add_u32 s35, s51, 1152
	buffer_store_dwordx4 v[204:207], v6, s[16:19], s35 offen sc1
	s_cmp_ge_u32 s3, 2
	s_cbranch_scc1 L_k3_nosingle
	v_lshlrev_b32 v16, 16, v192
	v_and_b32 v17, s59, v192
	v_lshlrev_b32 v18, 16, v193
	v_and_b32 v19, s59, v193
	v_lshlrev_b32 v24, 16, v168
	v_and_b32 v25, s59, v168
	v_lshlrev_b32 v26, 16, v169
	v_and_b32 v27, s59, v169
	v_pk_add_f32 v[16:17], v[16:17], v[24:25]
	v_pk_add_f32 v[18:19], v[18:19], v[26:27]
	v_lshlrev_b32 v24, 16, v170
	v_and_b32 v25, s59, v170
	v_lshlrev_b32 v26, 16, v171
	v_and_b32 v27, s59, v171
	v_pk_add_f32 v[16:17], v[16:17], v[24:25]
	v_pk_add_f32 v[18:19], v[18:19], v[26:27]
	v_lshlrev_b32 v24, 16, v172
	v_and_b32 v25, s59, v172
	v_lshlrev_b32 v26, 16, v173
	v_and_b32 v27, s59, v173
	v_pk_add_f32 v[16:17], v[16:17], v[24:25]
	v_pk_add_f32 v[18:19], v[18:19], v[26:27]
	v_lshlrev_b32 v24, 16, v124
	v_and_b32 v25, s59, v124
	v_lshlrev_b32 v26, 16, v125
	v_and_b32 v27, s59, v125
	v_pk_fma_f32 v[16:17], v[16:17], v[136:137], v[24:25]
	v_pk_fma_f32 v[18:19], v[18:19], v[138:139], v[26:27]
	v_cvt_pk_bf16_f32 v208, v16, v17
	v_cvt_pk_bf16_f32 v209, v18, v19
	buffer_store_dwordx2 v[208:209], v7, s[16:19], s56 offen sc1
L_k3_nosingle:
	s_endpgm
L_k3_spin1:
	s_mov_b32 s35, 0x40000
L_k3_spin1_l:
	buffer_load_dword v220, v221, s[8:11], s29 offen sc1
	s_sub_u32 s35, s35, 1
	s_waitcnt vmcnt(0)
	v_cmp_gt_u32 vcc, 2, v220
	s_cmp_eq_u32 s35, 0
	s_cbranch_scc1 L_k3_back1
	s_nop 2
	s_cbranch_vccnz L_k3_spin1_l
	s_branch L_k3_back1
L_k3_spin2:
	s_mov_b32 s35, 0x40000
L_k3_spin2_l:
	buffer_load_dword v220, v221, s[8:11], s29 offen sc1
	s_sub_u32 s35, s35, 1
	s_waitcnt vmcnt(0)
	v_cmp_gt_u32 vcc, 3, v220
	s_cmp_eq_u32 s35, 0
	s_cbranch_scc1 L_k3_back2
	s_nop 2
	s_cbranch_vccnz L_k3_spin2_l
	s_branch L_k3_back2
L_k3_spin3:
	s_mov_b32 s35, 0x40000
L_k3_spin3_l:
	buffer_load_dword v220, v221, s[8:11], s29 offen sc1
	s_sub_u32 s35, s35, 1
	s_waitcnt vmcnt(0)
	v_cmp_gt_u32 vcc, 4, v220
	s_cmp_eq_u32 s35, 0
	s_cbranch_scc1 L_k3_back3
	s_nop 2
	s_cbranch_vccnz L_k3_spin3_l
	s_branch L_k3_back3
L_k3_spin4:
	s_mov_b32 s35, 0x40000
L_k3_spin4_l:
	buffer_load_dword v220, v221, s[8:11], s29 offen sc1
	s_sub_u32 s35, s35, 1
	s_waitcnt vmcnt(0)
	v_cmp_gt_u32 vcc, 5, v220
	s_cmp_eq_u32 s35, 0
	s_cbranch_scc1 L_k3_back4
	s_nop 2
	s_cbranch_vccnz L_k3_spin4_l
	s_branch L_k3_back4
L_k3_exit:
	s_endpgm
L_text_pf_end:
.section .rodata,"a"
.p2align 6
.amdhsa_kernel k1_front_kernel
  .amdhsa_next_free_vgpr 256
  .amdhsa_next_free_sgpr 102
  .amdhsa_accum_offset 256
  .amdhsa_group_segment_fixed_size 0
  .amdhsa_kernarg_size 144
  .amdhsa_user_sgpr_count 2
  .amdhsa_user_sgpr_kernarg_segment_ptr 1
  .amdhsa_system_sgpr_workgroup_id_x 1
  .amdhsa_float_denorm_mode_32 3
.end_amdhsa_kernel
.p2align 6
.amdhsa_kernel k3_ffn_kernel
  .amdhsa_next_free_vgpr 400
  .amdhsa_next_free_sgpr 102
  .amdhsa_accum_offset 256
  .amdhsa_group_segment_fixed_size 0
  .amdhsa_kernarg_size 144
  .amdhsa_user_sgpr_count 2
  .amdhsa_user_sgpr_kernarg_segment_ptr 1
  .amdhsa_system_sgpr_workgroup_id_x 1
  .amdhsa_float_denorm_mode_32 3
.end_amdhsa_kernel
```
